```python
import torch

def _softmax(x, axis=-1):
    return torch.softmax(x, dim=axis)
def _gelu(x):
    return torch.nn.functional.gelu(x, approximate="tanh")
def _silu(x):
    return torch.nn.functional.silu(x)
def _sigmoid(x):
    return torch.sigmoid(x)
def _layernorm(x, axis=-1, eps=1e-5):
    m = x.mean(dim=axis, keepdim=True)
    v = x.var(dim=axis, keepdim=True, unbiased=False)
    return (x - m) / torch.sqrt(v + eps)
def _scatter_add(tgt, idx, src, axis=0):
    return tgt.clone().index_add_(axis, idx, src)
def _segment_sum(src, seg, n):
    out = torch.zeros((n,) + src.shape[1:], dtype=src.dtype)
    return out.index_add_(0, seg, src)
def _pad(x, pw):
    flat = tuple(v for pair in reversed(pw) for v in pair)
    return torch.nn.functional.pad(x, flat)

kernel_name = 'standalone__mha_block_cached__near_ridge'

def setup_inputs():

    _w = (lambda a: (lambda t: t.to(torch.bfloat16) if t.is_floating_point() else t)(torch.as_tensor(a)))
    B, Sq, D = 8, 240, 640
    H, Sk, Dh = 32, 2048, 128
    return {
        "x": _w((lambda *s: torch.randn(*s, dtype=torch.bfloat16) * 0.8)(B, Sq, D)),
        "k_cache": _w((lambda *s: torch.randn(*s, dtype=torch.bfloat16) * 0.8)(B, H, Sk, Dh)),
        "v_cache": _w((lambda *s: torch.randn(*s, dtype=torch.bfloat16) * 0.05)(B, H, Sk, Dh)),
        "wq": _w((lambda *s: torch.randn(*s, dtype=torch.bfloat16) * 0.8)(D, H * Dh) * (D ** -0.5)),
        "wo": _w((lambda *s: torch.randn(*s, dtype=torch.bfloat16) * 0.05)(H * Dh, D) * ((H * Dh) ** -0.5)),
    }

def reference(x, k_cache, v_cache, wq, wo):
    B, Sq, D = x.shape
    H, Dh = 32, 128
    q = (lambda x, *d: x.permute(*d))((x @ wq).reshape(B, Sq, H, Dh), 0, 2, 1, 3)
    scores = torch.einsum("bhqd,bhkd->bhqk", q, k_cache) * (Dh ** -0.5)
    p = _softmax(scores, axis=-1)
    o = torch.einsum("bhqk,bhkd->bhqd", p, v_cache)
    return (lambda x, *d: x.permute(*d))(o, 0, 2, 1, 3).reshape(B, Sq, H * Dh) @ wo
```

```asm
; @launch grid=(256,1,1) block=(256,1,1) lds=163840
.amdgcn_target "amdgcn-amd-amdhsa--gfx950"
.text
.globl standalone__mha_block_cached__near_ridge_kernel
.p2align 8
.type standalone__mha_block_cached__near_ridge_kernel,@function
standalone__mha_block_cached__near_ridge_kernel:
    s_cmp_ge_u32 s2, 256
    s_cbranch_scc1 L_exit
    s_getpc_b64 s[8:9]
    s_load_dwordx16 s[84:99], s[0:1], 0
    s_getreg_b32 s6, hwreg(HW_REG_XCC_ID, 0, 3)
    s_getreg_b32 s7, hwreg(HW_REG_HW_ID, 13, 2)
    s_getreg_b32 s4, hwreg(HW_REG_HW_ID, 8, 4)
    s_mul_i32 s7, s7, 9
    s_add_u32 s7, s7, s4
    s_mov_b32 s10, L_exit-standalone__mha_block_cached__near_ridge_kernel-16
    s_mov_b32 s11, 0x20000
    s_mul_i32 s4, s7, 2304
    v_lshrrev_b32 v11, 2, v0
    v_lshlrev_b32 v11, 7, v11
    v_lshrrev_b32 v1, 6, v0
    v_and_b32 v3, 63, v0
    v_lshrrev_b32 v4, 4, v3
    v_readfirstlane_b32 s28, v1
    v_and_b32 v5, 15, v3
    v_lshlrev_b32 v2, 4, v3
    v_lshrrev_b32 v6, 3, v3
    v_and_b32 v7, 7, v3
    buffer_load_dword v12, v11, s[8:11], s4 offen
    v_lshl_add_u32 v8, v1, 6, v6
    v_mul_u32_u24 v8, 1280, v8
    v_xor_b32 v9, v7, v4
    v_xor_b32 v10, 0, v9
    v_lshl_add_u32 v10, v10, 4, v8
    v_add_u32 v36, 0, v10
    v_xor_b32 v10, 4, v9
    v_lshl_add_u32 v10, v10, 4, v8
    v_add_u32 v37, 9216, v10
    v_xor_b32 v10, 0, v9
    v_lshl_add_u32 v10, v10, 4, v8
    v_add_u32 v38, 18432, v10
    v_xor_b32 v10, 4, v9
    v_lshl_add_u32 v10, v10, 4, v8
    v_add_u32 v39, 27648, v10
    v_xor_b32 v10, 0, v9
    v_lshl_add_u32 v10, v10, 4, v8
    v_add_u32 v40, 40960, v10
    v_xor_b32 v10, 4, v9
    v_lshl_add_u32 v10, v10, 4, v8
    v_add_u32 v41, 50176, v10
    v_xor_b32 v10, 0, v9
    v_lshl_add_u32 v10, v10, 4, v8
    v_add_u32 v42, 59392, v10
    v_xor_b32 v10, 4, v9
    v_lshl_add_u32 v10, v10, 4, v8
    v_add_u32 v43, 68608, v10
    v_lshl_add_u32 v8, v1, 4, v4
    v_lshlrev_b32 v8, 13, v8
    v_lshlrev_b32 v9, 2, v4
    v_xor_b32 v9, v9, v5
    v_lshl_add_u32 v8, v9, 4, v8
    v_add_u32 v44, 0, v8
    v_add_u32 v45, 31744, v8
    v_add_u32 v46, 63480, v8
    v_add_u32 v47, 95224, v8
    s_lshl_b32 s31, s28, 13
    s_lshl_b32 s30, s28, 12
    s_add_u32 s29, s30, 98304
    s_mul_i32 s32, s28, 4112
    s_waitcnt lgkmcnt(0)
    s_and_b32 s38, s2, 1
    s_lshl_b32 s36, s38, 2
    s_bfe_u32 s38, s2, 0x20003
    s_add_u32 s36, s36, s38
    s_and_b32 s37, s2, 6
    s_lshl_b32 s37, s37, 2
    s_lshr_b32 s39, s2, 5
    s_add_u32 s37, s37, s39
    s_add_u32 s81, s37, s36
    s_and_b32 s81, s81, 3
    s_mul_i32 s38, s36, 307200
    s_lshl_b32 s39, s37, 8
    s_mov_b32 s18, 307200
    s_mov_b32 s19, 0x20000
    s_mov_b32 s23, 0x20000
    s_sub_u32 s22, 5242880, s39
    s_add_u32 s16, s84, s38
    s_addc_u32 s17, s85, 0
    s_add_u32 s20, s90, s39
    s_addc_u32 s21, s91, 0
    s_lshl_b32 s38, s81, 7
    s_lshl_b32 s39, s81, 19
    s_add_u32 s81, s81, 1
    s_cmp_eq_u32 s81, 10
    s_cselect_b32 s81, 0, s81
    s_add_u32 m0, s32, 80896
    s_nop 0
    buffer_load_dwordx4 v44, s[20:23], s39 offen offset:0 lds
    buffer_load_dwordx4 v45, s[20:23], s39 offen offset:1024 lds
    buffer_load_dwordx4 v46, s[20:23], s39 offen offset:2056 lds
    buffer_load_dwordx4 v47, s[20:23], s39 offen offset:3080 lds
    s_add_u32 m0, s31, 49152
    s_nop 0
    buffer_load_dwordx4 v36, s[16:19], s38 offen offset:0 lds
    buffer_load_dwordx4 v37, s[16:19], s38 offen offset:1024 lds
    buffer_load_dwordx4 v38, s[16:19], s38 offen offset:2048 lds
    buffer_load_dwordx4 v39, s[16:19], s38 offen offset:3072 lds
    s_add_u32 m0, s31, 53248
    s_nop 0
    buffer_load_dwordx4 v40, s[16:19], s38 offen offset:0 lds
    buffer_load_dwordx4 v41, s[16:19], s38 offen offset:1024 lds
    s_cmp_eq_u32 s28, 3
    s_cbranch_scc1 L_x6
    buffer_load_dwordx4 v42, s[16:19], s38 offen offset:2048 lds
    buffer_load_dwordx4 v43, s[16:19], s38 offen offset:3072 lds
L_x6:
    v_lshlrev_b32 v8, 12, v1
    v_lshl_add_u32 v8, v4, 8, v8
    v_xor_b32 v9, v5, v4
    v_xor_b32 v10, 0, v9
    v_lshl_add_u32 v28, v10, 4, v8
    v_xor_b32 v10, 4, v9
    v_lshl_add_u32 v29, v10, 4, v8
    v_xor_b32 v10, 8, v9
    v_lshl_add_u32 v30, v10, 4, v8
    v_xor_b32 v10, 12, v9
    v_lshl_add_u32 v31, v10, 4, v8
    v_lshlrev_b32 v9, 1, v4
    v_xor_b32 v9, v9, v5
    v_xor_b32 v10, 0, v9
    v_lshl_add_u32 v32, v10, 4, v8
    v_mov_b32 v34, v32
    v_xor_b32 v10, 8, v9
    v_lshl_add_u32 v33, v10, 4, v8
    v_mov_b32 v35, v33
    v_lshrrev_b32 v8, 2, v3
    v_and_b32 v9, 7, v8
    v_lshlrev_b32 v8, 8, v8
    v_and_b32 v10, 3, v3
    v_lshl_add_u32 v8, v10, 3, v8
    v_xor_b32 v10, 0, v9
    v_lshl_add_u32 v20, v10, 5, v8
    v_xor_b32 v10, 1, v9
    v_lshl_add_u32 v21, v10, 5, v8
    v_xor_b32 v10, 2, v9
    v_lshl_add_u32 v22, v10, 5, v8
    v_xor_b32 v10, 3, v9
    v_lshl_add_u32 v23, v10, 5, v8
    v_xor_b32 v10, 4, v9
    v_lshl_add_u32 v24, v10, 5, v8
    v_xor_b32 v10, 5, v9
    v_lshl_add_u32 v25, v10, 5, v8
    v_xor_b32 v10, 6, v9
    v_lshl_add_u32 v26, v10, 5, v8
    v_xor_b32 v10, 7, v9
    v_lshl_add_u32 v27, v10, 5, v8
    v_lshlrev_b32 v8, 13, v1
    v_lshl_add_u32 v8, v5, 7, v8
    v_add_u32 v8, 49152, v8
    v_lshrrev_b32 v9, 1, v5
    v_xor_b32 v9, v9, v4
    v_xor_b32 v10, 0, v9
    v_lshl_add_u32 v64, v10, 4, v8
    v_xor_b32 v10, 4, v9
    v_lshl_add_u32 v65, v10, 4, v8
    v_bfe_u32 v9, v3, 2, 2
    v_lshl_add_u32 v8, v4, 3, v9
    v_lshlrev_b32 v8, 8, v8
    v_and_b32 v10, 3, v3
    v_lshl_add_u32 v8, v10, 4, v8
    v_add_u32 v8, 49152, v8
    v_lshl_add_u32 v8, v4, 3, v8
    v_xor_b32 v10, 0, v9
    v_lshl_add_u32 v66, v10, 6, v8
    v_xor_b32 v10, 1, v9
    v_lshl_add_u32 v67, v10, 6, v8
    v_xor_b32 v10, 2, v9
    v_lshl_add_u32 v68, v10, 6, v8
    v_xor_b32 v10, 3, v9
    v_lshl_add_u32 v69, v10, 6, v8
    v_and_b32 v8, 15, v3
    v_cmp_eq_u32 vcc, 0, v8
    v_mov_b32 v9, 0x3f803f80
    v_mov_b32 v10, 0
    v_cndmask_b32 v9, v10, v9, vcc
    v_accvgpr_write_b32 a144, v9
    v_accvgpr_write_b32 a145, v9
    v_accvgpr_write_b32 a146, v9
    v_accvgpr_write_b32 a147, v9
    v_lshlrev_b32 v8, 8, v5
    v_add_u32 v8, 98304, v8
    v_xor_b32 v9, v4, v5
    v_xor_b32 v10, 0, v9
    v_lshl_add_u32 v16, v10, 4, v8
    v_xor_b32 v10, 4, v9
    v_lshl_add_u32 v17, v10, 4, v8
    v_xor_b32 v10, 8, v9
    v_lshl_add_u32 v18, v10, 4, v8
    v_xor_b32 v10, 12, v9
    v_lshl_add_u32 v19, v10, 4, v8
    s_lshl_b32 s38, s36, 5
    s_add_u32 s38, s38, s37
    s_lshl_b32 s38, s38, 19
    s_add_u32 s8, s86, s38
    s_addc_u32 s9, s87, 0
    s_mov_b32 s10, 524288
    s_mov_b32 s11, 0x20000
    s_add_u32 s12, s88, s38
    s_addc_u32 s13, s89, 0
    s_mov_b32 s14, 524288
    s_mov_b32 s15, 0x20000
    s_mov_b32 s24, s98
    s_mov_b32 s25, s99
    s_mov_b32 s26, 15728640
    s_mov_b32 s27, 0x20000
    s_mul_i32 s3, s36, 96
    s_add_u32 s3, s3, s37
    s_mul_i32 s3, s3, 20480
    s_lshr_b32 s80, s2, 3
    s_lshl_b32 s80, s80, 14
    s_lshr_b32 s4, s2, 3
    s_mul_i32 s6, s4, 52
    s_lshr_b32 s6, s6, 8
    s_mul_i32 s5, s6, 5
    s_sub_u32 s5, s4, s5
    s_mov_b32 s82, 0
    s_and_b32 s7, s2, 1
    s_mul_i32 s7, s7, 5
    s_add_u32 s5, s5, s7
    s_and_b32 s83, s2, 6
    s_mul_i32 s83, s83, 3
    s_add_u32 s83, s83, s6
    s_mul_i32 s6, s28, 1310720
    s_lshl_b32 s7, s5, 7
    s_add_u32 s6, s6, s7
    s_add_u32 s76, s92, s6
    s_addc_u32 s77, s93, 0
    s_sub_u32 s78, 5242880, s6
    s_cmp_ge_u32 s2, 240
    s_cselect_b32 s78, 0, s78
    s_mov_b32 s79, 0x20000
    s_lshl_b32 s38, s81, 7
    s_lshl_b32 s39, s81, 19
    s_add_u32 s81, s81, 1
    s_cmp_eq_u32 s81, 10
    s_cselect_b32 s81, 0, s81
    s_add_u32 m0, s32, 130048
    s_nop 0
    buffer_load_dwordx4 v44, s[20:23], s39 offen offset:0 lds
    buffer_load_dwordx4 v45, s[20:23], s39 offen offset:1024 lds
    buffer_load_dwordx4 v46, s[20:23], s39 offen offset:2056 lds
    buffer_load_dwordx4 v47, s[20:23], s39 offen offset:3080 lds
    s_cmp_eq_u32 s28, 3
    s_cbranch_scc1 L_waveB
    s_waitcnt vmcnt(4)
    s_barrier
    ds_read_b128 a[148:151], v64 offset:0
    ds_read_b128 a[152:155], v64 offset:2048
    ds_read_b128 a[156:159], v64 offset:4096
    ds_read_b128 a[160:163], v64 offset:6144
    ds_read_b64_tr_b16 a[64:65], v66 offset:31744
    ds_read_b64_tr_b16 a[66:67], v66 offset:32768
    ds_read_b64_tr_b16 a[68:69], v66 offset:31752
    ds_read_b64_tr_b16 a[70:71], v66 offset:32776
    ds_read_b64_tr_b16 a[72:73], v67 offset:31744
    ds_read_b64_tr_b16 a[74:75], v67 offset:32768
    ds_read_b64_tr_b16 a[76:77], v67 offset:31752
    ds_read_b64_tr_b16 a[78:79], v67 offset:32776
    ds_read_b64_tr_b16 a[80:81], v68 offset:31744
    ds_read_b64_tr_b16 a[82:83], v68 offset:32768
    ds_read_b64_tr_b16 a[84:85], v68 offset:31752
    ds_read_b64_tr_b16 a[86:87], v68 offset:32776
    ds_read_b64_tr_b16 a[88:89], v69 offset:31744
    ds_read_b64_tr_b16 a[90:91], v69 offset:32768
    ds_read_b64_tr_b16 a[92:93], v69 offset:31752
    ds_read_b64_tr_b16 a[94:95], v69 offset:32776
    s_add_u32 m0, s31, 98304
    s_nop 0
    buffer_load_dwordx4 v36, s[16:19], s38 offen offset:0 lds
    buffer_load_dwordx4 v37, s[16:19], s38 offen offset:1024 lds
    buffer_load_dwordx4 v38, s[16:19], s38 offen offset:2048 lds
    buffer_load_dwordx4 v39, s[16:19], s38 offen offset:3072 lds
    s_add_u32 m0, s31, 102400
    s_nop 0
    buffer_load_dwordx4 v40, s[16:19], s38 offen offset:0 lds
    buffer_load_dwordx4 v41, s[16:19], s38 offen offset:1024 lds
    buffer_load_dwordx4 v42, s[16:19], s38 offen offset:2048 lds
    buffer_load_dwordx4 v43, s[16:19], s38 offen offset:3072 lds
    s_waitcnt lgkmcnt(0)
    v_mfma_f32_16x16x32_bf16 v[128:131], a[64:67], a[148:151], 0
    s_lshl_b32 s38, s81, 7
    s_lshl_b32 s39, s81, 19
    ds_read_b128 a[164:167], v65 offset:0
    v_mfma_f32_16x16x32_bf16 v[160:163], a[64:67], a[152:155], 0
    s_add_u32 s81, s81, 1
    s_cmp_eq_u32 s81, 10
    ds_read_b128 a[168:171], v65 offset:2048
    v_mfma_f32_16x16x32_bf16 v[192:195], a[64:67], a[156:159], 0
    s_cselect_b32 s81, 0, s81
    s_add_u32 m0, s31, 0
    ds_read_b128 a[172:175], v65 offset:4096
    v_mfma_f32_16x16x32_bf16 v[224:227], a[64:67], a[160:163], 0
    buffer_load_dwordx4 v36, s[16:19], s38 offen offset:0 lds
    v_mfma_f32_16x16x32_bf16 v[132:135], a[68:71], a[148:151], 0
    buffer_load_dwordx4 v37, s[16:19], s38 offen offset:1024 lds
    v_mfma_f32_16x16x32_bf16 v[164:167], a[68:71], a[152:155], 0
    ds_read_b128 a[176:179], v65 offset:6144
    v_mfma_f32_16x16x32_bf16 v[196:199], a[68:71], a[156:159], 0
    buffer_load_dwordx4 v38, s[16:19], s38 offen offset:2048 lds
    v_mfma_f32_16x16x32_bf16 v[228:231], a[68:71], a[160:163], 0
    ds_read_b64_tr_b16 a[96:97], v66 offset:39968
    v_mfma_f32_16x16x32_bf16 v[136:139], a[72:75], a[148:151], 0
    buffer_load_dwordx4 v39, s[16:19], s38 offen offset:3072 lds
    v_mfma_f32_16x16x32_bf16 v[168:171], a[72:75], a[152:155], 0
    ds_read_b64_tr_b16 a[98:99], v66 offset:40992
    v_mfma_f32_16x16x32_bf16 v[200:203], a[72:75], a[156:159], 0
    s_add_u32 m0, s31, 4096
    ds_read_b64_tr_b16 a[100:101], v66 offset:39976
    v_mfma_f32_16x16x32_bf16 v[232:235], a[72:75], a[160:163], 0
    buffer_load_dwordx4 v40, s[16:19], s38 offen offset:0 lds
    v_mfma_f32_16x16x32_bf16 v[140:143], a[76:79], a[148:151], 0
    ds_read_b64_tr_b16 a[102:103], v66 offset:41000
    v_mfma_f32_16x16x32_bf16 v[172:175], a[76:79], a[152:155], 0
    buffer_load_dwordx4 v41, s[16:19], s38 offen offset:1024 lds
    v_mfma_f32_16x16x32_bf16 v[204:207], a[76:79], a[156:159], 0
    ds_read_b64_tr_b16 a[104:105], v67 offset:39968
    v_mfma_f32_16x16x32_bf16 v[236:239], a[76:79], a[160:163], 0
    ds_read_b64_tr_b16 a[106:107], v67 offset:40992
    v_mfma_f32_16x16x32_bf16 v[144:147], a[80:83], a[148:151], 0
    buffer_load_dwordx4 v42, s[16:19], s38 offen offset:2048 lds
    v_mfma_f32_16x16x32_bf16 v[176:179], a[80:83], a[152:155], 0
    ds_read_b64_tr_b16 a[108:109], v67 offset:39976
    v_mfma_f32_16x16x32_bf16 v[208:211], a[80:83], a[156:159], 0
    buffer_load_dwordx4 v43, s[16:19], s38 offen offset:3072 lds
    v_mfma_f32_16x16x32_bf16 v[240:243], a[80:83], a[160:163], 0
    ds_read_b64_tr_b16 a[110:111], v67 offset:41000
    v_mfma_f32_16x16x32_bf16 v[148:151], a[84:87], a[148:151], 0
    s_add_u32 m0, s32, 31744
    ds_read_b64_tr_b16 a[112:113], v68 offset:39968
    v_mfma_f32_16x16x32_bf16 v[180:183], a[84:87], a[152:155], 0
    buffer_load_dwordx4 v44, s[20:23], s39 offen offset:0 lds
    v_mfma_f32_16x16x32_bf16 v[212:215], a[84:87], a[156:159], 0
    ds_read_b64_tr_b16 a[114:115], v68 offset:40992
    v_mfma_f32_16x16x32_bf16 v[244:247], a[84:87], a[160:163], 0
    buffer_load_dwordx4 v45, s[20:23], s39 offen offset:1024 lds
    v_mfma_f32_16x16x32_bf16 v[152:155], a[88:91], a[148:151], 0
    ds_read_b64_tr_b16 a[116:117], v68 offset:39976
    v_mfma_f32_16x16x32_bf16 v[184:187], a[88:91], a[152:155], 0
    ds_read_b64_tr_b16 a[118:119], v68 offset:41000
    v_mfma_f32_16x16x32_bf16 v[216:219], a[88:91], a[156:159], 0
    buffer_load_dwordx4 v46, s[20:23], s39 offen offset:2056 lds
    v_mfma_f32_16x16x32_bf16 v[248:251], a[88:91], a[160:163], 0
    ds_read_b64_tr_b16 a[120:121], v69 offset:39968
    v_mfma_f32_16x16x32_bf16 v[156:159], a[92:95], a[148:151], 0
    buffer_load_dwordx4 v47, s[20:23], s39 offen offset:3080 lds
    v_mfma_f32_16x16x32_bf16 v[188:191], a[92:95], a[152:155], 0
    ds_read_b64_tr_b16 a[122:123], v69 offset:40992
    v_mfma_f32_16x16x32_bf16 v[220:223], a[92:95], a[156:159], 0
    ds_read_b64_tr_b16 a[124:125], v69 offset:39976
    v_mfma_f32_16x16x32_bf16 v[252:255], a[92:95], a[160:163], 0
    s_waitcnt lgkmcnt(10)
    ds_read_b64_tr_b16 a[126:127], v69 offset:41000
    v_mfma_f32_16x16x32_bf16 v[128:131], a[96:99], a[164:167], v[128:131]
    v_mfma_f32_16x16x32_bf16 v[160:163], a[96:99], a[168:171], v[160:163]
    v_add_u32 v64, 49152, v64
    v_add_u32 v65, 49152, v65
    v_mfma_f32_16x16x32_bf16 v[192:195], a[96:99], a[172:175], v[192:195]
    v_add_u32 v66, 49152, v66
    v_add_u32 v67, 49152, v67
    v_mfma_f32_16x16x32_bf16 v[224:227], a[96:99], a[176:179], v[224:227]
    v_add_u32 v68, 49152, v68
    v_add_u32 v69, 49152, v69
    v_mfma_f32_16x16x32_bf16 v[132:135], a[100:103], a[164:167], v[132:135]
    s_waitcnt vmcnt(12) lgkmcnt(0)
    s_barrier
    v_mfma_f32_16x16x32_bf16 v[164:167], a[100:103], a[168:171], v[164:167]
    s_lshl_b32 s38, s81, 7
    s_lshl_b32 s39, s81, 19
    ds_read_b128 a[148:151], v64 offset:0
    v_mfma_f32_16x16x32_bf16 v[196:199], a[100:103], a[172:175], v[196:199]
    s_add_u32 s81, s81, 1
    s_cmp_eq_u32 s81, 10
    ds_read_b128 a[152:155], v64 offset:2048
    v_mfma_f32_16x16x32_bf16 v[228:231], a[100:103], a[176:179], v[228:231]
    s_cselect_b32 s81, 0, s81
    s_add_u32 m0, s31, 49152
    ds_read_b128 a[156:159], v64 offset:4096
    v_mfma_f32_16x16x32_bf16 v[136:139], a[104:107], a[164:167], v[136:139]
    buffer_load_dwordx4 v36, s[16:19], s38 offen offset:0 lds
    v_mfma_f32_16x16x32_bf16 v[168:171], a[104:107], a[168:171], v[168:171]
    ds_read_b128 a[160:163], v64 offset:6144
    v_mfma_f32_16x16x32_bf16 v[200:203], a[104:107], a[172:175], v[200:203]
    buffer_load_dwordx4 v37, s[16:19], s38 offen offset:1024 lds
    v_mfma_f32_16x16x32_bf16 v[232:235], a[104:107], a[176:179], v[232:235]
    ds_read_b64_tr_b16 a[64:65], v66 offset:31744
    v_mfma_f32_16x16x32_bf16 v[140:143], a[108:111], a[164:167], v[140:143]
    ds_read_b64_tr_b16 a[66:67], v66 offset:32768
    v_mfma_f32_16x16x32_bf16 v[172:175], a[108:111], a[168:171], v[172:175]
    ds_read_b64_tr_b16 a[68:69], v66 offset:31752
    v_mfma_f32_16x16x32_bf16 v[204:207], a[108:111], a[172:175], v[204:207]
    ds_read_b64_tr_b16 a[70:71], v66 offset:32776
    v_mfma_f32_16x16x32_bf16 v[236:239], a[108:111], a[176:179], v[236:239]
    buffer_load_dwordx4 v38, s[16:19], s38 offen offset:2048 lds
    v_mfma_f32_16x16x32_bf16 v[144:147], a[112:115], a[164:167], v[144:147]
    ds_read_b64_tr_b16 a[72:73], v67 offset:31744
    v_mfma_f32_16x16x32_bf16 v[176:179], a[112:115], a[168:171], v[176:179]
    ds_read_b64_tr_b16 a[74:75], v67 offset:32768
    v_mfma_f32_16x16x32_bf16 v[208:211], a[112:115], a[172:175], v[208:211]
    ds_read_b64_tr_b16 a[76:77], v67 offset:31752
    v_mfma_f32_16x16x32_bf16 v[240:243], a[112:115], a[176:179], v[240:243]
    ds_read_b64_tr_b16 a[78:79], v67 offset:32776
    v_mfma_f32_16x16x32_bf16 v[148:151], a[116:119], a[164:167], v[148:151]
    buffer_load_dwordx4 v39, s[16:19], s38 offen offset:3072 lds
    v_mfma_f32_16x16x32_bf16 v[180:183], a[116:119], a[168:171], v[180:183]
    ds_read_b64_tr_b16 a[80:81], v68 offset:31744
    v_mfma_f32_16x16x32_bf16 v[212:215], a[116:119], a[172:175], v[212:215]
    ds_read_b64_tr_b16 a[82:83], v68 offset:32768
    v_mfma_f32_16x16x32_bf16 v[244:247], a[116:119], a[176:179], v[244:247]
    ds_read_b64_tr_b16 a[84:85], v68 offset:31752
    v_mfma_f32_16x16x32_bf16 v[152:155], a[120:123], a[164:167], v[152:155]
    s_add_u32 m0, s31, 53248
    ds_read_b64_tr_b16 a[86:87], v68 offset:32776
    v_mfma_f32_16x16x32_bf16 v[184:187], a[120:123], a[168:171], v[184:187]
    buffer_load_dwordx4 v40, s[16:19], s38 offen offset:0 lds
    v_mfma_f32_16x16x32_bf16 v[216:219], a[120:123], a[172:175], v[216:219]
    ds_read_b64_tr_b16 a[88:89], v69 offset:31744
    v_mfma_f32_16x16x32_bf16 v[248:251], a[120:123], a[176:179], v[248:251]
    ds_read_b64_tr_b16 a[90:91], v69 offset:32768
    v_mfma_f32_16x16x32_bf16 v[156:159], a[124:127], a[164:167], v[156:159]
    ds_read_b64_tr_b16 a[92:93], v69 offset:31752
    v_mfma_f32_16x16x32_bf16 v[188:191], a[124:127], a[168:171], v[188:191]
    ds_read_b64_tr_b16 a[94:95], v69 offset:32776
    v_mfma_f32_16x16x32_bf16 v[220:223], a[124:127], a[172:175], v[220:223]
    buffer_load_dwordx4 v41, s[16:19], s38 offen offset:1024 lds
    v_mfma_f32_16x16x32_bf16 v[252:255], a[124:127], a[176:179], v[252:255]
    s_waitcnt lgkmcnt(10)
    ds_read_b64_tr_b16 a[96:97], v66 offset:39968
    v_mfma_f32_16x16x32_bf16 v[128:131], a[64:67], a[148:151], v[128:131]
    ds_read_b64_tr_b16 a[98:99], v66 offset:40992
    v_mfma_f32_16x16x32_bf16 v[160:163], a[64:67], a[152:155], v[160:163]
    ds_read_b64_tr_b16 a[100:101], v66 offset:39976
    v_mfma_f32_16x16x32_bf16 v[192:195], a[64:67], a[156:159], v[192:195]
    ds_read_b64_tr_b16 a[102:103], v66 offset:41000
    v_mfma_f32_16x16x32_bf16 v[224:227], a[64:67], a[160:163], v[224:227]
    buffer_load_dwordx4 v42, s[16:19], s38 offen offset:2048 lds
    v_mfma_f32_16x16x32_bf16 v[132:135], a[68:71], a[148:151], v[132:135]
    ds_read_b128 a[164:167], v65 offset:0
    v_mfma_f32_16x16x32_bf16 v[164:167], a[68:71], a[152:155], v[164:167]
    ds_read_b128 a[168:171], v65 offset:2048
    v_mfma_f32_16x16x32_bf16 v[196:199], a[68:71], a[156:159], v[196:199]
    ds_read_b128 a[172:175], v65 offset:4096
    v_mfma_f32_16x16x32_bf16 v[228:231], a[68:71], a[160:163], v[228:231]
    ds_read_b128 a[176:179], v65 offset:6144
    v_mfma_f32_16x16x32_bf16 v[136:139], a[72:75], a[148:151], v[136:139]
    buffer_load_dwordx4 v43, s[16:19], s38 offen offset:3072 lds
    v_mfma_f32_16x16x32_bf16 v[168:171], a[72:75], a[152:155], v[168:171]
    ds_read_b64_tr_b16 a[104:105], v67 offset:39968
    v_mfma_f32_16x16x32_bf16 v[200:203], a[72:75], a[156:159], v[200:203]
    ds_read_b64_tr_b16 a[106:107], v67 offset:40992
    v_mfma_f32_16x16x32_bf16 v[232:235], a[72:75], a[160:163], v[232:235]
    s_waitcnt lgkmcnt(10)
    ds_read_b64_tr_b16 a[108:109], v67 offset:39976
    v_mfma_f32_16x16x32_bf16 v[140:143], a[76:79], a[148:151], v[140:143]
    s_add_u32 m0, s32, 80896
    ds_read_b64_tr_b16 a[110:111], v67 offset:41000
    v_mfma_f32_16x16x32_bf16 v[172:175], a[76:79], a[152:155], v[172:175]
    buffer_load_dwordx4 v44, s[20:23], s39 offen offset:0 lds
    v_mfma_f32_16x16x32_bf16 v[204:207], a[76:79], a[156:159], v[204:207]
    ds_read_b64_tr_b16 a[112:113], v68 offset:39968
    v_mfma_f32_16x16x32_bf16 v[236:239], a[76:79], a[160:163], v[236:239]
    ds_read_b64_tr_b16 a[114:115], v68 offset:40992
    v_mfma_f32_16x16x32_bf16 v[144:147], a[80:83], a[148:151], v[144:147]
    ds_read_b64_tr_b16 a[116:117], v68 offset:39976
    v_mfma_f32_16x16x32_bf16 v[176:179], a[80:83], a[152:155], v[176:179]
    ds_read_b64_tr_b16 a[118:119], v68 offset:41000
    v_mfma_f32_16x16x32_bf16 v[208:211], a[80:83], a[156:159], v[208:211]
    buffer_load_dwordx4 v45, s[20:23], s39 offen offset:1024 lds
    v_mfma_f32_16x16x32_bf16 v[240:243], a[80:83], a[160:163], v[240:243]
    ds_read_b64_tr_b16 a[120:121], v69 offset:39968
    v_mfma_f32_16x16x32_bf16 v[148:151], a[84:87], a[148:151], v[148:151]
    ds_read_b64_tr_b16 a[122:123], v69 offset:40992
    v_mfma_f32_16x16x32_bf16 v[180:183], a[84:87], a[152:155], v[180:183]
    ds_read_b64_tr_b16 a[124:125], v69 offset:39976
    v_mfma_f32_16x16x32_bf16 v[212:215], a[84:87], a[156:159], v[212:215]
    ds_read_b64_tr_b16 a[126:127], v69 offset:41000
    v_mfma_f32_16x16x32_bf16 v[244:247], a[84:87], a[160:163], v[244:247]
    buffer_load_dwordx4 v46, s[20:23], s39 offen offset:2056 lds
    v_mfma_f32_16x16x32_bf16 v[152:155], a[88:91], a[148:151], v[152:155]
    v_mfma_f32_16x16x32_bf16 v[184:187], a[88:91], a[152:155], v[184:187]
    v_mfma_f32_16x16x32_bf16 v[216:219], a[88:91], a[156:159], v[216:219]
    v_mfma_f32_16x16x32_bf16 v[248:251], a[88:91], a[160:163], v[248:251]
    v_mfma_f32_16x16x32_bf16 v[156:159], a[92:95], a[148:151], v[156:159]
    buffer_load_dwordx4 v47, s[20:23], s39 offen offset:3080 lds
    v_mfma_f32_16x16x32_bf16 v[188:191], a[92:95], a[152:155], v[188:191]
    v_mfma_f32_16x16x32_bf16 v[220:223], a[92:95], a[156:159], v[220:223]
    v_mfma_f32_16x16x32_bf16 v[252:255], a[92:95], a[160:163], v[252:255]
    s_waitcnt lgkmcnt(10)
    v_mfma_f32_16x16x32_bf16 v[128:131], a[96:99], a[164:167], v[128:131]
    v_mfma_f32_16x16x32_bf16 v[160:163], a[96:99], a[168:171], v[160:163]
    v_subrev_u32 v64, 98304, v64
    v_subrev_u32 v65, 98304, v65
    v_mfma_f32_16x16x32_bf16 v[192:195], a[96:99], a[172:175], v[192:195]
    v_subrev_u32 v66, 98304, v66
    v_subrev_u32 v67, 98304, v67
    v_mfma_f32_16x16x32_bf16 v[224:227], a[96:99], a[176:179], v[224:227]
    v_subrev_u32 v68, 98304, v68
    v_subrev_u32 v69, 98304, v69
    v_mfma_f32_16x16x32_bf16 v[132:135], a[100:103], a[164:167], v[132:135]
    s_waitcnt vmcnt(12) lgkmcnt(0)
    s_barrier
    v_mfma_f32_16x16x32_bf16 v[164:167], a[100:103], a[168:171], v[164:167]
    s_lshl_b32 s38, s81, 7
    s_lshl_b32 s39, s81, 19
    ds_read_b128 a[148:151], v64 offset:0
    v_mfma_f32_16x16x32_bf16 v[196:199], a[100:103], a[172:175], v[196:199]
    s_add_u32 s81, s81, 1
    s_cmp_eq_u32 s81, 10
    ds_read_b128 a[152:155], v64 offset:2048
    v_mfma_f32_16x16x32_bf16 v[228:231], a[100:103], a[176:179], v[228:231]
    s_cselect_b32 s81, 0, s81
    s_add_u32 m0, s31, 98304
    ds_read_b128 a[156:159], v64 offset:4096
    v_mfma_f32_16x16x32_bf16 v[136:139], a[104:107], a[164:167], v[136:139]
    buffer_load_dwordx4 v36, s[16:19], s38 offen offset:0 lds
    v_mfma_f32_16x16x32_bf16 v[168:171], a[104:107], a[168:171], v[168:171]
    ds_read_b128 a[160:163], v64 offset:6144
    v_mfma_f32_16x16x32_bf16 v[200:203], a[104:107], a[172:175], v[200:203]
    buffer_load_dwordx4 v37, s[16:19], s38 offen offset:1024 lds
    v_mfma_f32_16x16x32_bf16 v[232:235], a[104:107], a[176:179], v[232:235]
    ds_read_b64_tr_b16 a[64:65], v66 offset:31744
    v_mfma_f32_16x16x32_bf16 v[140:143], a[108:111], a[164:167], v[140:143]
    ds_read_b64_tr_b16 a[66:67], v66 offset:32768
    v_mfma_f32_16x16x32_bf16 v[172:175], a[108:111], a[168:171], v[172:175]
    ds_read_b64_tr_b16 a[68:69], v66 offset:31752
    v_mfma_f32_16x16x32_bf16 v[204:207], a[108:111], a[172:175], v[204:207]
    ds_read_b64_tr_b16 a[70:71], v66 offset:32776
    v_mfma_f32_16x16x32_bf16 v[236:239], a[108:111], a[176:179], v[236:239]
    buffer_load_dwordx4 v38, s[16:19], s38 offen offset:2048 lds
    v_mfma_f32_16x16x32_bf16 v[144:147], a[112:115], a[164:167], v[144:147]
    ds_read_b64_tr_b16 a[72:73], v67 offset:31744
    v_mfma_f32_16x16x32_bf16 v[176:179], a[112:115], a[168:171], v[176:179]
    ds_read_b64_tr_b16 a[74:75], v67 offset:32768
    v_mfma_f32_16x16x32_bf16 v[208:211], a[112:115], a[172:175], v[208:211]
    ds_read_b64_tr_b16 a[76:77], v67 offset:31752
    v_mfma_f32_16x16x32_bf16 v[240:243], a[112:115], a[176:179], v[240:243]
    ds_read_b64_tr_b16 a[78:79], v67 offset:32776
    v_mfma_f32_16x16x32_bf16 v[148:151], a[116:119], a[164:167], v[148:151]
    buffer_load_dwordx4 v39, s[16:19], s38 offen offset:3072 lds
    v_mfma_f32_16x16x32_bf16 v[180:183], a[116:119], a[168:171], v[180:183]
    ds_read_b64_tr_b16 a[80:81], v68 offset:31744
    v_mfma_f32_16x16x32_bf16 v[212:215], a[116:119], a[172:175], v[212:215]
    ds_read_b64_tr_b16 a[82:83], v68 offset:32768
    v_mfma_f32_16x16x32_bf16 v[244:247], a[116:119], a[176:179], v[244:247]
    ds_read_b64_tr_b16 a[84:85], v68 offset:31752
    v_mfma_f32_16x16x32_bf16 v[152:155], a[120:123], a[164:167], v[152:155]
    s_add_u32 m0, s31, 102400
    ds_read_b64_tr_b16 a[86:87], v68 offset:32776
    v_mfma_f32_16x16x32_bf16 v[184:187], a[120:123], a[168:171], v[184:187]
    buffer_load_dwordx4 v40, s[16:19], s38 offen offset:0 lds
    v_mfma_f32_16x16x32_bf16 v[216:219], a[120:123], a[172:175], v[216:219]
    ds_read_b64_tr_b16 a[88:89], v69 offset:31744
    v_mfma_f32_16x16x32_bf16 v[248:251], a[120:123], a[176:179], v[248:251]
    ds_read_b64_tr_b16 a[90:91], v69 offset:32768
    v_mfma_f32_16x16x32_bf16 v[156:159], a[124:127], a[164:167], v[156:159]
    ds_read_b64_tr_b16 a[92:93], v69 offset:31752
    v_mfma_f32_16x16x32_bf16 v[188:191], a[124:127], a[168:171], v[188:191]
    ds_read_b64_tr_b16 a[94:95], v69 offset:32776
    v_mfma_f32_16x16x32_bf16 v[220:223], a[124:127], a[172:175], v[220:223]
    buffer_load_dwordx4 v41, s[16:19], s38 offen offset:1024 lds
    v_mfma_f32_16x16x32_bf16 v[252:255], a[124:127], a[176:179], v[252:255]
    s_waitcnt lgkmcnt(10)
    ds_read_b64_tr_b16 a[96:97], v66 offset:39968
    v_mfma_f32_16x16x32_bf16 v[128:131], a[64:67], a[148:151], v[128:131]
    ds_read_b64_tr_b16 a[98:99], v66 offset:40992
    v_mfma_f32_16x16x32_bf16 v[160:163], a[64:67], a[152:155], v[160:163]
    ds_read_b64_tr_b16 a[100:101], v66 offset:39976
    v_mfma_f32_16x16x32_bf16 v[192:195], a[64:67], a[156:159], v[192:195]
    ds_read_b64_tr_b16 a[102:103], v66 offset:41000
    v_mfma_f32_16x16x32_bf16 v[224:227], a[64:67], a[160:163], v[224:227]
    buffer_load_dwordx4 v42, s[16:19], s38 offen offset:2048 lds
    v_mfma_f32_16x16x32_bf16 v[132:135], a[68:71], a[148:151], v[132:135]
    ds_read_b128 a[164:167], v65 offset:0
    v_mfma_f32_16x16x32_bf16 v[164:167], a[68:71], a[152:155], v[164:167]
    ds_read_b128 a[168:171], v65 offset:2048
    v_mfma_f32_16x16x32_bf16 v[196:199], a[68:71], a[156:159], v[196:199]
    ds_read_b128 a[172:175], v65 offset:4096
    v_mfma_f32_16x16x32_bf16 v[228:231], a[68:71], a[160:163], v[228:231]
    ds_read_b128 a[176:179], v65 offset:6144
    v_mfma_f32_16x16x32_bf16 v[136:139], a[72:75], a[148:151], v[136:139]
    buffer_load_dwordx4 v43, s[16:19], s38 offen offset:3072 lds
    v_mfma_f32_16x16x32_bf16 v[168:171], a[72:75], a[152:155], v[168:171]
    ds_read_b64_tr_b16 a[104:105], v67 offset:39968
    v_mfma_f32_16x16x32_bf16 v[200:203], a[72:75], a[156:159], v[200:203]
    ds_read_b64_tr_b16 a[106:107], v67 offset:40992
    v_mfma_f32_16x16x32_bf16 v[232:235], a[72:75], a[160:163], v[232:235]
    s_waitcnt lgkmcnt(10)
    ds_read_b64_tr_b16 a[108:109], v67 offset:39976
    v_mfma_f32_16x16x32_bf16 v[140:143], a[76:79], a[148:151], v[140:143]
    s_add_u32 m0, s32, 130048
    ds_read_b64_tr_b16 a[110:111], v67 offset:41000
    v_mfma_f32_16x16x32_bf16 v[172:175], a[76:79], a[152:155], v[172:175]
    buffer_load_dwordx4 v44, s[20:23], s39 offen offset:0 lds
    v_mfma_f32_16x16x32_bf16 v[204:207], a[76:79], a[156:159], v[204:207]
    ds_read_b64_tr_b16 a[112:113], v68 offset:39968
    v_mfma_f32_16x16x32_bf16 v[236:239], a[76:79], a[160:163], v[236:239]
    ds_read_b64_tr_b16 a[114:115], v68 offset:40992
    v_mfma_f32_16x16x32_bf16 v[144:147], a[80:83], a[148:151], v[144:147]
    ds_read_b64_tr_b16 a[116:117], v68 offset:39976
    v_mfma_f32_16x16x32_bf16 v[176:179], a[80:83], a[152:155], v[176:179]
    ds_read_b64_tr_b16 a[118:119], v68 offset:41000
    v_mfma_f32_16x16x32_bf16 v[208:211], a[80:83], a[156:159], v[208:211]
    buffer_load_dwordx4 v45, s[20:23], s39 offen offset:1024 lds
    v_mfma_f32_16x16x32_bf16 v[240:243], a[80:83], a[160:163], v[240:243]
    ds_read_b64_tr_b16 a[120:121], v69 offset:39968
    v_mfma_f32_16x16x32_bf16 v[148:151], a[84:87], a[148:151], v[148:151]
    ds_read_b64_tr_b16 a[122:123], v69 offset:40992
    v_mfma_f32_16x16x32_bf16 v[180:183], a[84:87], a[152:155], v[180:183]
    ds_read_b64_tr_b16 a[124:125], v69 offset:39976
    v_mfma_f32_16x16x32_bf16 v[212:215], a[84:87], a[156:159], v[212:215]
    ds_read_b64_tr_b16 a[126:127], v69 offset:41000
    v_mfma_f32_16x16x32_bf16 v[244:247], a[84:87], a[160:163], v[244:247]
    buffer_load_dwordx4 v46, s[20:23], s39 offen offset:2056 lds
    v_mfma_f32_16x16x32_bf16 v[152:155], a[88:91], a[148:151], v[152:155]
    v_mfma_f32_16x16x32_bf16 v[184:187], a[88:91], a[152:155], v[184:187]
    v_mfma_f32_16x16x32_bf16 v[216:219], a[88:91], a[156:159], v[216:219]
    v_mfma_f32_16x16x32_bf16 v[248:251], a[88:91], a[160:163], v[248:251]
    v_mfma_f32_16x16x32_bf16 v[156:159], a[92:95], a[148:151], v[156:159]
    buffer_load_dwordx4 v47, s[20:23], s39 offen offset:3080 lds
    v_mfma_f32_16x16x32_bf16 v[188:191], a[92:95], a[152:155], v[188:191]
    v_mfma_f32_16x16x32_bf16 v[220:223], a[92:95], a[156:159], v[220:223]
    v_mfma_f32_16x16x32_bf16 v[252:255], a[92:95], a[160:163], v[252:255]
    s_waitcnt lgkmcnt(10)
    v_mfma_f32_16x16x32_bf16 v[128:131], a[96:99], a[164:167], v[128:131]
    v_mfma_f32_16x16x32_bf16 v[160:163], a[96:99], a[168:171], v[160:163]
    v_add_u32 v64, 49152, v64
    v_add_u32 v65, 49152, v65
    v_mfma_f32_16x16x32_bf16 v[192:195], a[96:99], a[172:175], v[192:195]
    v_add_u32 v66, 49152, v66
    v_add_u32 v67, 49152, v67
    v_mfma_f32_16x16x32_bf16 v[224:227], a[96:99], a[176:179], v[224:227]
    v_add_u32 v68, 49152, v68
    v_add_u32 v69, 49152, v69
    v_mfma_f32_16x16x32_bf16 v[132:135], a[100:103], a[164:167], v[132:135]
    s_waitcnt vmcnt(12) lgkmcnt(0)
    s_barrier
    v_mfma_f32_16x16x32_bf16 v[164:167], a[100:103], a[168:171], v[164:167]
    s_lshl_b32 s38, s81, 7
    s_lshl_b32 s39, s81, 19
    ds_read_b128 a[148:151], v64 offset:0
    v_mfma_f32_16x16x32_bf16 v[196:199], a[100:103], a[172:175], v[196:199]
    s_add_u32 s81, s81, 1
    s_cmp_eq_u32 s81, 10
    ds_read_b128 a[152:155], v64 offset:2048
    v_mfma_f32_16x16x32_bf16 v[228:231], a[100:103], a[176:179], v[228:231]
    s_cselect_b32 s81, 0, s81
    s_add_u32 m0, s31, 0
    ds_read_b128 a[156:159], v64 offset:4096
    v_mfma_f32_16x16x32_bf16 v[136:139], a[104:107], a[164:167], v[136:139]
    buffer_load_dwordx4 v36, s[16:19], s38 offen offset:0 lds
    v_mfma_f32_16x16x32_bf16 v[168:171], a[104:107], a[168:171], v[168:171]
    buffer_load_dwordx4 v37, s[16:19], s38 offen offset:1024 lds
    v_mfma_f32_16x16x32_bf16 v[200:203], a[104:107], a[172:175], v[200:203]
    ds_read_b128 a[160:163], v64 offset:6144
    v_mfma_f32_16x16x32_bf16 v[232:235], a[104:107], a[176:179], v[232:235]
    ds_read_b64_tr_b16 a[64:65], v66 offset:31744
    v_mfma_f32_16x16x32_bf16 v[140:143], a[108:111], a[164:167], v[140:143]
    ds_read_b64_tr_b16 a[66:67], v66 offset:32768
    v_mfma_f32_16x16x32_bf16 v[172:175], a[108:111], a[168:171], v[172:175]
    buffer_load_dwordx4 v38, s[16:19], s38 offen offset:2048 lds
    v_mfma_f32_16x16x32_bf16 v[204:207], a[108:111], a[172:175], v[204:207]
    ds_read_b64_tr_b16 a[68:69], v66 offset:31752
    v_mfma_f32_16x16x32_bf16 v[236:239], a[108:111], a[176:179], v[236:239]
    ds_read_b64_tr_b16 a[70:71], v66 offset:32776
    v_mfma_f32_16x16x32_bf16 v[144:147], a[112:115], a[164:167], v[144:147]
    ds_read_b64_tr_b16 a[72:73], v67 offset:31744
    v_mfma_f32_16x16x32_bf16 v[176:179], a[112:115], a[168:171], v[176:179]
    buffer_load_dwordx4 v39, s[16:19], s38 offen offset:3072 lds
    v_mfma_f32_16x16x32_bf16 v[208:211], a[112:115], a[172:175], v[208:211]
    ds_read_b64_tr_b16 a[74:75], v67 offset:32768
    v_mfma_f32_16x16x32_bf16 v[240:243], a[112:115], a[176:179], v[240:243]
    s_add_u32 m0, s31, 4096
    ds_read_b64_tr_b16 a[76:77], v67 offset:31752
    v_mfma_f32_16x16x32_bf16 v[148:151], a[116:119], a[164:167], v[148:151]
    buffer_load_dwordx4 v40, s[16:19], s38 offen offset:0 lds
    v_mfma_f32_16x16x32_bf16 v[180:183], a[116:119], a[168:171], v[180:183]
    ds_read_b64_tr_b16 a[78:79], v67 offset:32776
    v_mfma_f32_16x16x32_bf16 v[212:215], a[116:119], a[172:175], v[212:215]
    ds_read_b64_tr_b16 a[80:81], v68 offset:31744
    v_mfma_f32_16x16x32_bf16 v[244:247], a[116:119], a[176:179], v[244:247]
    ds_read_b64_tr_b16 a[82:83], v68 offset:32768
    v_mfma_f32_16x16x32_bf16 v[152:155], a[120:123], a[164:167], v[152:155]
    buffer_load_dwordx4 v41, s[16:19], s38 offen offset:1024 lds
    v_mfma_f32_16x16x32_bf16 v[184:187], a[120:123], a[168:171], v[184:187]
    ds_read_b64_tr_b16 a[84:85], v68 offset:31752
    v_mfma_f32_16x16x32_bf16 v[216:219], a[120:123], a[172:175], v[216:219]
    ds_read_b64_tr_b16 a[86:87], v68 offset:32776
    v_mfma_f32_16x16x32_bf16 v[248:251], a[120:123], a[176:179], v[248:251]
    ds_read_b64_tr_b16 a[88:89], v69 offset:31744
    v_mfma_f32_16x16x32_bf16 v[156:159], a[124:127], a[164:167], v[156:159]
    buffer_load_dwordx4 v42, s[16:19], s38 offen offset:2048 lds
    v_mfma_f32_16x16x32_bf16 v[188:191], a[124:127], a[168:171], v[188:191]
    ds_read_b64_tr_b16 a[90:91], v69 offset:32768
    v_mfma_f32_16x16x32_bf16 v[220:223], a[124:127], a[172:175], v[220:223]
    ds_read_b64_tr_b16 a[92:93], v69 offset:31752
    v_mfma_f32_16x16x32_bf16 v[252:255], a[124:127], a[176:179], v[252:255]
    s_waitcnt lgkmcnt(10)
    buffer_load_dwordx4 v43, s[16:19], s38 offen offset:3072 lds
    v_mfma_f32_16x16x32_bf16 v[128:131], a[64:67], a[148:151], v[128:131]
    ds_read_b64_tr_b16 a[94:95], v69 offset:32776
    v_mfma_f32_16x16x32_bf16 v[160:163], a[64:67], a[152:155], v[160:163]
    ds_read_b64_tr_b16 a[96:97], v66 offset:39968
    v_mfma_f32_16x16x32_bf16 v[192:195], a[64:67], a[156:159], v[192:195]
    s_add_u32 m0, s32, 31744
    ds_read_b64_tr_b16 a[98:99], v66 offset:40992
    v_mfma_f32_16x16x32_bf16 v[224:227], a[64:67], a[160:163], v[224:227]
    buffer_load_dwordx4 v44, s[20:23], s39 offen offset:0 lds
    v_mfma_f32_16x16x32_bf16 v[132:135], a[68:71], a[148:151], v[132:135]
    ds_read_b64_tr_b16 a[100:101], v66 offset:39976
    v_mfma_f32_16x16x32_bf16 v[164:167], a[68:71], a[152:155], v[164:167]
    ds_read_b64_tr_b16 a[102:103], v66 offset:41000
    v_mfma_f32_16x16x32_bf16 v[196:199], a[68:71], a[156:159], v[196:199]
    ds_read_b128 a[164:167], v65 offset:0
    v_mfma_f32_16x16x32_bf16 v[228:231], a[68:71], a[160:163], v[228:231]
    s_waitcnt lgkmcnt(10)
    buffer_load_dwordx4 v45, s[20:23], s39 offen offset:1024 lds
    v_mfma_f32_16x16x32_bf16 v[136:139], a[72:75], a[148:151], v[136:139]
    ds_read_b128 a[168:171], v65 offset:2048
    v_mfma_f32_16x16x32_bf16 v[168:171], a[72:75], a[152:155], v[168:171]
    ds_read_b128 a[172:175], v65 offset:4096
    v_mfma_f32_16x16x32_bf16 v[200:203], a[72:75], a[156:159], v[200:203]
    buffer_load_dwordx4 v46, s[20:23], s39 offen offset:2056 lds
    v_mfma_f32_16x16x32_bf16 v[232:235], a[72:75], a[160:163], v[232:235]
    ds_read_b128 a[176:179], v65 offset:6144
    v_mfma_f32_16x16x32_bf16 v[140:143], a[76:79], a[148:151], v[140:143]
    ds_read_b64_tr_b16 a[104:105], v67 offset:39968
    v_mfma_f32_16x16x32_bf16 v[172:175], a[76:79], a[152:155], v[172:175]
    ds_read_b64_tr_b16 a[106:107], v67 offset:40992
    v_mfma_f32_16x16x32_bf16 v[204:207], a[76:79], a[156:159], v[204:207]
    buffer_load_dwordx4 v47, s[20:23], s39 offen offset:3080 lds
    v_mfma_f32_16x16x32_bf16 v[236:239], a[76:79], a[160:163], v[236:239]
    ds_read_b64_tr_b16 a[108:109], v67 offset:39976
    v_mfma_f32_16x16x32_bf16 v[144:147], a[80:83], a[148:151], v[144:147]
    s_add_u32 s33, s80, 0
    ds_read_b64_tr_b16 a[110:111], v67 offset:41000
    v_mfma_f32_16x16x32_bf16 v[176:179], a[80:83], a[152:155], v[176:179]
    s_and_b32 s33, s33, 0x7ffff
    s_add_u32 m0, s29, 49152
    ds_read_b64_tr_b16 a[112:113], v68 offset:39968
    v_mfma_f32_16x16x32_bf16 v[208:211], a[80:83], a[156:159], v[208:211]
    buffer_load_dwordx4 v28, s[8:11], s33 offen offset:0 nt lds
    v_mfma_f32_16x16x32_bf16 v[240:243], a[80:83], a[160:163], v[240:243]
    s_waitcnt lgkmcnt(10)
    ds_read_b64_tr_b16 a[114:115], v68 offset:40992
    v_mfma_f32_16x16x32_bf16 v[148:151], a[84:87], a[148:151], v[148:151]
    ds_read_b64_tr_b16 a[116:117], v68 offset:39976
    v_mfma_f32_16x16x32_bf16 v[180:183], a[84:87], a[152:155], v[180:183]
    buffer_load_dwordx4 v29, s[8:11], s33 offen offset:1024 nt lds
    v_mfma_f32_16x16x32_bf16 v[212:215], a[84:87], a[156:159], v[212:215]
    ds_read_b64_tr_b16 a[118:119], v68 offset:41000
    v_mfma_f32_16x16x32_bf16 v[244:247], a[84:87], a[160:163], v[244:247]
    ds_read_b64_tr_b16 a[120:121], v69 offset:39968
    v_mfma_f32_16x16x32_bf16 v[152:155], a[88:91], a[148:151], v[152:155]
    ds_read_b64_tr_b16 a[122:123], v69 offset:40992
    v_mfma_f32_16x16x32_bf16 v[184:187], a[88:91], a[152:155], v[184:187]
    buffer_load_dwordx4 v30, s[8:11], s33 offen offset:2048 nt lds
    v_mfma_f32_16x16x32_bf16 v[216:219], a[88:91], a[156:159], v[216:219]
    ds_read_b64_tr_b16 a[124:125], v69 offset:39976
    v_mfma_f32_16x16x32_bf16 v[248:251], a[88:91], a[160:163], v[248:251]
    ds_read_b64_tr_b16 a[126:127], v69 offset:41000
    v_mfma_f32_16x16x32_bf16 v[156:159], a[92:95], a[148:151], v[156:159]
    v_mfma_f32_16x16x32_bf16 v[188:191], a[92:95], a[152:155], v[188:191]
    buffer_load_dwordx4 v31, s[8:11], s33 offen offset:3072 nt lds
    v_mfma_f32_16x16x32_bf16 v[220:223], a[92:95], a[156:159], v[220:223]
    v_mfma_f32_16x16x32_bf16 v[252:255], a[92:95], a[160:163], v[252:255]
    s_waitcnt lgkmcnt(10)
    v_mfma_f32_16x16x32_bf16 v[128:131], a[96:99], a[164:167], v[128:131]
    v_mfma_f32_16x16x32_bf16 v[160:163], a[96:99], a[168:171], v[160:163]
    v_add_u32 v64, 49152, v64
    v_add_u32 v65, 49152, v65
    v_mfma_f32_16x16x32_bf16 v[192:195], a[96:99], a[172:175], v[192:195]
    v_add_u32 v66, 49152, v66
    v_add_u32 v67, 49152, v67
    v_mfma_f32_16x16x32_bf16 v[224:227], a[96:99], a[176:179], v[224:227]
    v_add_u32 v68, 49152, v68
    v_add_u32 v69, 49152, v69
    v_mfma_f32_16x16x32_bf16 v[132:135], a[100:103], a[164:167], v[132:135]
    s_waitcnt vmcnt(16) lgkmcnt(0)
    s_barrier
    v_mfma_f32_16x16x32_bf16 v[164:167], a[100:103], a[168:171], v[164:167]
    s_lshl_b32 s38, s81, 7
    s_lshl_b32 s39, s81, 19
    ds_read_b128 a[148:151], v64 offset:0
    v_mfma_f32_16x16x32_bf16 v[196:199], a[100:103], a[172:175], v[196:199]
    s_add_u32 s81, s81, 1
    s_cmp_eq_u32 s81, 10
    ds_read_b128 a[152:155], v64 offset:2048
    v_mfma_f32_16x16x32_bf16 v[228:231], a[100:103], a[176:179], v[228:231]
    s_cselect_b32 s81, 0, s81
    s_add_u32 m0, s31, 49152
    ds_read_b128 a[156:159], v64 offset:4096
    v_mfma_f32_16x16x32_bf16 v[136:139], a[104:107], a[164:167], v[136:139]
    buffer_load_dwordx4 v36, s[16:19], s38 offen offset:0 lds
    v_mfma_f32_16x16x32_bf16 v[168:171], a[104:107], a[168:171], v[168:171]
    ds_read_b128 a[160:163], v64 offset:6144
    v_mfma_f32_16x16x32_bf16 v[200:203], a[104:107], a[172:175], v[200:203]
    buffer_load_dwordx4 v37, s[16:19], s38 offen offset:1024 lds
    v_mfma_f32_16x16x32_bf16 v[232:235], a[104:107], a[176:179], v[232:235]
    ds_read_b64_tr_b16 a[64:65], v66 offset:31744
    v_mfma_f32_16x16x32_bf16 v[140:143], a[108:111], a[164:167], v[140:143]
    ds_read_b64_tr_b16 a[66:67], v66 offset:32768
    v_mfma_f32_16x16x32_bf16 v[172:175], a[108:111], a[168:171], v[172:175]
    ds_read_b64_tr_b16 a[68:69], v66 offset:31752
    v_mfma_f32_16x16x32_bf16 v[204:207], a[108:111], a[172:175], v[204:207]
    ds_read_b64_tr_b16 a[70:71], v66 offset:32776
    v_mfma_f32_16x16x32_bf16 v[236:239], a[108:111], a[176:179], v[236:239]
    buffer_load_dwordx4 v38, s[16:19], s38 offen offset:2048 lds
    v_mfma_f32_16x16x32_bf16 v[144:147], a[112:115], a[164:167], v[144:147]
    ds_read_b64_tr_b16 a[72:73], v67 offset:31744
    v_mfma_f32_16x16x32_bf16 v[176:179], a[112:115], a[168:171], v[176:179]
    ds_read_b64_tr_b16 a[74:75], v67 offset:32768
    v_mfma_f32_16x16x32_bf16 v[208:211], a[112:115], a[172:175], v[208:211]
    ds_read_b64_tr_b16 a[76:77], v67 offset:31752
    v_mfma_f32_16x16x32_bf16 v[240:243], a[112:115], a[176:179], v[240:243]
    ds_read_b64_tr_b16 a[78:79], v67 offset:32776
    v_mfma_f32_16x16x32_bf16 v[148:151], a[116:119], a[164:167], v[148:151]
    buffer_load_dwordx4 v39, s[16:19], s38 offen offset:3072 lds
    v_mfma_f32_16x16x32_bf16 v[180:183], a[116:119], a[168:171], v[180:183]
    ds_read_b64_tr_b16 a[80:81], v68 offset:31744
    v_mfma_f32_16x16x32_bf16 v[212:215], a[116:119], a[172:175], v[212:215]
    ds_read_b64_tr_b16 a[82:83], v68 offset:32768
    v_mfma_f32_16x16x32_bf16 v[244:247], a[116:119], a[176:179], v[244:247]
    ds_read_b64_tr_b16 a[84:85], v68 offset:31752
    v_mfma_f32_16x16x32_bf16 v[152:155], a[120:123], a[164:167], v[152:155]
    s_add_u32 m0, s31, 53248
    ds_read_b64_tr_b16 a[86:87], v68 offset:32776
    v_mfma_f32_16x16x32_bf16 v[184:187], a[120:123], a[168:171], v[184:187]
    buffer_load_dwordx4 v40, s[16:19], s38 offen offset:0 lds
    v_mfma_f32_16x16x32_bf16 v[216:219], a[120:123], a[172:175], v[216:219]
    ds_read_b64_tr_b16 a[88:89], v69 offset:31744
    v_mfma_f32_16x16x32_bf16 v[248:251], a[120:123], a[176:179], v[248:251]
    ds_read_b64_tr_b16 a[90:91], v69 offset:32768
    v_mfma_f32_16x16x32_bf16 v[156:159], a[124:127], a[164:167], v[156:159]
    ds_read_b64_tr_b16 a[92:93], v69 offset:31752
    v_mfma_f32_16x16x32_bf16 v[188:191], a[124:127], a[168:171], v[188:191]
    ds_read_b64_tr_b16 a[94:95], v69 offset:32776
    v_mfma_f32_16x16x32_bf16 v[220:223], a[124:127], a[172:175], v[220:223]
    buffer_load_dwordx4 v41, s[16:19], s38 offen offset:1024 lds
    v_mfma_f32_16x16x32_bf16 v[252:255], a[124:127], a[176:179], v[252:255]
    s_waitcnt lgkmcnt(10)
    ds_read_b64_tr_b16 a[96:97], v66 offset:39968
    v_mfma_f32_16x16x32_bf16 v[128:131], a[64:67], a[148:151], v[128:131]
    ds_read_b64_tr_b16 a[98:99], v66 offset:40992
    v_mfma_f32_16x16x32_bf16 v[160:163], a[64:67], a[152:155], v[160:163]
    ds_read_b64_tr_b16 a[100:101], v66 offset:39976
    v_mfma_f32_16x16x32_bf16 v[192:195], a[64:67], a[156:159], v[192:195]
    ds_read_b64_tr_b16 a[102:103], v66 offset:41000
    v_mfma_f32_16x16x32_bf16 v[224:227], a[64:67], a[160:163], v[224:227]
    buffer_load_dwordx4 v42, s[16:19], s38 offen offset:2048 lds
    v_mfma_f32_16x16x32_bf16 v[132:135], a[68:71], a[148:151], v[132:135]
    ds_read_b128 a[164:167], v65 offset:0
    v_mfma_f32_16x16x32_bf16 v[164:167], a[68:71], a[152:155], v[164:167]
    ds_read_b128 a[168:171], v65 offset:2048
    v_mfma_f32_16x16x32_bf16 v[196:199], a[68:71], a[156:159], v[196:199]
    ds_read_b128 a[172:175], v65 offset:4096
    v_mfma_f32_16x16x32_bf16 v[228:231], a[68:71], a[160:163], v[228:231]
    ds_read_b128 a[176:179], v65 offset:6144
    v_mfma_f32_16x16x32_bf16 v[136:139], a[72:75], a[148:151], v[136:139]
    buffer_load_dwordx4 v43, s[16:19], s38 offen offset:3072 lds
    v_mfma_f32_16x16x32_bf16 v[168:171], a[72:75], a[152:155], v[168:171]
    ds_read_b64_tr_b16 a[104:105], v67 offset:39968
    v_mfma_f32_16x16x32_bf16 v[200:203], a[72:75], a[156:159], v[200:203]
    ds_read_b64_tr_b16 a[106:107], v67 offset:40992
    v_mfma_f32_16x16x32_bf16 v[232:235], a[72:75], a[160:163], v[232:235]
    s_waitcnt lgkmcnt(10)
    ds_read_b64_tr_b16 a[108:109], v67 offset:39976
    v_mfma_f32_16x16x32_bf16 v[140:143], a[76:79], a[148:151], v[140:143]
    s_add_u32 m0, s32, 80896
    ds_read_b64_tr_b16 a[110:111], v67 offset:41000
    v_mfma_f32_16x16x32_bf16 v[172:175], a[76:79], a[152:155], v[172:175]
    buffer_load_dwordx4 v44, s[20:23], s39 offen offset:0 lds
    v_mfma_f32_16x16x32_bf16 v[204:207], a[76:79], a[156:159], v[204:207]
    ds_read_b64_tr_b16 a[112:113], v68 offset:39968
    v_mfma_f32_16x16x32_bf16 v[236:239], a[76:79], a[160:163], v[236:239]
    ds_read_b64_tr_b16 a[114:115], v68 offset:40992
    v_mfma_f32_16x16x32_bf16 v[144:147], a[80:83], a[148:151], v[144:147]
    ds_read_b64_tr_b16 a[116:117], v68 offset:39976
    v_mfma_f32_16x16x32_bf16 v[176:179], a[80:83], a[152:155], v[176:179]
    ds_read_b64_tr_b16 a[118:119], v68 offset:41000
    v_mfma_f32_16x16x32_bf16 v[208:211], a[80:83], a[156:159], v[208:211]
    buffer_load_dwordx4 v45, s[20:23], s39 offen offset:1024 lds
    v_mfma_f32_16x16x32_bf16 v[240:243], a[80:83], a[160:163], v[240:243]
    ds_read_b64_tr_b16 a[120:121], v69 offset:39968
    v_mfma_f32_16x16x32_bf16 v[148:151], a[84:87], a[148:151], v[148:151]
    ds_read_b64_tr_b16 a[122:123], v69 offset:40992
    v_mfma_f32_16x16x32_bf16 v[180:183], a[84:87], a[152:155], v[180:183]
    ds_read_b64_tr_b16 a[124:125], v69 offset:39976
    v_mfma_f32_16x16x32_bf16 v[212:215], a[84:87], a[156:159], v[212:215]
    ds_read_b64_tr_b16 a[126:127], v69 offset:41000
    v_mfma_f32_16x16x32_bf16 v[244:247], a[84:87], a[160:163], v[244:247]
    buffer_load_dwordx4 v46, s[20:23], s39 offen offset:2056 lds
    v_mfma_f32_16x16x32_bf16 v[152:155], a[88:91], a[148:151], v[152:155]
    v_mfma_f32_16x16x32_bf16 v[184:187], a[88:91], a[152:155], v[184:187]
    v_mfma_f32_16x16x32_bf16 v[216:219], a[88:91], a[156:159], v[216:219]
    v_mfma_f32_16x16x32_bf16 v[248:251], a[88:91], a[160:163], v[248:251]
    v_mfma_f32_16x16x32_bf16 v[156:159], a[92:95], a[148:151], v[156:159]
    buffer_load_dwordx4 v47, s[20:23], s39 offen offset:3080 lds
    v_mfma_f32_16x16x32_bf16 v[188:191], a[92:95], a[152:155], v[188:191]
    v_mfma_f32_16x16x32_bf16 v[220:223], a[92:95], a[156:159], v[220:223]
    v_mfma_f32_16x16x32_bf16 v[252:255], a[92:95], a[160:163], v[252:255]
    s_waitcnt lgkmcnt(10)
    v_mfma_f32_16x16x32_bf16 v[128:131], a[96:99], a[164:167], v[128:131]
    v_mfma_f32_16x16x32_bf16 v[160:163], a[96:99], a[168:171], v[160:163]
    v_subrev_u32 v64, 98304, v64
    v_subrev_u32 v65, 98304, v65
    v_mfma_f32_16x16x32_bf16 v[192:195], a[96:99], a[172:175], v[192:195]
    v_subrev_u32 v66, 98304, v66
    v_subrev_u32 v67, 98304, v67
    v_mfma_f32_16x16x32_bf16 v[224:227], a[96:99], a[176:179], v[224:227]
    v_subrev_u32 v68, 98304, v68
    v_subrev_u32 v69, 98304, v69
    v_mfma_f32_16x16x32_bf16 v[132:135], a[100:103], a[164:167], v[132:135]
    s_waitcnt vmcnt(16) lgkmcnt(0)
    s_barrier
    v_mfma_f32_16x16x32_bf16 v[164:167], a[100:103], a[168:171], v[164:167]
    s_lshl_b32 s38, s81, 7
    s_lshl_b32 s39, s81, 19
    ds_read_b128 a[148:151], v64 offset:0
    v_mfma_f32_16x16x32_bf16 v[196:199], a[100:103], a[172:175], v[196:199]
    s_add_u32 s81, s81, 1
    s_cmp_eq_u32 s81, 10
    ds_read_b128 a[152:155], v64 offset:2048
    v_mfma_f32_16x16x32_bf16 v[228:231], a[100:103], a[176:179], v[228:231]
    s_cselect_b32 s81, 0, s81
    s_add_u32 m0, s31, 98304
    ds_read_b128 a[156:159], v64 offset:4096
    v_mfma_f32_16x16x32_bf16 v[136:139], a[104:107], a[164:167], v[136:139]
    buffer_load_dwordx4 v36, s[16:19], s38 offen offset:0 lds
    v_mfma_f32_16x16x32_bf16 v[168:171], a[104:107], a[168:171], v[168:171]
    ds_read_b128 a[160:163], v64 offset:6144
    v_mfma_f32_16x16x32_bf16 v[200:203], a[104:107], a[172:175], v[200:203]
    buffer_load_dwordx4 v37, s[16:19], s38 offen offset:1024 lds
    v_mfma_f32_16x16x32_bf16 v[232:235], a[104:107], a[176:179], v[232:235]
    ds_read_b64_tr_b16 a[64:65], v66 offset:31744
    v_mfma_f32_16x16x32_bf16 v[140:143], a[108:111], a[164:167], v[140:143]
    ds_read_b64_tr_b16 a[66:67], v66 offset:32768
    v_mfma_f32_16x16x32_bf16 v[172:175], a[108:111], a[168:171], v[172:175]
    ds_read_b64_tr_b16 a[68:69], v66 offset:31752
    v_mfma_f32_16x16x32_bf16 v[204:207], a[108:111], a[172:175], v[204:207]
    ds_read_b64_tr_b16 a[70:71], v66 offset:32776
    v_mfma_f32_16x16x32_bf16 v[236:239], a[108:111], a[176:179], v[236:239]
    buffer_load_dwordx4 v38, s[16:19], s38 offen offset:2048 lds
    v_mfma_f32_16x16x32_bf16 v[144:147], a[112:115], a[164:167], v[144:147]
    ds_read_b64_tr_b16 a[72:73], v67 offset:31744
    v_mfma_f32_16x16x32_bf16 v[176:179], a[112:115], a[168:171], v[176:179]
    ds_read_b64_tr_b16 a[74:75], v67 offset:32768
    v_mfma_f32_16x16x32_bf16 v[208:211], a[112:115], a[172:175], v[208:211]
    ds_read_b64_tr_b16 a[76:77], v67 offset:31752
    v_mfma_f32_16x16x32_bf16 v[240:243], a[112:115], a[176:179], v[240:243]
    ds_read_b64_tr_b16 a[78:79], v67 offset:32776
    v_mfma_f32_16x16x32_bf16 v[148:151], a[116:119], a[164:167], v[148:151]
    buffer_load_dwordx4 v39, s[16:19], s38 offen offset:3072 lds
    v_mfma_f32_16x16x32_bf16 v[180:183], a[116:119], a[168:171], v[180:183]
    ds_read_b64_tr_b16 a[80:81], v68 offset:31744
    v_mfma_f32_16x16x32_bf16 v[212:215], a[116:119], a[172:175], v[212:215]
    ds_read_b64_tr_b16 a[82:83], v68 offset:32768
    v_mfma_f32_16x16x32_bf16 v[244:247], a[116:119], a[176:179], v[244:247]
    ds_read_b64_tr_b16 a[84:85], v68 offset:31752
    v_mfma_f32_16x16x32_bf16 v[152:155], a[120:123], a[164:167], v[152:155]
    s_add_u32 m0, s31, 102400
    ds_read_b64_tr_b16 a[86:87], v68 offset:32776
    v_mfma_f32_16x16x32_bf16 v[184:187], a[120:123], a[168:171], v[184:187]
    buffer_load_dwordx4 v40, s[16:19], s38 offen offset:0 lds
    v_mfma_f32_16x16x32_bf16 v[216:219], a[120:123], a[172:175], v[216:219]
    ds_read_b64_tr_b16 a[88:89], v69 offset:31744
    v_mfma_f32_16x16x32_bf16 v[248:251], a[120:123], a[176:179], v[248:251]
    ds_read_b64_tr_b16 a[90:91], v69 offset:32768
    v_mfma_f32_16x16x32_bf16 v[156:159], a[124:127], a[164:167], v[156:159]
    ds_read_b64_tr_b16 a[92:93], v69 offset:31752
    v_mfma_f32_16x16x32_bf16 v[188:191], a[124:127], a[168:171], v[188:191]
    ds_read_b64_tr_b16 a[94:95], v69 offset:32776
    v_mfma_f32_16x16x32_bf16 v[220:223], a[124:127], a[172:175], v[220:223]
    buffer_load_dwordx4 v41, s[16:19], s38 offen offset:1024 lds
    v_mfma_f32_16x16x32_bf16 v[252:255], a[124:127], a[176:179], v[252:255]
    s_waitcnt lgkmcnt(10)
    ds_read_b64_tr_b16 a[96:97], v66 offset:39968
    v_mfma_f32_16x16x32_bf16 v[128:131], a[64:67], a[148:151], v[128:131]
    ds_read_b64_tr_b16 a[98:99], v66 offset:40992
    v_mfma_f32_16x16x32_bf16 v[160:163], a[64:67], a[152:155], v[160:163]
    ds_read_b64_tr_b16 a[100:101], v66 offset:39976
    v_mfma_f32_16x16x32_bf16 v[192:195], a[64:67], a[156:159], v[192:195]
    ds_read_b64_tr_b16 a[102:103], v66 offset:41000
    v_mfma_f32_16x16x32_bf16 v[224:227], a[64:67], a[160:163], v[224:227]
    buffer_load_dwordx4 v42, s[16:19], s38 offen offset:2048 lds
    v_mfma_f32_16x16x32_bf16 v[132:135], a[68:71], a[148:151], v[132:135]
    ds_read_b128 a[164:167], v65 offset:0
    v_mfma_f32_16x16x32_bf16 v[164:167], a[68:71], a[152:155], v[164:167]
    ds_read_b128 a[168:171], v65 offset:2048
    v_mfma_f32_16x16x32_bf16 v[196:199], a[68:71], a[156:159], v[196:199]
    ds_read_b128 a[172:175], v65 offset:4096
    v_mfma_f32_16x16x32_bf16 v[228:231], a[68:71], a[160:163], v[228:231]
    ds_read_b128 a[176:179], v65 offset:6144
    v_mfma_f32_16x16x32_bf16 v[136:139], a[72:75], a[148:151], v[136:139]
    buffer_load_dwordx4 v43, s[16:19], s38 offen offset:3072 lds
    v_mfma_f32_16x16x32_bf16 v[168:171], a[72:75], a[152:155], v[168:171]
    ds_read_b64_tr_b16 a[104:105], v67 offset:39968
    v_mfma_f32_16x16x32_bf16 v[200:203], a[72:75], a[156:159], v[200:203]
    ds_read_b64_tr_b16 a[106:107], v67 offset:40992
    v_mfma_f32_16x16x32_bf16 v[232:235], a[72:75], a[160:163], v[232:235]
    s_waitcnt lgkmcnt(10)
    ds_read_b64_tr_b16 a[108:109], v67 offset:39976
    v_mfma_f32_16x16x32_bf16 v[140:143], a[76:79], a[148:151], v[140:143]
    s_add_u32 m0, s32, 130048
    ds_read_b64_tr_b16 a[110:111], v67 offset:41000
    v_mfma_f32_16x16x32_bf16 v[172:175], a[76:79], a[152:155], v[172:175]
    buffer_load_dwordx4 v44, s[20:23], s39 offen offset:0 lds
    v_mfma_f32_16x16x32_bf16 v[204:207], a[76:79], a[156:159], v[204:207]
    ds_read_b64_tr_b16 a[112:113], v68 offset:39968
    v_mfma_f32_16x16x32_bf16 v[236:239], a[76:79], a[160:163], v[236:239]
    ds_read_b64_tr_b16 a[114:115], v68 offset:40992
    v_mfma_f32_16x16x32_bf16 v[144:147], a[80:83], a[148:151], v[144:147]
    ds_read_b64_tr_b16 a[116:117], v68 offset:39976
    v_mfma_f32_16x16x32_bf16 v[176:179], a[80:83], a[152:155], v[176:179]
    ds_read_b64_tr_b16 a[118:119], v68 offset:41000
    v_mfma_f32_16x16x32_bf16 v[208:211], a[80:83], a[156:159], v[208:211]
    buffer_load_dwordx4 v45, s[20:23], s39 offen offset:1024 lds
    v_mfma_f32_16x16x32_bf16 v[240:243], a[80:83], a[160:163], v[240:243]
    ds_read_b64_tr_b16 a[120:121], v69 offset:39968
    v_mfma_f32_16x16x32_bf16 v[148:151], a[84:87], a[148:151], v[148:151]
    ds_read_b64_tr_b16 a[122:123], v69 offset:40992
    v_mfma_f32_16x16x32_bf16 v[180:183], a[84:87], a[152:155], v[180:183]
    ds_read_b64_tr_b16 a[124:125], v69 offset:39976
    v_mfma_f32_16x16x32_bf16 v[212:215], a[84:87], a[156:159], v[212:215]
    ds_read_b64_tr_b16 a[126:127], v69 offset:41000
    v_mfma_f32_16x16x32_bf16 v[244:247], a[84:87], a[160:163], v[244:247]
    buffer_load_dwordx4 v46, s[20:23], s39 offen offset:2056 lds
    v_mfma_f32_16x16x32_bf16 v[152:155], a[88:91], a[148:151], v[152:155]
    v_mfma_f32_16x16x32_bf16 v[184:187], a[88:91], a[152:155], v[184:187]
    v_mfma_f32_16x16x32_bf16 v[216:219], a[88:91], a[156:159], v[216:219]
    v_mfma_f32_16x16x32_bf16 v[248:251], a[88:91], a[160:163], v[248:251]
    v_mfma_f32_16x16x32_bf16 v[156:159], a[92:95], a[148:151], v[156:159]
    buffer_load_dwordx4 v47, s[20:23], s39 offen offset:3080 lds
    v_mfma_f32_16x16x32_bf16 v[188:191], a[92:95], a[152:155], v[188:191]
    v_mfma_f32_16x16x32_bf16 v[220:223], a[92:95], a[156:159], v[220:223]
    v_mfma_f32_16x16x32_bf16 v[252:255], a[92:95], a[160:163], v[252:255]
    s_waitcnt lgkmcnt(10)
    v_mfma_f32_16x16x32_bf16 v[128:131], a[96:99], a[164:167], v[128:131]
    v_mfma_f32_16x16x32_bf16 v[160:163], a[96:99], a[168:171], v[160:163]
    v_add_u32 v64, 49152, v64
    v_add_u32 v65, 49152, v65
    v_mfma_f32_16x16x32_bf16 v[192:195], a[96:99], a[172:175], v[192:195]
    v_add_u32 v66, 49152, v66
    v_add_u32 v67, 49152, v67
    v_mfma_f32_16x16x32_bf16 v[224:227], a[96:99], a[176:179], v[224:227]
    v_add_u32 v68, 49152, v68
    v_add_u32 v69, 49152, v69
    v_mfma_f32_16x16x32_bf16 v[132:135], a[100:103], a[164:167], v[132:135]
    s_waitcnt vmcnt(12) lgkmcnt(0)
    s_barrier
    v_mfma_f32_16x16x32_bf16 v[164:167], a[100:103], a[168:171], v[164:167]
    s_lshl_b32 s38, s81, 7
    s_lshl_b32 s39, s81, 19
    ds_read_b128 a[148:151], v64 offset:0
    v_mfma_f32_16x16x32_bf16 v[196:199], a[100:103], a[172:175], v[196:199]
    s_add_u32 s81, s81, 1
    s_cmp_eq_u32 s81, 10
    ds_read_b128 a[152:155], v64 offset:2048
    v_mfma_f32_16x16x32_bf16 v[228:231], a[100:103], a[176:179], v[228:231]
    s_cselect_b32 s81, 0, s81
    s_add_u32 m0, s31, 0
    ds_read_b128 a[156:159], v64 offset:4096
    v_mfma_f32_16x16x32_bf16 v[136:139], a[104:107], a[164:167], v[136:139]
    buffer_load_dwordx4 v36, s[16:19], s38 offen offset:0 lds
    v_mfma_f32_16x16x32_bf16 v[168:171], a[104:107], a[168:171], v[168:171]
    ds_read_b128 a[160:163], v64 offset:6144
    v_mfma_f32_16x16x32_bf16 v[200:203], a[104:107], a[172:175], v[200:203]
    buffer_load_dwordx4 v37, s[16:19], s38 offen offset:1024 lds
    v_mfma_f32_16x16x32_bf16 v[232:235], a[104:107], a[176:179], v[232:235]
    ds_read_b64_tr_b16 a[64:65], v66 offset:31744
    v_mfma_f32_16x16x32_bf16 v[140:143], a[108:111], a[164:167], v[140:143]
    ds_read_b64_tr_b16 a[66:67], v66 offset:32768
    v_mfma_f32_16x16x32_bf16 v[172:175], a[108:111], a[168:171], v[172:175]
    ds_read_b64_tr_b16 a[68:69], v66 offset:31752
    v_mfma_f32_16x16x32_bf16 v[204:207], a[108:111], a[172:175], v[204:207]
    ds_read_b64_tr_b16 a[70:71], v66 offset:32776
    v_mfma_f32_16x16x32_bf16 v[236:239], a[108:111], a[176:179], v[236:239]
    buffer_load_dwordx4 v38, s[16:19], s38 offen offset:2048 lds
    v_mfma_f32_16x16x32_bf16 v[144:147], a[112:115], a[164:167], v[144:147]
    ds_read_b64_tr_b16 a[72:73], v67 offset:31744
    v_mfma_f32_16x16x32_bf16 v[176:179], a[112:115], a[168:171], v[176:179]
    ds_read_b64_tr_b16 a[74:75], v67 offset:32768
    v_mfma_f32_16x16x32_bf16 v[208:211], a[112:115], a[172:175], v[208:211]
    ds_read_b64_tr_b16 a[76:77], v67 offset:31752
    v_mfma_f32_16x16x32_bf16 v[240:243], a[112:115], a[176:179], v[240:243]
    ds_read_b64_tr_b16 a[78:79], v67 offset:32776
    v_mfma_f32_16x16x32_bf16 v[148:151], a[116:119], a[164:167], v[148:151]
    buffer_load_dwordx4 v39, s[16:19], s38 offen offset:3072 lds
    v_mfma_f32_16x16x32_bf16 v[180:183], a[116:119], a[168:171], v[180:183]
    ds_read_b64_tr_b16 a[80:81], v68 offset:31744
    v_mfma_f32_16x16x32_bf16 v[212:215], a[116:119], a[172:175], v[212:215]
    ds_read_b64_tr_b16 a[82:83], v68 offset:32768
    v_mfma_f32_16x16x32_bf16 v[244:247], a[116:119], a[176:179], v[244:247]
    ds_read_b64_tr_b16 a[84:85], v68 offset:31752
    v_mfma_f32_16x16x32_bf16 v[152:155], a[120:123], a[164:167], v[152:155]
    s_add_u32 m0, s31, 4096
    ds_read_b64_tr_b16 a[86:87], v68 offset:32776
    v_mfma_f32_16x16x32_bf16 v[184:187], a[120:123], a[168:171], v[184:187]
    buffer_load_dwordx4 v40, s[16:19], s38 offen offset:0 lds
    v_mfma_f32_16x16x32_bf16 v[216:219], a[120:123], a[172:175], v[216:219]
    ds_read_b64_tr_b16 a[88:89], v69 offset:31744
    v_mfma_f32_16x16x32_bf16 v[248:251], a[120:123], a[176:179], v[248:251]
    ds_read_b64_tr_b16 a[90:91], v69 offset:32768
    v_mfma_f32_16x16x32_bf16 v[156:159], a[124:127], a[164:167], v[156:159]
    ds_read_b64_tr_b16 a[92:93], v69 offset:31752
    v_mfma_f32_16x16x32_bf16 v[188:191], a[124:127], a[168:171], v[188:191]
    ds_read_b64_tr_b16 a[94:95], v69 offset:32776
    v_mfma_f32_16x16x32_bf16 v[220:223], a[124:127], a[172:175], v[220:223]
    buffer_load_dwordx4 v41, s[16:19], s38 offen offset:1024 lds
    v_mfma_f32_16x16x32_bf16 v[252:255], a[124:127], a[176:179], v[252:255]
    s_waitcnt lgkmcnt(10)
    ds_read_b64_tr_b16 a[96:97], v66 offset:39968
    v_mfma_f32_16x16x32_bf16 v[128:131], a[64:67], a[148:151], v[128:131]
    ds_read_b64_tr_b16 a[98:99], v66 offset:40992
    v_mfma_f32_16x16x32_bf16 v[160:163], a[64:67], a[152:155], v[160:163]
    ds_read_b64_tr_b16 a[100:101], v66 offset:39976
    v_mfma_f32_16x16x32_bf16 v[192:195], a[64:67], a[156:159], v[192:195]
    ds_read_b64_tr_b16 a[102:103], v66 offset:41000
    v_mfma_f32_16x16x32_bf16 v[224:227], a[64:67], a[160:163], v[224:227]
    buffer_load_dwordx4 v42, s[16:19], s38 offen offset:2048 lds
    v_mfma_f32_16x16x32_bf16 v[132:135], a[68:71], a[148:151], v[132:135]
    ds_read_b128 a[164:167], v65 offset:0
    v_mfma_f32_16x16x32_bf16 v[164:167], a[68:71], a[152:155], v[164:167]
    ds_read_b128 a[168:171], v65 offset:2048
    v_mfma_f32_16x16x32_bf16 v[196:199], a[68:71], a[156:159], v[196:199]
    ds_read_b128 a[172:175], v65 offset:4096
    v_mfma_f32_16x16x32_bf16 v[228:231], a[68:71], a[160:163], v[228:231]
    ds_read_b128 a[176:179], v65 offset:6144
    v_mfma_f32_16x16x32_bf16 v[136:139], a[72:75], a[148:151], v[136:139]
    buffer_load_dwordx4 v43, s[16:19], s38 offen offset:3072 lds
    v_mfma_f32_16x16x32_bf16 v[168:171], a[72:75], a[152:155], v[168:171]
    ds_read_b64_tr_b16 a[104:105], v67 offset:39968
    v_mfma_f32_16x16x32_bf16 v[200:203], a[72:75], a[156:159], v[200:203]
    ds_read_b64_tr_b16 a[106:107], v67 offset:40992
    v_mfma_f32_16x16x32_bf16 v[232:235], a[72:75], a[160:163], v[232:235]
    s_waitcnt lgkmcnt(10)
    ds_read_b64_tr_b16 a[108:109], v67 offset:39976
    v_mfma_f32_16x16x32_bf16 v[140:143], a[76:79], a[148:151], v[140:143]
    s_add_u32 m0, s32, 31744
    ds_read_b64_tr_b16 a[110:111], v67 offset:41000
    v_mfma_f32_16x16x32_bf16 v[172:175], a[76:79], a[152:155], v[172:175]
    buffer_load_dwordx4 v44, s[20:23], s39 offen offset:0 lds
    v_mfma_f32_16x16x32_bf16 v[204:207], a[76:79], a[156:159], v[204:207]
    ds_read_b64_tr_b16 a[112:113], v68 offset:39968
    v_mfma_f32_16x16x32_bf16 v[236:239], a[76:79], a[160:163], v[236:239]
    ds_read_b64_tr_b16 a[114:115], v68 offset:40992
    v_mfma_f32_16x16x32_bf16 v[144:147], a[80:83], a[148:151], v[144:147]
    ds_read_b64_tr_b16 a[116:117], v68 offset:39976
    v_mfma_f32_16x16x32_bf16 v[176:179], a[80:83], a[152:155], v[176:179]
    ds_read_b64_tr_b16 a[118:119], v68 offset:41000
    v_mfma_f32_16x16x32_bf16 v[208:211], a[80:83], a[156:159], v[208:211]
    buffer_load_dwordx4 v45, s[20:23], s39 offen offset:1024 lds
    v_mfma_f32_16x16x32_bf16 v[240:243], a[80:83], a[160:163], v[240:243]
    ds_read_b64_tr_b16 a[120:121], v69 offset:39968
    v_mfma_f32_16x16x32_bf16 v[148:151], a[84:87], a[148:151], v[148:151]
    ds_read_b64_tr_b16 a[122:123], v69 offset:40992
    v_mfma_f32_16x16x32_bf16 v[180:183], a[84:87], a[152:155], v[180:183]
    ds_read_b64_tr_b16 a[124:125], v69 offset:39976
    v_mfma_f32_16x16x32_bf16 v[212:215], a[84:87], a[156:159], v[212:215]
    ds_read_b64_tr_b16 a[126:127], v69 offset:41000
    v_mfma_f32_16x16x32_bf16 v[244:247], a[84:87], a[160:163], v[244:247]
    buffer_load_dwordx4 v46, s[20:23], s39 offen offset:2056 lds
    v_mfma_f32_16x16x32_bf16 v[152:155], a[88:91], a[148:151], v[152:155]
    v_mfma_f32_16x16x32_bf16 v[184:187], a[88:91], a[152:155], v[184:187]
    v_mfma_f32_16x16x32_bf16 v[216:219], a[88:91], a[156:159], v[216:219]
    v_mfma_f32_16x16x32_bf16 v[248:251], a[88:91], a[160:163], v[248:251]
    v_mfma_f32_16x16x32_bf16 v[156:159], a[92:95], a[148:151], v[156:159]
    buffer_load_dwordx4 v47, s[20:23], s39 offen offset:3080 lds
    v_mfma_f32_16x16x32_bf16 v[188:191], a[92:95], a[152:155], v[188:191]
    v_mfma_f32_16x16x32_bf16 v[220:223], a[92:95], a[156:159], v[220:223]
    v_mfma_f32_16x16x32_bf16 v[252:255], a[92:95], a[160:163], v[252:255]
    s_waitcnt lgkmcnt(10)
    v_mfma_f32_16x16x32_bf16 v[128:131], a[96:99], a[164:167], v[128:131]
    v_mfma_f32_16x16x32_bf16 v[160:163], a[96:99], a[168:171], v[160:163]
    v_add_u32 v64, 49152, v64
    v_add_u32 v65, 49152, v65
    v_mfma_f32_16x16x32_bf16 v[192:195], a[96:99], a[172:175], v[192:195]
    v_add_u32 v66, 49152, v66
    v_add_u32 v67, 49152, v67
    v_mfma_f32_16x16x32_bf16 v[224:227], a[96:99], a[176:179], v[224:227]
    v_add_u32 v68, 49152, v68
    v_add_u32 v69, 49152, v69
    v_mfma_f32_16x16x32_bf16 v[132:135], a[100:103], a[164:167], v[132:135]
    s_waitcnt vmcnt(12) lgkmcnt(0)
    s_barrier
    v_mfma_f32_16x16x32_bf16 v[164:167], a[100:103], a[168:171], v[164:167]
    s_lshl_b32 s38, s81, 7
    s_lshl_b32 s39, s81, 19
    ds_read_b128 a[148:151], v64 offset:0
    v_mfma_f32_16x16x32_bf16 v[196:199], a[100:103], a[172:175], v[196:199]
    s_add_u32 s81, s81, 1
    s_cmp_eq_u32 s81, 10
    ds_read_b128 a[152:155], v64 offset:2048
    v_mfma_f32_16x16x32_bf16 v[228:231], a[100:103], a[176:179], v[228:231]
    s_cselect_b32 s81, 0, s81
    s_add_u32 m0, s31, 49152
    ds_read_b128 a[156:159], v64 offset:4096
    v_mfma_f32_16x16x32_bf16 v[136:139], a[104:107], a[164:167], v[136:139]
    buffer_load_dwordx4 v36, s[16:19], s38 offen offset:0 lds
    v_mfma_f32_16x16x32_bf16 v[168:171], a[104:107], a[168:171], v[168:171]
    ds_read_b128 a[160:163], v64 offset:6144
    v_mfma_f32_16x16x32_bf16 v[200:203], a[104:107], a[172:175], v[200:203]
    buffer_load_dwordx4 v37, s[16:19], s38 offen offset:1024 lds
    v_mfma_f32_16x16x32_bf16 v[232:235], a[104:107], a[176:179], v[232:235]
    ds_read_b64_tr_b16 a[64:65], v66 offset:31744
    v_mfma_f32_16x16x32_bf16 v[140:143], a[108:111], a[164:167], v[140:143]
    ds_read_b64_tr_b16 a[66:67], v66 offset:32768
    v_mfma_f32_16x16x32_bf16 v[172:175], a[108:111], a[168:171], v[172:175]
    ds_read_b64_tr_b16 a[68:69], v66 offset:31752
    v_mfma_f32_16x16x32_bf16 v[204:207], a[108:111], a[172:175], v[204:207]
    ds_read_b64_tr_b16 a[70:71], v66 offset:32776
    v_mfma_f32_16x16x32_bf16 v[236:239], a[108:111], a[176:179], v[236:239]
    buffer_load_dwordx4 v38, s[16:19], s38 offen offset:2048 lds
    v_mfma_f32_16x16x32_bf16 v[144:147], a[112:115], a[164:167], v[144:147]
    ds_read_b64_tr_b16 a[72:73], v67 offset:31744
    v_mfma_f32_16x16x32_bf16 v[176:179], a[112:115], a[168:171], v[176:179]
    ds_read_b64_tr_b16 a[74:75], v67 offset:32768
    v_mfma_f32_16x16x32_bf16 v[208:211], a[112:115], a[172:175], v[208:211]
    ds_read_b64_tr_b16 a[76:77], v67 offset:31752
    v_mfma_f32_16x16x32_bf16 v[240:243], a[112:115], a[176:179], v[240:243]
    ds_read_b64_tr_b16 a[78:79], v67 offset:32776
    v_mfma_f32_16x16x32_bf16 v[148:151], a[116:119], a[164:167], v[148:151]
    buffer_load_dwordx4 v39, s[16:19], s38 offen offset:3072 lds
    v_mfma_f32_16x16x32_bf16 v[180:183], a[116:119], a[168:171], v[180:183]
    ds_read_b64_tr_b16 a[80:81], v68 offset:31744
    v_mfma_f32_16x16x32_bf16 v[212:215], a[116:119], a[172:175], v[212:215]
    ds_read_b64_tr_b16 a[82:83], v68 offset:32768
    v_mfma_f32_16x16x32_bf16 v[244:247], a[116:119], a[176:179], v[244:247]
    ds_read_b64_tr_b16 a[84:85], v68 offset:31752
    v_mfma_f32_16x16x32_bf16 v[152:155], a[120:123], a[164:167], v[152:155]
    s_add_u32 m0, s31, 53248
    ds_read_b64_tr_b16 a[86:87], v68 offset:32776
    v_mfma_f32_16x16x32_bf16 v[184:187], a[120:123], a[168:171], v[184:187]
    buffer_load_dwordx4 v40, s[16:19], s38 offen offset:0 lds
    v_mfma_f32_16x16x32_bf16 v[216:219], a[120:123], a[172:175], v[216:219]
    ds_read_b64_tr_b16 a[88:89], v69 offset:31744
    v_mfma_f32_16x16x32_bf16 v[248:251], a[120:123], a[176:179], v[248:251]
    ds_read_b64_tr_b16 a[90:91], v69 offset:32768
    v_mfma_f32_16x16x32_bf16 v[156:159], a[124:127], a[164:167], v[156:159]
    ds_read_b64_tr_b16 a[92:93], v69 offset:31752
    v_mfma_f32_16x16x32_bf16 v[188:191], a[124:127], a[168:171], v[188:191]
    ds_read_b64_tr_b16 a[94:95], v69 offset:32776
    v_mfma_f32_16x16x32_bf16 v[220:223], a[124:127], a[172:175], v[220:223]
    buffer_load_dwordx4 v41, s[16:19], s38 offen offset:1024 lds
    v_mfma_f32_16x16x32_bf16 v[252:255], a[124:127], a[176:179], v[252:255]
    s_waitcnt lgkmcnt(10)
    ds_read_b64_tr_b16 a[96:97], v66 offset:39968
    v_mfma_f32_16x16x32_bf16 v[128:131], a[64:67], a[148:151], v[128:131]
    ds_read_b64_tr_b16 a[98:99], v66 offset:40992
    v_mfma_f32_16x16x32_bf16 v[160:163], a[64:67], a[152:155], v[160:163]
    ds_read_b64_tr_b16 a[100:101], v66 offset:39976
    v_mfma_f32_16x16x32_bf16 v[192:195], a[64:67], a[156:159], v[192:195]
    ds_read_b64_tr_b16 a[102:103], v66 offset:41000
    v_mfma_f32_16x16x32_bf16 v[224:227], a[64:67], a[160:163], v[224:227]
    buffer_load_dwordx4 v42, s[16:19], s38 offen offset:2048 lds
    v_mfma_f32_16x16x32_bf16 v[132:135], a[68:71], a[148:151], v[132:135]
    ds_read_b128 a[164:167], v65 offset:0
    v_mfma_f32_16x16x32_bf16 v[164:167], a[68:71], a[152:155], v[164:167]
    ds_read_b128 a[168:171], v65 offset:2048
    v_mfma_f32_16x16x32_bf16 v[196:199], a[68:71], a[156:159], v[196:199]
    ds_read_b128 a[172:175], v65 offset:4096
    v_mfma_f32_16x16x32_bf16 v[228:231], a[68:71], a[160:163], v[228:231]
    ds_read_b128 a[176:179], v65 offset:6144
    v_mfma_f32_16x16x32_bf16 v[136:139], a[72:75], a[148:151], v[136:139]
    buffer_load_dwordx4 v43, s[16:19], s38 offen offset:3072 lds
    v_mfma_f32_16x16x32_bf16 v[168:171], a[72:75], a[152:155], v[168:171]
    ds_read_b64_tr_b16 a[104:105], v67 offset:39968
    v_mfma_f32_16x16x32_bf16 v[200:203], a[72:75], a[156:159], v[200:203]
    ds_read_b64_tr_b16 a[106:107], v67 offset:40992
    v_mfma_f32_16x16x32_bf16 v[232:235], a[72:75], a[160:163], v[232:235]
    s_waitcnt lgkmcnt(10)
    ds_read_b64_tr_b16 a[108:109], v67 offset:39976
    v_mfma_f32_16x16x32_bf16 v[140:143], a[76:79], a[148:151], v[140:143]
    s_add_u32 m0, s32, 80896
    ds_read_b64_tr_b16 a[110:111], v67 offset:41000
    v_mfma_f32_16x16x32_bf16 v[172:175], a[76:79], a[152:155], v[172:175]
    buffer_load_dwordx4 v44, s[20:23], s39 offen offset:0 lds
    v_mfma_f32_16x16x32_bf16 v[204:207], a[76:79], a[156:159], v[204:207]
    ds_read_b64_tr_b16 a[112:113], v68 offset:39968
    v_mfma_f32_16x16x32_bf16 v[236:239], a[76:79], a[160:163], v[236:239]
    ds_read_b64_tr_b16 a[114:115], v68 offset:40992
    v_mfma_f32_16x16x32_bf16 v[144:147], a[80:83], a[148:151], v[144:147]
    ds_read_b64_tr_b16 a[116:117], v68 offset:39976
    v_mfma_f32_16x16x32_bf16 v[176:179], a[80:83], a[152:155], v[176:179]
    ds_read_b64_tr_b16 a[118:119], v68 offset:41000
    v_mfma_f32_16x16x32_bf16 v[208:211], a[80:83], a[156:159], v[208:211]
    buffer_load_dwordx4 v45, s[20:23], s39 offen offset:1024 lds
    v_mfma_f32_16x16x32_bf16 v[240:243], a[80:83], a[160:163], v[240:243]
    ds_read_b64_tr_b16 a[120:121], v69 offset:39968
    v_mfma_f32_16x16x32_bf16 v[148:151], a[84:87], a[148:151], v[148:151]
    ds_read_b64_tr_b16 a[122:123], v69 offset:40992
    v_mfma_f32_16x16x32_bf16 v[180:183], a[84:87], a[152:155], v[180:183]
    ds_read_b64_tr_b16 a[124:125], v69 offset:39976
    v_mfma_f32_16x16x32_bf16 v[212:215], a[84:87], a[156:159], v[212:215]
    ds_read_b64_tr_b16 a[126:127], v69 offset:41000
    v_mfma_f32_16x16x32_bf16 v[244:247], a[84:87], a[160:163], v[244:247]
    buffer_load_dwordx4 v46, s[20:23], s39 offen offset:2056 lds
    v_mfma_f32_16x16x32_bf16 v[152:155], a[88:91], a[148:151], v[152:155]
    v_mfma_f32_16x16x32_bf16 v[184:187], a[88:91], a[152:155], v[184:187]
    v_mfma_f32_16x16x32_bf16 v[216:219], a[88:91], a[156:159], v[216:219]
    v_mfma_f32_16x16x32_bf16 v[248:251], a[88:91], a[160:163], v[248:251]
    v_mfma_f32_16x16x32_bf16 v[156:159], a[92:95], a[148:151], v[156:159]
    buffer_load_dwordx4 v47, s[20:23], s39 offen offset:3080 lds
    v_mfma_f32_16x16x32_bf16 v[188:191], a[92:95], a[152:155], v[188:191]
    v_mfma_f32_16x16x32_bf16 v[220:223], a[92:95], a[156:159], v[220:223]
    v_mfma_f32_16x16x32_bf16 v[252:255], a[92:95], a[160:163], v[252:255]
    s_waitcnt lgkmcnt(10)
    v_mfma_f32_16x16x32_bf16 v[128:131], a[96:99], a[164:167], v[128:131]
    v_mfma_f32_16x16x32_bf16 v[160:163], a[96:99], a[168:171], v[160:163]
    v_subrev_u32 v64, 98304, v64
    v_subrev_u32 v65, 98304, v65
    v_mfma_f32_16x16x32_bf16 v[192:195], a[96:99], a[172:175], v[192:195]
    v_subrev_u32 v66, 98304, v66
    v_subrev_u32 v67, 98304, v67
    v_mfma_f32_16x16x32_bf16 v[224:227], a[96:99], a[176:179], v[224:227]
    v_subrev_u32 v68, 98304, v68
    v_subrev_u32 v69, 98304, v69
    v_mfma_f32_16x16x32_bf16 v[132:135], a[100:103], a[164:167], v[132:135]
    s_waitcnt vmcnt(12) lgkmcnt(0)
    s_barrier
    v_mfma_f32_16x16x32_bf16 v[164:167], a[100:103], a[168:171], v[164:167]
    s_add_u32 s33, s80, 16384
    ds_read_b128 a[148:151], v64 offset:0
    v_mfma_f32_16x16x32_bf16 v[196:199], a[100:103], a[172:175], v[196:199]
    s_and_b32 s33, s33, 0x7ffff
    s_add_u32 m0, s29, 0
    ds_read_b128 a[152:155], v64 offset:2048
    v_mfma_f32_16x16x32_bf16 v[228:231], a[100:103], a[176:179], v[228:231]
    buffer_load_dwordx4 v28, s[8:11], s33 offen offset:0 nt lds
    v_mfma_f32_16x16x32_bf16 v[136:139], a[104:107], a[164:167], v[136:139]
    ds_read_b128 a[156:159], v64 offset:4096
    v_mfma_f32_16x16x32_bf16 v[168:171], a[104:107], a[168:171], v[168:171]
    ds_read_b128 a[160:163], v64 offset:6144
    v_mfma_f32_16x16x32_bf16 v[200:203], a[104:107], a[172:175], v[200:203]
    ds_read_b64_tr_b16 a[64:65], v66 offset:31744
    v_mfma_f32_16x16x32_bf16 v[232:235], a[104:107], a[176:179], v[232:235]
    ds_read_b64_tr_b16 a[66:67], v66 offset:32768
    v_mfma_f32_16x16x32_bf16 v[140:143], a[108:111], a[164:167], v[140:143]
    ds_read_b64_tr_b16 a[68:69], v66 offset:31752
    v_mfma_f32_16x16x32_bf16 v[172:175], a[108:111], a[168:171], v[172:175]
    buffer_load_dwordx4 v29, s[8:11], s33 offen offset:1024 nt lds
    v_mfma_f32_16x16x32_bf16 v[204:207], a[108:111], a[172:175], v[204:207]
    ds_read_b64_tr_b16 a[70:71], v66 offset:32776
    v_mfma_f32_16x16x32_bf16 v[236:239], a[108:111], a[176:179], v[236:239]
    ds_read_b64_tr_b16 a[72:73], v67 offset:31744
    v_mfma_f32_16x16x32_bf16 v[144:147], a[112:115], a[164:167], v[144:147]
    ds_read_b64_tr_b16 a[74:75], v67 offset:32768
    v_mfma_f32_16x16x32_bf16 v[176:179], a[112:115], a[168:171], v[176:179]
    ds_read_b64_tr_b16 a[76:77], v67 offset:31752
    v_mfma_f32_16x16x32_bf16 v[208:211], a[112:115], a[172:175], v[208:211]
    ds_read_b64_tr_b16 a[78:79], v67 offset:32776
    v_mfma_f32_16x16x32_bf16 v[240:243], a[112:115], a[176:179], v[240:243]
    ds_read_b64_tr_b16 a[80:81], v68 offset:31744
    v_mfma_f32_16x16x32_bf16 v[148:151], a[116:119], a[164:167], v[148:151]
    buffer_load_dwordx4 v30, s[8:11], s33 offen offset:2048 nt lds
    v_mfma_f32_16x16x32_bf16 v[180:183], a[116:119], a[168:171], v[180:183]
    ds_read_b64_tr_b16 a[82:83], v68 offset:32768
    v_mfma_f32_16x16x32_bf16 v[212:215], a[116:119], a[172:175], v[212:215]
    ds_read_b64_tr_b16 a[84:85], v68 offset:31752
    v_mfma_f32_16x16x32_bf16 v[244:247], a[116:119], a[176:179], v[244:247]
    ds_read_b64_tr_b16 a[86:87], v68 offset:32776
    v_mfma_f32_16x16x32_bf16 v[152:155], a[120:123], a[164:167], v[152:155]
    ds_read_b64_tr_b16 a[88:89], v69 offset:31744
    v_mfma_f32_16x16x32_bf16 v[184:187], a[120:123], a[168:171], v[184:187]
    ds_read_b64_tr_b16 a[90:91], v69 offset:32768
    v_mfma_f32_16x16x32_bf16 v[216:219], a[120:123], a[172:175], v[216:219]
    ds_read_b64_tr_b16 a[92:93], v69 offset:31752
    v_mfma_f32_16x16x32_bf16 v[248:251], a[120:123], a[176:179], v[248:251]
    ds_read_b64_tr_b16 a[94:95], v69 offset:32776
    v_mfma_f32_16x16x32_bf16 v[156:159], a[124:127], a[164:167], v[156:159]
    buffer_load_dwordx4 v31, s[8:11], s33 offen offset:3072 nt lds
    v_mfma_f32_16x16x32_bf16 v[188:191], a[124:127], a[168:171], v[188:191]
    ds_read_b64_tr_b16 a[96:97], v66 offset:39968
    v_mfma_f32_16x16x32_bf16 v[220:223], a[124:127], a[172:175], v[220:223]
    ds_read_b64_tr_b16 a[98:99], v66 offset:40992
    v_mfma_f32_16x16x32_bf16 v[252:255], a[124:127], a[176:179], v[252:255]
    s_waitcnt lgkmcnt(10)
    ds_read_b64_tr_b16 a[100:101], v66 offset:39976
    v_mfma_f32_16x16x32_bf16 v[128:131], a[64:67], a[148:151], v[128:131]
    ds_read_b64_tr_b16 a[102:103], v66 offset:41000
    v_mfma_f32_16x16x32_bf16 v[160:163], a[64:67], a[152:155], v[160:163]
    s_add_u32 s33, s80, 32768
    ds_read_b128 a[164:167], v65 offset:0
    v_mfma_f32_16x16x32_bf16 v[192:195], a[64:67], a[156:159], v[192:195]
    s_and_b32 s33, s33, 0x7ffff
    s_add_u32 m0, s29, 16384
    ds_read_b128 a[168:171], v65 offset:2048
    v_mfma_f32_16x16x32_bf16 v[224:227], a[64:67], a[160:163], v[224:227]
    buffer_load_dwordx4 v28, s[8:11], s33 offen offset:0 nt lds
    v_mfma_f32_16x16x32_bf16 v[132:135], a[68:71], a[148:151], v[132:135]
    ds_read_b128 a[172:175], v65 offset:4096
    v_mfma_f32_16x16x32_bf16 v[164:167], a[68:71], a[152:155], v[164:167]
    ds_read_b128 a[176:179], v65 offset:6144
    v_mfma_f32_16x16x32_bf16 v[196:199], a[68:71], a[156:159], v[196:199]
    ds_read_b64_tr_b16 a[104:105], v67 offset:39968
    v_mfma_f32_16x16x32_bf16 v[228:231], a[68:71], a[160:163], v[228:231]
    ds_read_b64_tr_b16 a[106:107], v67 offset:40992
    v_mfma_f32_16x16x32_bf16 v[136:139], a[72:75], a[148:151], v[136:139]
    ds_read_b64_tr_b16 a[108:109], v67 offset:39976
    v_mfma_f32_16x16x32_bf16 v[168:171], a[72:75], a[152:155], v[168:171]
    ds_read_b64_tr_b16 a[110:111], v67 offset:41000
    v_mfma_f32_16x16x32_bf16 v[200:203], a[72:75], a[156:159], v[200:203]
    buffer_load_dwordx4 v29, s[8:11], s33 offen offset:1024 nt lds
    v_mfma_f32_16x16x32_bf16 v[232:235], a[72:75], a[160:163], v[232:235]
    ds_read_b64_tr_b16 a[112:113], v68 offset:39968
    v_mfma_f32_16x16x32_bf16 v[140:143], a[76:79], a[148:151], v[140:143]
    ds_read_b64_tr_b16 a[114:115], v68 offset:40992
    v_mfma_f32_16x16x32_bf16 v[172:175], a[76:79], a[152:155], v[172:175]
    ds_read_b64_tr_b16 a[116:117], v68 offset:39976
    v_mfma_f32_16x16x32_bf16 v[204:207], a[76:79], a[156:159], v[204:207]
    ds_read_b64_tr_b16 a[118:119], v68 offset:41000
    v_mfma_f32_16x16x32_bf16 v[236:239], a[76:79], a[160:163], v[236:239]
    s_waitcnt lgkmcnt(10)
    ds_read_b64_tr_b16 a[120:121], v69 offset:39968
    v_mfma_f32_16x16x32_bf16 v[144:147], a[80:83], a[148:151], v[144:147]
    ds_read_b64_tr_b16 a[122:123], v69 offset:40992
    v_mfma_f32_16x16x32_bf16 v[176:179], a[80:83], a[152:155], v[176:179]
    ds_read_b64_tr_b16 a[124:125], v69 offset:39976
    v_mfma_f32_16x16x32_bf16 v[208:211], a[80:83], a[156:159], v[208:211]
    buffer_load_dwordx4 v30, s[8:11], s33 offen offset:2048 nt lds
    v_mfma_f32_16x16x32_bf16 v[240:243], a[80:83], a[160:163], v[240:243]
    ds_read_b64_tr_b16 a[126:127], v69 offset:41000
    v_mfma_f32_16x16x32_bf16 v[148:151], a[84:87], a[148:151], v[148:151]
    ds_read_b128 a[180:183], v16 offset:49152
    v_mfma_f32_16x16x32_bf16 v[180:183], a[84:87], a[152:155], v[180:183]
    ds_read_b128 a[184:187], v17 offset:49152
    v_mfma_f32_16x16x32_bf16 v[212:215], a[84:87], a[156:159], v[212:215]
    ds_read_b128 a[188:191], v18 offset:49152
    v_mfma_f32_16x16x32_bf16 v[244:247], a[84:87], a[160:163], v[244:247]
    ds_read_b128 a[192:195], v19 offset:49152
    v_mfma_f32_16x16x32_bf16 v[152:155], a[88:91], a[148:151], v[152:155]
    ds_read_b128 a[196:199], v16 offset:53248
    v_mfma_f32_16x16x32_bf16 v[184:187], a[88:91], a[152:155], v[184:187]
    buffer_load_dwordx4 v31, s[8:11], s33 offen offset:3072 nt lds
    v_mfma_f32_16x16x32_bf16 v[216:219], a[88:91], a[156:159], v[216:219]
    ds_read_b128 a[200:203], v17 offset:53248
    v_mfma_f32_16x16x32_bf16 v[248:251], a[88:91], a[160:163], v[248:251]
    ds_read_b128 a[204:207], v18 offset:53248
    v_mfma_f32_16x16x32_bf16 v[156:159], a[92:95], a[148:151], v[156:159]
    ds_read_b128 a[208:211], v19 offset:53248
    v_mfma_f32_16x16x32_bf16 v[188:191], a[92:95], a[152:155], v[188:191]
    v_mfma_f32_16x16x32_bf16 v[220:223], a[92:95], a[156:159], v[220:223]
    v_mfma_f32_16x16x32_bf16 v[252:255], a[92:95], a[160:163], v[252:255]
    s_waitcnt lgkmcnt(10)
    v_mfma_f32_16x16x32_bf16 v[128:131], a[96:99], a[164:167], v[128:131]
    v_mfma_f32_16x16x32_bf16 v[160:163], a[96:99], a[168:171], v[160:163]
    v_add_u32 v64, 49152, v64
    v_add_u32 v65, 49152, v65
    v_mfma_f32_16x16x32_bf16 v[192:195], a[96:99], a[172:175], v[192:195]
    v_add_u32 v66, 49152, v66
    v_add_u32 v67, 49152, v67
    v_mfma_f32_16x16x32_bf16 v[224:227], a[96:99], a[176:179], v[224:227]
    v_add_u32 v68, 49152, v68
    v_add_u32 v69, 49152, v69
    v_mfma_f32_16x16x32_bf16 v[132:135], a[100:103], a[164:167], v[132:135]
    s_waitcnt vmcnt(8) lgkmcnt(0)
    s_barrier
    v_mfma_f32_16x16x32_bf16 v[164:167], a[100:103], a[168:171], v[164:167]
    s_add_u32 s34, s80, 0
    ds_read_b128 a[148:151], v64 offset:0
    v_mfma_f32_16x16x32_bf16 v[196:199], a[100:103], a[172:175], v[196:199]
    s_and_b32 s34, s34, 0x7ffff
    s_add_u32 m0, s30, 0
    ds_read_b128 a[152:155], v64 offset:2048
    v_lshlrev_b32 v8, 1, v4
    v_mfma_f32_16x16x32_bf16 v[228:231], a[100:103], a[176:179], v[228:231]
    buffer_load_dwordx4 v32, s[12:15], s34 offen offset:0 nt lds
    v_mfma_f32_16x16x32_bf16 v[136:139], a[104:107], a[164:167], v[136:139]
    ds_read_b128 a[156:159], v64 offset:4096
    v_xor_b32 v8, v8, v7
    v_mfma_f32_16x16x32_bf16 v[168:171], a[104:107], a[168:171], v[168:171]
    ds_read_b128 a[160:163], v64 offset:6144
    v_mul_u32_u24 v9, 1280, v6
    v_mfma_f32_16x16x32_bf16 v[200:203], a[104:107], a[172:175], v[200:203]
    ds_read_b64_tr_b16 a[64:65], v66 offset:31744
    v_lshl_add_u32 v8, v8, 4, v9
    v_mfma_f32_16x16x32_bf16 v[232:235], a[104:107], a[176:179], v[232:235]
    ds_read_b64_tr_b16 a[66:67], v66 offset:32768
    v_add_u32 v36, 0, v8
    v_mfma_f32_16x16x32_bf16 v[140:143], a[108:111], a[164:167], v[140:143]
    buffer_load_dwordx4 v33, s[12:15], s34 offen offset:1024 nt lds
    v_mfma_f32_16x16x32_bf16 v[172:175], a[108:111], a[168:171], v[172:175]
    ds_read_b64_tr_b16 a[68:69], v66 offset:31752
    v_add_u32 v37, 9216, v8
    v_mfma_f32_16x16x32_bf16 v[204:207], a[108:111], a[172:175], v[204:207]
    ds_read_b64_tr_b16 a[70:71], v66 offset:32776
    v_add_u32 v38, 18432, v8
    v_mfma_f32_16x16x32_bf16 v[236:239], a[108:111], a[176:179], v[236:239]
    ds_read_b64_tr_b16 a[72:73], v67 offset:31744
    v_add_u32 v39, 27648, v8
    v_mfma_f32_16x16x32_bf16 v[144:147], a[112:115], a[164:167], v[144:147]
    ds_read_b64_tr_b16 a[74:75], v67 offset:32768
    v_lshrrev_b32 v12, 2, v3
    v_mfma_f32_16x16x32_bf16 v[176:179], a[112:115], a[168:171], v[176:179]
    ds_read_b64_tr_b16 a[76:77], v67 offset:31752
    v_lshlrev_b32 v12, 7, v12
    v_mfma_f32_16x16x32_bf16 v[208:211], a[112:115], a[172:175], v[208:211]
    ds_read_b64_tr_b16 a[78:79], v67 offset:32776
    v_and_b32 v15, 3, v3
    v_mfma_f32_16x16x32_bf16 v[240:243], a[112:115], a[176:179], v[240:243]
    buffer_load_dwordx4 v34, s[12:15], s34 offen offset:2048 nt lds
    v_mfma_f32_16x16x32_bf16 v[148:151], a[116:119], a[164:167], v[148:151]
    ds_read_b64_tr_b16 a[80:81], v68 offset:31744
    v_lshl_add_u32 v12, v15, 3, v12
    v_mfma_f32_16x16x32_bf16 v[180:183], a[116:119], a[168:171], v[180:183]
    ds_read_b64_tr_b16 a[82:83], v68 offset:32768
    v_add_u32 v12, s30, v12
    v_mfma_f32_16x16x32_bf16 v[212:215], a[116:119], a[172:175], v[212:215]
    ds_read_b64_tr_b16 a[84:85], v68 offset:31752
    v_bfe_u32 v15, v3, 3, 2
    v_mfma_f32_16x16x32_bf16 v[244:247], a[116:119], a[176:179], v[244:247]
    ds_read_b64_tr_b16 a[86:87], v68 offset:32776
    v_xor_b32 v40, 0, v15
    v_mfma_f32_16x16x32_bf16 v[152:155], a[120:123], a[164:167], v[152:155]
    ds_read_b64_tr_b16 a[88:89], v69 offset:31744
    v_lshl_add_u32 v40, v40, 5, v12
    v_mfma_f32_16x16x32_bf16 v[184:187], a[120:123], a[168:171], v[184:187]
    ds_read_b64_tr_b16 a[90:91], v69 offset:32768
    v_add_u32 v44, 0x10000, v40
    v_mfma_f32_16x16x32_bf16 v[216:219], a[120:123], a[172:175], v[216:219]
    buffer_load_dwordx4 v35, s[12:15], s34 offen offset:3072 nt lds
    v_mfma_f32_16x16x32_bf16 v[248:251], a[120:123], a[176:179], v[248:251]
    ds_read_b64_tr_b16 a[92:93], v69 offset:31752
    v_add_u32 v8, 0x20000, v40
    v_mfma_f32_16x16x32_bf16 v[156:159], a[124:127], a[164:167], v[156:159]
    ds_read_b64_tr_b16 a[94:95], v69 offset:32776
    v_xor_b32 v41, 1, v15
    v_mfma_f32_16x16x32_bf16 v[188:191], a[124:127], a[168:171], v[188:191]
    ds_read_b64_tr_b16 a[96:97], v66 offset:39968
    v_lshl_add_u32 v41, v41, 5, v12
    v_mfma_f32_16x16x32_bf16 v[220:223], a[124:127], a[172:175], v[220:223]
    ds_read_b64_tr_b16 a[98:99], v66 offset:40992
    v_add_u32 v45, 0x10000, v41
    v_mfma_f32_16x16x32_bf16 v[252:255], a[124:127], a[176:179], v[252:255]
    s_waitcnt lgkmcnt(10)
    s_add_u32 s34, s80, 16384
    ds_read_b64_tr_b16 a[100:101], v66 offset:39976
    v_add_u32 v9, 0x20000, v41
    v_mfma_f32_16x16x32_bf16 v[128:131], a[64:67], a[148:151], v[128:131]
    s_and_b32 s34, s34, 0x7ffff
    s_add_u32 m0, s30, 16384
    s_mov_b32 s81, s5
    ds_read_b64_tr_b16 a[102:103], v66 offset:41000
    v_xor_b32 v42, 2, v15
    v_mfma_f32_16x16x32_bf16 v[160:163], a[64:67], a[152:155], v[160:163]
    s_lshr_b32 s4, s2, 3
    buffer_load_dwordx4 v32, s[12:15], s34 offen offset:0 nt lds
    v_mfma_f32_16x16x32_bf16 v[192:195], a[64:67], a[156:159], v[192:195]
    s_mul_i32 s4, s4, 52
    ds_read_b128 a[164:167], v65 offset:0
    v_lshl_add_u32 v42, v42, 5, v12
    v_mfma_f32_16x16x32_bf16 v[224:227], a[64:67], a[160:163], v[224:227]
    s_lshr_b32 s4, s4, 8
    ds_read_b128 a[168:171], v65 offset:2048
    v_add_u32 v46, 0x10000, v42
    v_mfma_f32_16x16x32_bf16 v[132:135], a[68:71], a[148:151], v[132:135]
    s_lshl_b32 s38, s4, 1
    ds_read_b128 a[172:175], v65 offset:4096
    v_add_u32 v10, 0x20000, v42
    v_mfma_f32_16x16x32_bf16 v[164:167], a[68:71], a[152:155], v[164:167]
    s_add_u32 s38, s38, s82
    ds_read_b128 a[176:179], v65 offset:6144
    v_xor_b32 v43, 3, v15
    v_mfma_f32_16x16x32_bf16 v[196:199], a[68:71], a[156:159], v[196:199]
    s_add_u32 s6, s38, 14
    ds_read_b64_tr_b16 a[104:105], v67 offset:39968
    v_lshl_add_u32 v43, v43, 5, v12
    v_mfma_f32_16x16x32_bf16 v[228:231], a[68:71], a[160:163], v[228:231]
    s_and_b32 s6, s6, 31
    buffer_load_dwordx4 v33, s[12:15], s34 offen offset:1024 nt lds
    v_mfma_f32_16x16x32_bf16 v[136:139], a[72:75], a[148:151], v[136:139]
    s_mul_i32 s6, s6, 40960
    ds_read_b64_tr_b16 a[106:107], v67 offset:40992
    v_add_u32 v47, 0x10000, v43
    v_mfma_f32_16x16x32_bf16 v[168:171], a[72:75], a[152:155], v[168:171]
    s_add_u32 s7, s38, 26
    ds_read_b64_tr_b16 a[108:109], v67 offset:39976
    v_add_u32 v11, 0x20000, v43
    v_mfma_f32_16x16x32_bf16 v[200:203], a[72:75], a[156:159], v[200:203]
    s_and_b32 s7, s7, 31
    ds_read_b64_tr_b16 a[110:111], v67 offset:41000
    v_mul_u32_u24 v14, 1280, v3
    v_mfma_f32_16x16x32_bf16 v[232:235], a[72:75], a[160:163], v[232:235]
    s_mul_i32 s7, s7, 40960
    ds_read_b64_tr_b16 a[112:113], v68 offset:39968
    v_accvgpr_write_b32 a128, 0
    v_mfma_f32_16x16x32_bf16 v[140:143], a[76:79], a[148:151], v[140:143]
    s_cmp_ge_u32 s4, 3
    s_cselect_b32 s7, 0x7f000000, s7
    ds_read_b64_tr_b16 a[114:115], v68 offset:40992
    v_accvgpr_write_b32 a129, 0
    v_mfma_f32_16x16x32_bf16 v[172:175], a[76:79], a[152:155], v[172:175]
    s_mul_i32 s38, s2, 20480
    ds_read_b64_tr_b16 a[116:117], v68 offset:39976
    v_accvgpr_write_b32 a130, 0
    v_mfma_f32_16x16x32_bf16 v[204:207], a[76:79], a[156:159], v[204:207]
    s_add_u32 s16, s92, s38
    s_addc_u32 s17, s93, 0
    buffer_load_dwordx4 v34, s[12:15], s34 offen offset:2048 nt lds
    v_mfma_f32_16x16x32_bf16 v[236:239], a[76:79], a[160:163], v[236:239]
    s_waitcnt lgkmcnt(10)
    s_mov_b32 s18, 20480
    ds_read_b64_tr_b16 a[118:119], v68 offset:41000
    v_accvgpr_write_b32 a131, 0
    v_mfma_f32_16x16x32_bf16 v[144:147], a[80:83], a[148:151], v[144:147]
    s_mov_b32 s39, 0x3e0293ee
    ds_read_b64_tr_b16 a[120:121], v69 offset:39968
    v_accvgpr_write_b32 a132, 0
    v_mfma_f32_16x16x32_bf16 v[176:179], a[80:83], a[152:155], v[176:179]
    s_mov_b32 s32, 0x07060302
    ds_read_b64_tr_b16 a[122:123], v69 offset:40992
    v_accvgpr_write_b32 a133, 0
    v_mfma_f32_16x16x32_bf16 v[208:211], a[80:83], a[156:159], v[208:211]
    ds_read_b64_tr_b16 a[124:125], v69 offset:39976
    v_accvgpr_write_b32 a134, 0
    v_mfma_f32_16x16x32_bf16 v[240:243], a[80:83], a[160:163], v[240:243]
    ds_read_b64_tr_b16 a[126:127], v69 offset:41000
    v_accvgpr_write_b32 a135, 0
    v_mfma_f32_16x16x32_bf16 v[148:151], a[84:87], a[148:151], v[148:151]
    v_accvgpr_write_b32 a136, 0
    v_mfma_f32_16x16x32_bf16 v[180:183], a[84:87], a[152:155], v[180:183]
    buffer_load_dwordx4 v35, s[12:15], s34 offen offset:3072 nt lds
    v_mfma_f32_16x16x32_bf16 v[212:215], a[84:87], a[156:159], v[212:215]
    v_accvgpr_write_b32 a137, 0
    v_mfma_f32_16x16x32_bf16 v[244:247], a[84:87], a[160:163], v[244:247]
    v_accvgpr_write_b32 a138, 0
    v_mfma_f32_16x16x32_bf16 v[152:155], a[88:91], a[148:151], v[152:155]
    v_accvgpr_write_b32 a139, 0
    v_mfma_f32_16x16x32_bf16 v[184:187], a[88:91], a[152:155], v[184:187]
    v_accvgpr_write_b32 a140, 0
    v_mfma_f32_16x16x32_bf16 v[216:219], a[88:91], a[156:159], v[216:219]
    v_accvgpr_write_b32 a141, 0
    v_mfma_f32_16x16x32_bf16 v[248:251], a[88:91], a[160:163], v[248:251]
    v_accvgpr_write_b32 a142, 0
    v_mfma_f32_16x16x32_bf16 v[156:159], a[92:95], a[148:151], v[156:159]
    v_accvgpr_write_b32 a143, 0
    v_mfma_f32_16x16x32_bf16 v[188:191], a[92:95], a[152:155], v[188:191]
    v_mfma_f32_16x16x32_bf16 v[220:223], a[92:95], a[156:159], v[220:223]
    v_mfma_f32_16x16x32_bf16 v[252:255], a[92:95], a[160:163], v[252:255]
    s_waitcnt lgkmcnt(0)
    v_mfma_f32_16x16x32_bf16 v[128:131], a[96:99], a[164:167], v[128:131]
    ds_read_b128 a[64:67], v16 offset:57344
    v_mfma_f32_16x16x32_bf16 v[132:135], a[100:103], a[164:167], v[132:135]
    ds_read_b128 a[68:71], v17 offset:57344
    v_mfma_f32_16x16x32_bf16 v[136:139], a[104:107], a[164:167], v[136:139]
    ds_read_b128 a[72:75], v18 offset:57344
    v_mfma_f32_16x16x32_bf16 v[140:143], a[108:111], a[164:167], v[140:143]
    ds_read_b128 a[76:79], v19 offset:57344
    v_mfma_f32_16x16x32_bf16 v[144:147], a[112:115], a[164:167], v[144:147]
    ds_read_b128 a[80:83], v16 offset:61440
    v_mfma_f32_16x16x32_bf16 v[148:151], a[116:119], a[164:167], v[148:151]
    ds_read_b128 a[84:87], v17 offset:61440
    v_mfma_f32_16x16x32_bf16 v[152:155], a[120:123], a[164:167], v[152:155]
    ds_read_b128 a[88:91], v18 offset:61440
    v_mfma_f32_16x16x32_bf16 v[156:159], a[124:127], a[164:167], v[156:159]
    ds_read_b128 a[92:95], v19 offset:61440
    v_mfma_f32_16x16x32_bf16 v[160:163], a[96:99], a[168:171], v[160:163]
    v_mul_f32 v128, s39, v128
    v_mul_f32 v129, s39, v129
    v_mfma_f32_16x16x32_bf16 v[164:167], a[100:103], a[168:171], v[164:167]
    v_mul_f32 v130, s39, v130
    v_mul_f32 v131, s39, v131
    v_mfma_f32_16x16x32_bf16 v[168:171], a[104:107], a[168:171], v[168:171]
    v_mul_f32 v132, s39, v132
    v_mul_f32 v133, s39, v133
    v_mfma_f32_16x16x32_bf16 v[172:175], a[108:111], a[168:171], v[172:175]
    v_mul_f32 v134, s39, v134
    v_mul_f32 v135, s39, v135
    v_mfma_f32_16x16x32_bf16 v[176:179], a[112:115], a[168:171], v[176:179]
    v_cvt_pk_bf16_f32 v128, v128, v129
    v_cvt_pk_bf16_f32 v129, v130, v131
    v_mfma_f32_16x16x32_bf16 v[180:183], a[116:119], a[168:171], v[180:183]
    v_cvt_pk_bf16_f32 v130, v132, v133
    v_cvt_pk_bf16_f32 v131, v134, v135
    v_mfma_f32_16x16x32_bf16 v[184:187], a[120:123], a[168:171], v[184:187]
    v_accvgpr_write_b32 a0, v128
    v_accvgpr_write_b32 a1, v129
    v_mfma_f32_16x16x32_bf16 v[188:191], a[124:127], a[168:171], v[188:191]
    v_accvgpr_write_b32 a2, v130
    v_accvgpr_write_b32 a3, v131
    v_mfma_f32_16x16x32_bf16 v[192:195], a[96:99], a[172:175], v[192:195]
    v_mul_f32 v136, s39, v136
    v_mul_f32 v137, s39, v137
    v_mfma_f32_16x16x32_bf16 v[196:199], a[100:103], a[172:175], v[196:199]
    v_mul_f32 v138, s39, v138
    v_mul_f32 v139, s39, v139
    v_mfma_f32_16x16x32_bf16 v[200:203], a[104:107], a[172:175], v[200:203]
    v_mul_f32 v140, s39, v140
    v_mul_f32 v141, s39, v141
    v_mfma_f32_16x16x32_bf16 v[204:207], a[108:111], a[172:175], v[204:207]
    v_mul_f32 v142, s39, v142
    v_mul_f32 v143, s39, v143
    v_mfma_f32_16x16x32_bf16 v[208:211], a[112:115], a[172:175], v[208:211]
    v_cvt_pk_bf16_f32 v136, v136, v137
    v_cvt_pk_bf16_f32 v137, v138, v139
    v_mfma_f32_16x16x32_bf16 v[212:215], a[116:119], a[172:175], v[212:215]
    v_cvt_pk_bf16_f32 v138, v140, v141
    v_cvt_pk_bf16_f32 v139, v142, v143
    v_mfma_f32_16x16x32_bf16 v[216:219], a[120:123], a[172:175], v[216:219]
    v_accvgpr_write_b32 a4, v136
    v_accvgpr_write_b32 a5, v137
    v_mfma_f32_16x16x32_bf16 v[220:223], a[124:127], a[172:175], v[220:223]
    v_accvgpr_write_b32 a6, v138
    v_accvgpr_write_b32 a7, v139
    v_mfma_f32_16x16x32_bf16 v[224:227], a[96:99], a[176:179], v[224:227]
    v_mul_f32 v144, s39, v144
    v_mul_f32 v145, s39, v145
    v_mfma_f32_16x16x32_bf16 v[228:231], a[100:103], a[176:179], v[228:231]
    v_mul_f32 v146, s39, v146
    v_mul_f32 v147, s39, v147
    v_mfma_f32_16x16x32_bf16 v[232:235], a[104:107], a[176:179], v[232:235]
    v_mul_f32 v148, s39, v148
    v_mul_f32 v149, s39, v149
    v_mfma_f32_16x16x32_bf16 v[236:239], a[108:111], a[176:179], v[236:239]
    v_mul_f32 v150, s39, v150
    v_mul_f32 v151, s39, v151
    v_mfma_f32_16x16x32_bf16 v[240:243], a[112:115], a[176:179], v[240:243]
    v_cvt_pk_bf16_f32 v144, v144, v145
    v_cvt_pk_bf16_f32 v145, v146, v147
    v_mfma_f32_16x16x32_bf16 v[244:247], a[116:119], a[176:179], v[244:247]
    v_cvt_pk_bf16_f32 v146, v148, v149
    v_cvt_pk_bf16_f32 v147, v150, v151
    v_mfma_f32_16x16x32_bf16 v[248:251], a[120:123], a[176:179], v[248:251]
    v_accvgpr_write_b32 a8, v144
    v_accvgpr_write_b32 a9, v145
    v_mfma_f32_16x16x32_bf16 v[252:255], a[124:127], a[176:179], v[252:255]
    v_accvgpr_write_b32 a10, v146
    v_accvgpr_write_b32 a11, v147
    v_mul_f32 v152, s39, v152
    v_mul_f32 v153, s39, v153
    v_mul_f32 v154, s39, v154
    v_mul_f32 v155, s39, v155
    v_mul_f32 v156, s39, v156
    v_mul_f32 v157, s39, v157
    v_mul_f32 v158, s39, v158
    v_mul_f32 v159, s39, v159
    v_cvt_pk_bf16_f32 v152, v152, v153
    v_cvt_pk_bf16_f32 v153, v154, v155
    v_cvt_pk_bf16_f32 v154, v156, v157
    v_cvt_pk_bf16_f32 v155, v158, v159
    v_accvgpr_write_b32 a12, v152
    v_accvgpr_write_b32 a13, v153
    v_accvgpr_write_b32 a14, v154
    v_accvgpr_write_b32 a15, v155
    v_mul_f32 v160, s39, v160
    v_mul_f32 v161, s39, v161
    v_mfma_f32_16x16x32_bf16 v[64:67], a[180:183], a[0:3], 0
    v_mul_f32 v162, s39, v162
    v_mul_f32 v163, s39, v163
    v_mfma_f32_16x16x32_bf16 v[64:67], a[184:187], a[4:7], v[64:67]
    v_mul_f32 v164, s39, v164
    v_mul_f32 v165, s39, v165
    v_mfma_f32_16x16x32_bf16 v[64:67], a[188:191], a[8:11], v[64:67]
    v_mul_f32 v166, s39, v166
    v_mul_f32 v167, s39, v167
    v_mfma_f32_16x16x32_bf16 v[64:67], a[192:195], a[12:15], v[64:67]
    v_cvt_pk_bf16_f32 v160, v160, v161
    v_cvt_pk_bf16_f32 v161, v162, v163
    v_mfma_f32_16x16x32_bf16 v[68:71], a[196:199], a[0:3], 0
    v_cvt_pk_bf16_f32 v162, v164, v165
    v_cvt_pk_bf16_f32 v163, v166, v167
    v_mfma_f32_16x16x32_bf16 v[68:71], a[200:203], a[4:7], v[68:71]
    v_accvgpr_write_b32 a16, v160
    v_accvgpr_write_b32 a17, v161
    v_mfma_f32_16x16x32_bf16 v[68:71], a[204:207], a[8:11], v[68:71]
    v_accvgpr_write_b32 a18, v162
    v_accvgpr_write_b32 a19, v163
    v_mfma_f32_16x16x32_bf16 v[68:71], a[208:211], a[12:15], v[68:71]
    v_mul_f32 v168, s39, v168
    v_mul_f32 v169, s39, v169
    v_mfma_f32_32x32x16_bf16 v[128:143], a[128:131], a[128:131], 0
    v_mul_f32 v170, s39, v170
    v_mul_f32 v171, s39, v171
    v_mfma_f32_32x32x16_bf16 v[144:159], a[128:131], a[128:131], 0
    v_mul_f32 v172, s39, v172
    v_mul_f32 v173, s39, v173
    v_mul_f32 v174, s39, v174
    v_mul_f32 v175, s39, v175
    v_cvt_pk_bf16_f32 v168, v168, v169
    v_cvt_pk_bf16_f32 v169, v170, v171
    v_cvt_pk_bf16_f32 v170, v172, v173
    v_cvt_pk_bf16_f32 v171, v174, v175
    v_accvgpr_write_b32 a20, v168
    v_accvgpr_write_b32 a21, v169
    v_accvgpr_write_b32 a22, v170
    v_accvgpr_write_b32 a23, v171
    v_mul_f32 v176, s39, v176
    v_mul_f32 v177, s39, v177
    v_mul_f32 v178, s39, v178
    v_mul_f32 v179, s39, v179
    v_mul_f32 v180, s39, v180
    v_mul_f32 v181, s39, v181
    v_mul_f32 v182, s39, v182
    v_mul_f32 v183, s39, v183
    v_cvt_pk_bf16_f32 v176, v176, v177
    v_cvt_pk_bf16_f32 v177, v178, v179
    v_cvt_pk_bf16_f32 v178, v180, v181
    v_cvt_pk_bf16_f32 v179, v182, v183
    v_accvgpr_write_b32 a24, v176
    v_accvgpr_write_b32 a25, v177
    v_accvgpr_write_b32 a26, v178
    v_accvgpr_write_b32 a27, v179
    v_mul_f32 v184, s39, v184
    v_mul_f32 v185, s39, v185
    v_mul_f32 v186, s39, v186
    v_mul_f32 v187, s39, v187
    v_mul_f32 v188, s39, v188
    v_mul_f32 v189, s39, v189
    v_mul_f32 v190, s39, v190
    v_mul_f32 v191, s39, v191
    v_cvt_pk_bf16_f32 v184, v184, v185
    v_cvt_pk_bf16_f32 v185, v186, v187
    v_cvt_pk_bf16_f32 v186, v188, v189
    v_cvt_pk_bf16_f32 v187, v190, v191
    v_accvgpr_write_b32 a28, v184
    v_accvgpr_write_b32 a29, v185
    v_accvgpr_write_b32 a30, v186
    v_accvgpr_write_b32 a31, v187
    s_add_u32 s33, s80, 49152
    s_and_b32 s33, s33, 0x7ffff
    v_mfma_f32_16x16x32_bf16 v[72:75], a[180:183], a[16:19], 0
    s_add_u32 m0, s29, 32768
    s_nop 0
    buffer_load_dwordx4 v28, s[8:11], s33 offen offset:0 nt lds
    v_mfma_f32_16x16x32_bf16 v[72:75], a[184:187], a[20:23], v[72:75]
    buffer_load_dwordx4 v29, s[8:11], s33 offen offset:1024 nt lds
    v_mfma_f32_16x16x32_bf16 v[72:75], a[188:191], a[24:27], v[72:75]
    buffer_load_dwordx4 v30, s[8:11], s33 offen offset:2048 nt lds
    v_mfma_f32_16x16x32_bf16 v[72:75], a[192:195], a[28:31], v[72:75]
    buffer_load_dwordx4 v31, s[8:11], s33 offen offset:3072 nt lds
    v_mfma_f32_16x16x32_bf16 v[76:79], a[196:199], a[16:19], 0
    s_waitcnt lgkmcnt(0)
    v_mul_f32 v192, s39, v192
    v_mfma_f32_16x16x32_bf16 v[76:79], a[200:203], a[20:23], v[76:79]
    v_mul_f32 v193, s39, v193
    v_mul_f32 v194, s39, v194
    v_mfma_f32_16x16x32_bf16 v[76:79], a[204:207], a[24:27], v[76:79]
    v_mul_f32 v195, s39, v195
    v_mul_f32 v196, s39, v196
    v_mfma_f32_16x16x32_bf16 v[76:79], a[208:211], a[28:31], v[76:79]
    v_mul_f32 v197, s39, v197
    v_mul_f32 v198, s39, v198
    v_mfma_f32_32x32x16_bf16 v[160:175], a[128:131], a[128:131], 0
    v_mul_f32 v199, s39, v199
    v_cvt_pk_bf16_f32 v192, v192, v193
    v_mfma_f32_32x32x16_bf16 v[176:191], a[128:131], a[128:131], 0
    v_cvt_pk_bf16_f32 v193, v194, v195
    v_cvt_pk_bf16_f32 v194, v196, v197
    v_cvt_pk_bf16_f32 v195, v198, v199
    v_accvgpr_write_b32 a32, v192
    v_accvgpr_write_b32 a33, v193
    v_accvgpr_write_b32 a34, v194
    v_accvgpr_write_b32 a35, v195
    v_mul_f32 v200, s39, v200
    v_mul_f32 v201, s39, v201
    v_mul_f32 v202, s39, v202
    v_mul_f32 v203, s39, v203
    v_mul_f32 v204, s39, v204
    v_mul_f32 v205, s39, v205
    v_mul_f32 v206, s39, v206
    v_mul_f32 v207, s39, v207
    v_cvt_pk_bf16_f32 v200, v200, v201
    v_cvt_pk_bf16_f32 v201, v202, v203
    v_cvt_pk_bf16_f32 v202, v204, v205
    v_cvt_pk_bf16_f32 v203, v206, v207
    v_accvgpr_write_b32 a36, v200
    v_accvgpr_write_b32 a37, v201
    v_accvgpr_write_b32 a38, v202
    v_accvgpr_write_b32 a39, v203
    v_mul_f32 v208, s39, v208
    v_mul_f32 v209, s39, v209
    v_mul_f32 v210, s39, v210
    v_mul_f32 v211, s39, v211
    v_mul_f32 v212, s39, v212
    v_mul_f32 v213, s39, v213
    v_mul_f32 v214, s39, v214
    v_mul_f32 v215, s39, v215
    v_cvt_pk_bf16_f32 v208, v208, v209
    v_cvt_pk_bf16_f32 v209, v210, v211
    v_cvt_pk_bf16_f32 v210, v212, v213
    v_cvt_pk_bf16_f32 v211, v214, v215
    v_accvgpr_write_b32 a40, v208
    v_accvgpr_write_b32 a41, v209
    v_accvgpr_write_b32 a42, v210
    v_accvgpr_write_b32 a43, v211
    v_mul_f32 v216, s39, v216
    v_mul_f32 v217, s39, v217
    v_mul_f32 v218, s39, v218
    v_mul_f32 v219, s39, v219
    v_mul_f32 v220, s39, v220
    v_mul_f32 v221, s39, v221
    v_mul_f32 v222, s39, v222
    v_mul_f32 v223, s39, v223
    v_cvt_pk_bf16_f32 v216, v216, v217
    v_cvt_pk_bf16_f32 v217, v218, v219
    v_cvt_pk_bf16_f32 v218, v220, v221
    v_cvt_pk_bf16_f32 v219, v222, v223
    v_accvgpr_write_b32 a44, v216
    v_accvgpr_write_b32 a45, v217
    v_accvgpr_write_b32 a46, v218
    v_accvgpr_write_b32 a47, v219
    v_max3_f32 v48, v64, v65, v66
    v_max3_f32 v49, v67, v68, v69
    v_max3_f32 v48, v48, v70, v71
    v_mfma_f32_16x16x32_bf16 v[80:83], a[180:183], a[32:35], 0
    v_max_f32 v48, v48, v49
    v_max3_f32 v52, v72, v73, v74
    v_mfma_f32_16x16x32_bf16 v[80:83], a[184:187], a[36:39], v[80:83]
    v_max3_f32 v53, v75, v76, v77
    v_max3_f32 v52, v52, v78, v79
    v_mfma_f32_16x16x32_bf16 v[80:83], a[188:191], a[40:43], v[80:83]
    v_max_f32 v52, v52, v53
    v_mov_b32 v49, v48
    v_mfma_f32_16x16x32_bf16 v[80:83], a[192:195], a[44:47], v[80:83]
    v_mov_b32 v53, v52
    v_permlane32_swap_b32 v48, v49
    v_mfma_f32_16x16x32_bf16 v[84:87], a[196:199], a[32:35], 0
    v_permlane32_swap_b32 v52, v53
    v_max_f32 v48, v48, v49
    v_mfma_f32_16x16x32_bf16 v[84:87], a[200:203], a[36:39], v[84:87]
    v_max_f32 v52, v52, v53
    v_mov_b32 v49, v48
    v_mfma_f32_16x16x32_bf16 v[84:87], a[204:207], a[40:43], v[84:87]
    v_mov_b32 v53, v52
    v_permlane16_swap_b32 v48, v49
    v_mfma_f32_16x16x32_bf16 v[84:87], a[208:211], a[44:47], v[84:87]
    v_permlane16_swap_b32 v52, v53
    v_max_f32 v48, v48, v49
    v_mfma_f32_32x32x16_bf16 v[192:207], a[128:131], a[128:131], 0
    v_max_f32 v52, v52, v53
    v_sub_f32 v48, 0, v48
    v_mfma_f32_32x32x16_bf16 v[208:223], a[128:131], a[128:131], 0
    v_mov_b32 v49, v48
    v_mov_b32 v50, v48
    v_mov_b32 v51, v48
    v_add_f32 v64, v64, v48
    v_add_f32 v65, v65, v48
    v_add_f32 v66, v66, v48
    v_add_f32 v67, v67, v48
    v_add_f32 v68, v68, v48
    v_add_f32 v69, v69, v48
    v_add_f32 v70, v70, v48
    v_add_f32 v71, v71, v48
    v_sub_f32 v52, 0, v52
    v_mov_b32 v53, v52
    v_mov_b32 v54, v52
    v_mov_b32 v55, v52
    v_add_f32 v72, v72, v52
    v_add_f32 v73, v73, v52
    v_add_f32 v74, v74, v52
    v_add_f32 v75, v75, v52
    v_add_f32 v76, v76, v52
    v_add_f32 v77, v77, v52
    v_add_f32 v78, v78, v52
    v_add_f32 v79, v79, v52
    v_mul_f32 v224, s39, v224
    v_mul_f32 v225, s39, v225
    v_mul_f32 v226, s39, v226
    v_mul_f32 v227, s39, v227
    v_mul_f32 v228, s39, v228
    v_mul_f32 v229, s39, v229
    v_mul_f32 v230, s39, v230
    v_mul_f32 v231, s39, v231
    v_cvt_pk_bf16_f32 v224, v224, v225
    v_cvt_pk_bf16_f32 v225, v226, v227
    v_cvt_pk_bf16_f32 v226, v228, v229
    v_cvt_pk_bf16_f32 v227, v230, v231
    v_accvgpr_write_b32 a48, v224
    v_accvgpr_write_b32 a49, v225
    v_accvgpr_write_b32 a50, v226
    v_accvgpr_write_b32 a51, v227
    v_mul_f32 v232, s39, v232
    v_mul_f32 v233, s39, v233
    v_mul_f32 v234, s39, v234
    v_mul_f32 v235, s39, v235
    v_mul_f32 v236, s39, v236
    v_mul_f32 v237, s39, v237
    v_mul_f32 v238, s39, v238
    v_mul_f32 v239, s39, v239
    v_cvt_pk_bf16_f32 v232, v232, v233
    v_cvt_pk_bf16_f32 v233, v234, v235
    v_cvt_pk_bf16_f32 v234, v236, v237
    v_cvt_pk_bf16_f32 v235, v238, v239
    v_accvgpr_write_b32 a52, v232
    v_accvgpr_write_b32 a53, v233
    v_accvgpr_write_b32 a54, v234
    v_accvgpr_write_b32 a55, v235
    v_mul_f32 v240, s39, v240
    v_mul_f32 v241, s39, v241
    v_mul_f32 v242, s39, v242
    v_mul_f32 v243, s39, v243
    v_mul_f32 v244, s39, v244
    v_mul_f32 v245, s39, v245
    v_mul_f32 v246, s39, v246
    v_mul_f32 v247, s39, v247
    v_cvt_pk_bf16_f32 v240, v240, v241
    v_cvt_pk_bf16_f32 v241, v242, v243
    v_cvt_pk_bf16_f32 v242, v244, v245
    v_cvt_pk_bf16_f32 v243, v246, v247
    v_accvgpr_write_b32 a56, v240
    v_accvgpr_write_b32 a57, v241
    v_accvgpr_write_b32 a58, v242
    v_accvgpr_write_b32 a59, v243
    v_mul_f32 v248, s39, v248
    v_mul_f32 v249, s39, v249
    v_mul_f32 v250, s39, v250
    v_mul_f32 v251, s39, v251
    v_mul_f32 v252, s39, v252
    v_mul_f32 v253, s39, v253
    v_mul_f32 v254, s39, v254
    v_mul_f32 v255, s39, v255
    v_cvt_pk_bf16_f32 v248, v248, v249
    v_cvt_pk_bf16_f32 v249, v250, v251
    v_cvt_pk_bf16_f32 v250, v252, v253
    v_cvt_pk_bf16_f32 v251, v254, v255
    v_accvgpr_write_b32 a60, v248
    v_accvgpr_write_b32 a61, v249
    v_accvgpr_write_b32 a62, v250
    v_accvgpr_write_b32 a63, v251
    v_lshlrev_b32 v12, 7, v0
    buffer_load_dword v12, v12, s[16:19], 0 offen
    v_mfma_f32_16x16x32_bf16 v[88:91], a[180:183], a[48:51], 0
    s_add_u32 s34, s80, 32768
    s_and_b32 s34, s34, 0x7ffff
    v_mfma_f32_16x16x32_bf16 v[88:91], a[184:187], a[52:55], v[88:91]
    s_add_u32 m0, s30, 32768
    s_nop 0
    buffer_load_dwordx4 v32, s[12:15], s34 offen offset:0 nt lds
    v_mfma_f32_16x16x32_bf16 v[88:91], a[188:191], a[56:59], v[88:91]
    buffer_load_dwordx4 v33, s[12:15], s34 offen offset:1024 nt lds
    v_mfma_f32_16x16x32_bf16 v[88:91], a[192:195], a[60:63], v[88:91]
    buffer_load_dwordx4 v34, s[12:15], s34 offen offset:2048 nt lds
    v_mfma_f32_16x16x32_bf16 v[92:95], a[196:199], a[48:51], 0
    buffer_load_dwordx4 v35, s[12:15], s34 offen offset:3072 nt lds
    v_mfma_f32_16x16x32_bf16 v[92:95], a[200:203], a[52:55], v[92:95]
    v_exp_f32 v64, v64
    v_mfma_f32_16x16x32_bf16 v[92:95], a[204:207], a[56:59], v[92:95]
    v_exp_f32 v65, v65
    v_mfma_f32_16x16x32_bf16 v[92:95], a[208:211], a[60:63], v[92:95]
    v_exp_f32 v66, v66
    v_mfma_f32_32x32x16_bf16 v[224:239], a[128:131], a[128:131], 0
    v_exp_f32 v67, v67
    v_mfma_f32_32x32x16_bf16 v[240:255], a[128:131], a[128:131], 0
    v_exp_f32 v72, v72
    v_mfma_f32_16x16x32_bf16 v[96:99], a[64:67], a[0:3], v[48:51]
    v_exp_f32 v73, v73
    v_mfma_f32_16x16x32_bf16 v[96:99], a[68:71], a[4:7], v[96:99]
    v_exp_f32 v74, v74
    v_mfma_f32_16x16x32_bf16 v[96:99], a[72:75], a[8:11], v[96:99]
    v_exp_f32 v75, v75
    v_mfma_f32_16x16x32_bf16 v[96:99], a[76:79], a[12:15], v[96:99]
    v_exp_f32 v68, v68
    v_mfma_f32_16x16x32_bf16 v[104:107], a[64:67], a[16:19], v[52:55]
    v_exp_f32 v69, v69
    v_mfma_f32_16x16x32_bf16 v[104:107], a[68:71], a[20:23], v[104:107]
    v_exp_f32 v70, v70
    v_mfma_f32_16x16x32_bf16 v[104:107], a[72:75], a[24:27], v[104:107]
    v_exp_f32 v71, v71
    v_mfma_f32_16x16x32_bf16 v[104:107], a[76:79], a[28:31], v[104:107]
    v_exp_f32 v76, v76
    v_exp_f32 v77, v77
    v_exp_f32 v78, v78
    v_exp_f32 v79, v79
    v_cvt_pk_bf16_f32 v64, v64, v65
    v_cvt_pk_bf16_f32 v65, v66, v67
    v_cvt_pk_bf16_f32 v72, v72, v73
    v_cvt_pk_bf16_f32 v73, v74, v75
    v_cvt_pk_bf16_f32 v66, v68, v69
    v_cvt_pk_bf16_f32 v67, v70, v71
    v_cvt_pk_bf16_f32 v74, v76, v77
    v_cvt_pk_bf16_f32 v75, v78, v79
    v_max3_f32 v56, v80, v81, v82
    v_max3_f32 v57, v83, v84, v85
    v_max3_f32 v56, v56, v86, v87
    v_max_f32 v56, v56, v57
    v_max3_f32 v60, v88, v89, v90
    v_max3_f32 v61, v91, v92, v93
    v_max3_f32 v60, v60, v94, v95
    v_max_f32 v60, v60, v61
    v_mov_b32 v57, v56
    v_mov_b32 v61, v60
    s_nop 0
    v_permlane32_swap_b32 v56, v57
    v_permlane32_swap_b32 v60, v61
    s_nop 0
    v_max_f32 v56, v56, v57
    v_max_f32 v60, v60, v61
    v_mov_b32 v57, v56
    v_mov_b32 v61, v60
    s_nop 0
    v_permlane16_swap_b32 v56, v57
    v_permlane16_swap_b32 v60, v61
    s_nop 0
    v_max_f32 v56, v56, v57
    v_max_f32 v60, v60, v61
    v_sub_f32 v56, 0, v56
    v_mov_b32 v57, v56
    v_mov_b32 v58, v56
    v_mov_b32 v59, v56
    v_add_f32 v80, v80, v56
    v_add_f32 v81, v81, v56
    v_mfma_f32_16x16x32_bf16 v[112:115], a[64:67], a[32:35], v[56:59]
    v_add_f32 v82, v82, v56
    v_add_f32 v83, v83, v56
    v_mfma_f32_16x16x32_bf16 v[112:115], a[68:71], a[36:39], v[112:115]
    v_add_f32 v84, v84, v56
    v_add_f32 v85, v85, v56
    v_mfma_f32_16x16x32_bf16 v[112:115], a[72:75], a[40:43], v[112:115]
    v_add_f32 v86, v86, v56
    v_add_f32 v87, v87, v56
    v_mfma_f32_16x16x32_bf16 v[112:115], a[76:79], a[44:47], v[112:115]
    v_sub_f32 v60, 0, v60
    v_mov_b32 v61, v60
    v_mov_b32 v62, v60
    v_mov_b32 v63, v60
    v_add_f32 v88, v88, v60
    v_add_f32 v89, v89, v60
    v_mfma_f32_16x16x32_bf16 v[120:123], a[64:67], a[48:51], v[60:63]
    v_add_f32 v90, v90, v60
    v_add_f32 v91, v91, v60
    v_mfma_f32_16x16x32_bf16 v[120:123], a[68:71], a[52:55], v[120:123]
    v_add_f32 v92, v92, v60
    v_add_f32 v93, v93, v60
    v_mfma_f32_16x16x32_bf16 v[120:123], a[72:75], a[56:59], v[120:123]
    v_add_f32 v94, v94, v60
    v_add_f32 v95, v95, v60
    v_mfma_f32_16x16x32_bf16 v[120:123], a[76:79], a[60:63], v[120:123]
    v_exp_f32 v80, v80
    v_exp_f32 v81, v81
    v_exp_f32 v82, v82
    v_exp_f32 v83, v83
    v_exp_f32 v88, v88
    v_exp_f32 v89, v89
    v_exp_f32 v90, v90
    v_exp_f32 v91, v91
    v_exp_f32 v84, v84
    v_exp_f32 v85, v85
    v_cvt_pk_bf16_f32 v80, v80, v81
    v_cvt_pk_bf16_f32 v81, v82, v83
    v_cvt_pk_bf16_f32 v88, v88, v89
    v_cvt_pk_bf16_f32 v89, v90, v91
    v_cvt_pk_bf16_f32 v82, v84, v85
    s_mov_b32 s35, 7
    s_waitcnt vmcnt(13)
    s_barrier
    .p2align 6
L_loopA:
    v_mfma_f32_16x16x32_bf16 v[100:103], a[80:83], a[0:3], v[48:51]
    ds_read_b64_tr_b16 a[96:97], v20 offset:0
    v_mfma_f32_16x16x32_bf16 v[100:103], a[84:87], a[4:7], v[100:103]
    v_exp_f32 v86, v86
    v_mfma_f32_16x16x32_bf16 v[100:103], a[88:91], a[8:11], v[100:103]
    ds_read_b64_tr_b16 a[98:99], v20 offset:4096
    v_mfma_f32_16x16x32_bf16 v[100:103], a[92:95], a[12:15], v[100:103]
    v_exp_f32 v87, v87
    v_mfma_f32_16x16x32_bf16 v[108:111], a[92:95], a[28:31], v[52:55]
    ds_read_b64_tr_b16 a[100:101], v21 offset:0
    v_cvt_pk_bf16_f32 v83, v86, v87
    v_mfma_f32_16x16x32_bf16 v[108:111], a[88:91], a[24:27], v[108:111]
    v_exp_f32 v92, v92
    v_mfma_f32_16x16x32_bf16 v[108:111], a[84:87], a[20:23], v[108:111]
    ds_read_b64_tr_b16 a[102:103], v21 offset:4096
    v_mfma_f32_16x16x32_bf16 v[108:111], a[80:83], a[16:19], v[108:111]
    v_exp_f32 v93, v93
    v_mfma_f32_16x16x32_bf16 v[116:119], a[80:83], a[32:35], v[56:59]
    ds_read_b64_tr_b16 a[104:105], v22 offset:0
    v_cvt_pk_bf16_f32 v90, v92, v93
    v_mfma_f32_16x16x32_bf16 v[116:119], a[84:87], a[36:39], v[116:119]
    v_exp_f32 v94, v94
    v_mfma_f32_16x16x32_bf16 v[116:119], a[88:91], a[40:43], v[116:119]
    ds_read_b64_tr_b16 a[106:107], v22 offset:4096
    v_mfma_f32_16x16x32_bf16 v[116:119], a[92:95], a[44:47], v[116:119]
    v_exp_f32 v95, v95
    v_mfma_f32_16x16x32_bf16 v[124:127], a[92:95], a[60:63], v[60:63]
    ds_read_b64_tr_b16 a[108:109], v23 offset:0
    v_cvt_pk_bf16_f32 v91, v94, v95
    v_mfma_f32_16x16x32_bf16 v[124:127], a[88:91], a[56:59], v[124:127]
    v_mfma_f32_16x16x32_bf16 v[124:127], a[84:87], a[52:55], v[124:127]
    ds_read_b64_tr_b16 a[110:111], v23 offset:4096
    v_mfma_f32_16x16x32_bf16 v[124:127], a[80:83], a[48:51], v[124:127]
    s_waitcnt lgkmcnt(6)
    v_mfma_f32_16x16x32_bf16 v[128:131], a[96:99], v[64:67], v[128:131]
    ds_read_b64_tr_b16 a[112:113], v24 offset:0
    v_mfma_f32_16x16x32_bf16 v[160:163], a[96:99], v[72:75], v[160:163]
    v_exp_f32 v96, v96
    v_mfma_f32_16x16x32_bf16 v[192:195], a[96:99], v[80:83], v[192:195]
    ds_read_b64_tr_b16 a[114:115], v24 offset:4096
    v_mfma_f32_16x16x32_bf16 v[224:227], a[96:99], v[88:91], v[224:227]
    s_waitcnt lgkmcnt(6)
    v_exp_f32 v97, v97
    v_mfma_f32_16x16x32_bf16 v[228:231], a[100:103], v[88:91], v[228:231]
    ds_read_b64_tr_b16 a[116:117], v25 offset:0
    v_cvt_pk_bf16_f32 v96, v96, v97
    v_mfma_f32_16x16x32_bf16 v[196:199], a[100:103], v[80:83], v[196:199]
    v_exp_f32 v98, v98
    v_mfma_f32_16x16x32_bf16 v[164:167], a[100:103], v[72:75], v[164:167]
    ds_read_b64_tr_b16 a[118:119], v25 offset:4096
    v_mfma_f32_16x16x32_bf16 v[132:135], a[100:103], v[64:67], v[132:135]
    s_waitcnt lgkmcnt(6)
    v_exp_f32 v99, v99
    v_mfma_f32_16x16x32_bf16 v[136:139], a[104:107], v[64:67], v[136:139]
    ds_read_b64_tr_b16 a[120:121], v26 offset:0
    v_cvt_pk_bf16_f32 v97, v98, v99
    v_mfma_f32_16x16x32_bf16 v[168:171], a[104:107], v[72:75], v[168:171]
    v_exp_f32 v104, v104
    v_mfma_f32_16x16x32_bf16 v[200:203], a[104:107], v[80:83], v[200:203]
    ds_read_b64_tr_b16 a[122:123], v26 offset:4096
    v_mfma_f32_16x16x32_bf16 v[232:235], a[104:107], v[88:91], v[232:235]
    s_waitcnt lgkmcnt(6)
    v_exp_f32 v105, v105
    v_mfma_f32_16x16x32_bf16 v[236:239], a[108:111], v[88:91], v[236:239]
    ds_read_b64_tr_b16 a[124:125], v27 offset:0
    v_cvt_pk_bf16_f32 v104, v104, v105
    v_mfma_f32_16x16x32_bf16 v[204:207], a[108:111], v[80:83], v[204:207]
    v_exp_f32 v106, v106
    v_mfma_f32_16x16x32_bf16 v[172:175], a[108:111], v[72:75], v[172:175]
    ds_read_b64_tr_b16 a[126:127], v27 offset:4096
    v_mfma_f32_16x16x32_bf16 v[140:143], a[108:111], v[64:67], v[140:143]
    s_waitcnt lgkmcnt(6)
    ds_read_b128 a[64:67], v16 offset:0
    v_mfma_f32_16x16x32_bf16 v[144:147], a[112:115], v[64:67], v[144:147]
    v_exp_f32 v107, v107
    v_mfma_f32_16x16x32_bf16 v[176:179], a[112:115], v[72:75], v[176:179]
    v_exp_f32 v112, v112
    v_mfma_f32_16x16x32_bf16 v[208:211], a[112:115], v[80:83], v[208:211]
    ds_read_b128 a[68:71], v17 offset:0
    v_cvt_pk_bf16_f32 v105, v106, v107
    v_mfma_f32_16x16x32_bf16 v[240:243], a[112:115], v[88:91], v[240:243]
    s_waitcnt lgkmcnt(6)
    v_exp_f32 v113, v113
    v_mfma_f32_16x16x32_bf16 v[244:247], a[116:119], v[88:91], v[244:247]
    v_exp_f32 v114, v114
    v_mfma_f32_16x16x32_bf16 v[212:215], a[116:119], v[80:83], v[212:215]
    v_cvt_pk_bf16_f32 v112, v112, v113
    v_mfma_f32_16x16x32_bf16 v[180:183], a[116:119], v[72:75], v[180:183]
    ds_read_b128 a[72:75], v18 offset:0
    v_mfma_f32_16x16x32_bf16 v[148:151], a[116:119], v[64:67], v[148:151]
    s_waitcnt lgkmcnt(5)
    v_exp_f32 v115, v115
    v_mfma_f32_16x16x32_bf16 v[152:155], a[120:123], v[64:67], v[152:155]
    v_exp_f32 v120, v120
    v_mfma_f32_16x16x32_bf16 v[184:187], a[120:123], v[72:75], v[184:187]
    v_cvt_pk_bf16_f32 v113, v114, v115
    v_mfma_f32_16x16x32_bf16 v[216:219], a[120:123], v[80:83], v[216:219]
    ds_read_b128 a[76:79], v19 offset:0
    v_mfma_f32_16x16x32_bf16 v[248:251], a[120:123], v[88:91], v[248:251]
    s_waitcnt lgkmcnt(4)
    v_exp_f32 v121, v121
    v_mfma_f32_16x16x32_bf16 v[252:255], a[124:127], v[88:91], v[252:255]
    v_exp_f32 v122, v122
    v_mfma_f32_16x16x32_bf16 v[220:223], a[124:127], v[80:83], v[220:223]
    v_cvt_pk_bf16_f32 v120, v120, v121
    v_mfma_f32_16x16x32_bf16 v[188:191], a[124:127], v[72:75], v[188:191]
    ds_read_b128 a[80:83], v16 offset:4096
    v_mfma_f32_16x16x32_bf16 v[156:159], a[124:127], v[64:67], v[156:159]
    v_exp_f32 v123, v123
    v_mfma_f32_16x16x32_bf16 a[128:131], a[144:147], v[64:67], a[128:131]
    v_exp_f32 v100, v100
    v_mfma_f32_16x16x32_bf16 a[132:135], a[144:147], v[72:75], a[132:135]
    v_cvt_pk_bf16_f32 v121, v122, v123
    v_mfma_f32_16x16x32_bf16 a[136:139], a[144:147], v[80:83], a[136:139]
    ds_read_b128 a[84:87], v17 offset:4096
    v_mfma_f32_16x16x32_bf16 a[140:143], a[144:147], v[88:91], a[140:143]
    s_waitcnt lgkmcnt(2)
    v_exp_f32 v101, v101
    v_mfma_f32_16x16x32_bf16 v[64:67], a[64:67], a[0:3], v[48:51]
    v_exp_f32 v102, v102
    v_mfma_f32_16x16x32_bf16 v[64:67], a[68:71], a[4:7], v[64:67]
    v_cvt_pk_bf16_f32 v98, v100, v101
    v_mfma_f32_16x16x32_bf16 v[64:67], a[72:75], a[8:11], v[64:67]
    ds_read_b128 a[88:91], v18 offset:4096
    v_mfma_f32_16x16x32_bf16 v[64:67], a[76:79], a[12:15], v[64:67]
    v_exp_f32 v103, v103
    v_mfma_f32_16x16x32_bf16 v[72:75], a[76:79], a[28:31], v[52:55]
    v_exp_f32 v108, v108
    v_mfma_f32_16x16x32_bf16 v[72:75], a[72:75], a[24:27], v[72:75]
    v_cvt_pk_bf16_f32 v99, v102, v103
    v_mfma_f32_16x16x32_bf16 v[72:75], a[68:71], a[20:23], v[72:75]
    ds_read_b128 a[92:95], v19 offset:4096
    v_mfma_f32_16x16x32_bf16 v[72:75], a[64:67], a[16:19], v[72:75]
    v_exp_f32 v109, v109
    v_mfma_f32_16x16x32_bf16 v[80:83], a[64:67], a[32:35], v[56:59]
    v_exp_f32 v110, v110
    v_mfma_f32_16x16x32_bf16 v[80:83], a[68:71], a[36:39], v[80:83]
    v_cvt_pk_bf16_f32 v106, v108, v109
    v_mfma_f32_16x16x32_bf16 v[80:83], a[72:75], a[40:43], v[80:83]
    v_exp_f32 v111, v111
    v_mfma_f32_16x16x32_bf16 v[80:83], a[76:79], a[44:47], v[80:83]
    v_cvt_pk_bf16_f32 v107, v110, v111
    v_mfma_f32_16x16x32_bf16 v[88:91], a[76:79], a[60:63], v[60:63]
    ds_read_b64_tr_b16 a[96:97], v20 offset:8192
    v_mfma_f32_16x16x32_bf16 v[88:91], a[72:75], a[56:59], v[88:91]
    v_exp_f32 v116, v116
    v_mfma_f32_16x16x32_bf16 v[88:91], a[68:71], a[52:55], v[88:91]
    ds_read_b64_tr_b16 a[98:99], v20 offset:12288
    v_mfma_f32_16x16x32_bf16 v[88:91], a[64:67], a[48:51], v[88:91]
    s_waitcnt lgkmcnt(2)
    v_exp_f32 v117, v117
    v_mfma_f32_16x16x32_bf16 v[68:71], a[80:83], a[0:3], v[48:51]
    ds_read_b64_tr_b16 a[100:101], v21 offset:8192
    v_cvt_pk_bf16_f32 v114, v116, v117
    v_mfma_f32_16x16x32_bf16 v[68:71], a[84:87], a[4:7], v[68:71]
    v_exp_f32 v118, v118
    v_mfma_f32_16x16x32_bf16 v[68:71], a[88:91], a[8:11], v[68:71]
    ds_read_b64_tr_b16 a[102:103], v21 offset:12288
    v_mfma_f32_16x16x32_bf16 v[68:71], a[92:95], a[12:15], v[68:71]
    v_exp_f32 v119, v119
    v_mfma_f32_16x16x32_bf16 v[76:79], a[92:95], a[28:31], v[52:55]
    ds_read_b64_tr_b16 a[104:105], v22 offset:8192
    v_cvt_pk_bf16_f32 v115, v118, v119
    v_mfma_f32_16x16x32_bf16 v[76:79], a[88:91], a[24:27], v[76:79]
    v_exp_f32 v124, v124
    v_mfma_f32_16x16x32_bf16 v[76:79], a[84:87], a[20:23], v[76:79]
    ds_read_b64_tr_b16 a[106:107], v22 offset:12288
    v_mfma_f32_16x16x32_bf16 v[76:79], a[80:83], a[16:19], v[76:79]
    v_exp_f32 v125, v125
    v_mfma_f32_16x16x32_bf16 v[84:87], a[80:83], a[32:35], v[56:59]
    ds_read_b64_tr_b16 a[108:109], v23 offset:8192
    v_cvt_pk_bf16_f32 v122, v124, v125
    v_mfma_f32_16x16x32_bf16 v[84:87], a[84:87], a[36:39], v[84:87]
    v_exp_f32 v126, v126
    v_mfma_f32_16x16x32_bf16 v[84:87], a[88:91], a[40:43], v[84:87]
    ds_read_b64_tr_b16 a[110:111], v23 offset:12288
    v_mfma_f32_16x16x32_bf16 v[84:87], a[92:95], a[44:47], v[84:87]
    v_exp_f32 v127, v127
    v_mfma_f32_16x16x32_bf16 v[92:95], a[92:95], a[60:63], v[60:63]
    ds_read_b64_tr_b16 a[112:113], v24 offset:8192
    v_cvt_pk_bf16_f32 v123, v126, v127
    v_mfma_f32_16x16x32_bf16 v[92:95], a[88:91], a[56:59], v[92:95]
    v_mfma_f32_16x16x32_bf16 v[92:95], a[84:87], a[52:55], v[92:95]
    ds_read_b64_tr_b16 a[114:115], v24 offset:12288
    v_mfma_f32_16x16x32_bf16 v[92:95], a[80:83], a[48:51], v[92:95]
    s_waitcnt lgkmcnt(8)
    v_mfma_f32_16x16x32_bf16 v[128:131], a[96:99], v[96:99], v[128:131]
    ds_read_b64_tr_b16 a[116:117], v25 offset:8192
    v_mfma_f32_16x16x32_bf16 v[160:163], a[96:99], v[104:107], v[160:163]
    v_exp_f32 v64, v64
    v_mfma_f32_16x16x32_bf16 v[192:195], a[96:99], v[112:115], v[192:195]
    ds_read_b64_tr_b16 a[118:119], v25 offset:12288
    v_mfma_f32_16x16x32_bf16 v[224:227], a[96:99], v[120:123], v[224:227]
    s_waitcnt lgkmcnt(8)
    v_exp_f32 v65, v65
    v_mfma_f32_16x16x32_bf16 v[228:231], a[100:103], v[120:123], v[228:231]
    ds_read_b64_tr_b16 a[120:121], v26 offset:8192
    v_cvt_pk_bf16_f32 v64, v64, v65
    v_mfma_f32_16x16x32_bf16 v[196:199], a[100:103], v[112:115], v[196:199]
    v_exp_f32 v66, v66
    v_mfma_f32_16x16x32_bf16 v[164:167], a[100:103], v[104:107], v[164:167]
    ds_read_b64_tr_b16 a[122:123], v26 offset:12288
    v_mfma_f32_16x16x32_bf16 v[132:135], a[100:103], v[96:99], v[132:135]
    s_waitcnt lgkmcnt(8)
    v_exp_f32 v67, v67
    v_mfma_f32_16x16x32_bf16 v[136:139], a[104:107], v[96:99], v[136:139]
    ds_read_b64_tr_b16 a[124:125], v27 offset:8192
    v_cvt_pk_bf16_f32 v65, v66, v67
    v_mfma_f32_16x16x32_bf16 v[168:171], a[104:107], v[104:107], v[168:171]
    v_exp_f32 v72, v72
    v_mfma_f32_16x16x32_bf16 v[200:203], a[104:107], v[112:115], v[200:203]
    ds_read_b64_tr_b16 a[126:127], v27 offset:12288
    v_mfma_f32_16x16x32_bf16 v[232:235], a[104:107], v[120:123], v[232:235]
    s_waitcnt lgkmcnt(8)
    v_exp_f32 v73, v73
    v_mfma_f32_16x16x32_bf16 v[236:239], a[108:111], v[120:123], v[236:239]
    ds_read_b128 a[64:67], v16 offset:8192
    v_cvt_pk_bf16_f32 v72, v72, v73
    v_mfma_f32_16x16x32_bf16 v[204:207], a[108:111], v[112:115], v[204:207]
    v_exp_f32 v74, v74
    v_mfma_f32_16x16x32_bf16 v[172:175], a[108:111], v[104:107], v[172:175]
    v_exp_f32 v75, v75
    v_mfma_f32_16x16x32_bf16 v[140:143], a[108:111], v[96:99], v[140:143]
    s_waitcnt lgkmcnt(7)
    v_cvt_pk_bf16_f32 v73, v74, v75
    v_mfma_f32_16x16x32_bf16 v[144:147], a[112:115], v[96:99], v[144:147]
    ds_read_b128 a[68:71], v17 offset:8192
    v_mfma_f32_16x16x32_bf16 v[176:179], a[112:115], v[104:107], v[176:179]
    v_exp_f32 v80, v80
    v_mfma_f32_16x16x32_bf16 v[208:211], a[112:115], v[112:115], v[208:211]
    v_exp_f32 v81, v81
    v_mfma_f32_16x16x32_bf16 v[240:243], a[112:115], v[120:123], v[240:243]
    s_waitcnt lgkmcnt(6)
    v_cvt_pk_bf16_f32 v80, v80, v81
    v_mfma_f32_16x16x32_bf16 v[244:247], a[116:119], v[120:123], v[244:247]
    ds_read_b128 a[72:75], v18 offset:8192
    v_mfma_f32_16x16x32_bf16 v[212:215], a[116:119], v[112:115], v[212:215]
    v_exp_f32 v82, v82
    v_mfma_f32_16x16x32_bf16 v[180:183], a[116:119], v[104:107], v[180:183]
    v_exp_f32 v83, v83
    v_mfma_f32_16x16x32_bf16 v[148:151], a[116:119], v[96:99], v[148:151]
    s_waitcnt lgkmcnt(5)
    v_cvt_pk_bf16_f32 v81, v82, v83
    v_mfma_f32_16x16x32_bf16 v[152:155], a[120:123], v[96:99], v[152:155]
    ds_read_b128 a[76:79], v19 offset:8192
    v_mfma_f32_16x16x32_bf16 v[184:187], a[120:123], v[104:107], v[184:187]
    v_exp_f32 v88, v88
    v_mfma_f32_16x16x32_bf16 v[216:219], a[120:123], v[112:115], v[216:219]
    v_exp_f32 v89, v89
    v_mfma_f32_16x16x32_bf16 v[248:251], a[120:123], v[120:123], v[248:251]
    s_waitcnt lgkmcnt(4)
    v_cvt_pk_bf16_f32 v88, v88, v89
    v_mfma_f32_16x16x32_bf16 v[252:255], a[124:127], v[120:123], v[252:255]
    ds_read_b128 a[80:83], v16 offset:12288
    v_mfma_f32_16x16x32_bf16 v[220:223], a[124:127], v[112:115], v[220:223]
    v_exp_f32 v90, v90
    v_mfma_f32_16x16x32_bf16 v[188:191], a[124:127], v[104:107], v[188:191]
    v_exp_f32 v91, v91
    v_mfma_f32_16x16x32_bf16 v[156:159], a[124:127], v[96:99], v[156:159]
    v_cvt_pk_bf16_f32 v89, v90, v91
    v_mfma_f32_16x16x32_bf16 a[128:131], a[144:147], v[96:99], a[128:131]
    ds_read_b128 a[84:87], v17 offset:12288
    v_mfma_f32_16x16x32_bf16 a[132:135], a[144:147], v[104:107], a[132:135]
    v_exp_f32 v68, v68
    v_mfma_f32_16x16x32_bf16 a[136:139], a[144:147], v[112:115], a[136:139]
    v_exp_f32 v69, v69
    v_mfma_f32_16x16x32_bf16 a[140:143], a[144:147], v[120:123], a[140:143]
    s_waitcnt lgkmcnt(2)
    v_cvt_pk_bf16_f32 v66, v68, v69
    v_mfma_f32_16x16x32_bf16 v[96:99], a[64:67], a[0:3], v[48:51]
    ds_read_b128 a[88:91], v18 offset:12288
    v_mfma_f32_16x16x32_bf16 v[96:99], a[68:71], a[4:7], v[96:99]
    v_exp_f32 v70, v70
    v_mfma_f32_16x16x32_bf16 v[96:99], a[72:75], a[8:11], v[96:99]
    v_exp_f32 v71, v71
    v_mfma_f32_16x16x32_bf16 v[96:99], a[76:79], a[12:15], v[96:99]
    v_cvt_pk_bf16_f32 v67, v70, v71
    v_mfma_f32_16x16x32_bf16 v[104:107], a[76:79], a[28:31], v[52:55]
    ds_read_b128 a[92:95], v19 offset:12288
    v_mfma_f32_16x16x32_bf16 v[104:107], a[72:75], a[24:27], v[104:107]
    v_exp_f32 v76, v76
    v_mfma_f32_16x16x32_bf16 v[104:107], a[68:71], a[20:23], v[104:107]
    v_exp_f32 v77, v77
    v_mfma_f32_16x16x32_bf16 v[104:107], a[64:67], a[16:19], v[104:107]
    v_cvt_pk_bf16_f32 v74, v76, v77
    v_mfma_f32_16x16x32_bf16 v[112:115], a[64:67], a[32:35], v[56:59]
    v_exp_f32 v78, v78
    v_mfma_f32_16x16x32_bf16 v[112:115], a[68:71], a[36:39], v[112:115]
    v_mfma_f32_16x16x32_bf16 v[112:115], a[72:75], a[40:43], v[112:115]
    v_exp_f32 v79, v79
    v_mfma_f32_16x16x32_bf16 v[112:115], a[76:79], a[44:47], v[112:115]
    v_cvt_pk_bf16_f32 v75, v78, v79
    v_mfma_f32_16x16x32_bf16 v[120:123], a[76:79], a[60:63], v[60:63]
    v_exp_f32 v84, v84
    v_mfma_f32_16x16x32_bf16 v[120:123], a[72:75], a[56:59], v[120:123]
    v_mfma_f32_16x16x32_bf16 v[120:123], a[68:71], a[52:55], v[120:123]
    v_exp_f32 v85, v85
    v_mfma_f32_16x16x32_bf16 v[120:123], a[64:67], a[48:51], v[120:123]
    v_cvt_pk_bf16_f32 v82, v84, v85
    s_waitcnt vmcnt(8) lgkmcnt(0)
    s_barrier
    v_mfma_f32_16x16x32_bf16 v[100:103], a[80:83], a[0:3], v[48:51]
    ds_read_b64_tr_b16 a[96:97], v20 offset:16384
    v_mfma_f32_16x16x32_bf16 v[100:103], a[84:87], a[4:7], v[100:103]
    v_exp_f32 v86, v86
    v_mfma_f32_16x16x32_bf16 v[100:103], a[88:91], a[8:11], v[100:103]
    ds_read_b64_tr_b16 a[98:99], v20 offset:20480
    v_mfma_f32_16x16x32_bf16 v[100:103], a[92:95], a[12:15], v[100:103]
    v_exp_f32 v87, v87
    v_mfma_f32_16x16x32_bf16 v[108:111], a[92:95], a[28:31], v[52:55]
    ds_read_b64_tr_b16 a[100:101], v21 offset:16384
    v_cvt_pk_bf16_f32 v83, v86, v87
    v_mfma_f32_16x16x32_bf16 v[108:111], a[88:91], a[24:27], v[108:111]
    v_exp_f32 v92, v92
    v_mfma_f32_16x16x32_bf16 v[108:111], a[84:87], a[20:23], v[108:111]
    ds_read_b64_tr_b16 a[102:103], v21 offset:20480
    v_mfma_f32_16x16x32_bf16 v[108:111], a[80:83], a[16:19], v[108:111]
    v_exp_f32 v93, v93
    v_mfma_f32_16x16x32_bf16 v[116:119], a[80:83], a[32:35], v[56:59]
    ds_read_b64_tr_b16 a[104:105], v22 offset:16384
    v_cvt_pk_bf16_f32 v90, v92, v93
    v_mfma_f32_16x16x32_bf16 v[116:119], a[84:87], a[36:39], v[116:119]
    v_exp_f32 v94, v94
    v_mfma_f32_16x16x32_bf16 v[116:119], a[88:91], a[40:43], v[116:119]
    ds_read_b64_tr_b16 a[106:107], v22 offset:20480
    v_mfma_f32_16x16x32_bf16 v[116:119], a[92:95], a[44:47], v[116:119]
    v_exp_f32 v95, v95
    v_mfma_f32_16x16x32_bf16 v[124:127], a[92:95], a[60:63], v[60:63]
    ds_read_b64_tr_b16 a[108:109], v23 offset:16384
    v_cvt_pk_bf16_f32 v91, v94, v95
    v_mfma_f32_16x16x32_bf16 v[124:127], a[88:91], a[56:59], v[124:127]
    v_mfma_f32_16x16x32_bf16 v[124:127], a[84:87], a[52:55], v[124:127]
    ds_read_b64_tr_b16 a[110:111], v23 offset:20480
    v_mfma_f32_16x16x32_bf16 v[124:127], a[80:83], a[48:51], v[124:127]
    s_waitcnt lgkmcnt(6)
    v_mfma_f32_16x16x32_bf16 v[128:131], a[96:99], v[64:67], v[128:131]
    ds_read_b64_tr_b16 a[112:113], v24 offset:16384
    v_mfma_f32_16x16x32_bf16 v[160:163], a[96:99], v[72:75], v[160:163]
    v_exp_f32 v96, v96
    v_mfma_f32_16x16x32_bf16 v[192:195], a[96:99], v[80:83], v[192:195]
    ds_read_b64_tr_b16 a[114:115], v24 offset:20480
    v_mfma_f32_16x16x32_bf16 v[224:227], a[96:99], v[88:91], v[224:227]
    s_waitcnt lgkmcnt(6)
    v_exp_f32 v97, v97
    v_mfma_f32_16x16x32_bf16 v[228:231], a[100:103], v[88:91], v[228:231]
    ds_read_b64_tr_b16 a[116:117], v25 offset:16384
    v_cvt_pk_bf16_f32 v96, v96, v97
    v_mfma_f32_16x16x32_bf16 v[196:199], a[100:103], v[80:83], v[196:199]
    v_exp_f32 v98, v98
    v_mfma_f32_16x16x32_bf16 v[164:167], a[100:103], v[72:75], v[164:167]
    ds_read_b64_tr_b16 a[118:119], v25 offset:20480
    v_mfma_f32_16x16x32_bf16 v[132:135], a[100:103], v[64:67], v[132:135]
    s_waitcnt lgkmcnt(6)
    v_exp_f32 v99, v99
    v_mfma_f32_16x16x32_bf16 v[136:139], a[104:107], v[64:67], v[136:139]
    ds_read_b64_tr_b16 a[120:121], v26 offset:16384
    v_cvt_pk_bf16_f32 v97, v98, v99
    v_mfma_f32_16x16x32_bf16 v[168:171], a[104:107], v[72:75], v[168:171]
    v_exp_f32 v104, v104
    v_mfma_f32_16x16x32_bf16 v[200:203], a[104:107], v[80:83], v[200:203]
    ds_read_b64_tr_b16 a[122:123], v26 offset:20480
    v_mfma_f32_16x16x32_bf16 v[232:235], a[104:107], v[88:91], v[232:235]
    s_waitcnt lgkmcnt(6)
    v_exp_f32 v105, v105
    v_mfma_f32_16x16x32_bf16 v[236:239], a[108:111], v[88:91], v[236:239]
    ds_read_b64_tr_b16 a[124:125], v27 offset:16384
    v_cvt_pk_bf16_f32 v104, v104, v105
    v_mfma_f32_16x16x32_bf16 v[204:207], a[108:111], v[80:83], v[204:207]
    v_exp_f32 v106, v106
    v_mfma_f32_16x16x32_bf16 v[172:175], a[108:111], v[72:75], v[172:175]
    ds_read_b64_tr_b16 a[126:127], v27 offset:20480
    v_mfma_f32_16x16x32_bf16 v[140:143], a[108:111], v[64:67], v[140:143]
    s_waitcnt lgkmcnt(6)
    ds_read_b128 a[64:67], v16 offset:16384
    v_mfma_f32_16x16x32_bf16 v[144:147], a[112:115], v[64:67], v[144:147]
    v_exp_f32 v107, v107
    v_mfma_f32_16x16x32_bf16 v[176:179], a[112:115], v[72:75], v[176:179]
    v_exp_f32 v112, v112
    v_mfma_f32_16x16x32_bf16 v[208:211], a[112:115], v[80:83], v[208:211]
    ds_read_b128 a[68:71], v17 offset:16384
    v_cvt_pk_bf16_f32 v105, v106, v107
    v_mfma_f32_16x16x32_bf16 v[240:243], a[112:115], v[88:91], v[240:243]
    s_waitcnt lgkmcnt(6)
    v_exp_f32 v113, v113
    v_mfma_f32_16x16x32_bf16 v[244:247], a[116:119], v[88:91], v[244:247]
    v_exp_f32 v114, v114
    v_mfma_f32_16x16x32_bf16 v[212:215], a[116:119], v[80:83], v[212:215]
    v_cvt_pk_bf16_f32 v112, v112, v113
    v_mfma_f32_16x16x32_bf16 v[180:183], a[116:119], v[72:75], v[180:183]
    ds_read_b128 a[72:75], v18 offset:16384
    v_mfma_f32_16x16x32_bf16 v[148:151], a[116:119], v[64:67], v[148:151]
    s_waitcnt lgkmcnt(5)
    v_exp_f32 v115, v115
    v_mfma_f32_16x16x32_bf16 v[152:155], a[120:123], v[64:67], v[152:155]
    v_exp_f32 v120, v120
    v_mfma_f32_16x16x32_bf16 v[184:187], a[120:123], v[72:75], v[184:187]
    v_cvt_pk_bf16_f32 v113, v114, v115
    v_mfma_f32_16x16x32_bf16 v[216:219], a[120:123], v[80:83], v[216:219]
    ds_read_b128 a[76:79], v19 offset:16384
    v_mfma_f32_16x16x32_bf16 v[248:251], a[120:123], v[88:91], v[248:251]
    s_waitcnt lgkmcnt(4)
    v_exp_f32 v121, v121
    v_mfma_f32_16x16x32_bf16 v[252:255], a[124:127], v[88:91], v[252:255]
    v_exp_f32 v122, v122
    v_mfma_f32_16x16x32_bf16 v[220:223], a[124:127], v[80:83], v[220:223]
    v_cvt_pk_bf16_f32 v120, v120, v121
    v_mfma_f32_16x16x32_bf16 v[188:191], a[124:127], v[72:75], v[188:191]
    ds_read_b128 a[80:83], v16 offset:20480
    v_mfma_f32_16x16x32_bf16 v[156:159], a[124:127], v[64:67], v[156:159]
    v_exp_f32 v123, v123
    v_mfma_f32_16x16x32_bf16 a[128:131], a[144:147], v[64:67], a[128:131]
    v_exp_f32 v100, v100
    v_mfma_f32_16x16x32_bf16 a[132:135], a[144:147], v[72:75], a[132:135]
    v_cvt_pk_bf16_f32 v121, v122, v123
    v_mfma_f32_16x16x32_bf16 a[136:139], a[144:147], v[80:83], a[136:139]
    ds_read_b128 a[84:87], v17 offset:20480
    v_mfma_f32_16x16x32_bf16 a[140:143], a[144:147], v[88:91], a[140:143]
    s_waitcnt lgkmcnt(2)
    v_exp_f32 v101, v101
    v_mfma_f32_16x16x32_bf16 v[64:67], a[64:67], a[0:3], v[48:51]
    v_exp_f32 v102, v102
    v_mfma_f32_16x16x32_bf16 v[64:67], a[68:71], a[4:7], v[64:67]
    v_cvt_pk_bf16_f32 v98, v100, v101
    v_mfma_f32_16x16x32_bf16 v[64:67], a[72:75], a[8:11], v[64:67]
    ds_read_b128 a[88:91], v18 offset:20480
    v_mfma_f32_16x16x32_bf16 v[64:67], a[76:79], a[12:15], v[64:67]
    v_exp_f32 v103, v103
    v_mfma_f32_16x16x32_bf16 v[72:75], a[76:79], a[28:31], v[52:55]
    v_exp_f32 v108, v108
    v_mfma_f32_16x16x32_bf16 v[72:75], a[72:75], a[24:27], v[72:75]
    v_cvt_pk_bf16_f32 v99, v102, v103
    v_mfma_f32_16x16x32_bf16 v[72:75], a[68:71], a[20:23], v[72:75]
    ds_read_b128 a[92:95], v19 offset:20480
    v_mfma_f32_16x16x32_bf16 v[72:75], a[64:67], a[16:19], v[72:75]
    v_exp_f32 v109, v109
    v_mfma_f32_16x16x32_bf16 v[80:83], a[64:67], a[32:35], v[56:59]
    v_exp_f32 v110, v110
    v_mfma_f32_16x16x32_bf16 v[80:83], a[68:71], a[36:39], v[80:83]
    v_cvt_pk_bf16_f32 v106, v108, v109
    v_mfma_f32_16x16x32_bf16 v[80:83], a[72:75], a[40:43], v[80:83]
    v_exp_f32 v111, v111
    v_mfma_f32_16x16x32_bf16 v[80:83], a[76:79], a[44:47], v[80:83]
    v_cvt_pk_bf16_f32 v107, v110, v111
    v_mfma_f32_16x16x32_bf16 v[88:91], a[76:79], a[60:63], v[60:63]
    ds_read_b64_tr_b16 a[96:97], v20 offset:24576
    v_mfma_f32_16x16x32_bf16 v[88:91], a[72:75], a[56:59], v[88:91]
    v_exp_f32 v116, v116
    v_mfma_f32_16x16x32_bf16 v[88:91], a[68:71], a[52:55], v[88:91]
    ds_read_b64_tr_b16 a[98:99], v20 offset:28672
    v_mfma_f32_16x16x32_bf16 v[88:91], a[64:67], a[48:51], v[88:91]
    s_waitcnt lgkmcnt(2)
    v_exp_f32 v117, v117
    v_mfma_f32_16x16x32_bf16 v[68:71], a[80:83], a[0:3], v[48:51]
    ds_read_b64_tr_b16 a[100:101], v21 offset:24576
    v_cvt_pk_bf16_f32 v114, v116, v117
    v_mfma_f32_16x16x32_bf16 v[68:71], a[84:87], a[4:7], v[68:71]
    v_exp_f32 v118, v118
    v_mfma_f32_16x16x32_bf16 v[68:71], a[88:91], a[8:11], v[68:71]
    ds_read_b64_tr_b16 a[102:103], v21 offset:28672
    v_mfma_f32_16x16x32_bf16 v[68:71], a[92:95], a[12:15], v[68:71]
    v_exp_f32 v119, v119
    v_mfma_f32_16x16x32_bf16 v[76:79], a[92:95], a[28:31], v[52:55]
    ds_read_b64_tr_b16 a[104:105], v22 offset:24576
    v_cvt_pk_bf16_f32 v115, v118, v119
    v_mfma_f32_16x16x32_bf16 v[76:79], a[88:91], a[24:27], v[76:79]
    v_exp_f32 v124, v124
    v_mfma_f32_16x16x32_bf16 v[76:79], a[84:87], a[20:23], v[76:79]
    ds_read_b64_tr_b16 a[106:107], v22 offset:28672
    v_mfma_f32_16x16x32_bf16 v[76:79], a[80:83], a[16:19], v[76:79]
    v_exp_f32 v125, v125
    v_mfma_f32_16x16x32_bf16 v[84:87], a[80:83], a[32:35], v[56:59]
    ds_read_b64_tr_b16 a[108:109], v23 offset:24576
    v_cvt_pk_bf16_f32 v122, v124, v125
    v_mfma_f32_16x16x32_bf16 v[84:87], a[84:87], a[36:39], v[84:87]
    v_exp_f32 v126, v126
    v_mfma_f32_16x16x32_bf16 v[84:87], a[88:91], a[40:43], v[84:87]
    ds_read_b64_tr_b16 a[110:111], v23 offset:28672
    v_mfma_f32_16x16x32_bf16 v[84:87], a[92:95], a[44:47], v[84:87]
    v_exp_f32 v127, v127
    v_mfma_f32_16x16x32_bf16 v[92:95], a[92:95], a[60:63], v[60:63]
    ds_read_b64_tr_b16 a[112:113], v24 offset:24576
    v_cvt_pk_bf16_f32 v123, v126, v127
    v_mfma_f32_16x16x32_bf16 v[92:95], a[88:91], a[56:59], v[92:95]
    v_mfma_f32_16x16x32_bf16 v[92:95], a[84:87], a[52:55], v[92:95]
    ds_read_b64_tr_b16 a[114:115], v24 offset:28672
    v_mfma_f32_16x16x32_bf16 v[92:95], a[80:83], a[48:51], v[92:95]
    s_waitcnt lgkmcnt(8)
    v_mfma_f32_16x16x32_bf16 v[128:131], a[96:99], v[96:99], v[128:131]
    ds_read_b64_tr_b16 a[116:117], v25 offset:24576
    v_mfma_f32_16x16x32_bf16 v[160:163], a[96:99], v[104:107], v[160:163]
    v_exp_f32 v64, v64
    v_mfma_f32_16x16x32_bf16 v[192:195], a[96:99], v[112:115], v[192:195]
    ds_read_b64_tr_b16 a[118:119], v25 offset:28672
    v_mfma_f32_16x16x32_bf16 v[224:227], a[96:99], v[120:123], v[224:227]
    s_waitcnt lgkmcnt(8)
    v_exp_f32 v65, v65
    v_mfma_f32_16x16x32_bf16 v[228:231], a[100:103], v[120:123], v[228:231]
    ds_read_b64_tr_b16 a[120:121], v26 offset:24576
    v_cvt_pk_bf16_f32 v64, v64, v65
    v_mfma_f32_16x16x32_bf16 v[196:199], a[100:103], v[112:115], v[196:199]
    v_exp_f32 v66, v66
    v_mfma_f32_16x16x32_bf16 v[164:167], a[100:103], v[104:107], v[164:167]
    ds_read_b64_tr_b16 a[122:123], v26 offset:28672
    v_mfma_f32_16x16x32_bf16 v[132:135], a[100:103], v[96:99], v[132:135]
    s_waitcnt lgkmcnt(8)
    v_exp_f32 v67, v67
    v_mfma_f32_16x16x32_bf16 v[136:139], a[104:107], v[96:99], v[136:139]
    ds_read_b64_tr_b16 a[124:125], v27 offset:24576
    v_cvt_pk_bf16_f32 v65, v66, v67
    v_mfma_f32_16x16x32_bf16 v[168:171], a[104:107], v[104:107], v[168:171]
    v_exp_f32 v72, v72
    v_mfma_f32_16x16x32_bf16 v[200:203], a[104:107], v[112:115], v[200:203]
    ds_read_b64_tr_b16 a[126:127], v27 offset:28672
    v_mfma_f32_16x16x32_bf16 v[232:235], a[104:107], v[120:123], v[232:235]
    s_waitcnt lgkmcnt(8)
    v_exp_f32 v73, v73
    v_mfma_f32_16x16x32_bf16 v[236:239], a[108:111], v[120:123], v[236:239]
    ds_read_b128 a[64:67], v16 offset:24576
    v_cvt_pk_bf16_f32 v72, v72, v73
    v_mfma_f32_16x16x32_bf16 v[204:207], a[108:111], v[112:115], v[204:207]
    v_exp_f32 v74, v74
    v_mfma_f32_16x16x32_bf16 v[172:175], a[108:111], v[104:107], v[172:175]
    v_exp_f32 v75, v75
    v_mfma_f32_16x16x32_bf16 v[140:143], a[108:111], v[96:99], v[140:143]
    s_waitcnt lgkmcnt(7)
    v_cvt_pk_bf16_f32 v73, v74, v75
    v_mfma_f32_16x16x32_bf16 v[144:147], a[112:115], v[96:99], v[144:147]
    ds_read_b128 a[68:71], v17 offset:24576
    v_mfma_f32_16x16x32_bf16 v[176:179], a[112:115], v[104:107], v[176:179]
    v_exp_f32 v80, v80
    v_mfma_f32_16x16x32_bf16 v[208:211], a[112:115], v[112:115], v[208:211]
    v_exp_f32 v81, v81
    v_mfma_f32_16x16x32_bf16 v[240:243], a[112:115], v[120:123], v[240:243]
    s_waitcnt lgkmcnt(6)
    v_cvt_pk_bf16_f32 v80, v80, v81
    v_mfma_f32_16x16x32_bf16 v[244:247], a[116:119], v[120:123], v[244:247]
    ds_read_b128 a[72:75], v18 offset:24576
    v_mfma_f32_16x16x32_bf16 v[212:215], a[116:119], v[112:115], v[212:215]
    v_exp_f32 v82, v82
    v_mfma_f32_16x16x32_bf16 v[180:183], a[116:119], v[104:107], v[180:183]
    v_exp_f32 v83, v83
    v_mfma_f32_16x16x32_bf16 v[148:151], a[116:119], v[96:99], v[148:151]
    s_waitcnt lgkmcnt(5)
    v_cvt_pk_bf16_f32 v81, v82, v83
    v_mfma_f32_16x16x32_bf16 v[152:155], a[120:123], v[96:99], v[152:155]
    ds_read_b128 a[76:79], v19 offset:24576
    v_mfma_f32_16x16x32_bf16 v[184:187], a[120:123], v[104:107], v[184:187]
    v_exp_f32 v88, v88
    v_mfma_f32_16x16x32_bf16 v[216:219], a[120:123], v[112:115], v[216:219]
    v_exp_f32 v89, v89
    v_mfma_f32_16x16x32_bf16 v[248:251], a[120:123], v[120:123], v[248:251]
    s_waitcnt lgkmcnt(4)
    v_cvt_pk_bf16_f32 v88, v88, v89
    v_mfma_f32_16x16x32_bf16 v[252:255], a[124:127], v[120:123], v[252:255]
    ds_read_b128 a[80:83], v16 offset:28672
    v_mfma_f32_16x16x32_bf16 v[220:223], a[124:127], v[112:115], v[220:223]
    v_exp_f32 v90, v90
    v_mfma_f32_16x16x32_bf16 v[188:191], a[124:127], v[104:107], v[188:191]
    v_exp_f32 v91, v91
    v_mfma_f32_16x16x32_bf16 v[156:159], a[124:127], v[96:99], v[156:159]
    v_cvt_pk_bf16_f32 v89, v90, v91
    v_mfma_f32_16x16x32_bf16 a[128:131], a[144:147], v[96:99], a[128:131]
    ds_read_b128 a[84:87], v17 offset:28672
    v_mfma_f32_16x16x32_bf16 a[132:135], a[144:147], v[104:107], a[132:135]
    v_exp_f32 v68, v68
    v_mfma_f32_16x16x32_bf16 a[136:139], a[144:147], v[112:115], a[136:139]
    v_exp_f32 v69, v69
    v_mfma_f32_16x16x32_bf16 a[140:143], a[144:147], v[120:123], a[140:143]
    s_waitcnt lgkmcnt(2)
    v_cvt_pk_bf16_f32 v66, v68, v69
    v_mfma_f32_16x16x32_bf16 v[96:99], a[64:67], a[0:3], v[48:51]
    ds_read_b128 a[88:91], v18 offset:28672
    v_mfma_f32_16x16x32_bf16 v[96:99], a[68:71], a[4:7], v[96:99]
    v_exp_f32 v70, v70
    v_mfma_f32_16x16x32_bf16 v[96:99], a[72:75], a[8:11], v[96:99]
    v_exp_f32 v71, v71
    v_mfma_f32_16x16x32_bf16 v[96:99], a[76:79], a[12:15], v[96:99]
    v_cvt_pk_bf16_f32 v67, v70, v71
    v_mfma_f32_16x16x32_bf16 v[104:107], a[76:79], a[28:31], v[52:55]
    ds_read_b128 a[92:95], v19 offset:28672
    v_mfma_f32_16x16x32_bf16 v[104:107], a[72:75], a[24:27], v[104:107]
    v_exp_f32 v76, v76
    v_mfma_f32_16x16x32_bf16 v[104:107], a[68:71], a[20:23], v[104:107]
    v_exp_f32 v77, v77
    v_mfma_f32_16x16x32_bf16 v[104:107], a[64:67], a[16:19], v[104:107]
    v_cvt_pk_bf16_f32 v74, v76, v77
    v_mfma_f32_16x16x32_bf16 v[112:115], a[64:67], a[32:35], v[56:59]
    v_exp_f32 v78, v78
    v_mfma_f32_16x16x32_bf16 v[112:115], a[68:71], a[36:39], v[112:115]
    v_mfma_f32_16x16x32_bf16 v[112:115], a[72:75], a[40:43], v[112:115]
    v_exp_f32 v79, v79
    v_mfma_f32_16x16x32_bf16 v[112:115], a[76:79], a[44:47], v[112:115]
    v_cvt_pk_bf16_f32 v75, v78, v79
    v_mfma_f32_16x16x32_bf16 v[120:123], a[76:79], a[60:63], v[60:63]
    v_exp_f32 v84, v84
    v_mfma_f32_16x16x32_bf16 v[120:123], a[72:75], a[56:59], v[120:123]
    v_mfma_f32_16x16x32_bf16 v[120:123], a[68:71], a[52:55], v[120:123]
    v_exp_f32 v85, v85
    v_mfma_f32_16x16x32_bf16 v[120:123], a[64:67], a[48:51], v[120:123]
    v_cvt_pk_bf16_f32 v82, v84, v85
    s_waitcnt vmcnt(0) lgkmcnt(0)
    s_barrier
    v_mfma_f32_16x16x32_bf16 v[100:103], a[80:83], a[0:3], v[48:51]
    ds_read_b64_tr_b16 a[96:97], v20 offset:32768
    v_mfma_f32_16x16x32_bf16 v[100:103], a[84:87], a[4:7], v[100:103]
    v_exp_f32 v86, v86
    v_mfma_f32_16x16x32_bf16 v[100:103], a[88:91], a[8:11], v[100:103]
    ds_read_b64_tr_b16 a[98:99], v20 offset:36864
    v_mfma_f32_16x16x32_bf16 v[100:103], a[92:95], a[12:15], v[100:103]
    v_exp_f32 v87, v87
    v_mfma_f32_16x16x32_bf16 v[108:111], a[92:95], a[28:31], v[52:55]
    ds_read_b64_tr_b16 a[100:101], v21 offset:32768
    v_cvt_pk_bf16_f32 v83, v86, v87
    v_mfma_f32_16x16x32_bf16 v[108:111], a[88:91], a[24:27], v[108:111]
    v_exp_f32 v92, v92
    v_mfma_f32_16x16x32_bf16 v[108:111], a[84:87], a[20:23], v[108:111]
    ds_read_b64_tr_b16 a[102:103], v21 offset:36864
    v_mfma_f32_16x16x32_bf16 v[108:111], a[80:83], a[16:19], v[108:111]
    v_exp_f32 v93, v93
    v_mfma_f32_16x16x32_bf16 v[116:119], a[80:83], a[32:35], v[56:59]
    ds_read_b64_tr_b16 a[104:105], v22 offset:32768
    v_cvt_pk_bf16_f32 v90, v92, v93
    v_mfma_f32_16x16x32_bf16 v[116:119], a[84:87], a[36:39], v[116:119]
    v_exp_f32 v94, v94
    v_mfma_f32_16x16x32_bf16 v[116:119], a[88:91], a[40:43], v[116:119]
    ds_read_b64_tr_b16 a[106:107], v22 offset:36864
    v_mfma_f32_16x16x32_bf16 v[116:119], a[92:95], a[44:47], v[116:119]
    v_exp_f32 v95, v95
    v_mfma_f32_16x16x32_bf16 v[124:127], a[92:95], a[60:63], v[60:63]
    ds_read_b64_tr_b16 a[108:109], v23 offset:32768
    v_cvt_pk_bf16_f32 v91, v94, v95
    v_mfma_f32_16x16x32_bf16 v[124:127], a[88:91], a[56:59], v[124:127]
    v_mfma_f32_16x16x32_bf16 v[124:127], a[84:87], a[52:55], v[124:127]
    ds_read_b64_tr_b16 a[110:111], v23 offset:36864
    v_mfma_f32_16x16x32_bf16 v[124:127], a[80:83], a[48:51], v[124:127]
    s_waitcnt lgkmcnt(6)
    v_mfma_f32_16x16x32_bf16 v[128:131], a[96:99], v[64:67], v[128:131]
    ds_read_b64_tr_b16 a[112:113], v24 offset:32768
    v_mfma_f32_16x16x32_bf16 v[160:163], a[96:99], v[72:75], v[160:163]
    v_exp_f32 v96, v96
    v_mfma_f32_16x16x32_bf16 v[192:195], a[96:99], v[80:83], v[192:195]
    ds_read_b64_tr_b16 a[114:115], v24 offset:36864
    v_mfma_f32_16x16x32_bf16 v[224:227], a[96:99], v[88:91], v[224:227]
    s_waitcnt lgkmcnt(6)
    v_exp_f32 v97, v97
    v_mfma_f32_16x16x32_bf16 v[228:231], a[100:103], v[88:91], v[228:231]
    ds_read_b64_tr_b16 a[116:117], v25 offset:32768
    v_cvt_pk_bf16_f32 v96, v96, v97
    v_mfma_f32_16x16x32_bf16 v[196:199], a[100:103], v[80:83], v[196:199]
    v_exp_f32 v98, v98
    v_mfma_f32_16x16x32_bf16 v[164:167], a[100:103], v[72:75], v[164:167]
    ds_read_b64_tr_b16 a[118:119], v25 offset:36864
    v_mfma_f32_16x16x32_bf16 v[132:135], a[100:103], v[64:67], v[132:135]
    s_waitcnt lgkmcnt(6)
    v_exp_f32 v99, v99
    v_mfma_f32_16x16x32_bf16 v[136:139], a[104:107], v[64:67], v[136:139]
    ds_read_b64_tr_b16 a[120:121], v26 offset:32768
    v_cvt_pk_bf16_f32 v97, v98, v99
    v_mfma_f32_16x16x32_bf16 v[168:171], a[104:107], v[72:75], v[168:171]
    v_exp_f32 v104, v104
    v_mfma_f32_16x16x32_bf16 v[200:203], a[104:107], v[80:83], v[200:203]
    ds_read_b64_tr_b16 a[122:123], v26 offset:36864
    v_mfma_f32_16x16x32_bf16 v[232:235], a[104:107], v[88:91], v[232:235]
    s_waitcnt lgkmcnt(6)
    v_exp_f32 v105, v105
    v_mfma_f32_16x16x32_bf16 v[236:239], a[108:111], v[88:91], v[236:239]
    ds_read_b64_tr_b16 a[124:125], v27 offset:32768
    v_cvt_pk_bf16_f32 v104, v104, v105
    v_mfma_f32_16x16x32_bf16 v[204:207], a[108:111], v[80:83], v[204:207]
    v_exp_f32 v106, v106
    v_mfma_f32_16x16x32_bf16 v[172:175], a[108:111], v[72:75], v[172:175]
    ds_read_b64_tr_b16 a[126:127], v27 offset:36864
    v_mfma_f32_16x16x32_bf16 v[140:143], a[108:111], v[64:67], v[140:143]
    s_waitcnt lgkmcnt(6)
    ds_read_b128 a[64:67], v16 offset:32768
    v_mfma_f32_16x16x32_bf16 v[144:147], a[112:115], v[64:67], v[144:147]
    v_exp_f32 v107, v107
    v_mfma_f32_16x16x32_bf16 v[176:179], a[112:115], v[72:75], v[176:179]
    v_exp_f32 v112, v112
    v_mfma_f32_16x16x32_bf16 v[208:211], a[112:115], v[80:83], v[208:211]
    ds_read_b128 a[68:71], v17 offset:32768
    v_cvt_pk_bf16_f32 v105, v106, v107
    v_mfma_f32_16x16x32_bf16 v[240:243], a[112:115], v[88:91], v[240:243]
    s_waitcnt lgkmcnt(6)
    v_exp_f32 v113, v113
    v_mfma_f32_16x16x32_bf16 v[244:247], a[116:119], v[88:91], v[244:247]
    v_exp_f32 v114, v114
    v_mfma_f32_16x16x32_bf16 v[212:215], a[116:119], v[80:83], v[212:215]
    v_cvt_pk_bf16_f32 v112, v112, v113
    v_mfma_f32_16x16x32_bf16 v[180:183], a[116:119], v[72:75], v[180:183]
    ds_read_b128 a[72:75], v18 offset:32768
    v_mfma_f32_16x16x32_bf16 v[148:151], a[116:119], v[64:67], v[148:151]
    s_waitcnt lgkmcnt(5)
    v_exp_f32 v115, v115
    v_mfma_f32_16x16x32_bf16 v[152:155], a[120:123], v[64:67], v[152:155]
    v_exp_f32 v120, v120
    v_mfma_f32_16x16x32_bf16 v[184:187], a[120:123], v[72:75], v[184:187]
    v_cvt_pk_bf16_f32 v113, v114, v115
    v_mfma_f32_16x16x32_bf16 v[216:219], a[120:123], v[80:83], v[216:219]
    ds_read_b128 a[76:79], v19 offset:32768
    v_mfma_f32_16x16x32_bf16 v[248:251], a[120:123], v[88:91], v[248:251]
    s_waitcnt lgkmcnt(4)
    v_exp_f32 v121, v121
    v_mfma_f32_16x16x32_bf16 v[252:255], a[124:127], v[88:91], v[252:255]
    v_exp_f32 v122, v122
    v_mfma_f32_16x16x32_bf16 v[220:223], a[124:127], v[80:83], v[220:223]
    v_cvt_pk_bf16_f32 v120, v120, v121
    v_mfma_f32_16x16x32_bf16 v[188:191], a[124:127], v[72:75], v[188:191]
    ds_read_b128 a[80:83], v16 offset:36864
    v_mfma_f32_16x16x32_bf16 v[156:159], a[124:127], v[64:67], v[156:159]
    v_exp_f32 v123, v123
    v_mfma_f32_16x16x32_bf16 a[128:131], a[144:147], v[64:67], a[128:131]
    v_exp_f32 v100, v100
    v_mfma_f32_16x16x32_bf16 a[132:135], a[144:147], v[72:75], a[132:135]
    v_cvt_pk_bf16_f32 v121, v122, v123
    v_mfma_f32_16x16x32_bf16 a[136:139], a[144:147], v[80:83], a[136:139]
    ds_read_b128 a[84:87], v17 offset:36864
    v_mfma_f32_16x16x32_bf16 a[140:143], a[144:147], v[88:91], a[140:143]
    s_waitcnt lgkmcnt(2)
    v_exp_f32 v101, v101
    v_mfma_f32_16x16x32_bf16 v[64:67], a[64:67], a[0:3], v[48:51]
    v_exp_f32 v102, v102
    v_mfma_f32_16x16x32_bf16 v[64:67], a[68:71], a[4:7], v[64:67]
    v_cvt_pk_bf16_f32 v98, v100, v101
    v_mfma_f32_16x16x32_bf16 v[64:67], a[72:75], a[8:11], v[64:67]
    ds_read_b128 a[88:91], v18 offset:36864
    v_mfma_f32_16x16x32_bf16 v[64:67], a[76:79], a[12:15], v[64:67]
    v_exp_f32 v103, v103
    v_mfma_f32_16x16x32_bf16 v[72:75], a[76:79], a[28:31], v[52:55]
    v_exp_f32 v108, v108
    v_mfma_f32_16x16x32_bf16 v[72:75], a[72:75], a[24:27], v[72:75]
    v_cvt_pk_bf16_f32 v99, v102, v103
    v_mfma_f32_16x16x32_bf16 v[72:75], a[68:71], a[20:23], v[72:75]
    ds_read_b128 a[92:95], v19 offset:36864
    v_mfma_f32_16x16x32_bf16 v[72:75], a[64:67], a[16:19], v[72:75]
    v_exp_f32 v109, v109
    v_mfma_f32_16x16x32_bf16 v[80:83], a[64:67], a[32:35], v[56:59]
    v_exp_f32 v110, v110
    v_mfma_f32_16x16x32_bf16 v[80:83], a[68:71], a[36:39], v[80:83]
    v_cvt_pk_bf16_f32 v106, v108, v109
    v_mfma_f32_16x16x32_bf16 v[80:83], a[72:75], a[40:43], v[80:83]
    v_exp_f32 v111, v111
    v_mfma_f32_16x16x32_bf16 v[80:83], a[76:79], a[44:47], v[80:83]
    v_cvt_pk_bf16_f32 v107, v110, v111
    v_mfma_f32_16x16x32_bf16 v[88:91], a[76:79], a[60:63], v[60:63]
    ds_read_b64_tr_b16 a[96:97], v20 offset:40960
    v_mfma_f32_16x16x32_bf16 v[88:91], a[72:75], a[56:59], v[88:91]
    v_exp_f32 v116, v116
    v_mfma_f32_16x16x32_bf16 v[88:91], a[68:71], a[52:55], v[88:91]
    ds_read_b64_tr_b16 a[98:99], v20 offset:45056
    v_mfma_f32_16x16x32_bf16 v[88:91], a[64:67], a[48:51], v[88:91]
    s_waitcnt lgkmcnt(2)
    v_exp_f32 v117, v117
    v_mfma_f32_16x16x32_bf16 v[68:71], a[80:83], a[0:3], v[48:51]
    ds_read_b64_tr_b16 a[100:101], v21 offset:40960
    v_cvt_pk_bf16_f32 v114, v116, v117
    v_mfma_f32_16x16x32_bf16 v[68:71], a[84:87], a[4:7], v[68:71]
    v_exp_f32 v118, v118
    v_mfma_f32_16x16x32_bf16 v[68:71], a[88:91], a[8:11], v[68:71]
    ds_read_b64_tr_b16 a[102:103], v21 offset:45056
    v_mfma_f32_16x16x32_bf16 v[68:71], a[92:95], a[12:15], v[68:71]
    v_exp_f32 v119, v119
    v_mfma_f32_16x16x32_bf16 v[76:79], a[92:95], a[28:31], v[52:55]
    ds_read_b64_tr_b16 a[104:105], v22 offset:40960
    v_cvt_pk_bf16_f32 v115, v118, v119
    v_mfma_f32_16x16x32_bf16 v[76:79], a[88:91], a[24:27], v[76:79]
    v_exp_f32 v124, v124
    v_mfma_f32_16x16x32_bf16 v[76:79], a[84:87], a[20:23], v[76:79]
    ds_read_b64_tr_b16 a[106:107], v22 offset:45056
    v_mfma_f32_16x16x32_bf16 v[76:79], a[80:83], a[16:19], v[76:79]
    v_exp_f32 v125, v125
    v_mfma_f32_16x16x32_bf16 v[84:87], a[80:83], a[32:35], v[56:59]
    ds_read_b64_tr_b16 a[108:109], v23 offset:40960
    v_cvt_pk_bf16_f32 v122, v124, v125
    v_mfma_f32_16x16x32_bf16 v[84:87], a[84:87], a[36:39], v[84:87]
    v_exp_f32 v126, v126
    v_mfma_f32_16x16x32_bf16 v[84:87], a[88:91], a[40:43], v[84:87]
    ds_read_b64_tr_b16 a[110:111], v23 offset:45056
    v_mfma_f32_16x16x32_bf16 v[84:87], a[92:95], a[44:47], v[84:87]
    v_exp_f32 v127, v127
    v_mfma_f32_16x16x32_bf16 v[92:95], a[92:95], a[60:63], v[60:63]
    ds_read_b64_tr_b16 a[112:113], v24 offset:40960
    v_cvt_pk_bf16_f32 v123, v126, v127
    v_mfma_f32_16x16x32_bf16 v[92:95], a[88:91], a[56:59], v[92:95]
    v_mfma_f32_16x16x32_bf16 v[92:95], a[84:87], a[52:55], v[92:95]
    ds_read_b64_tr_b16 a[114:115], v24 offset:45056
    v_mfma_f32_16x16x32_bf16 v[92:95], a[80:83], a[48:51], v[92:95]
    s_waitcnt lgkmcnt(8)
    v_mfma_f32_16x16x32_bf16 v[128:131], a[96:99], v[96:99], v[128:131]
    ds_read_b64_tr_b16 a[116:117], v25 offset:40960
    v_mfma_f32_16x16x32_bf16 v[160:163], a[96:99], v[104:107], v[160:163]
    v_exp_f32 v64, v64
    v_mfma_f32_16x16x32_bf16 v[192:195], a[96:99], v[112:115], v[192:195]
    ds_read_b64_tr_b16 a[118:119], v25 offset:45056
    v_mfma_f32_16x16x32_bf16 v[224:227], a[96:99], v[120:123], v[224:227]
    s_waitcnt lgkmcnt(8)
    v_exp_f32 v65, v65
    v_mfma_f32_16x16x32_bf16 v[228:231], a[100:103], v[120:123], v[228:231]
    ds_read_b64_tr_b16 a[120:121], v26 offset:40960
    v_cvt_pk_bf16_f32 v64, v64, v65
    v_mfma_f32_16x16x32_bf16 v[196:199], a[100:103], v[112:115], v[196:199]
    v_exp_f32 v66, v66
    v_mfma_f32_16x16x32_bf16 v[164:167], a[100:103], v[104:107], v[164:167]
    ds_read_b64_tr_b16 a[122:123], v26 offset:45056
    v_mfma_f32_16x16x32_bf16 v[132:135], a[100:103], v[96:99], v[132:135]
    s_waitcnt lgkmcnt(8)
    v_exp_f32 v67, v67
    v_mfma_f32_16x16x32_bf16 v[136:139], a[104:107], v[96:99], v[136:139]
    ds_read_b64_tr_b16 a[124:125], v27 offset:40960
    v_cvt_pk_bf16_f32 v65, v66, v67
    v_mfma_f32_16x16x32_bf16 v[168:171], a[104:107], v[104:107], v[168:171]
    v_exp_f32 v72, v72
    v_mfma_f32_16x16x32_bf16 v[200:203], a[104:107], v[112:115], v[200:203]
    ds_read_b64_tr_b16 a[126:127], v27 offset:45056
    v_mfma_f32_16x16x32_bf16 v[232:235], a[104:107], v[120:123], v[232:235]
    s_waitcnt lgkmcnt(8)
    v_exp_f32 v73, v73
    v_mfma_f32_16x16x32_bf16 v[236:239], a[108:111], v[120:123], v[236:239]
    ds_read_b128 a[64:67], v16 offset:40960
    v_cvt_pk_bf16_f32 v72, v72, v73
    v_mfma_f32_16x16x32_bf16 v[204:207], a[108:111], v[112:115], v[204:207]
    v_exp_f32 v74, v74
    v_mfma_f32_16x16x32_bf16 v[172:175], a[108:111], v[104:107], v[172:175]
    v_exp_f32 v75, v75
    v_mfma_f32_16x16x32_bf16 v[140:143], a[108:111], v[96:99], v[140:143]
    s_waitcnt lgkmcnt(7)
    v_cvt_pk_bf16_f32 v73, v74, v75
    v_mfma_f32_16x16x32_bf16 v[144:147], a[112:115], v[96:99], v[144:147]
    ds_read_b128 a[68:71], v17 offset:40960
    v_mfma_f32_16x16x32_bf16 v[176:179], a[112:115], v[104:107], v[176:179]
    v_exp_f32 v80, v80
    v_mfma_f32_16x16x32_bf16 v[208:211], a[112:115], v[112:115], v[208:211]
    v_exp_f32 v81, v81
    v_mfma_f32_16x16x32_bf16 v[240:243], a[112:115], v[120:123], v[240:243]
    s_waitcnt lgkmcnt(6)
    v_cvt_pk_bf16_f32 v80, v80, v81
    v_mfma_f32_16x16x32_bf16 v[244:247], a[116:119], v[120:123], v[244:247]
    ds_read_b128 a[72:75], v18 offset:40960
    v_mfma_f32_16x16x32_bf16 v[212:215], a[116:119], v[112:115], v[212:215]
    v_exp_f32 v82, v82
    v_mfma_f32_16x16x32_bf16 v[180:183], a[116:119], v[104:107], v[180:183]
    v_exp_f32 v83, v83
    v_mfma_f32_16x16x32_bf16 v[148:151], a[116:119], v[96:99], v[148:151]
    s_waitcnt lgkmcnt(5)
    v_cvt_pk_bf16_f32 v81, v82, v83
    v_mfma_f32_16x16x32_bf16 v[152:155], a[120:123], v[96:99], v[152:155]
    ds_read_b128 a[76:79], v19 offset:40960
    v_mfma_f32_16x16x32_bf16 v[184:187], a[120:123], v[104:107], v[184:187]
    v_exp_f32 v88, v88
    v_mfma_f32_16x16x32_bf16 v[216:219], a[120:123], v[112:115], v[216:219]
    v_exp_f32 v89, v89
    v_mfma_f32_16x16x32_bf16 v[248:251], a[120:123], v[120:123], v[248:251]
    s_waitcnt lgkmcnt(4)
    v_cvt_pk_bf16_f32 v88, v88, v89
    v_mfma_f32_16x16x32_bf16 v[252:255], a[124:127], v[120:123], v[252:255]
    ds_read_b128 a[80:83], v16 offset:45056
    v_mfma_f32_16x16x32_bf16 v[220:223], a[124:127], v[112:115], v[220:223]
    v_exp_f32 v90, v90
    v_mfma_f32_16x16x32_bf16 v[188:191], a[124:127], v[104:107], v[188:191]
    v_exp_f32 v91, v91
    v_mfma_f32_16x16x32_bf16 v[156:159], a[124:127], v[96:99], v[156:159]
    v_cvt_pk_bf16_f32 v89, v90, v91
    v_mfma_f32_16x16x32_bf16 a[128:131], a[144:147], v[96:99], a[128:131]
    ds_read_b128 a[84:87], v17 offset:45056
    v_mfma_f32_16x16x32_bf16 a[132:135], a[144:147], v[104:107], a[132:135]
    v_exp_f32 v68, v68
    v_mfma_f32_16x16x32_bf16 a[136:139], a[144:147], v[112:115], a[136:139]
    v_exp_f32 v69, v69
    v_mfma_f32_16x16x32_bf16 a[140:143], a[144:147], v[120:123], a[140:143]
    s_waitcnt lgkmcnt(2)
    v_cvt_pk_bf16_f32 v66, v68, v69
    v_mfma_f32_16x16x32_bf16 v[96:99], a[64:67], a[0:3], v[48:51]
    ds_read_b128 a[88:91], v18 offset:45056
    v_mfma_f32_16x16x32_bf16 v[96:99], a[68:71], a[4:7], v[96:99]
    v_exp_f32 v70, v70
    v_mfma_f32_16x16x32_bf16 v[96:99], a[72:75], a[8:11], v[96:99]
    v_exp_f32 v71, v71
    v_mfma_f32_16x16x32_bf16 v[96:99], a[76:79], a[12:15], v[96:99]
    v_cvt_pk_bf16_f32 v67, v70, v71
    v_mfma_f32_16x16x32_bf16 v[104:107], a[76:79], a[28:31], v[52:55]
    ds_read_b128 a[92:95], v19 offset:45056
    v_mfma_f32_16x16x32_bf16 v[104:107], a[72:75], a[24:27], v[104:107]
    v_exp_f32 v76, v76
    v_mfma_f32_16x16x32_bf16 v[104:107], a[68:71], a[20:23], v[104:107]
    v_exp_f32 v77, v77
    v_mfma_f32_16x16x32_bf16 v[104:107], a[64:67], a[16:19], v[104:107]
    v_cvt_pk_bf16_f32 v74, v76, v77
    v_mfma_f32_16x16x32_bf16 v[112:115], a[64:67], a[32:35], v[56:59]
    v_exp_f32 v78, v78
    v_mfma_f32_16x16x32_bf16 v[112:115], a[68:71], a[36:39], v[112:115]
    v_mfma_f32_16x16x32_bf16 v[112:115], a[72:75], a[40:43], v[112:115]
    v_exp_f32 v79, v79
    v_mfma_f32_16x16x32_bf16 v[112:115], a[76:79], a[44:47], v[112:115]
    v_cvt_pk_bf16_f32 v75, v78, v79
    v_mfma_f32_16x16x32_bf16 v[120:123], a[76:79], a[60:63], v[60:63]
    v_exp_f32 v84, v84
    v_mfma_f32_16x16x32_bf16 v[120:123], a[72:75], a[56:59], v[120:123]
    v_mfma_f32_16x16x32_bf16 v[120:123], a[68:71], a[52:55], v[120:123]
    v_exp_f32 v85, v85
    v_mfma_f32_16x16x32_bf16 v[120:123], a[64:67], a[48:51], v[120:123]
    v_cvt_pk_bf16_f32 v82, v84, v85
    s_waitcnt vmcnt(0) lgkmcnt(0)
    s_barrier
    v_mfma_f32_16x16x32_bf16 v[100:103], a[80:83], a[0:3], v[48:51]
    ds_read_b64_tr_b16 a[96:97], v20 offset:49152
    v_mfma_f32_16x16x32_bf16 v[100:103], a[84:87], a[4:7], v[100:103]
    v_exp_f32 v86, v86
    v_mfma_f32_16x16x32_bf16 v[100:103], a[88:91], a[8:11], v[100:103]
    ds_read_b64_tr_b16 a[98:99], v20 offset:53248
    v_mfma_f32_16x16x32_bf16 v[100:103], a[92:95], a[12:15], v[100:103]
    v_exp_f32 v87, v87
    v_mfma_f32_16x16x32_bf16 v[108:111], a[92:95], a[28:31], v[52:55]
    ds_read_b64_tr_b16 a[100:101], v21 offset:49152
    v_cvt_pk_bf16_f32 v83, v86, v87
    v_mfma_f32_16x16x32_bf16 v[108:111], a[88:91], a[24:27], v[108:111]
    v_exp_f32 v92, v92
    v_mfma_f32_16x16x32_bf16 v[108:111], a[84:87], a[20:23], v[108:111]
    ds_read_b64_tr_b16 a[102:103], v21 offset:53248
    v_mfma_f32_16x16x32_bf16 v[108:111], a[80:83], a[16:19], v[108:111]
    v_exp_f32 v93, v93
    v_mfma_f32_16x16x32_bf16 v[116:119], a[80:83], a[32:35], v[56:59]
    ds_read_b64_tr_b16 a[104:105], v22 offset:49152
    v_cvt_pk_bf16_f32 v90, v92, v93
    v_mfma_f32_16x16x32_bf16 v[116:119], a[84:87], a[36:39], v[116:119]
    v_exp_f32 v94, v94
    v_mfma_f32_16x16x32_bf16 v[116:119], a[88:91], a[40:43], v[116:119]
    ds_read_b64_tr_b16 a[106:107], v22 offset:53248
    v_mfma_f32_16x16x32_bf16 v[116:119], a[92:95], a[44:47], v[116:119]
    v_exp_f32 v95, v95
    v_mfma_f32_16x16x32_bf16 v[124:127], a[92:95], a[60:63], v[60:63]
    ds_read_b64_tr_b16 a[108:109], v23 offset:49152
    v_cvt_pk_bf16_f32 v91, v94, v95
    v_mfma_f32_16x16x32_bf16 v[124:127], a[88:91], a[56:59], v[124:127]
    v_mfma_f32_16x16x32_bf16 v[124:127], a[84:87], a[52:55], v[124:127]
    ds_read_b64_tr_b16 a[110:111], v23 offset:53248
    v_mfma_f32_16x16x32_bf16 v[124:127], a[80:83], a[48:51], v[124:127]
    s_waitcnt lgkmcnt(6)
    v_mfma_f32_16x16x32_bf16 v[128:131], a[96:99], v[64:67], v[128:131]
    ds_read_b64_tr_b16 a[112:113], v24 offset:49152
    v_mfma_f32_16x16x32_bf16 v[160:163], a[96:99], v[72:75], v[160:163]
    v_exp_f32 v96, v96
    v_mfma_f32_16x16x32_bf16 v[192:195], a[96:99], v[80:83], v[192:195]
    ds_read_b64_tr_b16 a[114:115], v24 offset:53248
    v_mfma_f32_16x16x32_bf16 v[224:227], a[96:99], v[88:91], v[224:227]
    s_waitcnt lgkmcnt(6)
    v_exp_f32 v97, v97
    v_mfma_f32_16x16x32_bf16 v[228:231], a[100:103], v[88:91], v[228:231]
    ds_read_b64_tr_b16 a[116:117], v25 offset:49152
    v_cvt_pk_bf16_f32 v96, v96, v97
    v_mfma_f32_16x16x32_bf16 v[196:199], a[100:103], v[80:83], v[196:199]
    v_exp_f32 v98, v98
    v_mfma_f32_16x16x32_bf16 v[164:167], a[100:103], v[72:75], v[164:167]
    ds_read_b64_tr_b16 a[118:119], v25 offset:53248
    v_mfma_f32_16x16x32_bf16 v[132:135], a[100:103], v[64:67], v[132:135]
    s_waitcnt lgkmcnt(6)
    v_exp_f32 v99, v99
    v_mfma_f32_16x16x32_bf16 v[136:139], a[104:107], v[64:67], v[136:139]
    ds_read_b64_tr_b16 a[120:121], v26 offset:49152
    v_cvt_pk_bf16_f32 v97, v98, v99
    v_mfma_f32_16x16x32_bf16 v[168:171], a[104:107], v[72:75], v[168:171]
    v_exp_f32 v104, v104
    v_mfma_f32_16x16x32_bf16 v[200:203], a[104:107], v[80:83], v[200:203]
    ds_read_b64_tr_b16 a[122:123], v26 offset:53248
    v_mfma_f32_16x16x32_bf16 v[232:235], a[104:107], v[88:91], v[232:235]
    s_waitcnt lgkmcnt(6)
    v_exp_f32 v105, v105
    v_mfma_f32_16x16x32_bf16 v[236:239], a[108:111], v[88:91], v[236:239]
    ds_read_b64_tr_b16 a[124:125], v27 offset:49152
    v_cvt_pk_bf16_f32 v104, v104, v105
    v_mfma_f32_16x16x32_bf16 v[204:207], a[108:111], v[80:83], v[204:207]
    v_exp_f32 v106, v106
    v_mfma_f32_16x16x32_bf16 v[172:175], a[108:111], v[72:75], v[172:175]
    ds_read_b64_tr_b16 a[126:127], v27 offset:53248
    v_mfma_f32_16x16x32_bf16 v[140:143], a[108:111], v[64:67], v[140:143]
    s_waitcnt lgkmcnt(6)
    ds_read_b128 a[64:67], v16 offset:49152
    v_mfma_f32_16x16x32_bf16 v[144:147], a[112:115], v[64:67], v[144:147]
    v_exp_f32 v107, v107
    v_mfma_f32_16x16x32_bf16 v[176:179], a[112:115], v[72:75], v[176:179]
    v_exp_f32 v112, v112
    v_mfma_f32_16x16x32_bf16 v[208:211], a[112:115], v[80:83], v[208:211]
    ds_read_b128 a[68:71], v17 offset:49152
    v_cvt_pk_bf16_f32 v105, v106, v107
    v_mfma_f32_16x16x32_bf16 v[240:243], a[112:115], v[88:91], v[240:243]
    s_waitcnt lgkmcnt(6)
    v_exp_f32 v113, v113
    v_mfma_f32_16x16x32_bf16 v[244:247], a[116:119], v[88:91], v[244:247]
    v_exp_f32 v114, v114
    v_mfma_f32_16x16x32_bf16 v[212:215], a[116:119], v[80:83], v[212:215]
    v_cvt_pk_bf16_f32 v112, v112, v113
    v_mfma_f32_16x16x32_bf16 v[180:183], a[116:119], v[72:75], v[180:183]
    ds_read_b128 a[72:75], v18 offset:49152
    v_mfma_f32_16x16x32_bf16 v[148:151], a[116:119], v[64:67], v[148:151]
    s_waitcnt lgkmcnt(5)
    v_exp_f32 v115, v115
    v_mfma_f32_16x16x32_bf16 v[152:155], a[120:123], v[64:67], v[152:155]
    v_exp_f32 v120, v120
    v_mfma_f32_16x16x32_bf16 v[184:187], a[120:123], v[72:75], v[184:187]
    v_cvt_pk_bf16_f32 v113, v114, v115
    v_mfma_f32_16x16x32_bf16 v[216:219], a[120:123], v[80:83], v[216:219]
    ds_read_b128 a[76:79], v19 offset:49152
    v_mfma_f32_16x16x32_bf16 v[248:251], a[120:123], v[88:91], v[248:251]
    s_waitcnt lgkmcnt(4)
    v_exp_f32 v121, v121
    v_mfma_f32_16x16x32_bf16 v[252:255], a[124:127], v[88:91], v[252:255]
    v_exp_f32 v122, v122
    v_mfma_f32_16x16x32_bf16 v[220:223], a[124:127], v[80:83], v[220:223]
    v_cvt_pk_bf16_f32 v120, v120, v121
    v_mfma_f32_16x16x32_bf16 v[188:191], a[124:127], v[72:75], v[188:191]
    ds_read_b128 a[80:83], v16 offset:53248
    v_mfma_f32_16x16x32_bf16 v[156:159], a[124:127], v[64:67], v[156:159]
    v_exp_f32 v123, v123
    v_mfma_f32_16x16x32_bf16 a[128:131], a[144:147], v[64:67], a[128:131]
    v_exp_f32 v100, v100
    v_mfma_f32_16x16x32_bf16 a[132:135], a[144:147], v[72:75], a[132:135]
    v_cvt_pk_bf16_f32 v121, v122, v123
    v_mfma_f32_16x16x32_bf16 a[136:139], a[144:147], v[80:83], a[136:139]
    ds_read_b128 a[84:87], v17 offset:53248
    v_mfma_f32_16x16x32_bf16 a[140:143], a[144:147], v[88:91], a[140:143]
    s_waitcnt lgkmcnt(2)
    v_exp_f32 v101, v101
    v_mfma_f32_16x16x32_bf16 v[64:67], a[64:67], a[0:3], v[48:51]
    v_exp_f32 v102, v102
    v_mfma_f32_16x16x32_bf16 v[64:67], a[68:71], a[4:7], v[64:67]
    v_cvt_pk_bf16_f32 v98, v100, v101
    v_mfma_f32_16x16x32_bf16 v[64:67], a[72:75], a[8:11], v[64:67]
    ds_read_b128 a[88:91], v18 offset:53248
    v_mfma_f32_16x16x32_bf16 v[64:67], a[76:79], a[12:15], v[64:67]
    v_exp_f32 v103, v103
    v_mfma_f32_16x16x32_bf16 v[72:75], a[76:79], a[28:31], v[52:55]
    v_exp_f32 v108, v108
    v_mfma_f32_16x16x32_bf16 v[72:75], a[72:75], a[24:27], v[72:75]
    v_cvt_pk_bf16_f32 v99, v102, v103
    v_mfma_f32_16x16x32_bf16 v[72:75], a[68:71], a[20:23], v[72:75]
    ds_read_b128 a[92:95], v19 offset:53248
    v_mfma_f32_16x16x32_bf16 v[72:75], a[64:67], a[16:19], v[72:75]
    v_exp_f32 v109, v109
    v_mfma_f32_16x16x32_bf16 v[80:83], a[64:67], a[32:35], v[56:59]
    v_exp_f32 v110, v110
    v_mfma_f32_16x16x32_bf16 v[80:83], a[68:71], a[36:39], v[80:83]
    v_cvt_pk_bf16_f32 v106, v108, v109
    v_mfma_f32_16x16x32_bf16 v[80:83], a[72:75], a[40:43], v[80:83]
    v_exp_f32 v111, v111
    v_mfma_f32_16x16x32_bf16 v[80:83], a[76:79], a[44:47], v[80:83]
    v_cvt_pk_bf16_f32 v107, v110, v111
    v_mfma_f32_16x16x32_bf16 v[88:91], a[76:79], a[60:63], v[60:63]
    ds_read_b64_tr_b16 a[96:97], v20 offset:57344
    v_mfma_f32_16x16x32_bf16 v[88:91], a[72:75], a[56:59], v[88:91]
    v_exp_f32 v116, v116
    v_mfma_f32_16x16x32_bf16 v[88:91], a[68:71], a[52:55], v[88:91]
    ds_read_b64_tr_b16 a[98:99], v20 offset:61440
    v_mfma_f32_16x16x32_bf16 v[88:91], a[64:67], a[48:51], v[88:91]
    s_waitcnt lgkmcnt(2)
    v_exp_f32 v117, v117
    v_mfma_f32_16x16x32_bf16 v[68:71], a[80:83], a[0:3], v[48:51]
    ds_read_b64_tr_b16 a[100:101], v21 offset:57344
    v_cvt_pk_bf16_f32 v114, v116, v117
    v_mfma_f32_16x16x32_bf16 v[68:71], a[84:87], a[4:7], v[68:71]
    v_exp_f32 v118, v118
    v_mfma_f32_16x16x32_bf16 v[68:71], a[88:91], a[8:11], v[68:71]
    ds_read_b64_tr_b16 a[102:103], v21 offset:61440
    v_mfma_f32_16x16x32_bf16 v[68:71], a[92:95], a[12:15], v[68:71]
    v_exp_f32 v119, v119
    v_mfma_f32_16x16x32_bf16 v[76:79], a[92:95], a[28:31], v[52:55]
    ds_read_b64_tr_b16 a[104:105], v22 offset:57344
    v_cvt_pk_bf16_f32 v115, v118, v119
    v_mfma_f32_16x16x32_bf16 v[76:79], a[88:91], a[24:27], v[76:79]
    v_exp_f32 v124, v124
    v_mfma_f32_16x16x32_bf16 v[76:79], a[84:87], a[20:23], v[76:79]
    ds_read_b64_tr_b16 a[106:107], v22 offset:61440
    v_mfma_f32_16x16x32_bf16 v[76:79], a[80:83], a[16:19], v[76:79]
    v_exp_f32 v125, v125
    v_mfma_f32_16x16x32_bf16 v[84:87], a[80:83], a[32:35], v[56:59]
    ds_read_b64_tr_b16 a[108:109], v23 offset:57344
    v_cvt_pk_bf16_f32 v122, v124, v125
    v_mfma_f32_16x16x32_bf16 v[84:87], a[84:87], a[36:39], v[84:87]
    v_exp_f32 v126, v126
    v_mfma_f32_16x16x32_bf16 v[84:87], a[88:91], a[40:43], v[84:87]
    ds_read_b64_tr_b16 a[110:111], v23 offset:61440
    v_mfma_f32_16x16x32_bf16 v[84:87], a[92:95], a[44:47], v[84:87]
    v_exp_f32 v127, v127
    v_mfma_f32_16x16x32_bf16 v[92:95], a[92:95], a[60:63], v[60:63]
    ds_read_b64_tr_b16 a[112:113], v24 offset:57344
    v_cvt_pk_bf16_f32 v123, v126, v127
    v_mfma_f32_16x16x32_bf16 v[92:95], a[88:91], a[56:59], v[92:95]
    v_mfma_f32_16x16x32_bf16 v[92:95], a[84:87], a[52:55], v[92:95]
    ds_read_b64_tr_b16 a[114:115], v24 offset:61440
    v_mfma_f32_16x16x32_bf16 v[92:95], a[80:83], a[48:51], v[92:95]
    s_waitcnt lgkmcnt(8)
    v_mfma_f32_16x16x32_bf16 v[128:131], a[96:99], v[96:99], v[128:131]
    ds_read_b64_tr_b16 a[116:117], v25 offset:57344
    v_mfma_f32_16x16x32_bf16 v[160:163], a[96:99], v[104:107], v[160:163]
    v_exp_f32 v64, v64
    v_mfma_f32_16x16x32_bf16 v[192:195], a[96:99], v[112:115], v[192:195]
    ds_read_b64_tr_b16 a[118:119], v25 offset:61440
    v_mfma_f32_16x16x32_bf16 v[224:227], a[96:99], v[120:123], v[224:227]
    s_waitcnt lgkmcnt(8)
    v_exp_f32 v65, v65
    v_mfma_f32_16x16x32_bf16 v[228:231], a[100:103], v[120:123], v[228:231]
    ds_read_b64_tr_b16 a[120:121], v26 offset:57344
    v_cvt_pk_bf16_f32 v64, v64, v65
    v_mfma_f32_16x16x32_bf16 v[196:199], a[100:103], v[112:115], v[196:199]
    v_exp_f32 v66, v66
    v_mfma_f32_16x16x32_bf16 v[164:167], a[100:103], v[104:107], v[164:167]
    ds_read_b64_tr_b16 a[122:123], v26 offset:61440
    v_mfma_f32_16x16x32_bf16 v[132:135], a[100:103], v[96:99], v[132:135]
    s_waitcnt lgkmcnt(8)
    v_exp_f32 v67, v67
    v_mfma_f32_16x16x32_bf16 v[136:139], a[104:107], v[96:99], v[136:139]
    ds_read_b64_tr_b16 a[124:125], v27 offset:57344
    v_cvt_pk_bf16_f32 v65, v66, v67
    v_mfma_f32_16x16x32_bf16 v[168:171], a[104:107], v[104:107], v[168:171]
    v_exp_f32 v72, v72
    v_mfma_f32_16x16x32_bf16 v[200:203], a[104:107], v[112:115], v[200:203]
    ds_read_b64_tr_b16 a[126:127], v27 offset:61440
    v_mfma_f32_16x16x32_bf16 v[232:235], a[104:107], v[120:123], v[232:235]
    s_waitcnt lgkmcnt(8)
    v_exp_f32 v73, v73
    v_mfma_f32_16x16x32_bf16 v[236:239], a[108:111], v[120:123], v[236:239]
    ds_read_b128 a[64:67], v16 offset:57344
    v_cvt_pk_bf16_f32 v72, v72, v73
    v_mfma_f32_16x16x32_bf16 v[204:207], a[108:111], v[112:115], v[204:207]
    v_exp_f32 v74, v74
    v_mfma_f32_16x16x32_bf16 v[172:175], a[108:111], v[104:107], v[172:175]
    v_exp_f32 v75, v75
    v_mfma_f32_16x16x32_bf16 v[140:143], a[108:111], v[96:99], v[140:143]
    s_waitcnt lgkmcnt(7)
    v_cvt_pk_bf16_f32 v73, v74, v75
    v_mfma_f32_16x16x32_bf16 v[144:147], a[112:115], v[96:99], v[144:147]
    ds_read_b128 a[68:71], v17 offset:57344
    v_mfma_f32_16x16x32_bf16 v[176:179], a[112:115], v[104:107], v[176:179]
    v_exp_f32 v80, v80
    v_mfma_f32_16x16x32_bf16 v[208:211], a[112:115], v[112:115], v[208:211]
    v_exp_f32 v81, v81
    v_mfma_f32_16x16x32_bf16 v[240:243], a[112:115], v[120:123], v[240:243]
    s_waitcnt lgkmcnt(6)
    v_cvt_pk_bf16_f32 v80, v80, v81
    v_mfma_f32_16x16x32_bf16 v[244:247], a[116:119], v[120:123], v[244:247]
    ds_read_b128 a[72:75], v18 offset:57344
    v_mfma_f32_16x16x32_bf16 v[212:215], a[116:119], v[112:115], v[212:215]
    v_exp_f32 v82, v82
    v_mfma_f32_16x16x32_bf16 v[180:183], a[116:119], v[104:107], v[180:183]
    v_exp_f32 v83, v83
    v_mfma_f32_16x16x32_bf16 v[148:151], a[116:119], v[96:99], v[148:151]
    s_waitcnt lgkmcnt(5)
    v_cvt_pk_bf16_f32 v81, v82, v83
    v_mfma_f32_16x16x32_bf16 v[152:155], a[120:123], v[96:99], v[152:155]
    ds_read_b128 a[76:79], v19 offset:57344
    v_mfma_f32_16x16x32_bf16 v[184:187], a[120:123], v[104:107], v[184:187]
    v_exp_f32 v88, v88
    v_mfma_f32_16x16x32_bf16 v[216:219], a[120:123], v[112:115], v[216:219]
    v_exp_f32 v89, v89
    v_mfma_f32_16x16x32_bf16 v[248:251], a[120:123], v[120:123], v[248:251]
    s_waitcnt lgkmcnt(4)
    v_cvt_pk_bf16_f32 v88, v88, v89
    v_mfma_f32_16x16x32_bf16 v[252:255], a[124:127], v[120:123], v[252:255]
    ds_read_b128 a[80:83], v16 offset:61440
    v_mfma_f32_16x16x32_bf16 v[220:223], a[124:127], v[112:115], v[220:223]
    v_exp_f32 v90, v90
    v_mfma_f32_16x16x32_bf16 v[188:191], a[124:127], v[104:107], v[188:191]
    v_exp_f32 v91, v91
    v_mfma_f32_16x16x32_bf16 v[156:159], a[124:127], v[96:99], v[156:159]
    v_cvt_pk_bf16_f32 v89, v90, v91
    v_mfma_f32_16x16x32_bf16 a[128:131], a[144:147], v[96:99], a[128:131]
    ds_read_b128 a[84:87], v17 offset:61440
    v_mfma_f32_16x16x32_bf16 a[132:135], a[144:147], v[104:107], a[132:135]
    v_exp_f32 v68, v68
    v_mfma_f32_16x16x32_bf16 a[136:139], a[144:147], v[112:115], a[136:139]
    v_exp_f32 v69, v69
    v_mfma_f32_16x16x32_bf16 a[140:143], a[144:147], v[120:123], a[140:143]
    s_waitcnt lgkmcnt(2)
    v_cvt_pk_bf16_f32 v66, v68, v69
    v_mfma_f32_16x16x32_bf16 v[96:99], a[64:67], a[0:3], v[48:51]
    ds_read_b128 a[88:91], v18 offset:61440
    v_mfma_f32_16x16x32_bf16 v[96:99], a[68:71], a[4:7], v[96:99]
    v_exp_f32 v70, v70
    v_mfma_f32_16x16x32_bf16 v[96:99], a[72:75], a[8:11], v[96:99]
    v_exp_f32 v71, v71
    v_mfma_f32_16x16x32_bf16 v[96:99], a[76:79], a[12:15], v[96:99]
    v_cvt_pk_bf16_f32 v67, v70, v71
    v_mfma_f32_16x16x32_bf16 v[104:107], a[76:79], a[28:31], v[52:55]
    ds_read_b128 a[92:95], v19 offset:61440
    v_mfma_f32_16x16x32_bf16 v[104:107], a[72:75], a[24:27], v[104:107]
    v_exp_f32 v76, v76
    v_mfma_f32_16x16x32_bf16 v[104:107], a[68:71], a[20:23], v[104:107]
    v_exp_f32 v77, v77
    v_mfma_f32_16x16x32_bf16 v[104:107], a[64:67], a[16:19], v[104:107]
    v_cvt_pk_bf16_f32 v74, v76, v77
    v_mfma_f32_16x16x32_bf16 v[112:115], a[64:67], a[32:35], v[56:59]
    s_sub_u32 s35, s35, 1
    v_exp_f32 v78, v78
    v_mfma_f32_16x16x32_bf16 v[112:115], a[68:71], a[36:39], v[112:115]
    v_mfma_f32_16x16x32_bf16 v[112:115], a[72:75], a[40:43], v[112:115]
    v_exp_f32 v79, v79
    v_mfma_f32_16x16x32_bf16 v[112:115], a[76:79], a[44:47], v[112:115]
    v_cvt_pk_bf16_f32 v75, v78, v79
    v_mfma_f32_16x16x32_bf16 v[120:123], a[76:79], a[60:63], v[60:63]
    s_cmp_gt_u32 s35, 1
    v_exp_f32 v84, v84
    v_mfma_f32_16x16x32_bf16 v[120:123], a[72:75], a[56:59], v[120:123]
    v_mfma_f32_16x16x32_bf16 v[120:123], a[68:71], a[52:55], v[120:123]
    v_exp_f32 v85, v85
    v_mfma_f32_16x16x32_bf16 v[120:123], a[64:67], a[48:51], v[120:123]
    v_cvt_pk_bf16_f32 v82, v84, v85
    s_waitcnt vmcnt(0) lgkmcnt(0)
    s_barrier
    s_cbranch_scc1 L_loopA
    s_cmp_eq_u32 s35, 0
    s_cbranch_scc1 L_tailA
    s_add_u32 m0, s30, 65536
    s_mov_b32 s38, 0
    buffer_load_dwordx4 v36, s[76:79], s38 offen offset:0 lds
    buffer_load_dwordx4 v37, s[76:79], s38 offen offset:1024 lds
    buffer_load_dwordx4 v38, s[76:79], s38 offen offset:2048 lds
    buffer_load_dwordx4 v39, s[76:79], s38 offen offset:3072 lds
    s_add_u32 m0, s30, 81920
    s_mov_b32 s38, 40960
    buffer_load_dwordx4 v36, s[76:79], s38 offen offset:0 lds
    buffer_load_dwordx4 v37, s[76:79], s38 offen offset:1024 lds
    buffer_load_dwordx4 v38, s[76:79], s38 offen offset:2048 lds
    buffer_load_dwordx4 v39, s[76:79], s38 offen offset:3072 lds
    s_branch L_loopA
L_tailA:
    v_mfma_f32_16x16x32_bf16 v[100:103], a[80:83], a[0:3], v[48:51]
    ds_read_b64_tr_b16 a[96:97], v20 offset:0
    v_mfma_f32_16x16x32_bf16 v[100:103], a[84:87], a[4:7], v[100:103]
    v_exp_f32 v86, v86
    v_mfma_f32_16x16x32_bf16 v[100:103], a[88:91], a[8:11], v[100:103]
    s_add_u32 m0, s30, 147456
    s_mov_b32 s38, 81920
    ds_read_b64_tr_b16 a[98:99], v20 offset:4096
    v_mfma_f32_16x16x32_bf16 v[100:103], a[92:95], a[12:15], v[100:103]
    buffer_load_dwordx4 v36, s[76:79], s38 offen offset:0 lds
    v_mfma_f32_16x16x32_bf16 v[108:111], a[92:95], a[28:31], v[52:55]
    ds_read_b64_tr_b16 a[100:101], v21 offset:0
    v_mfma_f32_16x16x32_bf16 v[108:111], a[88:91], a[24:27], v[108:111]
    v_exp_f32 v87, v87
    v_mfma_f32_16x16x32_bf16 v[108:111], a[84:87], a[20:23], v[108:111]
    ds_read_b64_tr_b16 a[102:103], v21 offset:4096
    v_cvt_pk_bf16_f32 v83, v86, v87
    v_mfma_f32_16x16x32_bf16 v[108:111], a[80:83], a[16:19], v[108:111]
    v_exp_f32 v92, v92
    v_exp_f32 v93, v93
    v_mfma_f32_16x16x32_bf16 v[116:119], a[80:83], a[32:35], v[56:59]
    ds_read_b64_tr_b16 a[104:105], v22 offset:0
    v_cvt_pk_bf16_f32 v90, v92, v93
    v_mfma_f32_16x16x32_bf16 v[116:119], a[84:87], a[36:39], v[116:119]
    buffer_load_dwordx4 v37, s[76:79], s38 offen offset:1024 lds
    v_mfma_f32_16x16x32_bf16 v[116:119], a[88:91], a[40:43], v[116:119]
    ds_read_b64_tr_b16 a[106:107], v22 offset:4096
    v_mfma_f32_16x16x32_bf16 v[116:119], a[92:95], a[44:47], v[116:119]
    v_exp_f32 v94, v94
    v_mfma_f32_16x16x32_bf16 v[124:127], a[92:95], a[60:63], v[60:63]
    ds_read_b64_tr_b16 a[108:109], v23 offset:0
    v_mfma_f32_16x16x32_bf16 v[124:127], a[88:91], a[56:59], v[124:127]
    v_exp_f32 v95, v95
    v_mfma_f32_16x16x32_bf16 v[124:127], a[84:87], a[52:55], v[124:127]
    ds_read_b64_tr_b16 a[110:111], v23 offset:4096
    v_cvt_pk_bf16_f32 v91, v94, v95
    v_mfma_f32_16x16x32_bf16 v[124:127], a[80:83], a[48:51], v[124:127]
    s_waitcnt lgkmcnt(6)
    buffer_load_dwordx4 v38, s[76:79], s38 offen offset:2048 lds
    v_mfma_f32_16x16x32_bf16 v[128:131], a[96:99], v[64:67], v[128:131]
    ds_read_b64_tr_b16 a[112:113], v24 offset:0
    v_mfma_f32_16x16x32_bf16 v[160:163], a[96:99], v[72:75], v[160:163]
    v_exp_f32 v96, v96
    v_mfma_f32_16x16x32_bf16 v[192:195], a[96:99], v[80:83], v[192:195]
    ds_read_b64_tr_b16 a[114:115], v24 offset:4096
    v_mfma_f32_16x16x32_bf16 v[224:227], a[96:99], v[88:91], v[224:227]
    s_waitcnt lgkmcnt(6)
    v_exp_f32 v97, v97
    v_mfma_f32_16x16x32_bf16 v[228:231], a[100:103], v[88:91], v[228:231]
    ds_read_b64_tr_b16 a[116:117], v25 offset:0
    v_cvt_pk_bf16_f32 v96, v96, v97
    v_mfma_f32_16x16x32_bf16 v[196:199], a[100:103], v[80:83], v[196:199]
    buffer_load_dwordx4 v39, s[76:79], s38 offen offset:3072 lds
    v_mfma_f32_16x16x32_bf16 v[164:167], a[100:103], v[72:75], v[164:167]
    ds_read_b64_tr_b16 a[118:119], v25 offset:4096
    v_mfma_f32_16x16x32_bf16 v[132:135], a[100:103], v[64:67], v[132:135]
    s_waitcnt lgkmcnt(6)
    v_exp_f32 v98, v98
    v_mfma_f32_16x16x32_bf16 v[136:139], a[104:107], v[64:67], v[136:139]
    ds_read_b64_tr_b16 a[120:121], v26 offset:0
    v_mfma_f32_16x16x32_bf16 v[168:171], a[104:107], v[72:75], v[168:171]
    v_exp_f32 v99, v99
    v_mfma_f32_16x16x32_bf16 v[200:203], a[104:107], v[80:83], v[200:203]
    ds_read_b64_tr_b16 a[122:123], v26 offset:4096
    v_cvt_pk_bf16_f32 v97, v98, v99
    v_mfma_f32_16x16x32_bf16 v[232:235], a[104:107], v[88:91], v[232:235]
    s_waitcnt lgkmcnt(6)
    v_exp_f32 v104, v104
    v_mfma_f32_16x16x32_bf16 v[236:239], a[108:111], v[88:91], v[236:239]
    ds_read_b64_tr_b16 a[124:125], v27 offset:0
    v_mfma_f32_16x16x32_bf16 v[204:207], a[108:111], v[80:83], v[204:207]
    v_exp_f32 v105, v105
    v_exp_f32 v106, v106
    v_mfma_f32_16x16x32_bf16 v[172:175], a[108:111], v[72:75], v[172:175]
    ds_read_b64_tr_b16 a[126:127], v27 offset:4096
    v_cvt_pk_bf16_f32 v104, v104, v105
    v_mfma_f32_16x16x32_bf16 v[140:143], a[108:111], v[64:67], v[140:143]
    s_waitcnt lgkmcnt(6)
    ds_read_b128 a[64:67], v16 offset:0
    v_mfma_f32_16x16x32_bf16 v[144:147], a[112:115], v[64:67], v[144:147]
    ds_read_b64_tr_b16 a[160:161], v44 offset:0
    v_mfma_f32_16x16x32_bf16 v[176:179], a[112:115], v[72:75], v[176:179]
    v_exp_f32 v107, v107
    v_exp_f32 v112, v112
    v_mfma_f32_16x16x32_bf16 v[208:211], a[112:115], v[80:83], v[208:211]
    ds_read_b128 a[68:71], v17 offset:0
    v_cvt_pk_bf16_f32 v105, v106, v107
    v_mfma_f32_16x16x32_bf16 v[240:243], a[112:115], v[88:91], v[240:243]
    s_waitcnt lgkmcnt(7)
    ds_read_b64_tr_b16 a[162:163], v44 offset:2048
    v_mfma_f32_16x16x32_bf16 v[244:247], a[116:119], v[88:91], v[244:247]
    v_exp_f32 v113, v113
    v_exp_f32 v114, v114
    v_mfma_f32_16x16x32_bf16 v[212:215], a[116:119], v[80:83], v[212:215]
    ds_read_b64_tr_b16 a[164:165], v45 offset:0
    v_cvt_pk_bf16_f32 v112, v112, v113
    v_mfma_f32_16x16x32_bf16 v[180:183], a[116:119], v[72:75], v[180:183]
    ds_read_b128 a[72:75], v18 offset:0
    v_mfma_f32_16x16x32_bf16 v[148:151], a[116:119], v[64:67], v[148:151]
    s_waitcnt lgkmcnt(8)
    ds_read_b64_tr_b16 a[166:167], v45 offset:2048
    v_mfma_f32_16x16x32_bf16 v[152:155], a[120:123], v[64:67], v[152:155]
    v_exp_f32 v115, v115
    v_exp_f32 v120, v120
    v_mfma_f32_16x16x32_bf16 v[184:187], a[120:123], v[72:75], v[184:187]
    ds_read_b64_tr_b16 a[168:169], v46 offset:0
    v_cvt_pk_bf16_f32 v113, v114, v115
    v_mfma_f32_16x16x32_bf16 v[216:219], a[120:123], v[80:83], v[216:219]
    ds_read_b128 a[76:79], v19 offset:0
    v_mfma_f32_16x16x32_bf16 v[248:251], a[120:123], v[88:91], v[248:251]
    s_waitcnt lgkmcnt(9)
    ds_read_b64_tr_b16 a[170:171], v46 offset:2048
    v_mfma_f32_16x16x32_bf16 v[252:255], a[124:127], v[88:91], v[252:255]
    v_exp_f32 v121, v121
    v_exp_f32 v122, v122
    v_mfma_f32_16x16x32_bf16 v[220:223], a[124:127], v[80:83], v[220:223]
    ds_read_b64_tr_b16 a[172:173], v47 offset:0
    v_cvt_pk_bf16_f32 v120, v120, v121
    v_mfma_f32_16x16x32_bf16 v[188:191], a[124:127], v[72:75], v[188:191]
    ds_read_b128 a[80:83], v16 offset:4096
    v_mfma_f32_16x16x32_bf16 v[156:159], a[124:127], v[64:67], v[156:159]
    ds_read_b64_tr_b16 a[174:175], v47 offset:2048
    v_mfma_f32_16x16x32_bf16 a[128:131], a[144:147], v[64:67], a[128:131]
    v_exp_f32 v123, v123
    v_exp_f32 v100, v100
    v_mfma_f32_16x16x32_bf16 a[132:135], a[144:147], v[72:75], a[132:135]
    ds_read_b64_tr_b16 a[176:177], v44 offset:16384
    v_cvt_pk_bf16_f32 v121, v122, v123
    v_mfma_f32_16x16x32_bf16 a[136:139], a[144:147], v[80:83], a[136:139]
    ds_read_b128 a[84:87], v17 offset:4096
    v_mfma_f32_16x16x32_bf16 a[140:143], a[144:147], v[88:91], a[140:143]
    s_waitcnt lgkmcnt(6)
    ds_read_b64_tr_b16 a[178:179], v44 offset:18432
    v_mfma_f32_16x16x32_bf16 v[64:67], a[64:67], a[0:3], v[48:51]
    v_exp_f32 v101, v101
    v_exp_f32 v102, v102
    v_mfma_f32_16x16x32_bf16 v[64:67], a[68:71], a[4:7], v[64:67]
    ds_read_b64_tr_b16 a[180:181], v45 offset:16384
    v_cvt_pk_bf16_f32 v98, v100, v101
    v_mfma_f32_16x16x32_bf16 v[64:67], a[72:75], a[8:11], v[64:67]
    ds_read_b128 a[88:91], v18 offset:4096
    v_mfma_f32_16x16x32_bf16 v[64:67], a[76:79], a[12:15], v[64:67]
    ds_read_b64_tr_b16 a[182:183], v45 offset:18432
    v_mfma_f32_16x16x32_bf16 v[72:75], a[76:79], a[28:31], v[52:55]
    v_exp_f32 v103, v103
    v_exp_f32 v108, v108
    v_mfma_f32_16x16x32_bf16 v[72:75], a[72:75], a[24:27], v[72:75]
    ds_read_b64_tr_b16 a[184:185], v46 offset:16384
    v_cvt_pk_bf16_f32 v99, v102, v103
    v_mfma_f32_16x16x32_bf16 v[72:75], a[68:71], a[20:23], v[72:75]
    ds_read_b128 a[92:95], v19 offset:4096
    v_mfma_f32_16x16x32_bf16 v[72:75], a[64:67], a[16:19], v[72:75]
    ds_read_b64_tr_b16 a[186:187], v46 offset:18432
    v_mfma_f32_16x16x32_bf16 v[80:83], a[64:67], a[32:35], v[56:59]
    v_exp_f32 v109, v109
    v_mfma_f32_16x16x32_bf16 v[80:83], a[68:71], a[36:39], v[80:83]
    ds_read_b64_tr_b16 a[188:189], v47 offset:16384
    v_cvt_pk_bf16_f32 v106, v108, v109
    v_mfma_f32_16x16x32_bf16 v[80:83], a[72:75], a[40:43], v[80:83]
    v_exp_f32 v110, v110
    v_mfma_f32_16x16x32_bf16 v[80:83], a[76:79], a[44:47], v[80:83]
    ds_read_b64_tr_b16 a[190:191], v47 offset:18432
    v_mfma_f32_16x16x32_bf16 v[88:91], a[76:79], a[60:63], v[60:63]
    ds_read_b64_tr_b16 a[96:97], v20 offset:8192
    v_mfma_f32_16x16x32_bf16 v[88:91], a[72:75], a[56:59], v[88:91]
    v_exp_f32 v111, v111
    v_mfma_f32_16x16x32_bf16 v[88:91], a[68:71], a[52:55], v[88:91]
    ds_read_b64_tr_b16 a[98:99], v20 offset:12288
    v_cvt_pk_bf16_f32 v107, v110, v111
    v_mfma_f32_16x16x32_bf16 v[88:91], a[64:67], a[48:51], v[88:91]
    s_waitcnt lgkmcnt(5)
    v_exp_f32 v116, v116
    v_mfma_f32_16x16x32_bf16 v[68:71], a[80:83], a[0:3], v[48:51]
    ds_read_b64_tr_b16 a[100:101], v21 offset:8192
    v_mfma_f32_16x16x32_bf16 v[68:71], a[84:87], a[4:7], v[68:71]
    v_exp_f32 v117, v117
    v_mfma_f32_16x16x32_bf16 v[68:71], a[88:91], a[8:11], v[68:71]
    ds_read_b64_tr_b16 a[102:103], v21 offset:12288
    v_cvt_pk_bf16_f32 v114, v116, v117
    v_mfma_f32_16x16x32_bf16 v[68:71], a[92:95], a[12:15], v[68:71]
    v_exp_f32 v118, v118
    v_mfma_f32_16x16x32_bf16 v[76:79], a[92:95], a[28:31], v[52:55]
    ds_read_b64_tr_b16 a[104:105], v22 offset:8192
    v_mfma_f32_16x16x32_bf16 v[76:79], a[88:91], a[24:27], v[76:79]
    v_exp_f32 v119, v119
    v_mfma_f32_16x16x32_bf16 v[76:79], a[84:87], a[20:23], v[76:79]
    ds_read_b64_tr_b16 a[106:107], v22 offset:12288
    v_cvt_pk_bf16_f32 v115, v118, v119
    v_mfma_f32_16x16x32_bf16 v[76:79], a[80:83], a[16:19], v[76:79]
    v_exp_f32 v124, v124
    v_exp_f32 v125, v125
    v_mfma_f32_16x16x32_bf16 v[84:87], a[80:83], a[32:35], v[56:59]
    s_add_u32 m0, s30, 65536
    s_mov_b32 s38, 122880
    ds_read_b64_tr_b16 a[108:109], v23 offset:8192
    v_cvt_pk_bf16_f32 v122, v124, v125
    v_mfma_f32_16x16x32_bf16 v[84:87], a[84:87], a[36:39], v[84:87]
    buffer_load_dwordx4 v36, s[76:79], s38 offen offset:0 lds
    v_mfma_f32_16x16x32_bf16 v[84:87], a[88:91], a[40:43], v[84:87]
    ds_read_b64_tr_b16 a[110:111], v23 offset:12288
    v_mfma_f32_16x16x32_bf16 v[84:87], a[92:95], a[44:47], v[84:87]
    v_exp_f32 v126, v126
    v_exp_f32 v127, v127
    v_mfma_f32_16x16x32_bf16 v[92:95], a[92:95], a[60:63], v[60:63]
    ds_read_b64_tr_b16 a[112:113], v24 offset:8192
    v_cvt_pk_bf16_f32 v123, v126, v127
    v_mfma_f32_16x16x32_bf16 v[92:95], a[88:91], a[56:59], v[92:95]
    v_mfma_f32_16x16x32_bf16 v[92:95], a[84:87], a[52:55], v[92:95]
    ds_read_b64_tr_b16 a[114:115], v24 offset:12288
    v_mfma_f32_16x16x32_bf16 v[92:95], a[80:83], a[48:51], v[92:95]
    s_waitcnt lgkmcnt(8)
    buffer_load_dwordx4 v37, s[76:79], s38 offen offset:1024 lds
    v_mfma_f32_16x16x32_bf16 v[128:131], a[96:99], v[96:99], v[128:131]
    ds_read_b64_tr_b16 a[116:117], v25 offset:8192
    v_mfma_f32_16x16x32_bf16 v[160:163], a[96:99], v[104:107], v[160:163]
    v_exp_f32 v64, v64
    v_mfma_f32_16x16x32_bf16 v[192:195], a[96:99], v[112:115], v[192:195]
    ds_read_b64_tr_b16 a[118:119], v25 offset:12288
    v_mfma_f32_16x16x32_bf16 v[224:227], a[96:99], v[120:123], v[224:227]
    s_waitcnt lgkmcnt(8)
    v_exp_f32 v65, v65
    v_mfma_f32_16x16x32_bf16 v[228:231], a[100:103], v[120:123], v[228:231]
    ds_read_b64_tr_b16 a[120:121], v26 offset:8192
    v_cvt_pk_bf16_f32 v64, v64, v65
    v_mfma_f32_16x16x32_bf16 v[196:199], a[100:103], v[112:115], v[196:199]
    buffer_load_dwordx4 v38, s[76:79], s38 offen offset:2048 lds
    v_mfma_f32_16x16x32_bf16 v[164:167], a[100:103], v[104:107], v[164:167]
    ds_read_b64_tr_b16 a[122:123], v26 offset:12288
    v_mfma_f32_16x16x32_bf16 v[132:135], a[100:103], v[96:99], v[132:135]
    s_waitcnt lgkmcnt(8)
    v_exp_f32 v66, v66
    v_mfma_f32_16x16x32_bf16 v[136:139], a[104:107], v[96:99], v[136:139]
    ds_read_b64_tr_b16 a[124:125], v27 offset:8192
    v_mfma_f32_16x16x32_bf16 v[168:171], a[104:107], v[104:107], v[168:171]
    v_exp_f32 v67, v67
    v_exp_f32 v72, v72
    v_mfma_f32_16x16x32_bf16 v[200:203], a[104:107], v[112:115], v[200:203]
    ds_read_b64_tr_b16 a[126:127], v27 offset:12288
    v_cvt_pk_bf16_f32 v65, v66, v67
    v_mfma_f32_16x16x32_bf16 v[232:235], a[104:107], v[120:123], v[232:235]
    s_waitcnt lgkmcnt(8)
    buffer_load_dwordx4 v39, s[76:79], s38 offen offset:3072 lds
    v_mfma_f32_16x16x32_bf16 v[236:239], a[108:111], v[120:123], v[236:239]
    ds_read_b128 a[64:67], v16 offset:8192
    v_mfma_f32_16x16x32_bf16 v[204:207], a[108:111], v[112:115], v[204:207]
    s_add_u32 m0, s30, 81920
    s_mov_b32 s38, 163840
    v_exp_f32 v73, v73
    v_mfma_f32_16x16x32_bf16 v[172:175], a[108:111], v[104:107], v[172:175]
    buffer_load_dwordx4 v36, s[76:79], s38 offen offset:0 lds
    v_mfma_f32_16x16x32_bf16 v[140:143], a[108:111], v[96:99], v[140:143]
    s_waitcnt lgkmcnt(7)
    v_exp_f32 v74, v74
    v_mfma_f32_16x16x32_bf16 v[144:147], a[112:115], v[96:99], v[144:147]
    ds_read_b128 a[68:71], v17 offset:8192
    v_cvt_pk_bf16_f32 v72, v72, v73
    v_mfma_f32_16x16x32_bf16 v[176:179], a[112:115], v[104:107], v[176:179]
    v_exp_f32 v75, v75
    v_mfma_f32_16x16x32_bf16 v[208:211], a[112:115], v[112:115], v[208:211]
    v_exp_f32 v80, v80
    v_mfma_f32_16x16x32_bf16 v[240:243], a[112:115], v[120:123], v[240:243]
    s_waitcnt lgkmcnt(6)
    v_exp_f32 v81, v81
    v_mfma_f32_16x16x32_bf16 v[244:247], a[116:119], v[120:123], v[244:247]
    ds_read_b128 a[72:75], v18 offset:8192
    v_cvt_pk_bf16_f32 v73, v74, v75
    v_mfma_f32_16x16x32_bf16 v[212:215], a[116:119], v[112:115], v[212:215]
    buffer_load_dwordx4 v37, s[76:79], s38 offen offset:1024 lds
    v_mfma_f32_16x16x32_bf16 v[180:183], a[116:119], v[104:107], v[180:183]
    v_exp_f32 v82, v82
    v_mfma_f32_16x16x32_bf16 v[148:151], a[116:119], v[96:99], v[148:151]
    s_waitcnt lgkmcnt(5)
    v_exp_f32 v83, v83
    v_mfma_f32_16x16x32_bf16 v[152:155], a[120:123], v[96:99], v[152:155]
    ds_read_b128 a[76:79], v19 offset:8192
    v_cvt_pk_bf16_f32 v80, v80, v81
    v_mfma_f32_16x16x32_bf16 v[184:187], a[120:123], v[104:107], v[184:187]
    v_exp_f32 v88, v88
    v_mfma_f32_16x16x32_bf16 v[216:219], a[120:123], v[112:115], v[216:219]
    buffer_load_dwordx4 v38, s[76:79], s38 offen offset:2048 lds
    v_mfma_f32_16x16x32_bf16 v[248:251], a[120:123], v[120:123], v[248:251]
    s_waitcnt lgkmcnt(4)
    v_exp_f32 v89, v89
    v_mfma_f32_16x16x32_bf16 v[252:255], a[124:127], v[120:123], v[252:255]
    ds_read_b128 a[80:83], v16 offset:12288
    v_cvt_pk_bf16_f32 v81, v82, v83
    v_mfma_f32_16x16x32_bf16 v[220:223], a[124:127], v[112:115], v[220:223]
    v_exp_f32 v90, v90
    v_mfma_f32_16x16x32_bf16 v[188:191], a[124:127], v[104:107], v[188:191]
    v_exp_f32 v91, v91
    v_mfma_f32_16x16x32_bf16 v[156:159], a[124:127], v[96:99], v[156:159]
    v_cvt_pk_bf16_f32 v88, v88, v89
    v_cvt_pk_bf16_f32 v89, v90, v91
    v_mfma_f32_16x16x32_bf16 a[128:131], a[144:147], v[96:99], a[128:131]
    ds_read_b128 a[84:87], v17 offset:12288
    v_mfma_f32_16x16x32_bf16 a[132:135], a[144:147], v[104:107], a[132:135]
    buffer_load_dwordx4 v39, s[76:79], s38 offen offset:3072 lds
    v_mfma_f32_16x16x32_bf16 a[136:139], a[144:147], v[112:115], a[136:139]
    v_exp_f32 v68, v68
    v_mfma_f32_16x16x32_bf16 a[140:143], a[144:147], v[120:123], a[140:143]
    s_waitcnt lgkmcnt(2)
    v_exp_f32 v69, v69
    v_mfma_f32_16x16x32_bf16 v[96:99], a[64:67], a[0:3], v[48:51]
    ds_read_b128 a[88:91], v18 offset:12288
    v_cvt_pk_bf16_f32 v66, v68, v69
    v_mfma_f32_16x16x32_bf16 v[96:99], a[68:71], a[4:7], v[96:99]
    v_exp_f32 v70, v70
    v_mfma_f32_16x16x32_bf16 v[96:99], a[72:75], a[8:11], v[96:99]
    v_exp_f32 v71, v71
    v_mfma_f32_16x16x32_bf16 v[96:99], a[76:79], a[12:15], v[96:99]
    v_cvt_pk_bf16_f32 v67, v70, v71
    v_mfma_f32_16x16x32_bf16 v[104:107], a[76:79], a[28:31], v[52:55]
    ds_read_b128 a[92:95], v19 offset:12288
    v_mfma_f32_16x16x32_bf16 v[104:107], a[72:75], a[24:27], v[104:107]
    v_exp_f32 v76, v76
    v_mfma_f32_16x16x32_bf16 v[104:107], a[68:71], a[20:23], v[104:107]
    v_exp_f32 v77, v77
    v_mfma_f32_16x16x32_bf16 v[104:107], a[64:67], a[16:19], v[104:107]
    v_cvt_pk_bf16_f32 v74, v76, v77
    v_mfma_f32_16x16x32_bf16 v[112:115], a[64:67], a[32:35], v[56:59]
    v_exp_f32 v78, v78
    v_mfma_f32_16x16x32_bf16 v[112:115], a[68:71], a[36:39], v[112:115]
    v_mfma_f32_16x16x32_bf16 v[112:115], a[72:75], a[40:43], v[112:115]
    v_exp_f32 v79, v79
    v_mfma_f32_16x16x32_bf16 v[112:115], a[76:79], a[44:47], v[112:115]
    v_cvt_pk_bf16_f32 v75, v78, v79
    v_mfma_f32_16x16x32_bf16 v[120:123], a[76:79], a[60:63], v[60:63]
    v_exp_f32 v84, v84
    v_mfma_f32_16x16x32_bf16 v[120:123], a[72:75], a[56:59], v[120:123]
    v_mfma_f32_16x16x32_bf16 v[120:123], a[68:71], a[52:55], v[120:123]
    v_exp_f32 v85, v85
    v_mfma_f32_16x16x32_bf16 v[120:123], a[64:67], a[48:51], v[120:123]
    v_cvt_pk_bf16_f32 v82, v84, v85
    s_waitcnt vmcnt(60) lgkmcnt(0)
    s_barrier
    v_mfma_f32_16x16x32_bf16 v[100:103], a[80:83], a[0:3], v[48:51]
    ds_read_b64_tr_b16 a[96:97], v20 offset:16384
    v_mfma_f32_16x16x32_bf16 v[100:103], a[84:87], a[4:7], v[100:103]
    v_exp_f32 v86, v86
    v_mfma_f32_16x16x32_bf16 v[100:103], a[88:91], a[8:11], v[100:103]
    s_add_u32 m0, s30, 98304
    s_mov_b32 s38, 204800
    ds_read_b64_tr_b16 a[98:99], v20 offset:20480
    v_mfma_f32_16x16x32_bf16 v[100:103], a[92:95], a[12:15], v[100:103]
    buffer_load_dwordx4 v36, s[76:79], s38 offen offset:0 lds
    v_mfma_f32_16x16x32_bf16 v[108:111], a[92:95], a[28:31], v[52:55]
    ds_read_b64_tr_b16 a[100:101], v21 offset:16384
    v_mfma_f32_16x16x32_bf16 v[108:111], a[88:91], a[24:27], v[108:111]
    v_exp_f32 v87, v87
    v_mfma_f32_16x16x32_bf16 v[108:111], a[84:87], a[20:23], v[108:111]
    ds_read_b64_tr_b16 a[102:103], v21 offset:20480
    v_cvt_pk_bf16_f32 v83, v86, v87
    v_mfma_f32_16x16x32_bf16 v[108:111], a[80:83], a[16:19], v[108:111]
    v_exp_f32 v92, v92
    v_exp_f32 v93, v93
    v_mfma_f32_16x16x32_bf16 v[116:119], a[80:83], a[32:35], v[56:59]
    ds_read_b64_tr_b16 a[104:105], v22 offset:16384
    v_cvt_pk_bf16_f32 v90, v92, v93
    v_mfma_f32_16x16x32_bf16 v[116:119], a[84:87], a[36:39], v[116:119]
    buffer_load_dwordx4 v37, s[76:79], s38 offen offset:1024 lds
    v_mfma_f32_16x16x32_bf16 v[116:119], a[88:91], a[40:43], v[116:119]
    ds_read_b64_tr_b16 a[106:107], v22 offset:20480
    v_mfma_f32_16x16x32_bf16 v[116:119], a[92:95], a[44:47], v[116:119]
    v_exp_f32 v94, v94
    v_mfma_f32_16x16x32_bf16 v[124:127], a[92:95], a[60:63], v[60:63]
    ds_read_b64_tr_b16 a[108:109], v23 offset:16384
    v_mfma_f32_16x16x32_bf16 v[124:127], a[88:91], a[56:59], v[124:127]
    v_exp_f32 v95, v95
    v_mfma_f32_16x16x32_bf16 v[124:127], a[84:87], a[52:55], v[124:127]
    ds_read_b64_tr_b16 a[110:111], v23 offset:20480
    v_cvt_pk_bf16_f32 v91, v94, v95
    v_mfma_f32_16x16x32_bf16 v[124:127], a[80:83], a[48:51], v[124:127]
    s_waitcnt lgkmcnt(6)
    buffer_load_dwordx4 v38, s[76:79], s38 offen offset:2048 lds
    v_mfma_f32_16x16x32_bf16 v[128:131], a[96:99], v[64:67], v[128:131]
    ds_read_b64_tr_b16 a[112:113], v24 offset:16384
    v_mfma_f32_16x16x32_bf16 v[160:163], a[96:99], v[72:75], v[160:163]
    v_exp_f32 v96, v96
    v_mfma_f32_16x16x32_bf16 v[192:195], a[96:99], v[80:83], v[192:195]
    ds_read_b64_tr_b16 a[114:115], v24 offset:20480
    v_mfma_f32_16x16x32_bf16 v[224:227], a[96:99], v[88:91], v[224:227]
    s_waitcnt lgkmcnt(6)
    v_exp_f32 v97, v97
    v_mfma_f32_16x16x32_bf16 v[228:231], a[100:103], v[88:91], v[228:231]
    ds_read_b64_tr_b16 a[116:117], v25 offset:16384
    v_cvt_pk_bf16_f32 v96, v96, v97
    v_mfma_f32_16x16x32_bf16 v[196:199], a[100:103], v[80:83], v[196:199]
    buffer_load_dwordx4 v39, s[76:79], s38 offen offset:3072 lds
    v_mfma_f32_16x16x32_bf16 v[164:167], a[100:103], v[72:75], v[164:167]
    ds_read_b64_tr_b16 a[118:119], v25 offset:20480
    v_mfma_f32_16x16x32_bf16 v[132:135], a[100:103], v[64:67], v[132:135]
    s_waitcnt lgkmcnt(6)
    v_exp_f32 v98, v98
    v_exp_f32 v99, v99
    v_mfma_f32_16x16x32_bf16 v[136:139], a[104:107], v[64:67], v[136:139]
    s_add_u32 m0, s30, 0
    s_mov_b32 s38, 245760
    ds_read_b64_tr_b16 a[120:121], v26 offset:16384
    v_cvt_pk_bf16_f32 v97, v98, v99
    v_mfma_f32_16x16x32_bf16 v[168:171], a[104:107], v[72:75], v[168:171]
    buffer_load_dwordx4 v36, s[76:79], s38 offen offset:0 lds
    v_mfma_f32_16x16x32_bf16 v[200:203], a[104:107], v[80:83], v[200:203]
    ds_read_b64_tr_b16 a[122:123], v26 offset:20480
    v_mfma_f32_16x16x32_bf16 v[232:235], a[104:107], v[88:91], v[232:235]
    s_waitcnt lgkmcnt(6)
    v_exp_f32 v104, v104
    v_mfma_f32_16x16x32_bf16 v[236:239], a[108:111], v[88:91], v[236:239]
    ds_read_b64_tr_b16 a[124:125], v27 offset:16384
    v_mfma_f32_16x16x32_bf16 v[204:207], a[108:111], v[80:83], v[204:207]
    v_exp_f32 v105, v105
    v_exp_f32 v106, v106
    v_mfma_f32_16x16x32_bf16 v[172:175], a[108:111], v[72:75], v[172:175]
    ds_read_b64_tr_b16 a[126:127], v27 offset:20480
    v_exp_f32 v107, v107
    v_mfma_f32_16x16x32_bf16 v[140:143], a[108:111], v[64:67], v[140:143]
    s_waitcnt lgkmcnt(6)
    ds_read_b128 a[64:67], v16 offset:16384
    v_cvt_pk_bf16_f32 v104, v104, v105
    v_mfma_f32_16x16x32_bf16 v[144:147], a[112:115], v[64:67], v[144:147]
    s_waitcnt vmcnt(13)
    ds_read_b64_tr_b16 a[192:193], v8 offset:16384
    v_exp_f32 v112, v112
    v_mfma_f32_16x16x32_bf16 v[176:179], a[112:115], v[72:75], v[176:179]
    buffer_load_dwordx4 v37, s[76:79], s38 offen offset:1024 lds
    v_mfma_f32_16x16x32_bf16 v[208:211], a[112:115], v[80:83], v[208:211]
    ds_read_b128 a[68:71], v17 offset:16384
    v_exp_f32 v113, v113
    v_mfma_f32_16x16x32_bf16 v[240:243], a[112:115], v[88:91], v[240:243]
    s_waitcnt lgkmcnt(7)
    ds_read_b64_tr_b16 a[194:195], v8 offset:18432
    v_cvt_pk_bf16_f32 v105, v106, v107
    v_mfma_f32_16x16x32_bf16 v[244:247], a[116:119], v[88:91], v[244:247]
    buffer_load_dwordx4 v38, s[76:79], s38 offen offset:2048 lds
    v_exp_f32 v114, v114
    v_mfma_f32_16x16x32_bf16 v[212:215], a[116:119], v[80:83], v[212:215]
    ds_read_b64_tr_b16 a[196:197], v9 offset:16384
    v_cvt_pk_bf16_f32 v112, v112, v113
    v_mfma_f32_16x16x32_bf16 v[180:183], a[116:119], v[72:75], v[180:183]
    ds_read_b128 a[72:75], v18 offset:16384
    v_mfma_f32_16x16x32_bf16 v[148:151], a[116:119], v[64:67], v[148:151]
    s_waitcnt lgkmcnt(8)
    ds_read_b64_tr_b16 a[198:199], v9 offset:18432
    v_mfma_f32_16x16x32_bf16 v[152:155], a[120:123], v[64:67], v[152:155]
    v_exp_f32 v115, v115
    v_exp_f32 v120, v120
    v_mfma_f32_16x16x32_bf16 v[184:187], a[120:123], v[72:75], v[184:187]
    ds_read_b64_tr_b16 a[200:201], v10 offset:16384
    v_cvt_pk_bf16_f32 v113, v114, v115
    v_mfma_f32_16x16x32_bf16 v[216:219], a[120:123], v[80:83], v[216:219]
    ds_read_b128 a[76:79], v19 offset:16384
    v_exp_f32 v121, v121
    v_mfma_f32_16x16x32_bf16 v[248:251], a[120:123], v[88:91], v[248:251]
    s_waitcnt lgkmcnt(9)
    ds_read_b64_tr_b16 a[202:203], v10 offset:18432
    v_cvt_pk_bf16_f32 v120, v120, v121
    v_mfma_f32_16x16x32_bf16 v[252:255], a[124:127], v[88:91], v[252:255]
    buffer_load_dwordx4 v39, s[76:79], s38 offen offset:3072 lds
    v_exp_f32 v122, v122
    v_mfma_f32_16x16x32_bf16 v[220:223], a[124:127], v[80:83], v[220:223]
    ds_read_b64_tr_b16 a[204:205], v11 offset:16384
    v_mfma_f32_16x16x32_bf16 v[188:191], a[124:127], v[72:75], v[188:191]
    ds_read_b128 a[80:83], v16 offset:20480
    v_mfma_f32_16x16x32_bf16 v[156:159], a[124:127], v[64:67], v[156:159]
    ds_read_b64_tr_b16 a[206:207], v11 offset:18432
    v_mfma_f32_16x16x32_bf16 a[128:131], a[144:147], v[64:67], a[128:131]
    v_exp_f32 v123, v123
    v_exp_f32 v100, v100
    v_mfma_f32_16x16x32_bf16 a[132:135], a[144:147], v[72:75], a[132:135]
    s_waitcnt vmcnt(12)
    ds_read_b64_tr_b16 a[208:209], v44 offset:0
    v_cvt_pk_bf16_f32 v121, v122, v123
    v_mfma_f32_16x16x32_bf16 a[136:139], a[144:147], v[80:83], a[136:139]
    ds_read_b128 a[84:87], v17 offset:20480
    v_mfma_f32_16x16x32_bf16 a[140:143], a[144:147], v[88:91], a[140:143]
    s_waitcnt lgkmcnt(6)
    ds_read_b64_tr_b16 a[210:211], v44 offset:2048
    v_mfma_f32_16x16x32_bf16 v[64:67], a[64:67], a[0:3], v[48:51]
    v_exp_f32 v101, v101
    v_exp_f32 v102, v102
    v_mfma_f32_16x16x32_bf16 v[64:67], a[68:71], a[4:7], v[64:67]
    ds_read_b64_tr_b16 a[212:213], v45 offset:0
    v_cvt_pk_bf16_f32 v98, v100, v101
    v_mfma_f32_16x16x32_bf16 v[64:67], a[72:75], a[8:11], v[64:67]
    ds_read_b128 a[88:91], v18 offset:20480
    v_exp_f32 v103, v103
    v_mfma_f32_16x16x32_bf16 v[64:67], a[76:79], a[12:15], v[64:67]
    ds_read_b64_tr_b16 a[214:215], v45 offset:2048
    v_cvt_pk_bf16_f32 v99, v102, v103
    v_mfma_f32_16x16x32_bf16 v[72:75], a[76:79], a[28:31], v[52:55]
    buffer_load_dword v13, v14, s[76:79], s6 offen
    v_exp_f32 v108, v108
    v_mfma_f32_16x16x32_bf16 v[72:75], a[72:75], a[24:27], v[72:75]
    ds_read_b64_tr_b16 a[216:217], v46 offset:0
    v_mfma_f32_16x16x32_bf16 v[72:75], a[68:71], a[20:23], v[72:75]
    ds_read_b128 a[92:95], v19 offset:20480
    v_mfma_f32_16x16x32_bf16 v[72:75], a[64:67], a[16:19], v[72:75]
    ds_read_b64_tr_b16 a[218:219], v46 offset:2048
    v_mfma_f32_16x16x32_bf16 v[80:83], a[64:67], a[32:35], v[56:59]
    v_exp_f32 v109, v109
    v_mfma_f32_16x16x32_bf16 v[80:83], a[68:71], a[36:39], v[80:83]
    ds_read_b64_tr_b16 a[220:221], v47 offset:0
    v_cvt_pk_bf16_f32 v106, v108, v109
    v_mfma_f32_16x16x32_bf16 v[80:83], a[72:75], a[40:43], v[80:83]
    v_exp_f32 v110, v110
    v_mfma_f32_16x16x32_bf16 v[80:83], a[76:79], a[44:47], v[80:83]
    ds_read_b64_tr_b16 a[222:223], v47 offset:2048
    v_mfma_f32_16x16x32_bf16 v[88:91], a[76:79], a[60:63], v[60:63]
    ds_read_b64_tr_b16 a[96:97], v20 offset:24576
    v_mfma_f32_16x16x32_bf16 v[88:91], a[72:75], a[56:59], v[88:91]
    v_exp_f32 v111, v111
    v_mfma_f32_16x16x32_bf16 v[88:91], a[68:71], a[52:55], v[88:91]
    ds_read_b64_tr_b16 a[98:99], v20 offset:28672
    v_cvt_pk_bf16_f32 v107, v110, v111
    v_mfma_f32_16x16x32_bf16 v[88:91], a[64:67], a[48:51], v[88:91]
    s_waitcnt lgkmcnt(5)
    v_exp_f32 v116, v116
    v_mfma_f32_16x16x32_bf16 v[68:71], a[80:83], a[0:3], v[48:51]
    ds_read_b64_tr_b16 a[100:101], v21 offset:24576
    v_mfma_f32_16x16x32_bf16 v[68:71], a[84:87], a[4:7], v[68:71]
    v_exp_f32 v117, v117
    v_mfma_f32_16x16x32_bf16 v[68:71], a[88:91], a[8:11], v[68:71]
    ds_read_b64_tr_b16 a[102:103], v21 offset:28672
    v_cvt_pk_bf16_f32 v114, v116, v117
    v_mfma_f32_16x16x32_bf16 v[68:71], a[92:95], a[12:15], v[68:71]
    v_exp_f32 v118, v118
    v_mfma_f32_16x16x32_bf16 v[76:79], a[92:95], a[28:31], v[52:55]
    ds_read_b64_tr_b16 a[104:105], v22 offset:24576
    v_mfma_f32_16x16x32_bf16 v[76:79], a[88:91], a[24:27], v[76:79]
    v_exp_f32 v119, v119
    v_mfma_f32_16x16x32_bf16 v[76:79], a[84:87], a[20:23], v[76:79]
    ds_read_b64_tr_b16 a[106:107], v22 offset:28672
    v_cvt_pk_bf16_f32 v115, v118, v119
    v_mfma_f32_16x16x32_bf16 v[76:79], a[80:83], a[16:19], v[76:79]
    v_exp_f32 v124, v124
    v_exp_f32 v125, v125
    v_mfma_f32_16x16x32_bf16 v[84:87], a[80:83], a[32:35], v[56:59]
    s_add_u32 m0, s30, 147456
    s_mov_b32 s38, 286720
    ds_read_b64_tr_b16 a[108:109], v23 offset:24576
    v_cvt_pk_bf16_f32 v122, v124, v125
    v_mfma_f32_16x16x32_bf16 v[84:87], a[84:87], a[36:39], v[84:87]
    buffer_load_dwordx4 v36, s[76:79], s38 offen offset:0 lds
    v_mfma_f32_16x16x32_bf16 v[84:87], a[88:91], a[40:43], v[84:87]
    ds_read_b64_tr_b16 a[110:111], v23 offset:28672
    v_mfma_f32_16x16x32_bf16 v[84:87], a[92:95], a[44:47], v[84:87]
    v_exp_f32 v126, v126
    v_exp_f32 v127, v127
    v_mfma_f32_16x16x32_bf16 v[92:95], a[92:95], a[60:63], v[60:63]
    ds_read_b64_tr_b16 a[112:113], v24 offset:24576
    v_cvt_pk_bf16_f32 v123, v126, v127
    v_mfma_f32_16x16x32_bf16 v[92:95], a[88:91], a[56:59], v[92:95]
    v_mfma_f32_16x16x32_bf16 v[92:95], a[84:87], a[52:55], v[92:95]
    ds_read_b64_tr_b16 a[114:115], v24 offset:28672
    v_mfma_f32_16x16x32_bf16 v[92:95], a[80:83], a[48:51], v[92:95]
    s_waitcnt lgkmcnt(8)
    buffer_load_dwordx4 v37, s[76:79], s38 offen offset:1024 lds
    v_mfma_f32_16x16x32_bf16 v[128:131], a[96:99], v[96:99], v[128:131]
    ds_read_b64_tr_b16 a[116:117], v25 offset:24576
    v_mfma_f32_16x16x32_bf16 v[160:163], a[96:99], v[104:107], v[160:163]
    v_exp_f32 v64, v64
    v_mfma_f32_16x16x32_bf16 v[192:195], a[96:99], v[112:115], v[192:195]
    ds_read_b64_tr_b16 a[118:119], v25 offset:28672
    v_mfma_f32_16x16x32_bf16 v[224:227], a[96:99], v[120:123], v[224:227]
    s_waitcnt lgkmcnt(8)
    v_exp_f32 v65, v65
    v_mfma_f32_16x16x32_bf16 v[228:231], a[100:103], v[120:123], v[228:231]
    ds_read_b64_tr_b16 a[120:121], v26 offset:24576
    v_cvt_pk_bf16_f32 v64, v64, v65
    v_mfma_f32_16x16x32_bf16 v[196:199], a[100:103], v[112:115], v[196:199]
    buffer_load_dwordx4 v38, s[76:79], s38 offen offset:2048 lds
    v_mfma_f32_16x16x32_bf16 v[164:167], a[100:103], v[104:107], v[164:167]
    ds_read_b64_tr_b16 a[122:123], v26 offset:28672
    v_mfma_f32_16x16x32_bf16 v[132:135], a[100:103], v[96:99], v[132:135]
    s_waitcnt lgkmcnt(8)
    v_exp_f32 v66, v66
    v_mfma_f32_16x16x32_bf16 v[136:139], a[104:107], v[96:99], v[136:139]
    ds_read_b64_tr_b16 a[124:125], v27 offset:24576
    v_mfma_f32_16x16x32_bf16 v[168:171], a[104:107], v[104:107], v[168:171]
    v_exp_f32 v67, v67
    v_exp_f32 v72, v72
    v_mfma_f32_16x16x32_bf16 v[200:203], a[104:107], v[112:115], v[200:203]
    ds_read_b64_tr_b16 a[126:127], v27 offset:28672
    v_cvt_pk_bf16_f32 v65, v66, v67
    v_mfma_f32_16x16x32_bf16 v[232:235], a[104:107], v[120:123], v[232:235]
    s_waitcnt lgkmcnt(8)
    buffer_load_dwordx4 v39, s[76:79], s38 offen offset:3072 lds
    v_mfma_f32_16x16x32_bf16 v[236:239], a[108:111], v[120:123], v[236:239]
    ds_read_b128 a[64:67], v16 offset:24576
    v_mfma_f32_16x16x32_bf16 v[204:207], a[108:111], v[112:115], v[204:207]
    s_add_u32 m0, s30, 65536
    s_mov_b32 s38, 327680
    v_exp_f32 v73, v73
    v_mfma_f32_16x16x32_bf16 v[172:175], a[108:111], v[104:107], v[172:175]
    buffer_load_dwordx4 v36, s[76:79], s38 offen offset:0 lds
    v_mfma_f32_16x16x32_bf16 v[140:143], a[108:111], v[96:99], v[140:143]
    s_waitcnt lgkmcnt(7)
    v_exp_f32 v74, v74
    v_mfma_f32_16x16x32_bf16 v[144:147], a[112:115], v[96:99], v[144:147]
    ds_read_b128 a[68:71], v17 offset:24576
    v_cvt_pk_bf16_f32 v72, v72, v73
    v_mfma_f32_16x16x32_bf16 v[176:179], a[112:115], v[104:107], v[176:179]
    v_exp_f32 v75, v75
    v_mfma_f32_16x16x32_bf16 v[208:211], a[112:115], v[112:115], v[208:211]
    v_exp_f32 v80, v80
    v_mfma_f32_16x16x32_bf16 v[240:243], a[112:115], v[120:123], v[240:243]
    s_waitcnt lgkmcnt(6)
    v_exp_f32 v81, v81
    v_mfma_f32_16x16x32_bf16 v[244:247], a[116:119], v[120:123], v[244:247]
    ds_read_b128 a[72:75], v18 offset:24576
    v_cvt_pk_bf16_f32 v73, v74, v75
    v_mfma_f32_16x16x32_bf16 v[212:215], a[116:119], v[112:115], v[212:215]
    buffer_load_dwordx4 v37, s[76:79], s38 offen offset:1024 lds
    v_mfma_f32_16x16x32_bf16 v[180:183], a[116:119], v[104:107], v[180:183]
    v_exp_f32 v82, v82
    v_mfma_f32_16x16x32_bf16 v[148:151], a[116:119], v[96:99], v[148:151]
    s_waitcnt lgkmcnt(5)
    v_exp_f32 v83, v83
    v_mfma_f32_16x16x32_bf16 v[152:155], a[120:123], v[96:99], v[152:155]
    ds_read_b128 a[76:79], v19 offset:24576
    v_cvt_pk_bf16_f32 v80, v80, v81
    v_mfma_f32_16x16x32_bf16 v[184:187], a[120:123], v[104:107], v[184:187]
    v_exp_f32 v88, v88
    v_mfma_f32_16x16x32_bf16 v[216:219], a[120:123], v[112:115], v[216:219]
    buffer_load_dwordx4 v38, s[76:79], s38 offen offset:2048 lds
    v_mfma_f32_16x16x32_bf16 v[248:251], a[120:123], v[120:123], v[248:251]
    s_waitcnt lgkmcnt(4)
    v_exp_f32 v89, v89
    v_mfma_f32_16x16x32_bf16 v[252:255], a[124:127], v[120:123], v[252:255]
    ds_read_b128 a[80:83], v16 offset:28672
    v_cvt_pk_bf16_f32 v81, v82, v83
    v_mfma_f32_16x16x32_bf16 v[220:223], a[124:127], v[112:115], v[220:223]
    v_exp_f32 v90, v90
    v_mfma_f32_16x16x32_bf16 v[188:191], a[124:127], v[104:107], v[188:191]
    v_exp_f32 v91, v91
    v_mfma_f32_16x16x32_bf16 v[156:159], a[124:127], v[96:99], v[156:159]
    v_cvt_pk_bf16_f32 v88, v88, v89
    v_cvt_pk_bf16_f32 v89, v90, v91
    v_mfma_f32_16x16x32_bf16 a[128:131], a[144:147], v[96:99], a[128:131]
    ds_read_b128 a[84:87], v17 offset:28672
    v_mfma_f32_16x16x32_bf16 a[132:135], a[144:147], v[104:107], a[132:135]
    buffer_load_dwordx4 v39, s[76:79], s38 offen offset:3072 lds
    v_mfma_f32_16x16x32_bf16 a[136:139], a[144:147], v[112:115], a[136:139]
    v_exp_f32 v68, v68
    v_mfma_f32_16x16x32_bf16 a[140:143], a[144:147], v[120:123], a[140:143]
    s_waitcnt lgkmcnt(2)
    v_exp_f32 v69, v69
    v_mfma_f32_16x16x32_bf16 v[96:99], a[64:67], a[0:3], v[48:51]
    ds_read_b128 a[88:91], v18 offset:28672
    v_cvt_pk_bf16_f32 v66, v68, v69
    v_mfma_f32_16x16x32_bf16 v[96:99], a[68:71], a[4:7], v[96:99]
    v_exp_f32 v70, v70
    v_mfma_f32_16x16x32_bf16 v[96:99], a[72:75], a[8:11], v[96:99]
    v_exp_f32 v71, v71
    v_mfma_f32_16x16x32_bf16 v[96:99], a[76:79], a[12:15], v[96:99]
    v_cvt_pk_bf16_f32 v67, v70, v71
    v_mfma_f32_16x16x32_bf16 v[104:107], a[76:79], a[28:31], v[52:55]
    ds_read_b128 a[92:95], v19 offset:28672
    v_mfma_f32_16x16x32_bf16 v[104:107], a[72:75], a[24:27], v[104:107]
    v_exp_f32 v76, v76
    v_mfma_f32_16x16x32_bf16 v[104:107], a[68:71], a[20:23], v[104:107]
    v_exp_f32 v77, v77
    v_mfma_f32_16x16x32_bf16 v[104:107], a[64:67], a[16:19], v[104:107]
    v_cvt_pk_bf16_f32 v74, v76, v77
    v_mfma_f32_16x16x32_bf16 v[112:115], a[64:67], a[32:35], v[56:59]
    v_exp_f32 v78, v78
    v_mfma_f32_16x16x32_bf16 v[112:115], a[68:71], a[36:39], v[112:115]
    v_mfma_f32_16x16x32_bf16 v[112:115], a[72:75], a[40:43], v[112:115]
    v_exp_f32 v79, v79
    v_mfma_f32_16x16x32_bf16 v[112:115], a[76:79], a[44:47], v[112:115]
    v_cvt_pk_bf16_f32 v75, v78, v79
    v_mfma_f32_16x16x32_bf16 v[120:123], a[76:79], a[60:63], v[60:63]
    v_exp_f32 v84, v84
    v_mfma_f32_16x16x32_bf16 v[120:123], a[72:75], a[56:59], v[120:123]
    v_mfma_f32_16x16x32_bf16 v[120:123], a[68:71], a[52:55], v[120:123]
    v_exp_f32 v85, v85
    v_mfma_f32_16x16x32_bf16 v[120:123], a[64:67], a[48:51], v[120:123]
    v_cvt_pk_bf16_f32 v82, v84, v85
    s_waitcnt vmcnt(60) lgkmcnt(0)
    s_barrier
    v_mfma_f32_16x16x32_bf16 v[100:103], a[80:83], a[0:3], v[48:51]
    ds_read_b64_tr_b16 a[96:97], v20 offset:32768
    v_mfma_f32_16x16x32_bf16 v[100:103], a[84:87], a[4:7], v[100:103]
    v_exp_f32 v86, v86
    v_mfma_f32_16x16x32_bf16 v[100:103], a[88:91], a[8:11], v[100:103]
    s_add_u32 m0, s30, 114688
    s_mov_b32 s38, 368640
    ds_read_b64_tr_b16 a[98:99], v20 offset:36864
    v_mfma_f32_16x16x32_bf16 v[100:103], a[92:95], a[12:15], v[100:103]
    buffer_load_dwordx4 v36, s[76:79], s38 offen offset:0 lds
    v_mfma_f32_16x16x32_bf16 v[108:111], a[92:95], a[28:31], v[52:55]
    ds_read_b64_tr_b16 a[100:101], v21 offset:32768
    v_mfma_f32_16x16x32_bf16 v[108:111], a[88:91], a[24:27], v[108:111]
    v_exp_f32 v87, v87
    v_mfma_f32_16x16x32_bf16 v[108:111], a[84:87], a[20:23], v[108:111]
    ds_read_b64_tr_b16 a[102:103], v21 offset:36864
    v_cvt_pk_bf16_f32 v83, v86, v87
    v_mfma_f32_16x16x32_bf16 v[108:111], a[80:83], a[16:19], v[108:111]
    v_exp_f32 v92, v92
    v_exp_f32 v93, v93
    v_mfma_f32_16x16x32_bf16 v[116:119], a[80:83], a[32:35], v[56:59]
    ds_read_b64_tr_b16 a[104:105], v22 offset:32768
    v_cvt_pk_bf16_f32 v90, v92, v93
    v_mfma_f32_16x16x32_bf16 v[116:119], a[84:87], a[36:39], v[116:119]
    buffer_load_dwordx4 v37, s[76:79], s38 offen offset:1024 lds
    v_mfma_f32_16x16x32_bf16 v[116:119], a[88:91], a[40:43], v[116:119]
    ds_read_b64_tr_b16 a[106:107], v22 offset:36864
    v_mfma_f32_16x16x32_bf16 v[116:119], a[92:95], a[44:47], v[116:119]
    v_exp_f32 v94, v94
    v_mfma_f32_16x16x32_bf16 v[124:127], a[92:95], a[60:63], v[60:63]
    ds_read_b64_tr_b16 a[108:109], v23 offset:32768
    v_mfma_f32_16x16x32_bf16 v[124:127], a[88:91], a[56:59], v[124:127]
    v_exp_f32 v95, v95
    v_mfma_f32_16x16x32_bf16 v[124:127], a[84:87], a[52:55], v[124:127]
    ds_read_b64_tr_b16 a[110:111], v23 offset:36864
    v_cvt_pk_bf16_f32 v91, v94, v95
    v_mfma_f32_16x16x32_bf16 v[124:127], a[80:83], a[48:51], v[124:127]
    s_waitcnt lgkmcnt(6)
    buffer_load_dwordx4 v38, s[76:79], s38 offen offset:2048 lds
    v_mfma_f32_16x16x32_bf16 v[128:131], a[96:99], v[64:67], v[128:131]
    ds_read_b64_tr_b16 a[112:113], v24 offset:32768
    v_mfma_f32_16x16x32_bf16 v[160:163], a[96:99], v[72:75], v[160:163]
    v_exp_f32 v96, v96
    v_mfma_f32_16x16x32_bf16 v[192:195], a[96:99], v[80:83], v[192:195]
    ds_read_b64_tr_b16 a[114:115], v24 offset:36864
    v_mfma_f32_16x16x32_bf16 v[224:227], a[96:99], v[88:91], v[224:227]
    s_waitcnt lgkmcnt(6)
    v_exp_f32 v97, v97
    v_mfma_f32_16x16x32_bf16 v[228:231], a[100:103], v[88:91], v[228:231]
    ds_read_b64_tr_b16 a[116:117], v25 offset:32768
    v_cvt_pk_bf16_f32 v96, v96, v97
    v_mfma_f32_16x16x32_bf16 v[196:199], a[100:103], v[80:83], v[196:199]
    buffer_load_dwordx4 v39, s[76:79], s38 offen offset:3072 lds
    v_mfma_f32_16x16x32_bf16 v[164:167], a[100:103], v[72:75], v[164:167]
    ds_read_b64_tr_b16 a[118:119], v25 offset:36864
    v_mfma_f32_16x16x32_bf16 v[132:135], a[100:103], v[64:67], v[132:135]
    s_waitcnt lgkmcnt(6)
    v_exp_f32 v98, v98
    v_exp_f32 v99, v99
    v_mfma_f32_16x16x32_bf16 v[136:139], a[104:107], v[64:67], v[136:139]
    s_add_u32 m0, s30, 16384
    s_mov_b32 s38, 409600
    ds_read_b64_tr_b16 a[120:121], v26 offset:32768
    v_cvt_pk_bf16_f32 v97, v98, v99
    v_mfma_f32_16x16x32_bf16 v[168:171], a[104:107], v[72:75], v[168:171]
    buffer_load_dwordx4 v36, s[76:79], s38 offen offset:0 lds
    v_mfma_f32_16x16x32_bf16 v[200:203], a[104:107], v[80:83], v[200:203]
    ds_read_b64_tr_b16 a[122:123], v26 offset:36864
    v_mfma_f32_16x16x32_bf16 v[232:235], a[104:107], v[88:91], v[232:235]
    s_waitcnt lgkmcnt(6)
    v_exp_f32 v104, v104
    v_mfma_f32_16x16x32_bf16 v[236:239], a[108:111], v[88:91], v[236:239]
    ds_read_b64_tr_b16 a[124:125], v27 offset:32768
    v_mfma_f32_16x16x32_bf16 v[204:207], a[108:111], v[80:83], v[204:207]
    v_exp_f32 v105, v105
    v_exp_f32 v106, v106
    v_mfma_f32_16x16x32_bf16 v[172:175], a[108:111], v[72:75], v[172:175]
    ds_read_b64_tr_b16 a[126:127], v27 offset:36864
    v_exp_f32 v107, v107
    v_mfma_f32_16x16x32_bf16 v[140:143], a[108:111], v[64:67], v[140:143]
    s_waitcnt lgkmcnt(6)
    ds_read_b128 a[64:67], v16 offset:32768
    v_cvt_pk_bf16_f32 v104, v104, v105
    v_mfma_f32_16x16x32_bf16 v[144:147], a[112:115], v[64:67], v[144:147]
    s_waitcnt vmcnt(22)
    ds_read_b64_tr_b16 a[224:225], v44 offset:16384
    v_exp_f32 v112, v112
    v_mfma_f32_16x16x32_bf16 v[176:179], a[112:115], v[72:75], v[176:179]
    buffer_load_dwordx4 v37, s[76:79], s38 offen offset:1024 lds
    v_mfma_f32_16x16x32_bf16 v[208:211], a[112:115], v[80:83], v[208:211]
    ds_read_b128 a[68:71], v17 offset:32768
    v_exp_f32 v113, v113
    v_mfma_f32_16x16x32_bf16 v[240:243], a[112:115], v[88:91], v[240:243]
    s_waitcnt lgkmcnt(7)
    ds_read_b64_tr_b16 a[226:227], v44 offset:18432
    v_cvt_pk_bf16_f32 v105, v106, v107
    v_mfma_f32_16x16x32_bf16 v[244:247], a[116:119], v[88:91], v[244:247]
    buffer_load_dwordx4 v38, s[76:79], s38 offen offset:2048 lds
    v_exp_f32 v114, v114
    v_mfma_f32_16x16x32_bf16 v[212:215], a[116:119], v[80:83], v[212:215]
    ds_read_b64_tr_b16 a[228:229], v45 offset:16384
    v_cvt_pk_bf16_f32 v112, v112, v113
    v_mfma_f32_16x16x32_bf16 v[180:183], a[116:119], v[72:75], v[180:183]
    ds_read_b128 a[72:75], v18 offset:32768
    v_mfma_f32_16x16x32_bf16 v[148:151], a[116:119], v[64:67], v[148:151]
    s_waitcnt lgkmcnt(8)
    ds_read_b64_tr_b16 a[230:231], v45 offset:18432
    v_mfma_f32_16x16x32_bf16 v[152:155], a[120:123], v[64:67], v[152:155]
    v_exp_f32 v115, v115
    v_exp_f32 v120, v120
    v_mfma_f32_16x16x32_bf16 v[184:187], a[120:123], v[72:75], v[184:187]
    ds_read_b64_tr_b16 a[232:233], v46 offset:16384
    v_cvt_pk_bf16_f32 v113, v114, v115
    v_mfma_f32_16x16x32_bf16 v[216:219], a[120:123], v[80:83], v[216:219]
    ds_read_b128 a[76:79], v19 offset:32768
    v_exp_f32 v121, v121
    v_mfma_f32_16x16x32_bf16 v[248:251], a[120:123], v[88:91], v[248:251]
    s_waitcnt lgkmcnt(9)
    ds_read_b64_tr_b16 a[234:235], v46 offset:18432
    v_cvt_pk_bf16_f32 v120, v120, v121
    v_mfma_f32_16x16x32_bf16 v[252:255], a[124:127], v[88:91], v[252:255]
    buffer_load_dwordx4 v39, s[76:79], s38 offen offset:3072 lds
    v_exp_f32 v122, v122
    v_mfma_f32_16x16x32_bf16 v[220:223], a[124:127], v[80:83], v[220:223]
    ds_read_b64_tr_b16 a[236:237], v47 offset:16384
    v_mfma_f32_16x16x32_bf16 v[188:191], a[124:127], v[72:75], v[188:191]
    ds_read_b128 a[80:83], v16 offset:36864
    v_mfma_f32_16x16x32_bf16 v[156:159], a[124:127], v[64:67], v[156:159]
    ds_read_b64_tr_b16 a[238:239], v47 offset:18432
    v_mfma_f32_16x16x32_bf16 a[128:131], a[144:147], v[64:67], a[128:131]
    v_exp_f32 v123, v123
    v_exp_f32 v100, v100
    v_mfma_f32_16x16x32_bf16 a[132:135], a[144:147], v[72:75], a[132:135]
    s_waitcnt vmcnt(21)
    ds_read_b64_tr_b16 a[240:241], v44 offset:32768
    v_cvt_pk_bf16_f32 v121, v122, v123
    v_mfma_f32_16x16x32_bf16 a[136:139], a[144:147], v[80:83], a[136:139]
    ds_read_b128 a[84:87], v17 offset:36864
    v_mfma_f32_16x16x32_bf16 a[140:143], a[144:147], v[88:91], a[140:143]
    s_waitcnt lgkmcnt(6)
    ds_read_b64_tr_b16 a[242:243], v44 offset:34816
    v_mfma_f32_16x16x32_bf16 v[64:67], a[64:67], a[0:3], v[48:51]
    v_exp_f32 v101, v101
    v_exp_f32 v102, v102
    v_mfma_f32_16x16x32_bf16 v[64:67], a[68:71], a[4:7], v[64:67]
    ds_read_b64_tr_b16 a[244:245], v45 offset:32768
    v_cvt_pk_bf16_f32 v98, v100, v101
    v_mfma_f32_16x16x32_bf16 v[64:67], a[72:75], a[8:11], v[64:67]
    ds_read_b128 a[88:91], v18 offset:36864
    v_exp_f32 v103, v103
    v_mfma_f32_16x16x32_bf16 v[64:67], a[76:79], a[12:15], v[64:67]
    ds_read_b64_tr_b16 a[246:247], v45 offset:34816
    v_cvt_pk_bf16_f32 v99, v102, v103
    v_mfma_f32_16x16x32_bf16 v[72:75], a[76:79], a[28:31], v[52:55]
    buffer_load_dword v13, v14, s[76:79], s7 offen
    v_exp_f32 v108, v108
    v_mfma_f32_16x16x32_bf16 v[72:75], a[72:75], a[24:27], v[72:75]
    ds_read_b64_tr_b16 a[248:249], v46 offset:32768
    v_mfma_f32_16x16x32_bf16 v[72:75], a[68:71], a[20:23], v[72:75]
    ds_read_b128 a[92:95], v19 offset:36864
    v_mfma_f32_16x16x32_bf16 v[72:75], a[64:67], a[16:19], v[72:75]
    ds_read_b64_tr_b16 a[250:251], v46 offset:34816
    v_mfma_f32_16x16x32_bf16 v[80:83], a[64:67], a[32:35], v[56:59]
    v_exp_f32 v109, v109
    v_mfma_f32_16x16x32_bf16 v[80:83], a[68:71], a[36:39], v[80:83]
    ds_read_b64_tr_b16 a[252:253], v47 offset:32768
    v_cvt_pk_bf16_f32 v106, v108, v109
    v_mfma_f32_16x16x32_bf16 v[80:83], a[72:75], a[40:43], v[80:83]
    v_exp_f32 v110, v110
    v_mfma_f32_16x16x32_bf16 v[80:83], a[76:79], a[44:47], v[80:83]
    ds_read_b64_tr_b16 a[254:255], v47 offset:34816
    v_mfma_f32_16x16x32_bf16 v[88:91], a[76:79], a[60:63], v[60:63]
    ds_read_b64_tr_b16 a[96:97], v20 offset:40960
    v_mfma_f32_16x16x32_bf16 v[88:91], a[72:75], a[56:59], v[88:91]
    v_exp_f32 v111, v111
    v_mfma_f32_16x16x32_bf16 v[88:91], a[68:71], a[52:55], v[88:91]
    ds_read_b64_tr_b16 a[98:99], v20 offset:45056
    v_cvt_pk_bf16_f32 v107, v110, v111
    v_mfma_f32_16x16x32_bf16 v[88:91], a[64:67], a[48:51], v[88:91]
    s_waitcnt lgkmcnt(5)
    v_exp_f32 v116, v116
    v_mfma_f32_16x16x32_bf16 v[68:71], a[80:83], a[0:3], v[48:51]
    ds_read_b64_tr_b16 a[100:101], v21 offset:40960
    v_mfma_f32_16x16x32_bf16 v[68:71], a[84:87], a[4:7], v[68:71]
    v_exp_f32 v117, v117
    v_mfma_f32_16x16x32_bf16 v[68:71], a[88:91], a[8:11], v[68:71]
    ds_read_b64_tr_b16 a[102:103], v21 offset:45056
    v_cvt_pk_bf16_f32 v114, v116, v117
    v_mfma_f32_16x16x32_bf16 v[68:71], a[92:95], a[12:15], v[68:71]
    v_exp_f32 v118, v118
    v_mfma_f32_16x16x32_bf16 v[76:79], a[92:95], a[28:31], v[52:55]
    ds_read_b64_tr_b16 a[104:105], v22 offset:40960
    v_mfma_f32_16x16x32_bf16 v[76:79], a[88:91], a[24:27], v[76:79]
    v_exp_f32 v119, v119
    v_mfma_f32_16x16x32_bf16 v[76:79], a[84:87], a[20:23], v[76:79]
    ds_read_b64_tr_b16 a[106:107], v22 offset:45056
    v_cvt_pk_bf16_f32 v115, v118, v119
    v_mfma_f32_16x16x32_bf16 v[76:79], a[80:83], a[16:19], v[76:79]
    v_exp_f32 v124, v124
    v_exp_f32 v125, v125
    v_mfma_f32_16x16x32_bf16 v[84:87], a[80:83], a[32:35], v[56:59]
    s_add_u32 m0, s30, 81920
    s_mov_b32 s38, 450560
    ds_read_b64_tr_b16 a[108:109], v23 offset:40960
    v_cvt_pk_bf16_f32 v122, v124, v125
    v_mfma_f32_16x16x32_bf16 v[84:87], a[84:87], a[36:39], v[84:87]
    buffer_load_dwordx4 v36, s[76:79], s38 offen offset:0 lds
    v_mfma_f32_16x16x32_bf16 v[84:87], a[88:91], a[40:43], v[84:87]
    ds_read_b64_tr_b16 a[110:111], v23 offset:45056
    v_mfma_f32_16x16x32_bf16 v[84:87], a[92:95], a[44:47], v[84:87]
    v_exp_f32 v126, v126
    v_exp_f32 v127, v127
    v_mfma_f32_16x16x32_bf16 v[92:95], a[92:95], a[60:63], v[60:63]
    ds_read_b64_tr_b16 a[112:113], v24 offset:40960
    v_cvt_pk_bf16_f32 v123, v126, v127
    v_mfma_f32_16x16x32_bf16 v[92:95], a[88:91], a[56:59], v[92:95]
    v_mfma_f32_16x16x32_bf16 v[92:95], a[84:87], a[52:55], v[92:95]
    ds_read_b64_tr_b16 a[114:115], v24 offset:45056
    v_mfma_f32_16x16x32_bf16 v[92:95], a[80:83], a[48:51], v[92:95]
    s_waitcnt lgkmcnt(8)
    buffer_load_dwordx4 v37, s[76:79], s38 offen offset:1024 lds
    v_mfma_f32_16x16x32_bf16 v[128:131], a[96:99], v[96:99], v[128:131]
    ds_read_b64_tr_b16 a[116:117], v25 offset:40960
    v_mfma_f32_16x16x32_bf16 v[160:163], a[96:99], v[104:107], v[160:163]
    v_exp_f32 v64, v64
    v_mfma_f32_16x16x32_bf16 v[192:195], a[96:99], v[112:115], v[192:195]
    ds_read_b64_tr_b16 a[118:119], v25 offset:45056
    v_mfma_f32_16x16x32_bf16 v[224:227], a[96:99], v[120:123], v[224:227]
    s_waitcnt lgkmcnt(8)
    v_exp_f32 v65, v65
    v_mfma_f32_16x16x32_bf16 v[228:231], a[100:103], v[120:123], v[228:231]
    ds_read_b64_tr_b16 a[120:121], v26 offset:40960
    v_cvt_pk_bf16_f32 v64, v64, v65
    v_mfma_f32_16x16x32_bf16 v[196:199], a[100:103], v[112:115], v[196:199]
    buffer_load_dwordx4 v38, s[76:79], s38 offen offset:2048 lds
    v_mfma_f32_16x16x32_bf16 v[164:167], a[100:103], v[104:107], v[164:167]
    ds_read_b64_tr_b16 a[122:123], v26 offset:45056
    v_mfma_f32_16x16x32_bf16 v[132:135], a[100:103], v[96:99], v[132:135]
    s_waitcnt lgkmcnt(8)
    v_exp_f32 v66, v66
    v_mfma_f32_16x16x32_bf16 v[136:139], a[104:107], v[96:99], v[136:139]
    ds_read_b64_tr_b16 a[124:125], v27 offset:40960
    v_mfma_f32_16x16x32_bf16 v[168:171], a[104:107], v[104:107], v[168:171]
    v_exp_f32 v67, v67
    v_exp_f32 v72, v72
    v_mfma_f32_16x16x32_bf16 v[200:203], a[104:107], v[112:115], v[200:203]
    ds_read_b64_tr_b16 a[126:127], v27 offset:45056
    v_cvt_pk_bf16_f32 v65, v66, v67
    v_mfma_f32_16x16x32_bf16 v[232:235], a[104:107], v[120:123], v[232:235]
    s_waitcnt lgkmcnt(8)
    buffer_load_dwordx4 v39, s[76:79], s38 offen offset:3072 lds
    v_mfma_f32_16x16x32_bf16 v[236:239], a[108:111], v[120:123], v[236:239]
    ds_read_b128 a[64:67], v16 offset:40960
    v_mfma_f32_16x16x32_bf16 v[204:207], a[108:111], v[112:115], v[204:207]
    s_add_u32 m0, s30, 98304
    s_mov_b32 s38, 491520
    v_exp_f32 v73, v73
    v_mfma_f32_16x16x32_bf16 v[172:175], a[108:111], v[104:107], v[172:175]
    buffer_load_dwordx4 v36, s[76:79], s38 offen offset:0 lds
    v_mfma_f32_16x16x32_bf16 v[140:143], a[108:111], v[96:99], v[140:143]
    s_waitcnt lgkmcnt(7)
    v_exp_f32 v74, v74
    v_mfma_f32_16x16x32_bf16 v[144:147], a[112:115], v[96:99], v[144:147]
    ds_read_b128 a[68:71], v17 offset:40960
    v_cvt_pk_bf16_f32 v72, v72, v73
    v_mfma_f32_16x16x32_bf16 v[176:179], a[112:115], v[104:107], v[176:179]
    v_exp_f32 v75, v75
    v_mfma_f32_16x16x32_bf16 v[208:211], a[112:115], v[112:115], v[208:211]
    v_exp_f32 v80, v80
    v_mfma_f32_16x16x32_bf16 v[240:243], a[112:115], v[120:123], v[240:243]
    s_waitcnt lgkmcnt(6)
    v_exp_f32 v81, v81
    v_mfma_f32_16x16x32_bf16 v[244:247], a[116:119], v[120:123], v[244:247]
    ds_read_b128 a[72:75], v18 offset:40960
    v_cvt_pk_bf16_f32 v73, v74, v75
    v_mfma_f32_16x16x32_bf16 v[212:215], a[116:119], v[112:115], v[212:215]
    buffer_load_dwordx4 v37, s[76:79], s38 offen offset:1024 lds
    v_mfma_f32_16x16x32_bf16 v[180:183], a[116:119], v[104:107], v[180:183]
    v_exp_f32 v82, v82
    v_mfma_f32_16x16x32_bf16 v[148:151], a[116:119], v[96:99], v[148:151]
    s_waitcnt lgkmcnt(5)
    v_exp_f32 v83, v83
    v_mfma_f32_16x16x32_bf16 v[152:155], a[120:123], v[96:99], v[152:155]
    ds_read_b128 a[76:79], v19 offset:40960
    v_cvt_pk_bf16_f32 v80, v80, v81
    v_mfma_f32_16x16x32_bf16 v[184:187], a[120:123], v[104:107], v[184:187]
    v_exp_f32 v88, v88
    v_mfma_f32_16x16x32_bf16 v[216:219], a[120:123], v[112:115], v[216:219]
    buffer_load_dwordx4 v38, s[76:79], s38 offen offset:2048 lds
    v_mfma_f32_16x16x32_bf16 v[248:251], a[120:123], v[120:123], v[248:251]
    s_waitcnt lgkmcnt(4)
    v_exp_f32 v89, v89
    v_mfma_f32_16x16x32_bf16 v[252:255], a[124:127], v[120:123], v[252:255]
    ds_read_b128 a[80:83], v16 offset:45056
    v_cvt_pk_bf16_f32 v81, v82, v83
    v_mfma_f32_16x16x32_bf16 v[220:223], a[124:127], v[112:115], v[220:223]
    v_exp_f32 v90, v90
    v_mfma_f32_16x16x32_bf16 v[188:191], a[124:127], v[104:107], v[188:191]
    v_exp_f32 v91, v91
    v_mfma_f32_16x16x32_bf16 v[156:159], a[124:127], v[96:99], v[156:159]
    v_cvt_pk_bf16_f32 v88, v88, v89
    v_cvt_pk_bf16_f32 v89, v90, v91
    v_mfma_f32_16x16x32_bf16 a[128:131], a[144:147], v[96:99], a[128:131]
    ds_read_b128 a[84:87], v17 offset:45056
    v_mfma_f32_16x16x32_bf16 a[132:135], a[144:147], v[104:107], a[132:135]
    buffer_load_dwordx4 v39, s[76:79], s38 offen offset:3072 lds
    v_mfma_f32_16x16x32_bf16 a[136:139], a[144:147], v[112:115], a[136:139]
    v_exp_f32 v68, v68
    v_mfma_f32_16x16x32_bf16 a[140:143], a[144:147], v[120:123], a[140:143]
    s_waitcnt lgkmcnt(2)
    v_exp_f32 v69, v69
    v_mfma_f32_16x16x32_bf16 v[96:99], a[64:67], a[0:3], v[48:51]
    ds_read_b128 a[88:91], v18 offset:45056
    v_cvt_pk_bf16_f32 v66, v68, v69
    v_mfma_f32_16x16x32_bf16 v[96:99], a[68:71], a[4:7], v[96:99]
    v_exp_f32 v70, v70
    v_mfma_f32_16x16x32_bf16 v[96:99], a[72:75], a[8:11], v[96:99]
    v_exp_f32 v71, v71
    v_mfma_f32_16x16x32_bf16 v[96:99], a[76:79], a[12:15], v[96:99]
    v_cvt_pk_bf16_f32 v67, v70, v71
    v_mfma_f32_16x16x32_bf16 v[104:107], a[76:79], a[28:31], v[52:55]
    ds_read_b128 a[92:95], v19 offset:45056
    v_mfma_f32_16x16x32_bf16 v[104:107], a[72:75], a[24:27], v[104:107]
    v_exp_f32 v76, v76
    v_mfma_f32_16x16x32_bf16 v[104:107], a[68:71], a[20:23], v[104:107]
    v_exp_f32 v77, v77
    v_mfma_f32_16x16x32_bf16 v[104:107], a[64:67], a[16:19], v[104:107]
    v_cvt_pk_bf16_f32 v74, v76, v77
    v_mfma_f32_16x16x32_bf16 v[112:115], a[64:67], a[32:35], v[56:59]
    v_exp_f32 v78, v78
    v_mfma_f32_16x16x32_bf16 v[112:115], a[68:71], a[36:39], v[112:115]
    v_mfma_f32_16x16x32_bf16 v[112:115], a[72:75], a[40:43], v[112:115]
    v_exp_f32 v79, v79
    v_mfma_f32_16x16x32_bf16 v[112:115], a[76:79], a[44:47], v[112:115]
    v_cvt_pk_bf16_f32 v75, v78, v79
    v_mfma_f32_16x16x32_bf16 v[120:123], a[76:79], a[60:63], v[60:63]
    v_exp_f32 v84, v84
    v_mfma_f32_16x16x32_bf16 v[120:123], a[72:75], a[56:59], v[120:123]
    v_mfma_f32_16x16x32_bf16 v[120:123], a[68:71], a[52:55], v[120:123]
    v_exp_f32 v85, v85
    v_mfma_f32_16x16x32_bf16 v[120:123], a[64:67], a[48:51], v[120:123]
    v_cvt_pk_bf16_f32 v82, v84, v85
    s_waitcnt vmcnt(60) lgkmcnt(0)
    s_barrier
    v_mfma_f32_16x16x32_bf16 v[100:103], a[80:83], a[0:3], v[48:51]
    ds_read_b64_tr_b16 a[96:97], v20 offset:49152
    v_mfma_f32_16x16x32_bf16 v[100:103], a[84:87], a[4:7], v[100:103]
    v_exp_f32 v86, v86
    v_mfma_f32_16x16x32_bf16 v[100:103], a[88:91], a[8:11], v[100:103]
    s_add_u32 m0, s30, 131072
    s_mov_b32 s38, 532480
    ds_read_b64_tr_b16 a[98:99], v20 offset:53248
    v_mfma_f32_16x16x32_bf16 v[100:103], a[92:95], a[12:15], v[100:103]
    buffer_load_dwordx4 v36, s[76:79], s38 offen offset:0 lds
    v_mfma_f32_16x16x32_bf16 v[108:111], a[92:95], a[28:31], v[52:55]
    ds_read_b64_tr_b16 a[100:101], v21 offset:49152
    v_mfma_f32_16x16x32_bf16 v[108:111], a[88:91], a[24:27], v[108:111]
    v_exp_f32 v87, v87
    v_exp_f32 v92, v92
    v_mfma_f32_16x16x32_bf16 v[108:111], a[84:87], a[20:23], v[108:111]
    ds_read_b64_tr_b16 a[102:103], v21 offset:53248
    v_cvt_pk_bf16_f32 v83, v86, v87
    v_mfma_f32_16x16x32_bf16 v[108:111], a[80:83], a[16:19], v[108:111]
    buffer_load_dwordx4 v37, s[76:79], s38 offen offset:1024 lds
    v_mfma_f32_16x16x32_bf16 v[116:119], a[80:83], a[32:35], v[56:59]
    ds_read_b64_tr_b16 a[104:105], v22 offset:49152
    v_mfma_f32_16x16x32_bf16 v[116:119], a[84:87], a[36:39], v[116:119]
    v_exp_f32 v93, v93
    v_exp_f32 v94, v94
    v_mfma_f32_16x16x32_bf16 v[116:119], a[88:91], a[40:43], v[116:119]
    ds_read_b64_tr_b16 a[106:107], v22 offset:53248
    v_cvt_pk_bf16_f32 v90, v92, v93
    v_mfma_f32_16x16x32_bf16 v[116:119], a[92:95], a[44:47], v[116:119]
    buffer_load_dwordx4 v38, s[76:79], s38 offen offset:2048 lds
    v_mfma_f32_16x16x32_bf16 v[124:127], a[92:95], a[60:63], v[60:63]
    ds_read_b64_tr_b16 a[108:109], v23 offset:49152
    v_mfma_f32_16x16x32_bf16 v[124:127], a[88:91], a[56:59], v[124:127]
    v_exp_f32 v95, v95
    v_mfma_f32_16x16x32_bf16 v[124:127], a[84:87], a[52:55], v[124:127]
    ds_read_b64_tr_b16 a[110:111], v23 offset:53248
    v_cvt_pk_bf16_f32 v91, v94, v95
    v_mfma_f32_16x16x32_bf16 v[124:127], a[80:83], a[48:51], v[124:127]
    s_waitcnt lgkmcnt(6)
    buffer_load_dwordx4 v39, s[76:79], s38 offen offset:3072 lds
    v_mfma_f32_16x16x32_bf16 v[128:131], a[96:99], v[64:67], v[128:131]
    ds_read_b64_tr_b16 a[112:113], v24 offset:49152
    v_mfma_f32_16x16x32_bf16 v[160:163], a[96:99], v[72:75], v[160:163]
    v_exp_f32 v96, v96
    v_exp_f32 v97, v97
    v_mfma_f32_16x16x32_bf16 v[192:195], a[96:99], v[80:83], v[192:195]
    s_add_u32 m0, s30, 32768
    s_mov_b32 s38, 573440
    ds_read_b64_tr_b16 a[114:115], v24 offset:53248
    v_cvt_pk_bf16_f32 v96, v96, v97
    v_mfma_f32_16x16x32_bf16 v[224:227], a[96:99], v[88:91], v[224:227]
    s_waitcnt lgkmcnt(6)
    buffer_load_dwordx4 v36, s[76:79], s38 offen offset:0 lds
    v_mfma_f32_16x16x32_bf16 v[228:231], a[100:103], v[88:91], v[228:231]
    ds_read_b64_tr_b16 a[116:117], v25 offset:49152
    v_mfma_f32_16x16x32_bf16 v[196:199], a[100:103], v[80:83], v[196:199]
    v_exp_f32 v98, v98
    v_exp_f32 v99, v99
    v_mfma_f32_16x16x32_bf16 v[164:167], a[100:103], v[72:75], v[164:167]
    ds_read_b64_tr_b16 a[118:119], v25 offset:53248
    v_exp_f32 v104, v104
    v_mfma_f32_16x16x32_bf16 v[132:135], a[100:103], v[64:67], v[132:135]
    s_waitcnt lgkmcnt(6)
    buffer_load_dwordx4 v37, s[76:79], s38 offen offset:1024 lds
    v_exp_f32 v105, v105
    v_mfma_f32_16x16x32_bf16 v[136:139], a[104:107], v[64:67], v[136:139]
    ds_read_b64_tr_b16 a[120:121], v26 offset:49152
    v_cvt_pk_bf16_f32 v97, v98, v99
    v_mfma_f32_16x16x32_bf16 v[168:171], a[104:107], v[72:75], v[168:171]
    v_exp_f32 v106, v106
    v_exp_f32 v107, v107
    v_mfma_f32_16x16x32_bf16 v[200:203], a[104:107], v[80:83], v[200:203]
    ds_read_b64_tr_b16 a[122:123], v26 offset:53248
    v_exp_f32 v112, v112
    v_mfma_f32_16x16x32_bf16 v[232:235], a[104:107], v[88:91], v[232:235]
    s_waitcnt lgkmcnt(6)
    buffer_load_dwordx4 v38, s[76:79], s38 offen offset:2048 lds
    v_exp_f32 v113, v113
    v_mfma_f32_16x16x32_bf16 v[236:239], a[108:111], v[88:91], v[236:239]
    ds_read_b64_tr_b16 a[124:125], v27 offset:49152
    v_cvt_pk_bf16_f32 v104, v104, v105
    v_cvt_pk_bf16_f32 v105, v106, v107
    v_mfma_f32_16x16x32_bf16 v[204:207], a[108:111], v[80:83], v[204:207]
    v_exp_f32 v114, v114
    v_exp_f32 v115, v115
    v_mfma_f32_16x16x32_bf16 v[172:175], a[108:111], v[72:75], v[172:175]
    ds_read_b64_tr_b16 a[126:127], v27 offset:53248
    v_exp_f32 v120, v120
    v_mfma_f32_16x16x32_bf16 v[140:143], a[108:111], v[64:67], v[140:143]
    s_waitcnt lgkmcnt(6)
    buffer_load_dwordx4 v39, s[76:79], s38 offen offset:3072 lds
    v_exp_f32 v121, v121
    v_mfma_f32_16x16x32_bf16 v[144:147], a[112:115], v[64:67], v[144:147]
    ds_read_b64_tr_b16 a[96:97], v20 offset:57344
    v_cvt_pk_bf16_f32 v112, v112, v113
    v_mfma_f32_16x16x32_bf16 v[176:179], a[112:115], v[72:75], v[176:179]
    v_exp_f32 v122, v122
    v_exp_f32 v123, v123
    v_mfma_f32_16x16x32_bf16 v[208:211], a[112:115], v[80:83], v[208:211]
    ds_read_b64_tr_b16 a[98:99], v20 offset:61440
    v_cvt_pk_bf16_f32 v113, v114, v115
    v_mfma_f32_16x16x32_bf16 v[240:243], a[112:115], v[88:91], v[240:243]
    s_waitcnt lgkmcnt(6)
    v_exp_f32 v100, v100
    v_exp_f32 v101, v101
    v_mfma_f32_16x16x32_bf16 v[244:247], a[116:119], v[88:91], v[244:247]
    ds_read_b64_tr_b16 a[100:101], v21 offset:57344
    v_cvt_pk_bf16_f32 v120, v120, v121
    v_mfma_f32_16x16x32_bf16 v[212:215], a[116:119], v[80:83], v[212:215]
    v_exp_f32 v102, v102
    v_exp_f32 v103, v103
    v_mfma_f32_16x16x32_bf16 v[180:183], a[116:119], v[72:75], v[180:183]
    ds_read_b64_tr_b16 a[102:103], v21 offset:61440
    v_cvt_pk_bf16_f32 v121, v122, v123
    v_mfma_f32_16x16x32_bf16 v[148:151], a[116:119], v[64:67], v[148:151]
    s_waitcnt lgkmcnt(6)
    v_exp_f32 v108, v108
    v_exp_f32 v109, v109
    v_mfma_f32_16x16x32_bf16 v[152:155], a[120:123], v[64:67], v[152:155]
    ds_read_b64_tr_b16 a[104:105], v22 offset:57344
    v_cvt_pk_bf16_f32 v98, v100, v101
    v_mfma_f32_16x16x32_bf16 v[184:187], a[120:123], v[72:75], v[184:187]
    v_exp_f32 v110, v110
    v_exp_f32 v111, v111
    v_mfma_f32_16x16x32_bf16 v[216:219], a[120:123], v[80:83], v[216:219]
    ds_read_b64_tr_b16 a[106:107], v22 offset:61440
    v_cvt_pk_bf16_f32 v99, v102, v103
    v_mfma_f32_16x16x32_bf16 v[248:251], a[120:123], v[88:91], v[248:251]
    s_waitcnt lgkmcnt(6)
    v_exp_f32 v116, v116
    v_exp_f32 v117, v117
    v_mfma_f32_16x16x32_bf16 v[252:255], a[124:127], v[88:91], v[252:255]
    ds_read_b64_tr_b16 a[108:109], v23 offset:57344
    v_cvt_pk_bf16_f32 v106, v108, v109
    v_mfma_f32_16x16x32_bf16 v[220:223], a[124:127], v[80:83], v[220:223]
    v_exp_f32 v118, v118
    v_exp_f32 v119, v119
    v_mfma_f32_16x16x32_bf16 v[188:191], a[124:127], v[72:75], v[188:191]
    ds_read_b64_tr_b16 a[110:111], v23 offset:61440
    v_cvt_pk_bf16_f32 v107, v110, v111
    v_cvt_pk_bf16_f32 v114, v116, v117
    v_mfma_f32_16x16x32_bf16 v[156:159], a[124:127], v[64:67], v[156:159]
    v_exp_f32 v124, v124
    v_exp_f32 v125, v125
    v_mfma_f32_16x16x32_bf16 a[128:131], a[144:147], v[64:67], a[128:131]
    ds_read_b64_tr_b16 a[112:113], v24 offset:57344
    v_exp_f32 v126, v126
    v_exp_f32 v127, v127
    v_mfma_f32_16x16x32_bf16 a[132:135], a[144:147], v[72:75], a[132:135]
    v_cvt_pk_bf16_f32 v115, v118, v119
    v_cvt_pk_bf16_f32 v122, v124, v125
    v_mfma_f32_16x16x32_bf16 a[136:139], a[144:147], v[80:83], a[136:139]
    ds_read_b64_tr_b16 a[114:115], v24 offset:61440
    v_cvt_pk_bf16_f32 v123, v126, v127
    v_mfma_f32_16x16x32_bf16 a[140:143], a[144:147], v[88:91], a[140:143]
    s_waitcnt lgkmcnt(8)
    v_mfma_f32_16x16x32_bf16 v[128:131], a[96:99], v[96:99], v[128:131]
    ds_read_b64_tr_b16 a[116:117], v25 offset:57344
    v_mfma_f32_16x16x32_bf16 v[160:163], a[96:99], v[104:107], v[160:163]
    v_mfma_f32_16x16x32_bf16 v[192:195], a[96:99], v[112:115], v[192:195]
    ds_read_b64_tr_b16 a[118:119], v25 offset:61440
    v_mfma_f32_16x16x32_bf16 v[224:227], a[96:99], v[120:123], v[224:227]
    s_waitcnt lgkmcnt(8)
    v_mfma_f32_16x16x32_bf16 v[228:231], a[100:103], v[120:123], v[228:231]
    ds_read_b64_tr_b16 a[120:121], v26 offset:57344
    v_mfma_f32_16x16x32_bf16 v[196:199], a[100:103], v[112:115], v[196:199]
    v_mfma_f32_16x16x32_bf16 v[164:167], a[100:103], v[104:107], v[164:167]
    ds_read_b64_tr_b16 a[122:123], v26 offset:61440
    v_mfma_f32_16x16x32_bf16 v[132:135], a[100:103], v[96:99], v[132:135]
    s_waitcnt lgkmcnt(8)
    v_mfma_f32_16x16x32_bf16 v[136:139], a[104:107], v[96:99], v[136:139]
    ds_read_b64_tr_b16 a[124:125], v27 offset:57344
    v_mfma_f32_16x16x32_bf16 v[168:171], a[104:107], v[104:107], v[168:171]
    v_mfma_f32_16x16x32_bf16 v[200:203], a[104:107], v[112:115], v[200:203]
    ds_read_b64_tr_b16 a[126:127], v27 offset:61440
    v_mfma_f32_16x16x32_bf16 v[232:235], a[104:107], v[120:123], v[232:235]
    s_waitcnt lgkmcnt(8)
    v_mfma_f32_16x16x32_bf16 v[236:239], a[108:111], v[120:123], v[236:239]
    v_mfma_f32_16x16x32_bf16 v[204:207], a[108:111], v[112:115], v[204:207]
    v_mfma_f32_16x16x32_bf16 v[172:175], a[108:111], v[104:107], v[172:175]
    v_mfma_f32_16x16x32_bf16 v[140:143], a[108:111], v[96:99], v[140:143]
    s_waitcnt lgkmcnt(6)
    v_mfma_f32_16x16x32_bf16 v[144:147], a[112:115], v[96:99], v[144:147]
    v_mfma_f32_16x16x32_bf16 v[176:179], a[112:115], v[104:107], v[176:179]
    v_mfma_f32_16x16x32_bf16 v[208:211], a[112:115], v[112:115], v[208:211]
    v_mfma_f32_16x16x32_bf16 v[240:243], a[112:115], v[120:123], v[240:243]
    s_waitcnt lgkmcnt(4)
    v_mfma_f32_16x16x32_bf16 v[244:247], a[116:119], v[120:123], v[244:247]
    v_mfma_f32_16x16x32_bf16 v[212:215], a[116:119], v[112:115], v[212:215]
    v_mfma_f32_16x16x32_bf16 v[180:183], a[116:119], v[104:107], v[180:183]
    v_mfma_f32_16x16x32_bf16 v[148:151], a[116:119], v[96:99], v[148:151]
    s_waitcnt lgkmcnt(2)
    v_mfma_f32_16x16x32_bf16 v[152:155], a[120:123], v[96:99], v[152:155]
    v_mfma_f32_16x16x32_bf16 v[184:187], a[120:123], v[104:107], v[184:187]
    v_mfma_f32_16x16x32_bf16 v[216:219], a[120:123], v[112:115], v[216:219]
    v_mfma_f32_16x16x32_bf16 v[248:251], a[120:123], v[120:123], v[248:251]
    s_waitcnt lgkmcnt(0)
    v_mfma_f32_16x16x32_bf16 v[252:255], a[124:127], v[120:123], v[252:255]
    v_mfma_f32_16x16x32_bf16 v[220:223], a[124:127], v[112:115], v[220:223]
    v_mfma_f32_16x16x32_bf16 v[188:191], a[124:127], v[104:107], v[188:191]
    v_mfma_f32_16x16x32_bf16 v[156:159], a[124:127], v[96:99], v[156:159]
    v_mfma_f32_16x16x32_bf16 a[128:131], a[144:147], v[96:99], a[128:131]
    v_mfma_f32_16x16x32_bf16 a[132:135], a[144:147], v[104:107], a[132:135]
    v_mfma_f32_16x16x32_bf16 a[136:139], a[144:147], v[112:115], a[136:139]
    v_mfma_f32_16x16x32_bf16 a[140:143], a[144:147], v[120:123], a[140:143]
    s_nop 7
    v_accvgpr_read_b32 v48, a128
    v_accvgpr_read_b32 v52, a132
    v_accvgpr_read_b32 v56, a136
    v_accvgpr_read_b32 v60, a140
    v_mov_b32 v49, v48
    v_mov_b32 v53, v52
    v_mov_b32 v57, v56
    v_mov_b32 v61, v60
    s_nop 1
    v_permlane32_swap_b32 v48, v49
    v_permlane32_swap_b32 v52, v53
    v_permlane32_swap_b32 v56, v57
    v_permlane32_swap_b32 v60, v61
    s_nop 1
    v_add_f32 v48, v48, v49
    v_add_f32 v52, v52, v53
    v_add_f32 v56, v56, v57
    v_add_f32 v60, v60, v61
    v_mov_b32 v49, v48
    v_mov_b32 v53, v52
    v_mov_b32 v57, v56
    v_mov_b32 v61, v60
    s_nop 1
    v_permlane16_swap_b32 v48, v49
    v_permlane16_swap_b32 v52, v53
    v_permlane16_swap_b32 v56, v57
    v_permlane16_swap_b32 v60, v61
    s_nop 1
    v_add_f32 v48, v48, v49
    v_add_f32 v52, v52, v53
    v_add_f32 v56, v56, v57
    v_add_f32 v60, v60, v61
    s_mov_b32 s38, 0x5f800000
    s_mov_b64 s[4:5], 0
    v_cmp_ngt_f32 vcc, s38, v48
    s_or_b64 s[4:5], s[4:5], vcc
    v_cmp_ngt_f32 vcc, s38, v52
    s_or_b64 s[4:5], s[4:5], vcc
    v_cmp_ngt_f32 vcc, s38, v56
    s_or_b64 s[4:5], s[4:5], vcc
    v_cmp_ngt_f32 vcc, s38, v60
    s_or_b64 s[4:5], s[4:5], vcc
    s_cbranch_scc1 L_safeA
L_epiA:
    v_rcp_f32 v48, v48
    v_rcp_f32 v52, v52
    v_rcp_f32 v56, v56
    v_rcp_f32 v60, v60
    s_lshl_b32 s38, s28, 2
    s_add_u32 s38, s38, 0
    s_mul_i32 s39, s38, 52
    s_lshr_b32 s39, s39, 8
    s_mul_i32 s39, s39, 634880
    s_lshl_b32 s38, s38, 12
    s_add_u32 s38, s38, s39
    s_add_u32 s38, s38, s3
    v_pk_mul_f32 v[128:129], v[128:129], v[48:49] op_sel_hi:[1,0]
    v_pk_mul_f32 v[130:131], v[130:131], v[48:49] op_sel_hi:[1,0]
    v_pk_mul_f32 v[132:133], v[132:133], v[48:49] op_sel_hi:[1,0]
    v_pk_mul_f32 v[134:135], v[134:135], v[48:49] op_sel_hi:[1,0]
    v_cvt_pk_bf16_f32 v128, v128, v129
    v_cvt_pk_bf16_f32 v129, v130, v131
    v_cvt_pk_bf16_f32 v130, v132, v133
    v_cvt_pk_bf16_f32 v131, v134, v135
    buffer_store_dwordx4 v[128:131], v2, s[24:27], s38 offen offset:0 sc0 sc1
    v_pk_mul_f32 v[136:137], v[136:137], v[48:49] op_sel_hi:[1,0]
    v_pk_mul_f32 v[138:139], v[138:139], v[48:49] op_sel_hi:[1,0]
    v_pk_mul_f32 v[140:141], v[140:141], v[48:49] op_sel_hi:[1,0]
    v_pk_mul_f32 v[142:143], v[142:143], v[48:49] op_sel_hi:[1,0]
    v_cvt_pk_bf16_f32 v136, v136, v137
    v_cvt_pk_bf16_f32 v137, v138, v139
    v_cvt_pk_bf16_f32 v138, v140, v141
    v_cvt_pk_bf16_f32 v139, v142, v143
    buffer_store_dwordx4 v[136:139], v2, s[24:27], s38 offen offset:1024 sc0 sc1
    v_pk_mul_f32 v[144:145], v[144:145], v[48:49] op_sel_hi:[1,0]
    v_pk_mul_f32 v[146:147], v[146:147], v[48:49] op_sel_hi:[1,0]
    v_pk_mul_f32 v[148:149], v[148:149], v[48:49] op_sel_hi:[1,0]
    v_pk_mul_f32 v[150:151], v[150:151], v[48:49] op_sel_hi:[1,0]
    v_cvt_pk_bf16_f32 v144, v144, v145
    v_cvt_pk_bf16_f32 v145, v146, v147
    v_cvt_pk_bf16_f32 v146, v148, v149
    v_cvt_pk_bf16_f32 v147, v150, v151
    buffer_store_dwordx4 v[144:147], v2, s[24:27], s38 offen offset:2048 sc0 sc1
    v_pk_mul_f32 v[152:153], v[152:153], v[48:49] op_sel_hi:[1,0]
    v_pk_mul_f32 v[154:155], v[154:155], v[48:49] op_sel_hi:[1,0]
    v_pk_mul_f32 v[156:157], v[156:157], v[48:49] op_sel_hi:[1,0]
    v_pk_mul_f32 v[158:159], v[158:159], v[48:49] op_sel_hi:[1,0]
    v_cvt_pk_bf16_f32 v152, v152, v153
    v_cvt_pk_bf16_f32 v153, v154, v155
    v_cvt_pk_bf16_f32 v154, v156, v157
    v_cvt_pk_bf16_f32 v155, v158, v159
    buffer_store_dwordx4 v[152:155], v2, s[24:27], s38 offen offset:3072 sc0 sc1
    s_lshl_b32 s38, s28, 2
    s_add_u32 s38, s38, 1
    s_mul_i32 s39, s38, 52
    s_lshr_b32 s39, s39, 8
    s_mul_i32 s39, s39, 634880
    s_lshl_b32 s38, s38, 12
    s_add_u32 s38, s38, s39
    s_add_u32 s38, s38, s3
    v_pk_mul_f32 v[160:161], v[160:161], v[52:53] op_sel_hi:[1,0]
    v_pk_mul_f32 v[162:163], v[162:163], v[52:53] op_sel_hi:[1,0]
    v_pk_mul_f32 v[164:165], v[164:165], v[52:53] op_sel_hi:[1,0]
    v_pk_mul_f32 v[166:167], v[166:167], v[52:53] op_sel_hi:[1,0]
    v_cvt_pk_bf16_f32 v160, v160, v161
    v_cvt_pk_bf16_f32 v161, v162, v163
    v_cvt_pk_bf16_f32 v162, v164, v165
    v_cvt_pk_bf16_f32 v163, v166, v167
    buffer_store_dwordx4 v[160:163], v2, s[24:27], s38 offen offset:0 sc0 sc1
    v_pk_mul_f32 v[168:169], v[168:169], v[52:53] op_sel_hi:[1,0]
    v_pk_mul_f32 v[170:171], v[170:171], v[52:53] op_sel_hi:[1,0]
    v_pk_mul_f32 v[172:173], v[172:173], v[52:53] op_sel_hi:[1,0]
    v_pk_mul_f32 v[174:175], v[174:175], v[52:53] op_sel_hi:[1,0]
    v_cvt_pk_bf16_f32 v168, v168, v169
    v_cvt_pk_bf16_f32 v169, v170, v171
    v_cvt_pk_bf16_f32 v170, v172, v173
    v_cvt_pk_bf16_f32 v171, v174, v175
    buffer_store_dwordx4 v[168:171], v2, s[24:27], s38 offen offset:1024 sc0 sc1
    v_pk_mul_f32 v[176:177], v[176:177], v[52:53] op_sel_hi:[1,0]
    v_pk_mul_f32 v[178:179], v[178:179], v[52:53] op_sel_hi:[1,0]
    v_pk_mul_f32 v[180:181], v[180:181], v[52:53] op_sel_hi:[1,0]
    v_pk_mul_f32 v[182:183], v[182:183], v[52:53] op_sel_hi:[1,0]
    v_cvt_pk_bf16_f32 v176, v176, v177
    v_cvt_pk_bf16_f32 v177, v178, v179
    v_cvt_pk_bf16_f32 v178, v180, v181
    v_cvt_pk_bf16_f32 v179, v182, v183
    buffer_store_dwordx4 v[176:179], v2, s[24:27], s38 offen offset:2048 sc0 sc1
    v_pk_mul_f32 v[184:185], v[184:185], v[52:53] op_sel_hi:[1,0]
    v_pk_mul_f32 v[186:187], v[186:187], v[52:53] op_sel_hi:[1,0]
    v_pk_mul_f32 v[188:189], v[188:189], v[52:53] op_sel_hi:[1,0]
    v_pk_mul_f32 v[190:191], v[190:191], v[52:53] op_sel_hi:[1,0]
    v_cvt_pk_bf16_f32 v184, v184, v185
    v_cvt_pk_bf16_f32 v185, v186, v187
    v_cvt_pk_bf16_f32 v186, v188, v189
    v_cvt_pk_bf16_f32 v187, v190, v191
    buffer_store_dwordx4 v[184:187], v2, s[24:27], s38 offen offset:3072 sc0 sc1
    s_lshl_b32 s38, s28, 2
    s_add_u32 s38, s38, 2
    s_mul_i32 s39, s38, 52
    s_lshr_b32 s39, s39, 8
    s_mul_i32 s39, s39, 634880
    s_lshl_b32 s38, s38, 12
    s_add_u32 s38, s38, s39
    s_add_u32 s38, s38, s3
    v_pk_mul_f32 v[192:193], v[192:193], v[56:57] op_sel_hi:[1,0]
    v_pk_mul_f32 v[194:195], v[194:195], v[56:57] op_sel_hi:[1,0]
    v_pk_mul_f32 v[196:197], v[196:197], v[56:57] op_sel_hi:[1,0]
    v_pk_mul_f32 v[198:199], v[198:199], v[56:57] op_sel_hi:[1,0]
    v_cvt_pk_bf16_f32 v192, v192, v193
    v_cvt_pk_bf16_f32 v193, v194, v195
    v_cvt_pk_bf16_f32 v194, v196, v197
    v_cvt_pk_bf16_f32 v195, v198, v199
    buffer_store_dwordx4 v[192:195], v2, s[24:27], s38 offen offset:0 sc0 sc1
    v_pk_mul_f32 v[200:201], v[200:201], v[56:57] op_sel_hi:[1,0]
    v_pk_mul_f32 v[202:203], v[202:203], v[56:57] op_sel_hi:[1,0]
    v_pk_mul_f32 v[204:205], v[204:205], v[56:57] op_sel_hi:[1,0]
    v_pk_mul_f32 v[206:207], v[206:207], v[56:57] op_sel_hi:[1,0]
    v_cvt_pk_bf16_f32 v200, v200, v201
    v_cvt_pk_bf16_f32 v201, v202, v203
    v_cvt_pk_bf16_f32 v202, v204, v205
    v_cvt_pk_bf16_f32 v203, v206, v207
    buffer_store_dwordx4 v[200:203], v2, s[24:27], s38 offen offset:1024 sc0 sc1
    v_pk_mul_f32 v[208:209], v[208:209], v[56:57] op_sel_hi:[1,0]
    v_pk_mul_f32 v[210:211], v[210:211], v[56:57] op_sel_hi:[1,0]
    v_pk_mul_f32 v[212:213], v[212:213], v[56:57] op_sel_hi:[1,0]
    v_pk_mul_f32 v[214:215], v[214:215], v[56:57] op_sel_hi:[1,0]
    v_cvt_pk_bf16_f32 v208, v208, v209
    v_cvt_pk_bf16_f32 v209, v210, v211
    v_cvt_pk_bf16_f32 v210, v212, v213
    v_cvt_pk_bf16_f32 v211, v214, v215
    buffer_store_dwordx4 v[208:211], v2, s[24:27], s38 offen offset:2048 sc0 sc1
    v_pk_mul_f32 v[216:217], v[216:217], v[56:57] op_sel_hi:[1,0]
    v_pk_mul_f32 v[218:219], v[218:219], v[56:57] op_sel_hi:[1,0]
    v_pk_mul_f32 v[220:221], v[220:221], v[56:57] op_sel_hi:[1,0]
    v_pk_mul_f32 v[222:223], v[222:223], v[56:57] op_sel_hi:[1,0]
    v_cvt_pk_bf16_f32 v216, v216, v217
    v_cvt_pk_bf16_f32 v217, v218, v219
    v_cvt_pk_bf16_f32 v218, v220, v221
    v_cvt_pk_bf16_f32 v219, v222, v223
    buffer_store_dwordx4 v[216:219], v2, s[24:27], s38 offen offset:3072 sc0 sc1
    s_lshl_b32 s38, s28, 2
    s_add_u32 s38, s38, 3
    s_mul_i32 s39, s38, 52
    s_lshr_b32 s39, s39, 8
    s_mul_i32 s39, s39, 634880
    s_lshl_b32 s38, s38, 12
    s_add_u32 s38, s38, s39
    s_add_u32 s38, s38, s3
    v_pk_mul_f32 v[224:225], v[224:225], v[60:61] op_sel_hi:[1,0]
    v_pk_mul_f32 v[226:227], v[226:227], v[60:61] op_sel_hi:[1,0]
    v_pk_mul_f32 v[228:229], v[228:229], v[60:61] op_sel_hi:[1,0]
    v_pk_mul_f32 v[230:231], v[230:231], v[60:61] op_sel_hi:[1,0]
    v_cvt_pk_bf16_f32 v224, v224, v225
    v_cvt_pk_bf16_f32 v225, v226, v227
    v_cvt_pk_bf16_f32 v226, v228, v229
    v_cvt_pk_bf16_f32 v227, v230, v231
    buffer_store_dwordx4 v[224:227], v2, s[24:27], s38 offen offset:0 sc0 sc1
    v_pk_mul_f32 v[232:233], v[232:233], v[60:61] op_sel_hi:[1,0]
    v_pk_mul_f32 v[234:235], v[234:235], v[60:61] op_sel_hi:[1,0]
    v_pk_mul_f32 v[236:237], v[236:237], v[60:61] op_sel_hi:[1,0]
    v_pk_mul_f32 v[238:239], v[238:239], v[60:61] op_sel_hi:[1,0]
    v_cvt_pk_bf16_f32 v232, v232, v233
    v_cvt_pk_bf16_f32 v233, v234, v235
    v_cvt_pk_bf16_f32 v234, v236, v237
    v_cvt_pk_bf16_f32 v235, v238, v239
    buffer_store_dwordx4 v[232:235], v2, s[24:27], s38 offen offset:1024 sc0 sc1
    v_pk_mul_f32 v[240:241], v[240:241], v[60:61] op_sel_hi:[1,0]
    v_pk_mul_f32 v[242:243], v[242:243], v[60:61] op_sel_hi:[1,0]
    v_pk_mul_f32 v[244:245], v[244:245], v[60:61] op_sel_hi:[1,0]
    v_pk_mul_f32 v[246:247], v[246:247], v[60:61] op_sel_hi:[1,0]
    v_cvt_pk_bf16_f32 v240, v240, v241
    v_cvt_pk_bf16_f32 v241, v242, v243
    v_cvt_pk_bf16_f32 v242, v244, v245
    v_cvt_pk_bf16_f32 v243, v246, v247
    buffer_store_dwordx4 v[240:243], v2, s[24:27], s38 offen offset:2048 sc0 sc1
    v_pk_mul_f32 v[248:249], v[248:249], v[60:61] op_sel_hi:[1,0]
    v_pk_mul_f32 v[250:251], v[250:251], v[60:61] op_sel_hi:[1,0]
    v_pk_mul_f32 v[252:253], v[252:253], v[60:61] op_sel_hi:[1,0]
    v_pk_mul_f32 v[254:255], v[254:255], v[60:61] op_sel_hi:[1,0]
    v_cvt_pk_bf16_f32 v248, v248, v249
    v_cvt_pk_bf16_f32 v249, v250, v251
    v_cvt_pk_bf16_f32 v250, v252, v253
    v_cvt_pk_bf16_f32 v251, v254, v255
    buffer_store_dwordx4 v[248:251], v2, s[24:27], s38 offen offset:3072 sc0 sc1
    s_waitcnt vmcnt(24)
    s_branch L_common
L_safeA:
    s_waitcnt vmcnt(0) lgkmcnt(0)
    v_mov_b32 v128, 0
    v_mov_b32 v129, 0
    v_mov_b32 v130, 0
    v_mov_b32 v131, 0
    v_mov_b32 v132, 0
    v_mov_b32 v133, 0
    v_mov_b32 v134, 0
    v_mov_b32 v135, 0
    v_mov_b32 v136, 0
    v_mov_b32 v137, 0
    v_mov_b32 v138, 0
    v_mov_b32 v139, 0
    v_mov_b32 v140, 0
    v_mov_b32 v141, 0
    v_mov_b32 v142, 0
    v_mov_b32 v143, 0
    v_mov_b32 v144, 0
    v_mov_b32 v145, 0
    v_mov_b32 v146, 0
    v_mov_b32 v147, 0
    v_mov_b32 v148, 0
    v_mov_b32 v149, 0
    v_mov_b32 v150, 0
    v_mov_b32 v151, 0
    v_mov_b32 v152, 0
    v_mov_b32 v153, 0
    v_mov_b32 v154, 0
    v_mov_b32 v155, 0
    v_mov_b32 v156, 0
    v_mov_b32 v157, 0
    v_mov_b32 v158, 0
    v_mov_b32 v159, 0
    v_mov_b32 v160, 0
    v_mov_b32 v161, 0
    v_mov_b32 v162, 0
    v_mov_b32 v163, 0
    v_mov_b32 v164, 0
    v_mov_b32 v165, 0
    v_mov_b32 v166, 0
    v_mov_b32 v167, 0
    v_mov_b32 v168, 0
    v_mov_b32 v169, 0
    v_mov_b32 v170, 0
    v_mov_b32 v171, 0
    v_mov_b32 v172, 0
    v_mov_b32 v173, 0
    v_mov_b32 v174, 0
    v_mov_b32 v175, 0
    v_mov_b32 v176, 0
    v_mov_b32 v177, 0
    v_mov_b32 v178, 0
    v_mov_b32 v179, 0
    v_mov_b32 v180, 0
    v_mov_b32 v181, 0
    v_mov_b32 v182, 0
    v_mov_b32 v183, 0
    v_mov_b32 v184, 0
    v_mov_b32 v185, 0
    v_mov_b32 v186, 0
    v_mov_b32 v187, 0
    v_mov_b32 v188, 0
    v_mov_b32 v189, 0
    v_mov_b32 v190, 0
    v_mov_b32 v191, 0
    v_mov_b32 v192, 0
    v_mov_b32 v193, 0
    v_mov_b32 v194, 0
    v_mov_b32 v195, 0
    v_mov_b32 v196, 0
    v_mov_b32 v197, 0
    v_mov_b32 v198, 0
    v_mov_b32 v199, 0
    v_mov_b32 v200, 0
    v_mov_b32 v201, 0
    v_mov_b32 v202, 0
    v_mov_b32 v203, 0
    v_mov_b32 v204, 0
    v_mov_b32 v205, 0
    v_mov_b32 v206, 0
    v_mov_b32 v207, 0
    v_mov_b32 v208, 0
    v_mov_b32 v209, 0
    v_mov_b32 v210, 0
    v_mov_b32 v211, 0
    v_mov_b32 v212, 0
    v_mov_b32 v213, 0
    v_mov_b32 v214, 0
    v_mov_b32 v215, 0
    v_mov_b32 v216, 0
    v_mov_b32 v217, 0
    v_mov_b32 v218, 0
    v_mov_b32 v219, 0
    v_mov_b32 v220, 0
    v_mov_b32 v221, 0
    v_mov_b32 v222, 0
    v_mov_b32 v223, 0
    v_mov_b32 v224, 0
    v_mov_b32 v225, 0
    v_mov_b32 v226, 0
    v_mov_b32 v227, 0
    v_mov_b32 v228, 0
    v_mov_b32 v229, 0
    v_mov_b32 v230, 0
    v_mov_b32 v231, 0
    v_mov_b32 v232, 0
    v_mov_b32 v233, 0
    v_mov_b32 v234, 0
    v_mov_b32 v235, 0
    v_mov_b32 v236, 0
    v_mov_b32 v237, 0
    v_mov_b32 v238, 0
    v_mov_b32 v239, 0
    v_mov_b32 v240, 0
    v_mov_b32 v241, 0
    v_mov_b32 v242, 0
    v_mov_b32 v243, 0
    v_mov_b32 v244, 0
    v_mov_b32 v245, 0
    v_mov_b32 v246, 0
    v_mov_b32 v247, 0
    v_mov_b32 v248, 0
    v_mov_b32 v249, 0
    v_mov_b32 v250, 0
    v_mov_b32 v251, 0
    v_mov_b32 v252, 0
    v_mov_b32 v253, 0
    v_mov_b32 v254, 0
    v_mov_b32 v255, 0
    v_mov_b32 v48, 0xff800000
    v_mov_b32 v51, 0
    v_mov_b32 v52, 0xff800000
    v_mov_b32 v55, 0
    v_mov_b32 v56, 0xff800000
    v_mov_b32 v59, 0
    v_mov_b32 v60, 0xff800000
    v_mov_b32 v63, 0
    v_lshlrev_b32 v8, 8, v4
    v_xor_b32 v9, v5, v4
    v_xor_b32 v10, 0, v9
    v_lshl_add_u32 v28, v10, 4, v8
    v_xor_b32 v10, 4, v9
    v_lshl_add_u32 v29, v10, 4, v8
    v_xor_b32 v10, 8, v9
    v_lshl_add_u32 v30, v10, 4, v8
    v_xor_b32 v10, 12, v9
    v_lshl_add_u32 v31, v10, 4, v8
    v_lshlrev_b32 v9, 1, v4
    v_xor_b32 v9, v9, v5
    v_xor_b32 v10, 0, v9
    v_lshl_add_u32 v32, v10, 4, v8
    v_mov_b32 v34, v32
    v_xor_b32 v10, 8, v9
    v_lshl_add_u32 v33, v10, 4, v8
    v_mov_b32 v35, v33
    s_lshl_b32 s38, s36, 5
    s_add_u32 s38, s38, s37
    s_lshl_b32 s38, s38, 19
    s_add_u32 s8, s86, s38
    s_addc_u32 s9, s87, 0
    s_mov_b32 s10, 524288
    s_mov_b32 s11, 0x20000
    s_add_u32 s12, s88, s38
    s_addc_u32 s13, s89, 0
    s_mov_b32 s14, 524288
    s_mov_b32 s15, 0x20000
    s_add_u32 s29, s30, 65536
    s_sub_u32 s38, s29, 98304
    v_add_u32 v16, s38, v16
    v_add_u32 v17, s38, v17
    v_add_u32 v18, s38, v18
    v_add_u32 v19, s38, v19
    v_add_u32 v20, s29, v20
    v_add_u32 v21, s29, v21
    v_add_u32 v22, s29, v22
    v_add_u32 v23, s29, v23
    v_add_u32 v24, s29, v24
    v_add_u32 v25, s29, v25
    v_add_u32 v26, s29, v26
    v_add_u32 v27, s29, v27
    s_mov_b32 s33, 0
L_sloopA:
    s_add_u32 m0, s29, 0
    s_add_u32 s34, s33, 0
    buffer_load_dwordx4 v28, s[8:11], s34 offen offset:0 lds
    buffer_load_dwordx4 v29, s[8:11], s34 offen offset:1024 lds
    buffer_load_dwordx4 v30, s[8:11], s34 offen offset:2048 lds
    buffer_load_dwordx4 v31, s[8:11], s34 offen offset:3072 lds
    s_add_u32 m0, s29, 16384
    s_add_u32 s34, s33, 4096
    buffer_load_dwordx4 v28, s[8:11], s34 offen offset:0 lds
    buffer_load_dwordx4 v29, s[8:11], s34 offen offset:1024 lds
    buffer_load_dwordx4 v30, s[8:11], s34 offen offset:2048 lds
    buffer_load_dwordx4 v31, s[8:11], s34 offen offset:3072 lds
    s_waitcnt vmcnt(0)
    ds_read_b128 a[64:67], v16 offset:0
    ds_read_b128 a[68:71], v17 offset:0
    ds_read_b128 a[72:75], v18 offset:0
    ds_read_b128 a[76:79], v19 offset:0
    ds_read_b128 a[80:83], v16 offset:16384
    ds_read_b128 a[84:87], v17 offset:16384
    ds_read_b128 a[88:91], v18 offset:16384
    ds_read_b128 a[92:95], v19 offset:16384
    s_waitcnt lgkmcnt(0)
    s_add_u32 m0, s29, 0
    s_add_u32 s34, s33, 0
    buffer_load_dwordx4 v32, s[12:15], s34 offen offset:0 lds
    buffer_load_dwordx4 v33, s[12:15], s34 offen offset:1024 lds
    buffer_load_dwordx4 v34, s[12:15], s34 offen offset:2048 lds
    buffer_load_dwordx4 v35, s[12:15], s34 offen offset:3072 lds
    s_add_u32 m0, s29, 16384
    s_add_u32 s34, s33, 4096
    buffer_load_dwordx4 v32, s[12:15], s34 offen offset:0 lds
    buffer_load_dwordx4 v33, s[12:15], s34 offen offset:1024 lds
    buffer_load_dwordx4 v34, s[12:15], s34 offen offset:2048 lds
    buffer_load_dwordx4 v35, s[12:15], s34 offen offset:3072 lds
    v_mfma_f32_16x16x32_bf16 v[64:67], a[64:67], a[0:3], 0
    v_mfma_f32_16x16x32_bf16 v[72:75], a[64:67], a[16:19], 0
    v_mfma_f32_16x16x32_bf16 v[80:83], a[64:67], a[32:35], 0
    v_mfma_f32_16x16x32_bf16 v[88:91], a[64:67], a[48:51], 0
    v_mfma_f32_16x16x32_bf16 v[64:67], a[68:71], a[4:7], v[64:67]
    v_mfma_f32_16x16x32_bf16 v[72:75], a[68:71], a[20:23], v[72:75]
    v_mfma_f32_16x16x32_bf16 v[80:83], a[68:71], a[36:39], v[80:83]
    v_mfma_f32_16x16x32_bf16 v[88:91], a[68:71], a[52:55], v[88:91]
    v_mfma_f32_16x16x32_bf16 v[64:67], a[72:75], a[8:11], v[64:67]
    v_mfma_f32_16x16x32_bf16 v[72:75], a[72:75], a[24:27], v[72:75]
    v_mfma_f32_16x16x32_bf16 v[80:83], a[72:75], a[40:43], v[80:83]
    v_mfma_f32_16x16x32_bf16 v[88:91], a[72:75], a[56:59], v[88:91]
    v_mfma_f32_16x16x32_bf16 v[64:67], a[76:79], a[12:15], v[64:67]
    v_mfma_f32_16x16x32_bf16 v[72:75], a[76:79], a[28:31], v[72:75]
    v_mfma_f32_16x16x32_bf16 v[80:83], a[76:79], a[44:47], v[80:83]
    v_mfma_f32_16x16x32_bf16 v[88:91], a[76:79], a[60:63], v[88:91]
    v_mfma_f32_16x16x32_bf16 v[68:71], a[80:83], a[0:3], 0
    v_mfma_f32_16x16x32_bf16 v[76:79], a[80:83], a[16:19], 0
    v_mfma_f32_16x16x32_bf16 v[84:87], a[80:83], a[32:35], 0
    v_mfma_f32_16x16x32_bf16 v[92:95], a[80:83], a[48:51], 0
    v_mfma_f32_16x16x32_bf16 v[68:71], a[84:87], a[4:7], v[68:71]
    v_mfma_f32_16x16x32_bf16 v[76:79], a[84:87], a[20:23], v[76:79]
    v_mfma_f32_16x16x32_bf16 v[84:87], a[84:87], a[36:39], v[84:87]
    v_mfma_f32_16x16x32_bf16 v[92:95], a[84:87], a[52:55], v[92:95]
    v_mfma_f32_16x16x32_bf16 v[68:71], a[88:91], a[8:11], v[68:71]
    v_mfma_f32_16x16x32_bf16 v[76:79], a[88:91], a[24:27], v[76:79]
    v_mfma_f32_16x16x32_bf16 v[84:87], a[88:91], a[40:43], v[84:87]
    v_mfma_f32_16x16x32_bf16 v[92:95], a[88:91], a[56:59], v[92:95]
    v_mfma_f32_16x16x32_bf16 v[68:71], a[92:95], a[12:15], v[68:71]
    v_mfma_f32_16x16x32_bf16 v[76:79], a[92:95], a[28:31], v[76:79]
    v_mfma_f32_16x16x32_bf16 v[84:87], a[92:95], a[44:47], v[84:87]
    v_mfma_f32_16x16x32_bf16 v[92:95], a[92:95], a[60:63], v[92:95]
    s_nop 7
    v_max3_f32 v96, v64, v65, v66
    v_max3_f32 v97, v67, v68, v69
    v_max3_f32 v96, v96, v70, v71
    v_max3_f32 v96, v96, v97, v48
    v_max3_f32 v98, v72, v73, v74
    v_max3_f32 v99, v75, v76, v77
    v_max3_f32 v98, v98, v78, v79
    v_max3_f32 v98, v98, v99, v52
    v_max3_f32 v100, v80, v81, v82
    v_max3_f32 v101, v83, v84, v85
    v_max3_f32 v100, v100, v86, v87
    v_max3_f32 v100, v100, v101, v56
    v_max3_f32 v102, v88, v89, v90
    v_max3_f32 v103, v91, v92, v93
    v_max3_f32 v102, v102, v94, v95
    v_max3_f32 v102, v102, v103, v60
    v_mov_b32 v97, v96
    v_mov_b32 v99, v98
    v_mov_b32 v101, v100
    v_mov_b32 v103, v102
    s_nop 1
    v_permlane32_swap_b32 v96, v97
    v_permlane32_swap_b32 v98, v99
    v_permlane32_swap_b32 v100, v101
    v_permlane32_swap_b32 v102, v103
    s_nop 1
    v_max_f32 v96, v96, v97
    v_max_f32 v98, v98, v99
    v_max_f32 v100, v100, v101
    v_max_f32 v102, v102, v103
    v_mov_b32 v97, v96
    v_mov_b32 v99, v98
    v_mov_b32 v101, v100
    v_mov_b32 v103, v102
    s_nop 1
    v_permlane16_swap_b32 v96, v97
    v_permlane16_swap_b32 v98, v99
    v_permlane16_swap_b32 v100, v101
    v_permlane16_swap_b32 v102, v103
    s_nop 1
    v_max_f32 v96, v96, v97
    v_max_f32 v98, v98, v99
    v_max_f32 v100, v100, v101
    v_max_f32 v102, v102, v103
    v_sub_f32 v50, v48, v96
    v_exp_f32 v50, v50
    v_mov_b32 v48, v96
    v_sub_f32 v64, v64, v48
    v_sub_f32 v65, v65, v48
    v_sub_f32 v66, v66, v48
    v_sub_f32 v67, v67, v48
    v_sub_f32 v68, v68, v48
    v_sub_f32 v69, v69, v48
    v_sub_f32 v70, v70, v48
    v_sub_f32 v71, v71, v48
    v_exp_f32 v64, v64
    v_exp_f32 v65, v65
    v_exp_f32 v66, v66
    v_exp_f32 v67, v67
    v_exp_f32 v68, v68
    v_exp_f32 v69, v69
    v_exp_f32 v70, v70
    v_exp_f32 v71, v71
    v_mul_f32 v51, v51, v50
    v_mul_f32 v128, v128, v50
    v_mul_f32 v129, v129, v50
    v_mul_f32 v130, v130, v50
    v_mul_f32 v131, v131, v50
    v_mul_f32 v132, v132, v50
    v_mul_f32 v133, v133, v50
    v_mul_f32 v134, v134, v50
    v_mul_f32 v135, v135, v50
    v_mul_f32 v136, v136, v50
    v_mul_f32 v137, v137, v50
    v_mul_f32 v138, v138, v50
    v_mul_f32 v139, v139, v50
    v_mul_f32 v140, v140, v50
    v_mul_f32 v141, v141, v50
    v_mul_f32 v142, v142, v50
    v_mul_f32 v143, v143, v50
    v_mul_f32 v144, v144, v50
    v_mul_f32 v145, v145, v50
    v_mul_f32 v146, v146, v50
    v_mul_f32 v147, v147, v50
    v_mul_f32 v148, v148, v50
    v_mul_f32 v149, v149, v50
    v_mul_f32 v150, v150, v50
    v_mul_f32 v151, v151, v50
    v_mul_f32 v152, v152, v50
    v_mul_f32 v153, v153, v50
    v_mul_f32 v154, v154, v50
    v_mul_f32 v155, v155, v50
    v_mul_f32 v156, v156, v50
    v_mul_f32 v157, v157, v50
    v_mul_f32 v158, v158, v50
    v_mul_f32 v159, v159, v50
    v_cvt_pk_bf16_f32 v64, v64, v65
    v_cvt_pk_bf16_f32 v65, v66, v67
    v_cvt_pk_bf16_f32 v66, v68, v69
    v_cvt_pk_bf16_f32 v67, v70, v71
    v_lshlrev_b32 v68, 16, v64
    v_and_b32 v69, 0xffff0000, v64
    v_add_f32 v51, v51, v68
    v_add_f32 v51, v51, v69
    v_lshlrev_b32 v68, 16, v65
    v_and_b32 v69, 0xffff0000, v65
    v_add_f32 v51, v51, v68
    v_add_f32 v51, v51, v69
    v_lshlrev_b32 v68, 16, v66
    v_and_b32 v69, 0xffff0000, v66
    v_add_f32 v51, v51, v68
    v_add_f32 v51, v51, v69
    v_lshlrev_b32 v68, 16, v67
    v_and_b32 v69, 0xffff0000, v67
    v_add_f32 v51, v51, v68
    v_add_f32 v51, v51, v69
    v_sub_f32 v54, v52, v98
    v_exp_f32 v54, v54
    v_mov_b32 v52, v98
    v_sub_f32 v72, v72, v52
    v_sub_f32 v73, v73, v52
    v_sub_f32 v74, v74, v52
    v_sub_f32 v75, v75, v52
    v_sub_f32 v76, v76, v52
    v_sub_f32 v77, v77, v52
    v_sub_f32 v78, v78, v52
    v_sub_f32 v79, v79, v52
    v_exp_f32 v72, v72
    v_exp_f32 v73, v73
    v_exp_f32 v74, v74
    v_exp_f32 v75, v75
    v_exp_f32 v76, v76
    v_exp_f32 v77, v77
    v_exp_f32 v78, v78
    v_exp_f32 v79, v79
    v_mul_f32 v55, v55, v54
    v_mul_f32 v160, v160, v54
    v_mul_f32 v161, v161, v54
    v_mul_f32 v162, v162, v54
    v_mul_f32 v163, v163, v54
    v_mul_f32 v164, v164, v54
    v_mul_f32 v165, v165, v54
    v_mul_f32 v166, v166, v54
    v_mul_f32 v167, v167, v54
    v_mul_f32 v168, v168, v54
    v_mul_f32 v169, v169, v54
    v_mul_f32 v170, v170, v54
    v_mul_f32 v171, v171, v54
    v_mul_f32 v172, v172, v54
    v_mul_f32 v173, v173, v54
    v_mul_f32 v174, v174, v54
    v_mul_f32 v175, v175, v54
    v_mul_f32 v176, v176, v54
    v_mul_f32 v177, v177, v54
    v_mul_f32 v178, v178, v54
    v_mul_f32 v179, v179, v54
    v_mul_f32 v180, v180, v54
    v_mul_f32 v181, v181, v54
    v_mul_f32 v182, v182, v54
    v_mul_f32 v183, v183, v54
    v_mul_f32 v184, v184, v54
    v_mul_f32 v185, v185, v54
    v_mul_f32 v186, v186, v54
    v_mul_f32 v187, v187, v54
    v_mul_f32 v188, v188, v54
    v_mul_f32 v189, v189, v54
    v_mul_f32 v190, v190, v54
    v_mul_f32 v191, v191, v54
    v_cvt_pk_bf16_f32 v72, v72, v73
    v_cvt_pk_bf16_f32 v73, v74, v75
    v_cvt_pk_bf16_f32 v74, v76, v77
    v_cvt_pk_bf16_f32 v75, v78, v79
    v_lshlrev_b32 v76, 16, v72
    v_and_b32 v77, 0xffff0000, v72
    v_add_f32 v55, v55, v76
    v_add_f32 v55, v55, v77
    v_lshlrev_b32 v76, 16, v73
    v_and_b32 v77, 0xffff0000, v73
    v_add_f32 v55, v55, v76
    v_add_f32 v55, v55, v77
    v_lshlrev_b32 v76, 16, v74
    v_and_b32 v77, 0xffff0000, v74
    v_add_f32 v55, v55, v76
    v_add_f32 v55, v55, v77
    v_lshlrev_b32 v76, 16, v75
    v_and_b32 v77, 0xffff0000, v75
    v_add_f32 v55, v55, v76
    v_add_f32 v55, v55, v77
    v_sub_f32 v58, v56, v100
    v_exp_f32 v58, v58
    v_mov_b32 v56, v100
    v_sub_f32 v80, v80, v56
    v_sub_f32 v81, v81, v56
    v_sub_f32 v82, v82, v56
    v_sub_f32 v83, v83, v56
    v_sub_f32 v84, v84, v56
    v_sub_f32 v85, v85, v56
    v_sub_f32 v86, v86, v56
    v_sub_f32 v87, v87, v56
    v_exp_f32 v80, v80
    v_exp_f32 v81, v81
    v_exp_f32 v82, v82
    v_exp_f32 v83, v83
    v_exp_f32 v84, v84
    v_exp_f32 v85, v85
    v_exp_f32 v86, v86
    v_exp_f32 v87, v87
    v_mul_f32 v59, v59, v58
    v_mul_f32 v192, v192, v58
    v_mul_f32 v193, v193, v58
    v_mul_f32 v194, v194, v58
    v_mul_f32 v195, v195, v58
    v_mul_f32 v196, v196, v58
    v_mul_f32 v197, v197, v58
    v_mul_f32 v198, v198, v58
    v_mul_f32 v199, v199, v58
    v_mul_f32 v200, v200, v58
    v_mul_f32 v201, v201, v58
    v_mul_f32 v202, v202, v58
    v_mul_f32 v203, v203, v58
    v_mul_f32 v204, v204, v58
    v_mul_f32 v205, v205, v58
    v_mul_f32 v206, v206, v58
    v_mul_f32 v207, v207, v58
    v_mul_f32 v208, v208, v58
    v_mul_f32 v209, v209, v58
    v_mul_f32 v210, v210, v58
    v_mul_f32 v211, v211, v58
    v_mul_f32 v212, v212, v58
    v_mul_f32 v213, v213, v58
    v_mul_f32 v214, v214, v58
    v_mul_f32 v215, v215, v58
    v_mul_f32 v216, v216, v58
    v_mul_f32 v217, v217, v58
    v_mul_f32 v218, v218, v58
    v_mul_f32 v219, v219, v58
    v_mul_f32 v220, v220, v58
    v_mul_f32 v221, v221, v58
    v_mul_f32 v222, v222, v58
    v_mul_f32 v223, v223, v58
    v_cvt_pk_bf16_f32 v80, v80, v81
    v_cvt_pk_bf16_f32 v81, v82, v83
    v_cvt_pk_bf16_f32 v82, v84, v85
    v_cvt_pk_bf16_f32 v83, v86, v87
    v_lshlrev_b32 v84, 16, v80
    v_and_b32 v85, 0xffff0000, v80
    v_add_f32 v59, v59, v84
    v_add_f32 v59, v59, v85
    v_lshlrev_b32 v84, 16, v81
    v_and_b32 v85, 0xffff0000, v81
    v_add_f32 v59, v59, v84
    v_add_f32 v59, v59, v85
    v_lshlrev_b32 v84, 16, v82
    v_and_b32 v85, 0xffff0000, v82
    v_add_f32 v59, v59, v84
    v_add_f32 v59, v59, v85
    v_lshlrev_b32 v84, 16, v83
    v_and_b32 v85, 0xffff0000, v83
    v_add_f32 v59, v59, v84
    v_add_f32 v59, v59, v85
    v_sub_f32 v62, v60, v102
    v_exp_f32 v62, v62
    v_mov_b32 v60, v102
    v_sub_f32 v88, v88, v60
    v_sub_f32 v89, v89, v60
    v_sub_f32 v90, v90, v60
    v_sub_f32 v91, v91, v60
    v_sub_f32 v92, v92, v60
    v_sub_f32 v93, v93, v60
    v_sub_f32 v94, v94, v60
    v_sub_f32 v95, v95, v60
    v_exp_f32 v88, v88
    v_exp_f32 v89, v89
    v_exp_f32 v90, v90
    v_exp_f32 v91, v91
    v_exp_f32 v92, v92
    v_exp_f32 v93, v93
    v_exp_f32 v94, v94
    v_exp_f32 v95, v95
    v_mul_f32 v63, v63, v62
    v_mul_f32 v224, v224, v62
    v_mul_f32 v225, v225, v62
    v_mul_f32 v226, v226, v62
    v_mul_f32 v227, v227, v62
    v_mul_f32 v228, v228, v62
    v_mul_f32 v229, v229, v62
    v_mul_f32 v230, v230, v62
    v_mul_f32 v231, v231, v62
    v_mul_f32 v232, v232, v62
    v_mul_f32 v233, v233, v62
    v_mul_f32 v234, v234, v62
    v_mul_f32 v235, v235, v62
    v_mul_f32 v236, v236, v62
    v_mul_f32 v237, v237, v62
    v_mul_f32 v238, v238, v62
    v_mul_f32 v239, v239, v62
    v_mul_f32 v240, v240, v62
    v_mul_f32 v241, v241, v62
    v_mul_f32 v242, v242, v62
    v_mul_f32 v243, v243, v62
    v_mul_f32 v244, v244, v62
    v_mul_f32 v245, v245, v62
    v_mul_f32 v246, v246, v62
    v_mul_f32 v247, v247, v62
    v_mul_f32 v248, v248, v62
    v_mul_f32 v249, v249, v62
    v_mul_f32 v250, v250, v62
    v_mul_f32 v251, v251, v62
    v_mul_f32 v252, v252, v62
    v_mul_f32 v253, v253, v62
    v_mul_f32 v254, v254, v62
    v_mul_f32 v255, v255, v62
    v_cvt_pk_bf16_f32 v88, v88, v89
    v_cvt_pk_bf16_f32 v89, v90, v91
    v_cvt_pk_bf16_f32 v90, v92, v93
    v_cvt_pk_bf16_f32 v91, v94, v95
    v_lshlrev_b32 v92, 16, v88
    v_and_b32 v93, 0xffff0000, v88
    v_add_f32 v63, v63, v92
    v_add_f32 v63, v63, v93
    v_lshlrev_b32 v92, 16, v89
    v_and_b32 v93, 0xffff0000, v89
    v_add_f32 v63, v63, v92
    v_add_f32 v63, v63, v93
    v_lshlrev_b32 v92, 16, v90
    v_and_b32 v93, 0xffff0000, v90
    v_add_f32 v63, v63, v92
    v_add_f32 v63, v63, v93
    v_lshlrev_b32 v92, 16, v91
    v_and_b32 v93, 0xffff0000, v91
    v_add_f32 v63, v63, v92
    v_add_f32 v63, v63, v93
    s_waitcnt vmcnt(0)
    ds_read_b64_tr_b16 a[96:97], v20 offset:0
    ds_read_b64_tr_b16 a[98:99], v20 offset:16384
    ds_read_b64_tr_b16 a[100:101], v21 offset:0
    ds_read_b64_tr_b16 a[102:103], v21 offset:16384
    ds_read_b64_tr_b16 a[104:105], v22 offset:0
    ds_read_b64_tr_b16 a[106:107], v22 offset:16384
    ds_read_b64_tr_b16 a[108:109], v23 offset:0
    ds_read_b64_tr_b16 a[110:111], v23 offset:16384
    s_waitcnt lgkmcnt(0)
    ds_read_b64_tr_b16 a[112:113], v24 offset:0
    ds_read_b64_tr_b16 a[114:115], v24 offset:16384
    ds_read_b64_tr_b16 a[116:117], v25 offset:0
    ds_read_b64_tr_b16 a[118:119], v25 offset:16384
    ds_read_b64_tr_b16 a[120:121], v26 offset:0
    ds_read_b64_tr_b16 a[122:123], v26 offset:16384
    ds_read_b64_tr_b16 a[124:125], v27 offset:0
    ds_read_b64_tr_b16 a[126:127], v27 offset:16384
    s_waitcnt lgkmcnt(0)
    v_mfma_f32_16x16x32_bf16 v[128:131], a[96:99], v[64:67], v[128:131]
    v_mfma_f32_16x16x32_bf16 v[160:163], a[96:99], v[72:75], v[160:163]
    v_mfma_f32_16x16x32_bf16 v[192:195], a[96:99], v[80:83], v[192:195]
    v_mfma_f32_16x16x32_bf16 v[224:227], a[96:99], v[88:91], v[224:227]
    v_mfma_f32_16x16x32_bf16 v[132:135], a[100:103], v[64:67], v[132:135]
    v_mfma_f32_16x16x32_bf16 v[164:167], a[100:103], v[72:75], v[164:167]
    v_mfma_f32_16x16x32_bf16 v[196:199], a[100:103], v[80:83], v[196:199]
    v_mfma_f32_16x16x32_bf16 v[228:231], a[100:103], v[88:91], v[228:231]
    v_mfma_f32_16x16x32_bf16 v[136:139], a[104:107], v[64:67], v[136:139]
    v_mfma_f32_16x16x32_bf16 v[168:171], a[104:107], v[72:75], v[168:171]
    v_mfma_f32_16x16x32_bf16 v[200:203], a[104:107], v[80:83], v[200:203]
    v_mfma_f32_16x16x32_bf16 v[232:235], a[104:107], v[88:91], v[232:235]
    v_mfma_f32_16x16x32_bf16 v[140:143], a[108:111], v[64:67], v[140:143]
    v_mfma_f32_16x16x32_bf16 v[172:175], a[108:111], v[72:75], v[172:175]
    v_mfma_f32_16x16x32_bf16 v[204:207], a[108:111], v[80:83], v[204:207]
    v_mfma_f32_16x16x32_bf16 v[236:239], a[108:111], v[88:91], v[236:239]
    v_mfma_f32_16x16x32_bf16 v[144:147], a[112:115], v[64:67], v[144:147]
    v_mfma_f32_16x16x32_bf16 v[176:179], a[112:115], v[72:75], v[176:179]
    v_mfma_f32_16x16x32_bf16 v[208:211], a[112:115], v[80:83], v[208:211]
    v_mfma_f32_16x16x32_bf16 v[240:243], a[112:115], v[88:91], v[240:243]
    v_mfma_f32_16x16x32_bf16 v[148:151], a[116:119], v[64:67], v[148:151]
    v_mfma_f32_16x16x32_bf16 v[180:183], a[116:119], v[72:75], v[180:183]
    v_mfma_f32_16x16x32_bf16 v[212:215], a[116:119], v[80:83], v[212:215]
    v_mfma_f32_16x16x32_bf16 v[244:247], a[116:119], v[88:91], v[244:247]
    v_mfma_f32_16x16x32_bf16 v[152:155], a[120:123], v[64:67], v[152:155]
    v_mfma_f32_16x16x32_bf16 v[184:187], a[120:123], v[72:75], v[184:187]
    v_mfma_f32_16x16x32_bf16 v[216:219], a[120:123], v[80:83], v[216:219]
    v_mfma_f32_16x16x32_bf16 v[248:251], a[120:123], v[88:91], v[248:251]
    v_mfma_f32_16x16x32_bf16 v[156:159], a[124:127], v[64:67], v[156:159]
    v_mfma_f32_16x16x32_bf16 v[188:191], a[124:127], v[72:75], v[188:191]
    v_mfma_f32_16x16x32_bf16 v[220:223], a[124:127], v[80:83], v[220:223]
    v_mfma_f32_16x16x32_bf16 v[252:255], a[124:127], v[88:91], v[252:255]
    s_nop 7
    s_add_u32 s33, s33, 8192
    s_cmp_lt_u32 s33, 524288
    s_cbranch_scc1 L_sloopA
    v_mov_b32 v49, v51
    v_mov_b32 v53, v55
    v_mov_b32 v57, v59
    v_mov_b32 v61, v63
    s_nop 1
    v_permlane32_swap_b32 v51, v49
    v_permlane32_swap_b32 v55, v53
    v_permlane32_swap_b32 v59, v57
    v_permlane32_swap_b32 v63, v61
    s_nop 1
    v_add_f32 v51, v51, v49
    v_add_f32 v55, v55, v53
    v_add_f32 v59, v59, v57
    v_add_f32 v63, v63, v61
    v_mov_b32 v49, v51
    v_mov_b32 v53, v55
    v_mov_b32 v57, v59
    v_mov_b32 v61, v63
    s_nop 1
    v_permlane16_swap_b32 v51, v49
    v_permlane16_swap_b32 v55, v53
    v_permlane16_swap_b32 v59, v57
    v_permlane16_swap_b32 v63, v61
    s_nop 1
    v_add_f32 v51, v51, v49
    v_add_f32 v55, v55, v53
    v_add_f32 v59, v59, v57
    v_add_f32 v63, v63, v61
    v_mov_b32 v48, v51
    v_mov_b32 v52, v55
    v_mov_b32 v56, v59
    v_mov_b32 v60, v63
    v_lshrrev_b32 v12, 2, v3
    v_lshlrev_b32 v12, 7, v12
    v_and_b32 v15, 3, v3
    v_lshl_add_u32 v12, v15, 3, v12
    v_add_u32 v12, s30, v12
    v_bfe_u32 v15, v3, 3, 2
    v_xor_b32 v40, 0, v15
    v_lshl_add_u32 v40, v40, 5, v12
    v_add_u32 v44, 0x10000, v40
    v_add_u32 v8, 0x20000, v40
    v_xor_b32 v41, 1, v15
    v_lshl_add_u32 v41, v41, 5, v12
    v_add_u32 v45, 0x10000, v41
    v_add_u32 v9, 0x20000, v41
    v_xor_b32 v42, 2, v15
    v_lshl_add_u32 v42, v42, 5, v12
    v_add_u32 v46, 0x10000, v42
    v_add_u32 v10, 0x20000, v42
    v_xor_b32 v43, 3, v15
    v_lshl_add_u32 v43, v43, 5, v12
    v_add_u32 v47, 0x10000, v43
    v_add_u32 v11, 0x20000, v43
    v_mul_u32_u24 v14, 1280, v3
    s_add_u32 m0, s30, 65536
    s_mov_b32 s38, 327680
    buffer_load_dwordx4 v36, s[76:79], s38 offen offset:0 lds
    buffer_load_dwordx4 v37, s[76:79], s38 offen offset:1024 lds
    buffer_load_dwordx4 v38, s[76:79], s38 offen offset:2048 lds
    buffer_load_dwordx4 v39, s[76:79], s38 offen offset:3072 lds
    s_add_u32 m0, s30, 81920
    s_mov_b32 s38, 450560
    buffer_load_dwordx4 v36, s[76:79], s38 offen offset:0 lds
    buffer_load_dwordx4 v37, s[76:79], s38 offen offset:1024 lds
    buffer_load_dwordx4 v38, s[76:79], s38 offen offset:2048 lds
    buffer_load_dwordx4 v39, s[76:79], s38 offen offset:3072 lds
    s_waitcnt vmcnt(0)
    s_branch L_epiA
L_waveB:
    s_waitcnt vmcnt(4)
    s_barrier
    ds_read_b128 a[148:151], v64 offset:0
    ds_read_b128 a[152:155], v64 offset:2048
    ds_read_b128 a[156:159], v64 offset:4096
    ds_read_b64_tr_b16 a[64:65], v66 offset:31744
    ds_read_b64_tr_b16 a[66:67], v66 offset:32768
    ds_read_b64_tr_b16 a[68:69], v66 offset:31752
    ds_read_b64_tr_b16 a[70:71], v66 offset:32776
    ds_read_b64_tr_b16 a[72:73], v67 offset:31744
    ds_read_b64_tr_b16 a[74:75], v67 offset:32768
    ds_read_b64_tr_b16 a[76:77], v67 offset:31752
    ds_read_b64_tr_b16 a[78:79], v67 offset:32776
    ds_read_b64_tr_b16 a[80:81], v68 offset:31744
    ds_read_b64_tr_b16 a[82:83], v68 offset:32768
    ds_read_b64_tr_b16 a[84:85], v68 offset:31752
    ds_read_b64_tr_b16 a[86:87], v68 offset:32776
    ds_read_b64_tr_b16 a[88:89], v69 offset:31744
    ds_read_b64_tr_b16 a[90:91], v69 offset:32768
    ds_read_b64_tr_b16 a[92:93], v69 offset:31752
    ds_read_b64_tr_b16 a[94:95], v69 offset:32776
    s_add_u32 m0, s31, 98304
    s_nop 0
    buffer_load_dwordx4 v36, s[16:19], s38 offen offset:0 lds
    buffer_load_dwordx4 v37, s[16:19], s38 offen offset:1024 lds
    buffer_load_dwordx4 v38, s[16:19], s38 offen offset:2048 lds
    buffer_load_dwordx4 v39, s[16:19], s38 offen offset:3072 lds
    s_add_u32 m0, s31, 102400
    s_nop 0
    buffer_load_dwordx4 v40, s[16:19], s38 offen offset:0 lds
    buffer_load_dwordx4 v41, s[16:19], s38 offen offset:1024 lds
    s_waitcnt lgkmcnt(0)
    v_mfma_f32_16x16x32_bf16 v[128:131], a[64:67], a[148:151], 0
    s_lshl_b32 s38, s81, 7
    s_lshl_b32 s39, s81, 19
    ds_read_b128 a[164:167], v65 offset:0
    ds_read_b128 a[168:171], v65 offset:2048
    v_mfma_f32_16x16x32_bf16 v[160:163], a[64:67], a[152:155], 0
    s_add_u32 s81, s81, 1
    s_cmp_eq_u32 s81, 10
    ds_read_b128 a[172:175], v65 offset:4096
    ds_read_b64_tr_b16 a[96:97], v66 offset:39968
    v_mfma_f32_16x16x32_bf16 v[192:195], a[64:67], a[156:159], 0
    s_cselect_b32 s81, 0, s81
    s_add_u32 m0, s31, 0
    ds_read_b64_tr_b16 a[98:99], v66 offset:40992
    ds_read_b64_tr_b16 a[100:101], v66 offset:39976
    v_mfma_f32_16x16x32_bf16 v[132:135], a[68:71], a[148:151], 0
    buffer_load_dwordx4 v36, s[16:19], s38 offen offset:0 lds
    v_mfma_f32_16x16x32_bf16 v[164:167], a[68:71], a[152:155], 0
    buffer_load_dwordx4 v37, s[16:19], s38 offen offset:1024 lds
    v_mfma_f32_16x16x32_bf16 v[196:199], a[68:71], a[156:159], 0
    buffer_load_dwordx4 v38, s[16:19], s38 offen offset:2048 lds
    v_mfma_f32_16x16x32_bf16 v[136:139], a[72:75], a[148:151], 0
    ds_read_b64_tr_b16 a[102:103], v66 offset:41000
    ds_read_b64_tr_b16 a[104:105], v67 offset:39968
    v_mfma_f32_16x16x32_bf16 v[168:171], a[72:75], a[152:155], 0
    buffer_load_dwordx4 v39, s[16:19], s38 offen offset:3072 lds
    v_mfma_f32_16x16x32_bf16 v[200:203], a[72:75], a[156:159], 0
    s_add_u32 m0, s31, 4096
    ds_read_b64_tr_b16 a[106:107], v67 offset:40992
    ds_read_b64_tr_b16 a[108:109], v67 offset:39976
    v_mfma_f32_16x16x32_bf16 v[140:143], a[76:79], a[148:151], 0
    buffer_load_dwordx4 v40, s[16:19], s38 offen offset:0 lds
    v_mfma_f32_16x16x32_bf16 v[172:175], a[76:79], a[152:155], 0
    ds_read_b64_tr_b16 a[110:111], v67 offset:41000
    ds_read_b64_tr_b16 a[112:113], v68 offset:39968
    v_mfma_f32_16x16x32_bf16 v[204:207], a[76:79], a[156:159], 0
    ds_read_b64_tr_b16 a[114:115], v68 offset:40992
    ds_read_b64_tr_b16 a[116:117], v68 offset:39976
    v_mfma_f32_16x16x32_bf16 v[144:147], a[80:83], a[148:151], 0
    buffer_load_dwordx4 v41, s[16:19], s38 offen offset:1024 lds
    v_mfma_f32_16x16x32_bf16 v[176:179], a[80:83], a[152:155], 0
    s_add_u32 m0, s32, 31744
    ds_read_b64_tr_b16 a[118:119], v68 offset:41000
    ds_read_b64_tr_b16 a[120:121], v69 offset:39968
    v_mfma_f32_16x16x32_bf16 v[208:211], a[80:83], a[156:159], 0
    buffer_load_dwordx4 v44, s[20:23], s39 offen offset:0 lds
    v_mfma_f32_16x16x32_bf16 v[148:151], a[84:87], a[148:151], 0
    ds_read_b64_tr_b16 a[122:123], v69 offset:40992
    ds_read_b64_tr_b16 a[124:125], v69 offset:39976
    v_mfma_f32_16x16x32_bf16 v[180:183], a[84:87], a[152:155], 0
    buffer_load_dwordx4 v45, s[20:23], s39 offen offset:1024 lds
    v_mfma_f32_16x16x32_bf16 v[212:215], a[84:87], a[156:159], 0
    ds_read_b64_tr_b16 a[126:127], v69 offset:41000
    v_mfma_f32_16x16x32_bf16 v[152:155], a[88:91], a[148:151], 0
    buffer_load_dwordx4 v46, s[20:23], s39 offen offset:2056 lds
    v_mfma_f32_16x16x32_bf16 v[184:187], a[88:91], a[152:155], 0
    v_mfma_f32_16x16x32_bf16 v[216:219], a[88:91], a[156:159], 0
    buffer_load_dwordx4 v47, s[20:23], s39 offen offset:3080 lds
    v_mfma_f32_16x16x32_bf16 v[156:159], a[92:95], a[148:151], 0
    v_mfma_f32_16x16x32_bf16 v[188:191], a[92:95], a[152:155], 0
    v_mfma_f32_16x16x32_bf16 v[220:223], a[92:95], a[156:159], 0
    s_waitcnt lgkmcnt(10)
    v_mfma_f32_16x16x32_bf16 v[128:131], a[96:99], a[164:167], v[128:131]
    v_add_u32 v64, 49152, v64
    v_add_u32 v65, 49152, v65
    v_mfma_f32_16x16x32_bf16 v[160:163], a[96:99], a[168:171], v[160:163]
    v_add_u32 v66, 49152, v66
    v_add_u32 v67, 49152, v67
    v_mfma_f32_16x16x32_bf16 v[192:195], a[96:99], a[172:175], v[192:195]
    v_add_u32 v68, 49152, v68
    v_add_u32 v69, 49152, v69
    v_mfma_f32_16x16x32_bf16 v[132:135], a[100:103], a[164:167], v[132:135]
    s_waitcnt vmcnt(10) lgkmcnt(0)
    s_barrier
    v_mfma_f32_16x16x32_bf16 v[164:167], a[100:103], a[168:171], v[164:167]
    s_lshl_b32 s38, s81, 7
    s_lshl_b32 s39, s81, 19
    ds_read_b128 a[148:151], v64 offset:0
    ds_read_b128 a[152:155], v64 offset:2048
    v_mfma_f32_16x16x32_bf16 v[196:199], a[100:103], a[172:175], v[196:199]
    s_add_u32 s81, s81, 1
    s_cmp_eq_u32 s81, 10
    ds_read_b128 a[156:159], v64 offset:4096
    ds_read_b64_tr_b16 a[64:65], v66 offset:31744
    v_mfma_f32_16x16x32_bf16 v[136:139], a[104:107], a[164:167], v[136:139]
    s_cselect_b32 s81, 0, s81
    s_add_u32 m0, s31, 49152
    ds_read_b64_tr_b16 a[66:67], v66 offset:32768
    ds_read_b64_tr_b16 a[68:69], v66 offset:31752
    v_mfma_f32_16x16x32_bf16 v[168:171], a[104:107], a[168:171], v[168:171]
    buffer_load_dwordx4 v36, s[16:19], s38 offen offset:0 lds
    v_mfma_f32_16x16x32_bf16 v[200:203], a[104:107], a[172:175], v[200:203]
    ds_read_b64_tr_b16 a[70:71], v66 offset:32776
    ds_read_b64_tr_b16 a[72:73], v67 offset:31744
    v_mfma_f32_16x16x32_bf16 v[140:143], a[108:111], a[164:167], v[140:143]
    buffer_load_dwordx4 v37, s[16:19], s38 offen offset:1024 lds
    v_mfma_f32_16x16x32_bf16 v[172:175], a[108:111], a[168:171], v[172:175]
    ds_read_b64_tr_b16 a[74:75], v67 offset:32768
    ds_read_b64_tr_b16 a[76:77], v67 offset:31752
    v_mfma_f32_16x16x32_bf16 v[204:207], a[108:111], a[172:175], v[204:207]
    ds_read_b64_tr_b16 a[78:79], v67 offset:32776
    ds_read_b64_tr_b16 a[80:81], v68 offset:31744
    v_mfma_f32_16x16x32_bf16 v[144:147], a[112:115], a[164:167], v[144:147]
    ds_read_b64_tr_b16 a[82:83], v68 offset:32768
    ds_read_b64_tr_b16 a[84:85], v68 offset:31752
    v_mfma_f32_16x16x32_bf16 v[176:179], a[112:115], a[168:171], v[176:179]
    buffer_load_dwordx4 v38, s[16:19], s38 offen offset:2048 lds
    v_mfma_f32_16x16x32_bf16 v[208:211], a[112:115], a[172:175], v[208:211]
    ds_read_b64_tr_b16 a[86:87], v68 offset:32776
    ds_read_b64_tr_b16 a[88:89], v69 offset:31744
    v_mfma_f32_16x16x32_bf16 v[148:151], a[116:119], a[164:167], v[148:151]
    ds_read_b64_tr_b16 a[90:91], v69 offset:32768
    ds_read_b64_tr_b16 a[92:93], v69 offset:31752
    v_mfma_f32_16x16x32_bf16 v[180:183], a[116:119], a[168:171], v[180:183]
    ds_read_b64_tr_b16 a[94:95], v69 offset:32776
    ds_read_b64_tr_b16 a[96:97], v66 offset:39968
    v_mfma_f32_16x16x32_bf16 v[212:215], a[116:119], a[172:175], v[212:215]
    buffer_load_dwordx4 v39, s[16:19], s38 offen offset:3072 lds
    v_mfma_f32_16x16x32_bf16 v[152:155], a[120:123], a[164:167], v[152:155]
    ds_read_b64_tr_b16 a[98:99], v66 offset:40992
    ds_read_b64_tr_b16 a[100:101], v66 offset:39976
    v_mfma_f32_16x16x32_bf16 v[184:187], a[120:123], a[168:171], v[184:187]
    ds_read_b64_tr_b16 a[102:103], v66 offset:41000
    v_mfma_f32_16x16x32_bf16 v[216:219], a[120:123], a[172:175], v[216:219]
    v_mfma_f32_16x16x32_bf16 v[156:159], a[124:127], a[164:167], v[156:159]
    s_add_u32 m0, s31, 53248
    v_mfma_f32_16x16x32_bf16 v[188:191], a[124:127], a[168:171], v[188:191]
    buffer_load_dwordx4 v40, s[16:19], s38 offen offset:0 lds
    v_mfma_f32_16x16x32_bf16 v[220:223], a[124:127], a[172:175], v[220:223]
    s_waitcnt lgkmcnt(10)
    v_mfma_f32_16x16x32_bf16 v[128:131], a[64:67], a[148:151], v[128:131]
    ds_read_b128 a[164:167], v65 offset:0
    ds_read_b128 a[168:171], v65 offset:2048
    v_mfma_f32_16x16x32_bf16 v[160:163], a[64:67], a[152:155], v[160:163]
    ds_read_b128 a[172:175], v65 offset:4096
    ds_read_b64_tr_b16 a[104:105], v67 offset:39968
    v_mfma_f32_16x16x32_bf16 v[192:195], a[64:67], a[156:159], v[192:195]
    buffer_load_dwordx4 v41, s[16:19], s38 offen offset:1024 lds
    v_mfma_f32_16x16x32_bf16 v[132:135], a[68:71], a[148:151], v[132:135]
    ds_read_b64_tr_b16 a[106:107], v67 offset:40992
    ds_read_b64_tr_b16 a[108:109], v67 offset:39976
    v_mfma_f32_16x16x32_bf16 v[164:167], a[68:71], a[152:155], v[164:167]
    ds_read_b64_tr_b16 a[110:111], v67 offset:41000
    ds_read_b64_tr_b16 a[112:113], v68 offset:39968
    v_mfma_f32_16x16x32_bf16 v[196:199], a[68:71], a[156:159], v[196:199]
    s_add_u32 m0, s32, 80896
    ds_read_b64_tr_b16 a[114:115], v68 offset:40992
    ds_read_b64_tr_b16 a[116:117], v68 offset:39976
    v_mfma_f32_16x16x32_bf16 v[136:139], a[72:75], a[148:151], v[136:139]
    buffer_load_dwordx4 v44, s[20:23], s39 offen offset:0 lds
    v_mfma_f32_16x16x32_bf16 v[168:171], a[72:75], a[152:155], v[168:171]
    ds_read_b64_tr_b16 a[118:119], v68 offset:41000
    ds_read_b64_tr_b16 a[120:121], v69 offset:39968
    v_mfma_f32_16x16x32_bf16 v[200:203], a[72:75], a[156:159], v[200:203]
    ds_read_b64_tr_b16 a[122:123], v69 offset:40992
    ds_read_b64_tr_b16 a[124:125], v69 offset:39976
    v_mfma_f32_16x16x32_bf16 v[140:143], a[76:79], a[148:151], v[140:143]
    ds_read_b64_tr_b16 a[126:127], v69 offset:41000
    v_mfma_f32_16x16x32_bf16 v[172:175], a[76:79], a[152:155], v[172:175]
    v_mfma_f32_16x16x32_bf16 v[204:207], a[76:79], a[156:159], v[204:207]
    buffer_load_dwordx4 v45, s[20:23], s39 offen offset:1024 lds
    v_mfma_f32_16x16x32_bf16 v[144:147], a[80:83], a[148:151], v[144:147]
    v_mfma_f32_16x16x32_bf16 v[176:179], a[80:83], a[152:155], v[176:179]
    v_mfma_f32_16x16x32_bf16 v[208:211], a[80:83], a[156:159], v[208:211]
    s_waitcnt lgkmcnt(10)
    v_mfma_f32_16x16x32_bf16 v[148:151], a[84:87], a[148:151], v[148:151]
    buffer_load_dwordx4 v46, s[20:23], s39 offen offset:2056 lds
    v_mfma_f32_16x16x32_bf16 v[180:183], a[84:87], a[152:155], v[180:183]
    v_mfma_f32_16x16x32_bf16 v[212:215], a[84:87], a[156:159], v[212:215]
    v_mfma_f32_16x16x32_bf16 v[152:155], a[88:91], a[148:151], v[152:155]
    v_mfma_f32_16x16x32_bf16 v[184:187], a[88:91], a[152:155], v[184:187]
    buffer_load_dwordx4 v47, s[20:23], s39 offen offset:3080 lds
    v_mfma_f32_16x16x32_bf16 v[216:219], a[88:91], a[156:159], v[216:219]
    v_mfma_f32_16x16x32_bf16 v[156:159], a[92:95], a[148:151], v[156:159]
    v_mfma_f32_16x16x32_bf16 v[188:191], a[92:95], a[152:155], v[188:191]
    v_mfma_f32_16x16x32_bf16 v[220:223], a[92:95], a[156:159], v[220:223]
    v_mfma_f32_16x16x32_bf16 v[128:131], a[96:99], a[164:167], v[128:131]
    v_subrev_u32 v64, 98304, v64
    v_subrev_u32 v65, 98304, v65
    v_mfma_f32_16x16x32_bf16 v[160:163], a[96:99], a[168:171], v[160:163]
    v_subrev_u32 v66, 98304, v66
    v_subrev_u32 v67, 98304, v67
    v_mfma_f32_16x16x32_bf16 v[192:195], a[96:99], a[172:175], v[192:195]
    v_subrev_u32 v68, 98304, v68
    v_subrev_u32 v69, 98304, v69
    v_mfma_f32_16x16x32_bf16 v[132:135], a[100:103], a[164:167], v[132:135]
    s_waitcnt vmcnt(10) lgkmcnt(0)
    s_barrier
    v_mfma_f32_16x16x32_bf16 v[164:167], a[100:103], a[168:171], v[164:167]
    s_lshl_b32 s38, s81, 7
    s_lshl_b32 s39, s81, 19
    ds_read_b128 a[148:151], v64 offset:0
    ds_read_b128 a[152:155], v64 offset:2048
    v_mfma_f32_16x16x32_bf16 v[196:199], a[100:103], a[172:175], v[196:199]
    s_add_u32 s81, s81, 1
    s_cmp_eq_u32 s81, 10
    ds_read_b128 a[156:159], v64 offset:4096
    ds_read_b64_tr_b16 a[64:65], v66 offset:31744
    v_mfma_f32_16x16x32_bf16 v[136:139], a[104:107], a[164:167], v[136:139]
    s_cselect_b32 s81, 0, s81
    s_add_u32 m0, s31, 98304
    ds_read_b64_tr_b16 a[66:67], v66 offset:32768
    ds_read_b64_tr_b16 a[68:69], v66 offset:31752
    v_mfma_f32_16x16x32_bf16 v[168:171], a[104:107], a[168:171], v[168:171]
    buffer_load_dwordx4 v36, s[16:19], s38 offen offset:0 lds
    v_mfma_f32_16x16x32_bf16 v[200:203], a[104:107], a[172:175], v[200:203]
    ds_read_b64_tr_b16 a[70:71], v66 offset:32776
    ds_read_b64_tr_b16 a[72:73], v67 offset:31744
    v_mfma_f32_16x16x32_bf16 v[140:143], a[108:111], a[164:167], v[140:143]
    buffer_load_dwordx4 v37, s[16:19], s38 offen offset:1024 lds
    v_mfma_f32_16x16x32_bf16 v[172:175], a[108:111], a[168:171], v[172:175]
    ds_read_b64_tr_b16 a[74:75], v67 offset:32768
    ds_read_b64_tr_b16 a[76:77], v67 offset:31752
    v_mfma_f32_16x16x32_bf16 v[204:207], a[108:111], a[172:175], v[204:207]
    ds_read_b64_tr_b16 a[78:79], v67 offset:32776
    ds_read_b64_tr_b16 a[80:81], v68 offset:31744
    v_mfma_f32_16x16x32_bf16 v[144:147], a[112:115], a[164:167], v[144:147]
    ds_read_b64_tr_b16 a[82:83], v68 offset:32768
    ds_read_b64_tr_b16 a[84:85], v68 offset:31752
    v_mfma_f32_16x16x32_bf16 v[176:179], a[112:115], a[168:171], v[176:179]
    buffer_load_dwordx4 v38, s[16:19], s38 offen offset:2048 lds
    v_mfma_f32_16x16x32_bf16 v[208:211], a[112:115], a[172:175], v[208:211]
    ds_read_b64_tr_b16 a[86:87], v68 offset:32776
    ds_read_b64_tr_b16 a[88:89], v69 offset:31744
    v_mfma_f32_16x16x32_bf16 v[148:151], a[116:119], a[164:167], v[148:151]
    ds_read_b64_tr_b16 a[90:91], v69 offset:32768
    ds_read_b64_tr_b16 a[92:93], v69 offset:31752
    v_mfma_f32_16x16x32_bf16 v[180:183], a[116:119], a[168:171], v[180:183]
    ds_read_b64_tr_b16 a[94:95], v69 offset:32776
    ds_read_b64_tr_b16 a[96:97], v66 offset:39968
    v_mfma_f32_16x16x32_bf16 v[212:215], a[116:119], a[172:175], v[212:215]
    buffer_load_dwordx4 v39, s[16:19], s38 offen offset:3072 lds
    v_mfma_f32_16x16x32_bf16 v[152:155], a[120:123], a[164:167], v[152:155]
    ds_read_b64_tr_b16 a[98:99], v66 offset:40992
    ds_read_b64_tr_b16 a[100:101], v66 offset:39976
    v_mfma_f32_16x16x32_bf16 v[184:187], a[120:123], a[168:171], v[184:187]
    ds_read_b64_tr_b16 a[102:103], v66 offset:41000
    v_mfma_f32_16x16x32_bf16 v[216:219], a[120:123], a[172:175], v[216:219]
    v_mfma_f32_16x16x32_bf16 v[156:159], a[124:127], a[164:167], v[156:159]
    s_add_u32 m0, s31, 102400
    v_mfma_f32_16x16x32_bf16 v[188:191], a[124:127], a[168:171], v[188:191]
    buffer_load_dwordx4 v40, s[16:19], s38 offen offset:0 lds
    v_mfma_f32_16x16x32_bf16 v[220:223], a[124:127], a[172:175], v[220:223]
    s_waitcnt lgkmcnt(10)
    v_mfma_f32_16x16x32_bf16 v[128:131], a[64:67], a[148:151], v[128:131]
    ds_read_b128 a[164:167], v65 offset:0
    ds_read_b128 a[168:171], v65 offset:2048
    v_mfma_f32_16x16x32_bf16 v[160:163], a[64:67], a[152:155], v[160:163]
    ds_read_b128 a[172:175], v65 offset:4096
    ds_read_b64_tr_b16 a[104:105], v67 offset:39968
    v_mfma_f32_16x16x32_bf16 v[192:195], a[64:67], a[156:159], v[192:195]
    buffer_load_dwordx4 v41, s[16:19], s38 offen offset:1024 lds
    v_mfma_f32_16x16x32_bf16 v[132:135], a[68:71], a[148:151], v[132:135]
    ds_read_b64_tr_b16 a[106:107], v67 offset:40992
    ds_read_b64_tr_b16 a[108:109], v67 offset:39976
    v_mfma_f32_16x16x32_bf16 v[164:167], a[68:71], a[152:155], v[164:167]
    ds_read_b64_tr_b16 a[110:111], v67 offset:41000
    ds_read_b64_tr_b16 a[112:113], v68 offset:39968
    v_mfma_f32_16x16x32_bf16 v[196:199], a[68:71], a[156:159], v[196:199]
    s_add_u32 m0, s32, 130048
    ds_read_b64_tr_b16 a[114:115], v68 offset:40992
    ds_read_b64_tr_b16 a[116:117], v68 offset:39976
    v_mfma_f32_16x16x32_bf16 v[136:139], a[72:75], a[148:151], v[136:139]
    buffer_load_dwordx4 v44, s[20:23], s39 offen offset:0 lds
    v_mfma_f32_16x16x32_bf16 v[168:171], a[72:75], a[152:155], v[168:171]
    ds_read_b64_tr_b16 a[118:119], v68 offset:41000
    ds_read_b64_tr_b16 a[120:121], v69 offset:39968
    v_mfma_f32_16x16x32_bf16 v[200:203], a[72:75], a[156:159], v[200:203]
    ds_read_b64_tr_b16 a[122:123], v69 offset:40992
    ds_read_b64_tr_b16 a[124:125], v69 offset:39976
    v_mfma_f32_16x16x32_bf16 v[140:143], a[76:79], a[148:151], v[140:143]
    ds_read_b64_tr_b16 a[126:127], v69 offset:41000
    v_mfma_f32_16x16x32_bf16 v[172:175], a[76:79], a[152:155], v[172:175]
    v_mfma_f32_16x16x32_bf16 v[204:207], a[76:79], a[156:159], v[204:207]
    buffer_load_dwordx4 v45, s[20:23], s39 offen offset:1024 lds
    v_mfma_f32_16x16x32_bf16 v[144:147], a[80:83], a[148:151], v[144:147]
    v_mfma_f32_16x16x32_bf16 v[176:179], a[80:83], a[152:155], v[176:179]
    v_mfma_f32_16x16x32_bf16 v[208:211], a[80:83], a[156:159], v[208:211]
    s_waitcnt lgkmcnt(10)
    v_mfma_f32_16x16x32_bf16 v[148:151], a[84:87], a[148:151], v[148:151]
    buffer_load_dwordx4 v46, s[20:23], s39 offen offset:2056 lds
    v_mfma_f32_16x16x32_bf16 v[180:183], a[84:87], a[152:155], v[180:183]
    v_mfma_f32_16x16x32_bf16 v[212:215], a[84:87], a[156:159], v[212:215]
    v_mfma_f32_16x16x32_bf16 v[152:155], a[88:91], a[148:151], v[152:155]
    v_mfma_f32_16x16x32_bf16 v[184:187], a[88:91], a[152:155], v[184:187]
    buffer_load_dwordx4 v47, s[20:23], s39 offen offset:3080 lds
    v_mfma_f32_16x16x32_bf16 v[216:219], a[88:91], a[156:159], v[216:219]
    v_mfma_f32_16x16x32_bf16 v[156:159], a[92:95], a[148:151], v[156:159]
    v_mfma_f32_16x16x32_bf16 v[188:191], a[92:95], a[152:155], v[188:191]
    v_mfma_f32_16x16x32_bf16 v[220:223], a[92:95], a[156:159], v[220:223]
    v_mfma_f32_16x16x32_bf16 v[128:131], a[96:99], a[164:167], v[128:131]
    v_add_u32 v64, 49152, v64
    v_add_u32 v65, 49152, v65
    v_mfma_f32_16x16x32_bf16 v[160:163], a[96:99], a[168:171], v[160:163]
    v_add_u32 v66, 49152, v66
    v_add_u32 v67, 49152, v67
    v_mfma_f32_16x16x32_bf16 v[192:195], a[96:99], a[172:175], v[192:195]
    v_add_u32 v68, 49152, v68
    v_add_u32 v69, 49152, v69
    v_mfma_f32_16x16x32_bf16 v[132:135], a[100:103], a[164:167], v[132:135]
    s_waitcnt vmcnt(10) lgkmcnt(0)
    s_barrier
    v_mfma_f32_16x16x32_bf16 v[164:167], a[100:103], a[168:171], v[164:167]
    s_lshl_b32 s38, s81, 7
    s_lshl_b32 s39, s81, 19
    ds_read_b128 a[148:151], v64 offset:0
    ds_read_b128 a[152:155], v64 offset:2048
    v_mfma_f32_16x16x32_bf16 v[196:199], a[100:103], a[172:175], v[196:199]
    s_add_u32 s81, s81, 1
    s_cmp_eq_u32 s81, 10
    ds_read_b128 a[156:159], v64 offset:4096
    ds_read_b64_tr_b16 a[64:65], v66 offset:31744
    v_mfma_f32_16x16x32_bf16 v[136:139], a[104:107], a[164:167], v[136:139]
    s_cselect_b32 s81, 0, s81
    s_add_u32 m0, s31, 0
    ds_read_b64_tr_b16 a[66:67], v66 offset:32768
    ds_read_b64_tr_b16 a[68:69], v66 offset:31752
    v_mfma_f32_16x16x32_bf16 v[168:171], a[104:107], a[168:171], v[168:171]
    buffer_load_dwordx4 v36, s[16:19], s38 offen offset:0 lds
    v_mfma_f32_16x16x32_bf16 v[200:203], a[104:107], a[172:175], v[200:203]
    buffer_load_dwordx4 v37, s[16:19], s38 offen offset:1024 lds
    v_mfma_f32_16x16x32_bf16 v[140:143], a[108:111], a[164:167], v[140:143]
    ds_read_b64_tr_b16 a[70:71], v66 offset:32776
    ds_read_b64_tr_b16 a[72:73], v67 offset:31744
    v_mfma_f32_16x16x32_bf16 v[172:175], a[108:111], a[168:171], v[172:175]
    ds_read_b64_tr_b16 a[74:75], v67 offset:32768
    ds_read_b64_tr_b16 a[76:77], v67 offset:31752
    v_mfma_f32_16x16x32_bf16 v[204:207], a[108:111], a[172:175], v[204:207]
    buffer_load_dwordx4 v38, s[16:19], s38 offen offset:2048 lds
    v_mfma_f32_16x16x32_bf16 v[144:147], a[112:115], a[164:167], v[144:147]
    ds_read_b64_tr_b16 a[78:79], v67 offset:32776
    ds_read_b64_tr_b16 a[80:81], v68 offset:31744
    v_mfma_f32_16x16x32_bf16 v[176:179], a[112:115], a[168:171], v[176:179]
    ds_read_b64_tr_b16 a[82:83], v68 offset:32768
    ds_read_b64_tr_b16 a[84:85], v68 offset:31752
    v_mfma_f32_16x16x32_bf16 v[208:211], a[112:115], a[172:175], v[208:211]
    buffer_load_dwordx4 v39, s[16:19], s38 offen offset:3072 lds
    v_mfma_f32_16x16x32_bf16 v[148:151], a[116:119], a[164:167], v[148:151]
    ds_read_b64_tr_b16 a[86:87], v68 offset:32776
    ds_read_b64_tr_b16 a[88:89], v69 offset:31744
    v_mfma_f32_16x16x32_bf16 v[180:183], a[116:119], a[168:171], v[180:183]
    s_add_u32 m0, s31, 4096
    ds_read_b64_tr_b16 a[90:91], v69 offset:32768
    ds_read_b64_tr_b16 a[92:93], v69 offset:31752
    v_mfma_f32_16x16x32_bf16 v[212:215], a[116:119], a[172:175], v[212:215]
    buffer_load_dwordx4 v40, s[16:19], s38 offen offset:0 lds
    v_mfma_f32_16x16x32_bf16 v[152:155], a[120:123], a[164:167], v[152:155]
    ds_read_b64_tr_b16 a[94:95], v69 offset:32776
    ds_read_b64_tr_b16 a[96:97], v66 offset:39968
    v_mfma_f32_16x16x32_bf16 v[184:187], a[120:123], a[168:171], v[184:187]
    ds_read_b64_tr_b16 a[98:99], v66 offset:40992
    ds_read_b64_tr_b16 a[100:101], v66 offset:39976
    v_mfma_f32_16x16x32_bf16 v[216:219], a[120:123], a[172:175], v[216:219]
    buffer_load_dwordx4 v41, s[16:19], s38 offen offset:1024 lds
    v_mfma_f32_16x16x32_bf16 v[156:159], a[124:127], a[164:167], v[156:159]
    ds_read_b64_tr_b16 a[102:103], v66 offset:41000
    v_mfma_f32_16x16x32_bf16 v[188:191], a[124:127], a[168:171], v[188:191]
    s_add_u32 m0, s32, 31744
    v_mfma_f32_16x16x32_bf16 v[220:223], a[124:127], a[172:175], v[220:223]
    s_waitcnt lgkmcnt(10)
    buffer_load_dwordx4 v44, s[20:23], s39 offen offset:0 lds
    v_mfma_f32_16x16x32_bf16 v[128:131], a[64:67], a[148:151], v[128:131]
    ds_read_b128 a[164:167], v65 offset:0
    ds_read_b128 a[168:171], v65 offset:2048
    v_mfma_f32_16x16x32_bf16 v[160:163], a[64:67], a[152:155], v[160:163]
    ds_read_b128 a[172:175], v65 offset:4096
    ds_read_b64_tr_b16 a[104:105], v67 offset:39968
    v_mfma_f32_16x16x32_bf16 v[192:195], a[64:67], a[156:159], v[192:195]
    buffer_load_dwordx4 v45, s[20:23], s39 offen offset:1024 lds
    v_mfma_f32_16x16x32_bf16 v[132:135], a[68:71], a[148:151], v[132:135]
    ds_read_b64_tr_b16 a[106:107], v67 offset:40992
    ds_read_b64_tr_b16 a[108:109], v67 offset:39976
    v_mfma_f32_16x16x32_bf16 v[164:167], a[68:71], a[152:155], v[164:167]
    ds_read_b64_tr_b16 a[110:111], v67 offset:41000
    ds_read_b64_tr_b16 a[112:113], v68 offset:39968
    v_mfma_f32_16x16x32_bf16 v[196:199], a[68:71], a[156:159], v[196:199]
    buffer_load_dwordx4 v46, s[20:23], s39 offen offset:2056 lds
    v_mfma_f32_16x16x32_bf16 v[136:139], a[72:75], a[148:151], v[136:139]
    ds_read_b64_tr_b16 a[114:115], v68 offset:40992
    ds_read_b64_tr_b16 a[116:117], v68 offset:39976
    v_mfma_f32_16x16x32_bf16 v[168:171], a[72:75], a[152:155], v[168:171]
    ds_read_b64_tr_b16 a[118:119], v68 offset:41000
    ds_read_b64_tr_b16 a[120:121], v69 offset:39968
    v_mfma_f32_16x16x32_bf16 v[200:203], a[72:75], a[156:159], v[200:203]
    buffer_load_dwordx4 v47, s[20:23], s39 offen offset:3080 lds
    v_mfma_f32_16x16x32_bf16 v[140:143], a[76:79], a[148:151], v[140:143]
    s_add_u32 s33, s80, 0
    ds_read_b64_tr_b16 a[122:123], v69 offset:40992
    ds_read_b64_tr_b16 a[124:125], v69 offset:39976
    v_mfma_f32_16x16x32_bf16 v[172:175], a[76:79], a[152:155], v[172:175]
    s_and_b32 s33, s33, 0x7ffff
    s_add_u32 m0, s29, 49152
    ds_read_b64_tr_b16 a[126:127], v69 offset:41000
    v_mfma_f32_16x16x32_bf16 v[204:207], a[76:79], a[156:159], v[204:207]
    buffer_load_dwordx4 v28, s[8:11], s33 offen offset:0 nt lds
    v_mfma_f32_16x16x32_bf16 v[144:147], a[80:83], a[148:151], v[144:147]
    v_mfma_f32_16x16x32_bf16 v[176:179], a[80:83], a[152:155], v[176:179]
    v_mfma_f32_16x16x32_bf16 v[208:211], a[80:83], a[156:159], v[208:211]
    s_waitcnt lgkmcnt(10)
    buffer_load_dwordx4 v29, s[8:11], s33 offen offset:1024 nt lds
    v_mfma_f32_16x16x32_bf16 v[148:151], a[84:87], a[148:151], v[148:151]
    v_mfma_f32_16x16x32_bf16 v[180:183], a[84:87], a[152:155], v[180:183]
    v_mfma_f32_16x16x32_bf16 v[212:215], a[84:87], a[156:159], v[212:215]
    buffer_load_dwordx4 v30, s[8:11], s33 offen offset:2048 nt lds
    v_mfma_f32_16x16x32_bf16 v[152:155], a[88:91], a[148:151], v[152:155]
    v_mfma_f32_16x16x32_bf16 v[184:187], a[88:91], a[152:155], v[184:187]
    v_mfma_f32_16x16x32_bf16 v[216:219], a[88:91], a[156:159], v[216:219]
    buffer_load_dwordx4 v31, s[8:11], s33 offen offset:3072 nt lds
    v_mfma_f32_16x16x32_bf16 v[156:159], a[92:95], a[148:151], v[156:159]
    v_mfma_f32_16x16x32_bf16 v[188:191], a[92:95], a[152:155], v[188:191]
    v_mfma_f32_16x16x32_bf16 v[220:223], a[92:95], a[156:159], v[220:223]
    v_mfma_f32_16x16x32_bf16 v[128:131], a[96:99], a[164:167], v[128:131]
    v_add_u32 v64, 49152, v64
    v_add_u32 v65, 49152, v65
    v_mfma_f32_16x16x32_bf16 v[160:163], a[96:99], a[168:171], v[160:163]
    v_add_u32 v66, 49152, v66
    v_add_u32 v67, 49152, v67
    v_mfma_f32_16x16x32_bf16 v[192:195], a[96:99], a[172:175], v[192:195]
    v_add_u32 v68, 49152, v68
    v_add_u32 v69, 49152, v69
    v_mfma_f32_16x16x32_bf16 v[132:135], a[100:103], a[164:167], v[132:135]
    s_waitcnt vmcnt(14) lgkmcnt(0)
    s_barrier
    v_mfma_f32_16x16x32_bf16 v[164:167], a[100:103], a[168:171], v[164:167]
    s_lshl_b32 s38, s81, 7
    s_lshl_b32 s39, s81, 19
    ds_read_b128 a[148:151], v64 offset:0
    ds_read_b128 a[152:155], v64 offset:2048
    v_mfma_f32_16x16x32_bf16 v[196:199], a[100:103], a[172:175], v[196:199]
    s_add_u32 s81, s81, 1
    s_cmp_eq_u32 s81, 10
    ds_read_b128 a[156:159], v64 offset:4096
    ds_read_b64_tr_b16 a[64:65], v66 offset:31744
    v_mfma_f32_16x16x32_bf16 v[136:139], a[104:107], a[164:167], v[136:139]
    s_cselect_b32 s81, 0, s81
    s_add_u32 m0, s31, 49152
    ds_read_b64_tr_b16 a[66:67], v66 offset:32768
    ds_read_b64_tr_b16 a[68:69], v66 offset:31752
    v_mfma_f32_16x16x32_bf16 v[168:171], a[104:107], a[168:171], v[168:171]
    buffer_load_dwordx4 v36, s[16:19], s38 offen offset:0 lds
    v_mfma_f32_16x16x32_bf16 v[200:203], a[104:107], a[172:175], v[200:203]
    ds_read_b64_tr_b16 a[70:71], v66 offset:32776
    ds_read_b64_tr_b16 a[72:73], v67 offset:31744
    v_mfma_f32_16x16x32_bf16 v[140:143], a[108:111], a[164:167], v[140:143]
    buffer_load_dwordx4 v37, s[16:19], s38 offen offset:1024 lds
    v_mfma_f32_16x16x32_bf16 v[172:175], a[108:111], a[168:171], v[172:175]
    ds_read_b64_tr_b16 a[74:75], v67 offset:32768
    ds_read_b64_tr_b16 a[76:77], v67 offset:31752
    v_mfma_f32_16x16x32_bf16 v[204:207], a[108:111], a[172:175], v[204:207]
    ds_read_b64_tr_b16 a[78:79], v67 offset:32776
    ds_read_b64_tr_b16 a[80:81], v68 offset:31744
    v_mfma_f32_16x16x32_bf16 v[144:147], a[112:115], a[164:167], v[144:147]
    ds_read_b64_tr_b16 a[82:83], v68 offset:32768
    ds_read_b64_tr_b16 a[84:85], v68 offset:31752
    v_mfma_f32_16x16x32_bf16 v[176:179], a[112:115], a[168:171], v[176:179]
    buffer_load_dwordx4 v38, s[16:19], s38 offen offset:2048 lds
    v_mfma_f32_16x16x32_bf16 v[208:211], a[112:115], a[172:175], v[208:211]
    ds_read_b64_tr_b16 a[86:87], v68 offset:32776
    ds_read_b64_tr_b16 a[88:89], v69 offset:31744
    v_mfma_f32_16x16x32_bf16 v[148:151], a[116:119], a[164:167], v[148:151]
    ds_read_b64_tr_b16 a[90:91], v69 offset:32768
    ds_read_b64_tr_b16 a[92:93], v69 offset:31752
    v_mfma_f32_16x16x32_bf16 v[180:183], a[116:119], a[168:171], v[180:183]
    ds_read_b64_tr_b16 a[94:95], v69 offset:32776
    ds_read_b64_tr_b16 a[96:97], v66 offset:39968
    v_mfma_f32_16x16x32_bf16 v[212:215], a[116:119], a[172:175], v[212:215]
    buffer_load_dwordx4 v39, s[16:19], s38 offen offset:3072 lds
    v_mfma_f32_16x16x32_bf16 v[152:155], a[120:123], a[164:167], v[152:155]
    ds_read_b64_tr_b16 a[98:99], v66 offset:40992
    ds_read_b64_tr_b16 a[100:101], v66 offset:39976
    v_mfma_f32_16x16x32_bf16 v[184:187], a[120:123], a[168:171], v[184:187]
    ds_read_b64_tr_b16 a[102:103], v66 offset:41000
    v_mfma_f32_16x16x32_bf16 v[216:219], a[120:123], a[172:175], v[216:219]
    v_mfma_f32_16x16x32_bf16 v[156:159], a[124:127], a[164:167], v[156:159]
    s_add_u32 m0, s31, 53248
    v_mfma_f32_16x16x32_bf16 v[188:191], a[124:127], a[168:171], v[188:191]
    buffer_load_dwordx4 v40, s[16:19], s38 offen offset:0 lds
    v_mfma_f32_16x16x32_bf16 v[220:223], a[124:127], a[172:175], v[220:223]
    s_waitcnt lgkmcnt(10)
    v_mfma_f32_16x16x32_bf16 v[128:131], a[64:67], a[148:151], v[128:131]
    ds_read_b128 a[164:167], v65 offset:0
    ds_read_b128 a[168:171], v65 offset:2048
    v_mfma_f32_16x16x32_bf16 v[160:163], a[64:67], a[152:155], v[160:163]
    ds_read_b128 a[172:175], v65 offset:4096
    ds_read_b64_tr_b16 a[104:105], v67 offset:39968
    v_mfma_f32_16x16x32_bf16 v[192:195], a[64:67], a[156:159], v[192:195]
    buffer_load_dwordx4 v41, s[16:19], s38 offen offset:1024 lds
    v_mfma_f32_16x16x32_bf16 v[132:135], a[68:71], a[148:151], v[132:135]
    ds_read_b64_tr_b16 a[106:107], v67 offset:40992
    ds_read_b64_tr_b16 a[108:109], v67 offset:39976
    v_mfma_f32_16x16x32_bf16 v[164:167], a[68:71], a[152:155], v[164:167]
    ds_read_b64_tr_b16 a[110:111], v67 offset:41000
    ds_read_b64_tr_b16 a[112:113], v68 offset:39968
    v_mfma_f32_16x16x32_bf16 v[196:199], a[68:71], a[156:159], v[196:199]
    s_add_u32 m0, s32, 80896
    ds_read_b64_tr_b16 a[114:115], v68 offset:40992
    ds_read_b64_tr_b16 a[116:117], v68 offset:39976
    v_mfma_f32_16x16x32_bf16 v[136:139], a[72:75], a[148:151], v[136:139]
    buffer_load_dwordx4 v44, s[20:23], s39 offen offset:0 lds
    v_mfma_f32_16x16x32_bf16 v[168:171], a[72:75], a[152:155], v[168:171]
    ds_read_b64_tr_b16 a[118:119], v68 offset:41000
    ds_read_b64_tr_b16 a[120:121], v69 offset:39968
    v_mfma_f32_16x16x32_bf16 v[200:203], a[72:75], a[156:159], v[200:203]
    ds_read_b64_tr_b16 a[122:123], v69 offset:40992
    ds_read_b64_tr_b16 a[124:125], v69 offset:39976
    v_mfma_f32_16x16x32_bf16 v[140:143], a[76:79], a[148:151], v[140:143]
    ds_read_b64_tr_b16 a[126:127], v69 offset:41000
    v_mfma_f32_16x16x32_bf16 v[172:175], a[76:79], a[152:155], v[172:175]
    v_mfma_f32_16x16x32_bf16 v[204:207], a[76:79], a[156:159], v[204:207]
    buffer_load_dwordx4 v45, s[20:23], s39 offen offset:1024 lds
    v_mfma_f32_16x16x32_bf16 v[144:147], a[80:83], a[148:151], v[144:147]
    v_mfma_f32_16x16x32_bf16 v[176:179], a[80:83], a[152:155], v[176:179]
    v_mfma_f32_16x16x32_bf16 v[208:211], a[80:83], a[156:159], v[208:211]
    s_waitcnt lgkmcnt(10)
    v_mfma_f32_16x16x32_bf16 v[148:151], a[84:87], a[148:151], v[148:151]
    buffer_load_dwordx4 v46, s[20:23], s39 offen offset:2056 lds
    v_mfma_f32_16x16x32_bf16 v[180:183], a[84:87], a[152:155], v[180:183]
    v_mfma_f32_16x16x32_bf16 v[212:215], a[84:87], a[156:159], v[212:215]
    v_mfma_f32_16x16x32_bf16 v[152:155], a[88:91], a[148:151], v[152:155]
    v_mfma_f32_16x16x32_bf16 v[184:187], a[88:91], a[152:155], v[184:187]
    buffer_load_dwordx4 v47, s[20:23], s39 offen offset:3080 lds
    v_mfma_f32_16x16x32_bf16 v[216:219], a[88:91], a[156:159], v[216:219]
    v_mfma_f32_16x16x32_bf16 v[156:159], a[92:95], a[148:151], v[156:159]
    v_mfma_f32_16x16x32_bf16 v[188:191], a[92:95], a[152:155], v[188:191]
    v_mfma_f32_16x16x32_bf16 v[220:223], a[92:95], a[156:159], v[220:223]
    v_mfma_f32_16x16x32_bf16 v[128:131], a[96:99], a[164:167], v[128:131]
    v_subrev_u32 v64, 98304, v64
    v_subrev_u32 v65, 98304, v65
    v_mfma_f32_16x16x32_bf16 v[160:163], a[96:99], a[168:171], v[160:163]
    v_subrev_u32 v66, 98304, v66
    v_subrev_u32 v67, 98304, v67
    v_mfma_f32_16x16x32_bf16 v[192:195], a[96:99], a[172:175], v[192:195]
    v_subrev_u32 v68, 98304, v68
    v_subrev_u32 v69, 98304, v69
    v_mfma_f32_16x16x32_bf16 v[132:135], a[100:103], a[164:167], v[132:135]
    s_waitcnt vmcnt(14) lgkmcnt(0)
    s_barrier
    v_mfma_f32_16x16x32_bf16 v[164:167], a[100:103], a[168:171], v[164:167]
    s_lshl_b32 s38, s81, 7
    s_lshl_b32 s39, s81, 19
    ds_read_b128 a[148:151], v64 offset:0
    ds_read_b128 a[152:155], v64 offset:2048
    v_mfma_f32_16x16x32_bf16 v[196:199], a[100:103], a[172:175], v[196:199]
    s_add_u32 s81, s81, 1
    s_cmp_eq_u32 s81, 10
    ds_read_b128 a[156:159], v64 offset:4096
    ds_read_b64_tr_b16 a[64:65], v66 offset:31744
    v_mfma_f32_16x16x32_bf16 v[136:139], a[104:107], a[164:167], v[136:139]
    s_cselect_b32 s81, 0, s81
    s_add_u32 m0, s31, 98304
    ds_read_b64_tr_b16 a[66:67], v66 offset:32768
    ds_read_b64_tr_b16 a[68:69], v66 offset:31752
    v_mfma_f32_16x16x32_bf16 v[168:171], a[104:107], a[168:171], v[168:171]
    buffer_load_dwordx4 v36, s[16:19], s38 offen offset:0 lds
    v_mfma_f32_16x16x32_bf16 v[200:203], a[104:107], a[172:175], v[200:203]
    ds_read_b64_tr_b16 a[70:71], v66 offset:32776
    ds_read_b64_tr_b16 a[72:73], v67 offset:31744
    v_mfma_f32_16x16x32_bf16 v[140:143], a[108:111], a[164:167], v[140:143]
    buffer_load_dwordx4 v37, s[16:19], s38 offen offset:1024 lds
    v_mfma_f32_16x16x32_bf16 v[172:175], a[108:111], a[168:171], v[172:175]
    ds_read_b64_tr_b16 a[74:75], v67 offset:32768
    ds_read_b64_tr_b16 a[76:77], v67 offset:31752
    v_mfma_f32_16x16x32_bf16 v[204:207], a[108:111], a[172:175], v[204:207]
    ds_read_b64_tr_b16 a[78:79], v67 offset:32776
    ds_read_b64_tr_b16 a[80:81], v68 offset:31744
    v_mfma_f32_16x16x32_bf16 v[144:147], a[112:115], a[164:167], v[144:147]
    ds_read_b64_tr_b16 a[82:83], v68 offset:32768
    ds_read_b64_tr_b16 a[84:85], v68 offset:31752
    v_mfma_f32_16x16x32_bf16 v[176:179], a[112:115], a[168:171], v[176:179]
    buffer_load_dwordx4 v38, s[16:19], s38 offen offset:2048 lds
    v_mfma_f32_16x16x32_bf16 v[208:211], a[112:115], a[172:175], v[208:211]
    ds_read_b64_tr_b16 a[86:87], v68 offset:32776
    ds_read_b64_tr_b16 a[88:89], v69 offset:31744
    v_mfma_f32_16x16x32_bf16 v[148:151], a[116:119], a[164:167], v[148:151]
    ds_read_b64_tr_b16 a[90:91], v69 offset:32768
    ds_read_b64_tr_b16 a[92:93], v69 offset:31752
    v_mfma_f32_16x16x32_bf16 v[180:183], a[116:119], a[168:171], v[180:183]
    ds_read_b64_tr_b16 a[94:95], v69 offset:32776
    ds_read_b64_tr_b16 a[96:97], v66 offset:39968
    v_mfma_f32_16x16x32_bf16 v[212:215], a[116:119], a[172:175], v[212:215]
    buffer_load_dwordx4 v39, s[16:19], s38 offen offset:3072 lds
    v_mfma_f32_16x16x32_bf16 v[152:155], a[120:123], a[164:167], v[152:155]
    ds_read_b64_tr_b16 a[98:99], v66 offset:40992
    ds_read_b64_tr_b16 a[100:101], v66 offset:39976
    v_mfma_f32_16x16x32_bf16 v[184:187], a[120:123], a[168:171], v[184:187]
    ds_read_b64_tr_b16 a[102:103], v66 offset:41000
    v_mfma_f32_16x16x32_bf16 v[216:219], a[120:123], a[172:175], v[216:219]
    v_mfma_f32_16x16x32_bf16 v[156:159], a[124:127], a[164:167], v[156:159]
    s_add_u32 m0, s31, 102400
    v_mfma_f32_16x16x32_bf16 v[188:191], a[124:127], a[168:171], v[188:191]
    buffer_load_dwordx4 v40, s[16:19], s38 offen offset:0 lds
    v_mfma_f32_16x16x32_bf16 v[220:223], a[124:127], a[172:175], v[220:223]
    s_waitcnt lgkmcnt(10)
    v_mfma_f32_16x16x32_bf16 v[128:131], a[64:67], a[148:151], v[128:131]
    ds_read_b128 a[164:167], v65 offset:0
    ds_read_b128 a[168:171], v65 offset:2048
    v_mfma_f32_16x16x32_bf16 v[160:163], a[64:67], a[152:155], v[160:163]
    ds_read_b128 a[172:175], v65 offset:4096
    ds_read_b64_tr_b16 a[104:105], v67 offset:39968
    v_mfma_f32_16x16x32_bf16 v[192:195], a[64:67], a[156:159], v[192:195]
    buffer_load_dwordx4 v41, s[16:19], s38 offen offset:1024 lds
    v_mfma_f32_16x16x32_bf16 v[132:135], a[68:71], a[148:151], v[132:135]
    ds_read_b64_tr_b16 a[106:107], v67 offset:40992
    ds_read_b64_tr_b16 a[108:109], v67 offset:39976
    v_mfma_f32_16x16x32_bf16 v[164:167], a[68:71], a[152:155], v[164:167]
    ds_read_b64_tr_b16 a[110:111], v67 offset:41000
    ds_read_b64_tr_b16 a[112:113], v68 offset:39968
    v_mfma_f32_16x16x32_bf16 v[196:199], a[68:71], a[156:159], v[196:199]
    s_add_u32 m0, s32, 130048
    ds_read_b64_tr_b16 a[114:115], v68 offset:40992
    ds_read_b64_tr_b16 a[116:117], v68 offset:39976
    v_mfma_f32_16x16x32_bf16 v[136:139], a[72:75], a[148:151], v[136:139]
    buffer_load_dwordx4 v44, s[20:23], s39 offen offset:0 lds
    v_mfma_f32_16x16x32_bf16 v[168:171], a[72:75], a[152:155], v[168:171]
    ds_read_b64_tr_b16 a[118:119], v68 offset:41000
    ds_read_b64_tr_b16 a[120:121], v69 offset:39968
    v_mfma_f32_16x16x32_bf16 v[200:203], a[72:75], a[156:159], v[200:203]
    ds_read_b64_tr_b16 a[122:123], v69 offset:40992
    ds_read_b64_tr_b16 a[124:125], v69 offset:39976
    v_mfma_f32_16x16x32_bf16 v[140:143], a[76:79], a[148:151], v[140:143]
    ds_read_b64_tr_b16 a[126:127], v69 offset:41000
    v_mfma_f32_16x16x32_bf16 v[172:175], a[76:79], a[152:155], v[172:175]
    v_mfma_f32_16x16x32_bf16 v[204:207], a[76:79], a[156:159], v[204:207]
    buffer_load_dwordx4 v45, s[20:23], s39 offen offset:1024 lds
    v_mfma_f32_16x16x32_bf16 v[144:147], a[80:83], a[148:151], v[144:147]
    v_mfma_f32_16x16x32_bf16 v[176:179], a[80:83], a[152:155], v[176:179]
    v_mfma_f32_16x16x32_bf16 v[208:211], a[80:83], a[156:159], v[208:211]
    s_waitcnt lgkmcnt(10)
    v_mfma_f32_16x16x32_bf16 v[148:151], a[84:87], a[148:151], v[148:151]
    buffer_load_dwordx4 v46, s[20:23], s39 offen offset:2056 lds
    v_mfma_f32_16x16x32_bf16 v[180:183], a[84:87], a[152:155], v[180:183]
    v_mfma_f32_16x16x32_bf16 v[212:215], a[84:87], a[156:159], v[212:215]
    v_mfma_f32_16x16x32_bf16 v[152:155], a[88:91], a[148:151], v[152:155]
    v_mfma_f32_16x16x32_bf16 v[184:187], a[88:91], a[152:155], v[184:187]
    buffer_load_dwordx4 v47, s[20:23], s39 offen offset:3080 lds
    v_mfma_f32_16x16x32_bf16 v[216:219], a[88:91], a[156:159], v[216:219]
    v_mfma_f32_16x16x32_bf16 v[156:159], a[92:95], a[148:151], v[156:159]
    v_mfma_f32_16x16x32_bf16 v[188:191], a[92:95], a[152:155], v[188:191]
    v_mfma_f32_16x16x32_bf16 v[220:223], a[92:95], a[156:159], v[220:223]
    v_mfma_f32_16x16x32_bf16 v[128:131], a[96:99], a[164:167], v[128:131]
    v_add_u32 v64, 49152, v64
    v_add_u32 v65, 49152, v65
    v_mfma_f32_16x16x32_bf16 v[160:163], a[96:99], a[168:171], v[160:163]
    v_add_u32 v66, 49152, v66
    v_add_u32 v67, 49152, v67
    v_mfma_f32_16x16x32_bf16 v[192:195], a[96:99], a[172:175], v[192:195]
    v_add_u32 v68, 49152, v68
    v_add_u32 v69, 49152, v69
    v_mfma_f32_16x16x32_bf16 v[132:135], a[100:103], a[164:167], v[132:135]
    s_waitcnt vmcnt(10) lgkmcnt(0)
    s_barrier
    v_mfma_f32_16x16x32_bf16 v[164:167], a[100:103], a[168:171], v[164:167]
    s_lshl_b32 s38, s81, 7
    s_lshl_b32 s39, s81, 19
    ds_read_b128 a[148:151], v64 offset:0
    ds_read_b128 a[152:155], v64 offset:2048
    v_mfma_f32_16x16x32_bf16 v[196:199], a[100:103], a[172:175], v[196:199]
    s_add_u32 s81, s81, 1
    s_cmp_eq_u32 s81, 10
    ds_read_b128 a[156:159], v64 offset:4096
    ds_read_b64_tr_b16 a[64:65], v66 offset:31744
    v_mfma_f32_16x16x32_bf16 v[136:139], a[104:107], a[164:167], v[136:139]
    s_cselect_b32 s81, 0, s81
    s_add_u32 m0, s31, 0
    ds_read_b64_tr_b16 a[66:67], v66 offset:32768
    ds_read_b64_tr_b16 a[68:69], v66 offset:31752
    v_mfma_f32_16x16x32_bf16 v[168:171], a[104:107], a[168:171], v[168:171]
    buffer_load_dwordx4 v36, s[16:19], s38 offen offset:0 lds
    v_mfma_f32_16x16x32_bf16 v[200:203], a[104:107], a[172:175], v[200:203]
    ds_read_b64_tr_b16 a[70:71], v66 offset:32776
    ds_read_b64_tr_b16 a[72:73], v67 offset:31744
    v_mfma_f32_16x16x32_bf16 v[140:143], a[108:111], a[164:167], v[140:143]
    buffer_load_dwordx4 v37, s[16:19], s38 offen offset:1024 lds
    v_mfma_f32_16x16x32_bf16 v[172:175], a[108:111], a[168:171], v[172:175]
    ds_read_b64_tr_b16 a[74:75], v67 offset:32768
    ds_read_b64_tr_b16 a[76:77], v67 offset:31752
    v_mfma_f32_16x16x32_bf16 v[204:207], a[108:111], a[172:175], v[204:207]
    ds_read_b64_tr_b16 a[78:79], v67 offset:32776
    ds_read_b64_tr_b16 a[80:81], v68 offset:31744
    v_mfma_f32_16x16x32_bf16 v[144:147], a[112:115], a[164:167], v[144:147]
    ds_read_b64_tr_b16 a[82:83], v68 offset:32768
    ds_read_b64_tr_b16 a[84:85], v68 offset:31752
    v_mfma_f32_16x16x32_bf16 v[176:179], a[112:115], a[168:171], v[176:179]
    buffer_load_dwordx4 v38, s[16:19], s38 offen offset:2048 lds
    v_mfma_f32_16x16x32_bf16 v[208:211], a[112:115], a[172:175], v[208:211]
    ds_read_b64_tr_b16 a[86:87], v68 offset:32776
    ds_read_b64_tr_b16 a[88:89], v69 offset:31744
    v_mfma_f32_16x16x32_bf16 v[148:151], a[116:119], a[164:167], v[148:151]
    ds_read_b64_tr_b16 a[90:91], v69 offset:32768
    ds_read_b64_tr_b16 a[92:93], v69 offset:31752
    v_mfma_f32_16x16x32_bf16 v[180:183], a[116:119], a[168:171], v[180:183]
    ds_read_b64_tr_b16 a[94:95], v69 offset:32776
    ds_read_b64_tr_b16 a[96:97], v66 offset:39968
    v_mfma_f32_16x16x32_bf16 v[212:215], a[116:119], a[172:175], v[212:215]
    buffer_load_dwordx4 v39, s[16:19], s38 offen offset:3072 lds
    v_mfma_f32_16x16x32_bf16 v[152:155], a[120:123], a[164:167], v[152:155]
    ds_read_b64_tr_b16 a[98:99], v66 offset:40992
    ds_read_b64_tr_b16 a[100:101], v66 offset:39976
    v_mfma_f32_16x16x32_bf16 v[184:187], a[120:123], a[168:171], v[184:187]
    ds_read_b64_tr_b16 a[102:103], v66 offset:41000
    v_mfma_f32_16x16x32_bf16 v[216:219], a[120:123], a[172:175], v[216:219]
    v_mfma_f32_16x16x32_bf16 v[156:159], a[124:127], a[164:167], v[156:159]
    s_add_u32 m0, s31, 4096
    v_mfma_f32_16x16x32_bf16 v[188:191], a[124:127], a[168:171], v[188:191]
    buffer_load_dwordx4 v40, s[16:19], s38 offen offset:0 lds
    v_mfma_f32_16x16x32_bf16 v[220:223], a[124:127], a[172:175], v[220:223]
    s_waitcnt lgkmcnt(10)
    v_mfma_f32_16x16x32_bf16 v[128:131], a[64:67], a[148:151], v[128:131]
    ds_read_b128 a[164:167], v65 offset:0
    ds_read_b128 a[168:171], v65 offset:2048
    v_mfma_f32_16x16x32_bf16 v[160:163], a[64:67], a[152:155], v[160:163]
    ds_read_b128 a[172:175], v65 offset:4096
    ds_read_b64_tr_b16 a[104:105], v67 offset:39968
    v_mfma_f32_16x16x32_bf16 v[192:195], a[64:67], a[156:159], v[192:195]
    buffer_load_dwordx4 v41, s[16:19], s38 offen offset:1024 lds
    v_mfma_f32_16x16x32_bf16 v[132:135], a[68:71], a[148:151], v[132:135]
    ds_read_b64_tr_b16 a[106:107], v67 offset:40992
    ds_read_b64_tr_b16 a[108:109], v67 offset:39976
    v_mfma_f32_16x16x32_bf16 v[164:167], a[68:71], a[152:155], v[164:167]
    ds_read_b64_tr_b16 a[110:111], v67 offset:41000
    ds_read_b64_tr_b16 a[112:113], v68 offset:39968
    v_mfma_f32_16x16x32_bf16 v[196:199], a[68:71], a[156:159], v[196:199]
    s_add_u32 m0, s32, 31744
    ds_read_b64_tr_b16 a[114:115], v68 offset:40992
    ds_read_b64_tr_b16 a[116:117], v68 offset:39976
    v_mfma_f32_16x16x32_bf16 v[136:139], a[72:75], a[148:151], v[136:139]
    buffer_load_dwordx4 v44, s[20:23], s39 offen offset:0 lds
    v_mfma_f32_16x16x32_bf16 v[168:171], a[72:75], a[152:155], v[168:171]
    ds_read_b64_tr_b16 a[118:119], v68 offset:41000
    ds_read_b64_tr_b16 a[120:121], v69 offset:39968
    v_mfma_f32_16x16x32_bf16 v[200:203], a[72:75], a[156:159], v[200:203]
    ds_read_b64_tr_b16 a[122:123], v69 offset:40992
    ds_read_b64_tr_b16 a[124:125], v69 offset:39976
    v_mfma_f32_16x16x32_bf16 v[140:143], a[76:79], a[148:151], v[140:143]
    ds_read_b64_tr_b16 a[126:127], v69 offset:41000
    v_mfma_f32_16x16x32_bf16 v[172:175], a[76:79], a[152:155], v[172:175]
    v_mfma_f32_16x16x32_bf16 v[204:207], a[76:79], a[156:159], v[204:207]
    buffer_load_dwordx4 v45, s[20:23], s39 offen offset:1024 lds
    v_mfma_f32_16x16x32_bf16 v[144:147], a[80:83], a[148:151], v[144:147]
    v_mfma_f32_16x16x32_bf16 v[176:179], a[80:83], a[152:155], v[176:179]
    v_mfma_f32_16x16x32_bf16 v[208:211], a[80:83], a[156:159], v[208:211]
    s_waitcnt lgkmcnt(10)
    v_mfma_f32_16x16x32_bf16 v[148:151], a[84:87], a[148:151], v[148:151]
    buffer_load_dwordx4 v46, s[20:23], s39 offen offset:2056 lds
    v_mfma_f32_16x16x32_bf16 v[180:183], a[84:87], a[152:155], v[180:183]
    v_mfma_f32_16x16x32_bf16 v[212:215], a[84:87], a[156:159], v[212:215]
    v_mfma_f32_16x16x32_bf16 v[152:155], a[88:91], a[148:151], v[152:155]
    v_mfma_f32_16x16x32_bf16 v[184:187], a[88:91], a[152:155], v[184:187]
    buffer_load_dwordx4 v47, s[20:23], s39 offen offset:3080 lds
    v_mfma_f32_16x16x32_bf16 v[216:219], a[88:91], a[156:159], v[216:219]
    v_mfma_f32_16x16x32_bf16 v[156:159], a[92:95], a[148:151], v[156:159]
    v_mfma_f32_16x16x32_bf16 v[188:191], a[92:95], a[152:155], v[188:191]
    v_mfma_f32_16x16x32_bf16 v[220:223], a[92:95], a[156:159], v[220:223]
    v_mfma_f32_16x16x32_bf16 v[128:131], a[96:99], a[164:167], v[128:131]
    v_add_u32 v64, 49152, v64
    v_add_u32 v65, 49152, v65
    v_mfma_f32_16x16x32_bf16 v[160:163], a[96:99], a[168:171], v[160:163]
    v_add_u32 v66, 49152, v66
    v_add_u32 v67, 49152, v67
    v_mfma_f32_16x16x32_bf16 v[192:195], a[96:99], a[172:175], v[192:195]
    v_add_u32 v68, 49152, v68
    v_add_u32 v69, 49152, v69
    v_mfma_f32_16x16x32_bf16 v[132:135], a[100:103], a[164:167], v[132:135]
    s_waitcnt vmcnt(10) lgkmcnt(0)
    s_barrier
    v_mfma_f32_16x16x32_bf16 v[164:167], a[100:103], a[168:171], v[164:167]
    s_lshl_b32 s38, s81, 7
    s_lshl_b32 s39, s81, 19
    ds_read_b128 a[148:151], v64 offset:0
    ds_read_b128 a[152:155], v64 offset:2048
    v_mfma_f32_16x16x32_bf16 v[196:199], a[100:103], a[172:175], v[196:199]
    s_add_u32 s81, s81, 1
    s_cmp_eq_u32 s81, 10
    ds_read_b128 a[156:159], v64 offset:4096
    ds_read_b64_tr_b16 a[64:65], v66 offset:31744
    v_mfma_f32_16x16x32_bf16 v[136:139], a[104:107], a[164:167], v[136:139]
    s_cselect_b32 s81, 0, s81
    s_add_u32 m0, s31, 49152
    ds_read_b64_tr_b16 a[66:67], v66 offset:32768
    ds_read_b64_tr_b16 a[68:69], v66 offset:31752
    v_mfma_f32_16x16x32_bf16 v[168:171], a[104:107], a[168:171], v[168:171]
    buffer_load_dwordx4 v36, s[16:19], s38 offen offset:0 lds
    v_mfma_f32_16x16x32_bf16 v[200:203], a[104:107], a[172:175], v[200:203]
    ds_read_b64_tr_b16 a[70:71], v66 offset:32776
    ds_read_b64_tr_b16 a[72:73], v67 offset:31744
    v_mfma_f32_16x16x32_bf16 v[140:143], a[108:111], a[164:167], v[140:143]
    buffer_load_dwordx4 v37, s[16:19], s38 offen offset:1024 lds
    v_mfma_f32_16x16x32_bf16 v[172:175], a[108:111], a[168:171], v[172:175]
    ds_read_b64_tr_b16 a[74:75], v67 offset:32768
    ds_read_b64_tr_b16 a[76:77], v67 offset:31752
    v_mfma_f32_16x16x32_bf16 v[204:207], a[108:111], a[172:175], v[204:207]
    ds_read_b64_tr_b16 a[78:79], v67 offset:32776
    ds_read_b64_tr_b16 a[80:81], v68 offset:31744
    v_mfma_f32_16x16x32_bf16 v[144:147], a[112:115], a[164:167], v[144:147]
    ds_read_b64_tr_b16 a[82:83], v68 offset:32768
    ds_read_b64_tr_b16 a[84:85], v68 offset:31752
    v_mfma_f32_16x16x32_bf16 v[176:179], a[112:115], a[168:171], v[176:179]
    buffer_load_dwordx4 v38, s[16:19], s38 offen offset:2048 lds
    v_mfma_f32_16x16x32_bf16 v[208:211], a[112:115], a[172:175], v[208:211]
    ds_read_b64_tr_b16 a[86:87], v68 offset:32776
    ds_read_b64_tr_b16 a[88:89], v69 offset:31744
    v_mfma_f32_16x16x32_bf16 v[148:151], a[116:119], a[164:167], v[148:151]
    ds_read_b64_tr_b16 a[90:91], v69 offset:32768
    ds_read_b64_tr_b16 a[92:93], v69 offset:31752
    v_mfma_f32_16x16x32_bf16 v[180:183], a[116:119], a[168:171], v[180:183]
    ds_read_b64_tr_b16 a[94:95], v69 offset:32776
    ds_read_b64_tr_b16 a[96:97], v66 offset:39968
    v_mfma_f32_16x16x32_bf16 v[212:215], a[116:119], a[172:175], v[212:215]
    buffer_load_dwordx4 v39, s[16:19], s38 offen offset:3072 lds
    v_mfma_f32_16x16x32_bf16 v[152:155], a[120:123], a[164:167], v[152:155]
    ds_read_b64_tr_b16 a[98:99], v66 offset:40992
    ds_read_b64_tr_b16 a[100:101], v66 offset:39976
    v_mfma_f32_16x16x32_bf16 v[184:187], a[120:123], a[168:171], v[184:187]
    ds_read_b64_tr_b16 a[102:103], v66 offset:41000
    v_mfma_f32_16x16x32_bf16 v[216:219], a[120:123], a[172:175], v[216:219]
    v_mfma_f32_16x16x32_bf16 v[156:159], a[124:127], a[164:167], v[156:159]
    s_add_u32 m0, s31, 53248
    v_mfma_f32_16x16x32_bf16 v[188:191], a[124:127], a[168:171], v[188:191]
    buffer_load_dwordx4 v40, s[16:19], s38 offen offset:0 lds
    v_mfma_f32_16x16x32_bf16 v[220:223], a[124:127], a[172:175], v[220:223]
    s_waitcnt lgkmcnt(10)
    v_mfma_f32_16x16x32_bf16 v[128:131], a[64:67], a[148:151], v[128:131]
    ds_read_b128 a[164:167], v65 offset:0
    ds_read_b128 a[168:171], v65 offset:2048
    v_mfma_f32_16x16x32_bf16 v[160:163], a[64:67], a[152:155], v[160:163]
    ds_read_b128 a[172:175], v65 offset:4096
    ds_read_b64_tr_b16 a[104:105], v67 offset:39968
    v_mfma_f32_16x16x32_bf16 v[192:195], a[64:67], a[156:159], v[192:195]
    buffer_load_dwordx4 v41, s[16:19], s38 offen offset:1024 lds
    v_mfma_f32_16x16x32_bf16 v[132:135], a[68:71], a[148:151], v[132:135]
    ds_read_b64_tr_b16 a[106:107], v67 offset:40992
    ds_read_b64_tr_b16 a[108:109], v67 offset:39976
    v_mfma_f32_16x16x32_bf16 v[164:167], a[68:71], a[152:155], v[164:167]
    ds_read_b64_tr_b16 a[110:111], v67 offset:41000
    ds_read_b64_tr_b16 a[112:113], v68 offset:39968
    v_mfma_f32_16x16x32_bf16 v[196:199], a[68:71], a[156:159], v[196:199]
    s_add_u32 m0, s32, 80896
    ds_read_b64_tr_b16 a[114:115], v68 offset:40992
    ds_read_b64_tr_b16 a[116:117], v68 offset:39976
    v_mfma_f32_16x16x32_bf16 v[136:139], a[72:75], a[148:151], v[136:139]
    buffer_load_dwordx4 v44, s[20:23], s39 offen offset:0 lds
    v_mfma_f32_16x16x32_bf16 v[168:171], a[72:75], a[152:155], v[168:171]
    ds_read_b64_tr_b16 a[118:119], v68 offset:41000
    ds_read_b64_tr_b16 a[120:121], v69 offset:39968
    v_mfma_f32_16x16x32_bf16 v[200:203], a[72:75], a[156:159], v[200:203]
    ds_read_b64_tr_b16 a[122:123], v69 offset:40992
    ds_read_b64_tr_b16 a[124:125], v69 offset:39976
    v_mfma_f32_16x16x32_bf16 v[140:143], a[76:79], a[148:151], v[140:143]
    ds_read_b64_tr_b16 a[126:127], v69 offset:41000
    v_mfma_f32_16x16x32_bf16 v[172:175], a[76:79], a[152:155], v[172:175]
    v_mfma_f32_16x16x32_bf16 v[204:207], a[76:79], a[156:159], v[204:207]
    buffer_load_dwordx4 v45, s[20:23], s39 offen offset:1024 lds
    v_mfma_f32_16x16x32_bf16 v[144:147], a[80:83], a[148:151], v[144:147]
    v_mfma_f32_16x16x32_bf16 v[176:179], a[80:83], a[152:155], v[176:179]
    v_mfma_f32_16x16x32_bf16 v[208:211], a[80:83], a[156:159], v[208:211]
    s_waitcnt lgkmcnt(10)
    v_mfma_f32_16x16x32_bf16 v[148:151], a[84:87], a[148:151], v[148:151]
    buffer_load_dwordx4 v46, s[20:23], s39 offen offset:2056 lds
    v_mfma_f32_16x16x32_bf16 v[180:183], a[84:87], a[152:155], v[180:183]
    v_mfma_f32_16x16x32_bf16 v[212:215], a[84:87], a[156:159], v[212:215]
    v_mfma_f32_16x16x32_bf16 v[152:155], a[88:91], a[148:151], v[152:155]
    v_mfma_f32_16x16x32_bf16 v[184:187], a[88:91], a[152:155], v[184:187]
    buffer_load_dwordx4 v47, s[20:23], s39 offen offset:3080 lds
    v_mfma_f32_16x16x32_bf16 v[216:219], a[88:91], a[156:159], v[216:219]
    v_mfma_f32_16x16x32_bf16 v[156:159], a[92:95], a[148:151], v[156:159]
    v_mfma_f32_16x16x32_bf16 v[188:191], a[92:95], a[152:155], v[188:191]
    v_mfma_f32_16x16x32_bf16 v[220:223], a[92:95], a[156:159], v[220:223]
    v_mfma_f32_16x16x32_bf16 v[128:131], a[96:99], a[164:167], v[128:131]
    v_subrev_u32 v64, 98304, v64
    v_subrev_u32 v65, 98304, v65
    v_mfma_f32_16x16x32_bf16 v[160:163], a[96:99], a[168:171], v[160:163]
    v_subrev_u32 v66, 98304, v66
    v_subrev_u32 v67, 98304, v67
    v_mfma_f32_16x16x32_bf16 v[192:195], a[96:99], a[172:175], v[192:195]
    v_subrev_u32 v68, 98304, v68
    v_subrev_u32 v69, 98304, v69
    v_mfma_f32_16x16x32_bf16 v[132:135], a[100:103], a[164:167], v[132:135]
    s_waitcnt vmcnt(10) lgkmcnt(0)
    s_barrier
    v_mfma_f32_16x16x32_bf16 v[164:167], a[100:103], a[168:171], v[164:167]
    s_add_u32 s33, s80, 16384
    ds_read_b128 a[148:151], v64 offset:0
    ds_read_b128 a[152:155], v64 offset:2048
    v_mfma_f32_16x16x32_bf16 v[196:199], a[100:103], a[172:175], v[196:199]
    s_and_b32 s33, s33, 0x7ffff
    s_add_u32 m0, s29, 0
    ds_read_b128 a[156:159], v64 offset:4096
    ds_read_b64_tr_b16 a[64:65], v66 offset:31744
    v_mfma_f32_16x16x32_bf16 v[136:139], a[104:107], a[164:167], v[136:139]
    buffer_load_dwordx4 v28, s[8:11], s33 offen offset:0 nt lds
    v_mfma_f32_16x16x32_bf16 v[168:171], a[104:107], a[168:171], v[168:171]
    ds_read_b64_tr_b16 a[66:67], v66 offset:32768
    ds_read_b64_tr_b16 a[68:69], v66 offset:31752
    v_mfma_f32_16x16x32_bf16 v[200:203], a[104:107], a[172:175], v[200:203]
    ds_read_b64_tr_b16 a[70:71], v66 offset:32776
    ds_read_b64_tr_b16 a[72:73], v67 offset:31744
    v_mfma_f32_16x16x32_bf16 v[140:143], a[108:111], a[164:167], v[140:143]
    ds_read_b64_tr_b16 a[74:75], v67 offset:32768
    ds_read_b64_tr_b16 a[76:77], v67 offset:31752
    v_mfma_f32_16x16x32_bf16 v[172:175], a[108:111], a[168:171], v[172:175]
    buffer_load_dwordx4 v29, s[8:11], s33 offen offset:1024 nt lds
    v_mfma_f32_16x16x32_bf16 v[204:207], a[108:111], a[172:175], v[204:207]
    ds_read_b64_tr_b16 a[78:79], v67 offset:32776
    ds_read_b64_tr_b16 a[80:81], v68 offset:31744
    v_mfma_f32_16x16x32_bf16 v[144:147], a[112:115], a[164:167], v[144:147]
    ds_read_b64_tr_b16 a[82:83], v68 offset:32768
    ds_read_b64_tr_b16 a[84:85], v68 offset:31752
    v_mfma_f32_16x16x32_bf16 v[176:179], a[112:115], a[168:171], v[176:179]
    ds_read_b64_tr_b16 a[86:87], v68 offset:32776
    ds_read_b64_tr_b16 a[88:89], v69 offset:31744
    v_mfma_f32_16x16x32_bf16 v[208:211], a[112:115], a[172:175], v[208:211]
    ds_read_b64_tr_b16 a[90:91], v69 offset:32768
    ds_read_b64_tr_b16 a[92:93], v69 offset:31752
    v_mfma_f32_16x16x32_bf16 v[148:151], a[116:119], a[164:167], v[148:151]
    buffer_load_dwordx4 v30, s[8:11], s33 offen offset:2048 nt lds
    v_mfma_f32_16x16x32_bf16 v[180:183], a[116:119], a[168:171], v[180:183]
    ds_read_b64_tr_b16 a[94:95], v69 offset:32776
    ds_read_b64_tr_b16 a[96:97], v66 offset:39968
    v_mfma_f32_16x16x32_bf16 v[212:215], a[116:119], a[172:175], v[212:215]
    ds_read_b64_tr_b16 a[98:99], v66 offset:40992
    ds_read_b64_tr_b16 a[100:101], v66 offset:39976
    v_mfma_f32_16x16x32_bf16 v[152:155], a[120:123], a[164:167], v[152:155]
    ds_read_b64_tr_b16 a[102:103], v66 offset:41000
    v_mfma_f32_16x16x32_bf16 v[184:187], a[120:123], a[168:171], v[184:187]
    v_mfma_f32_16x16x32_bf16 v[216:219], a[120:123], a[172:175], v[216:219]
    v_mfma_f32_16x16x32_bf16 v[156:159], a[124:127], a[164:167], v[156:159]
    buffer_load_dwordx4 v31, s[8:11], s33 offen offset:3072 nt lds
    v_mfma_f32_16x16x32_bf16 v[188:191], a[124:127], a[168:171], v[188:191]
    v_mfma_f32_16x16x32_bf16 v[220:223], a[124:127], a[172:175], v[220:223]
    s_waitcnt lgkmcnt(10)
    v_mfma_f32_16x16x32_bf16 v[128:131], a[64:67], a[148:151], v[128:131]
    s_add_u32 s33, s80, 32768
    ds_read_b128 a[164:167], v65 offset:0
    ds_read_b128 a[168:171], v65 offset:2048
    v_mfma_f32_16x16x32_bf16 v[160:163], a[64:67], a[152:155], v[160:163]
    s_and_b32 s33, s33, 0x7ffff
    s_add_u32 m0, s29, 16384
    ds_read_b128 a[172:175], v65 offset:4096
    ds_read_b64_tr_b16 a[104:105], v67 offset:39968
    v_mfma_f32_16x16x32_bf16 v[192:195], a[64:67], a[156:159], v[192:195]
    buffer_load_dwordx4 v28, s[8:11], s33 offen offset:0 nt lds
    v_mfma_f32_16x16x32_bf16 v[132:135], a[68:71], a[148:151], v[132:135]
    ds_read_b64_tr_b16 a[106:107], v67 offset:40992
    ds_read_b64_tr_b16 a[108:109], v67 offset:39976
    v_mfma_f32_16x16x32_bf16 v[164:167], a[68:71], a[152:155], v[164:167]
    ds_read_b64_tr_b16 a[110:111], v67 offset:41000
    ds_read_b64_tr_b16 a[112:113], v68 offset:39968
    v_mfma_f32_16x16x32_bf16 v[196:199], a[68:71], a[156:159], v[196:199]
    ds_read_b64_tr_b16 a[114:115], v68 offset:40992
    ds_read_b64_tr_b16 a[116:117], v68 offset:39976
    v_mfma_f32_16x16x32_bf16 v[136:139], a[72:75], a[148:151], v[136:139]
    ds_read_b64_tr_b16 a[118:119], v68 offset:41000
    ds_read_b64_tr_b16 a[120:121], v69 offset:39968
    v_mfma_f32_16x16x32_bf16 v[168:171], a[72:75], a[152:155], v[168:171]
    buffer_load_dwordx4 v29, s[8:11], s33 offen offset:1024 nt lds
    v_mfma_f32_16x16x32_bf16 v[200:203], a[72:75], a[156:159], v[200:203]
    ds_read_b64_tr_b16 a[122:123], v69 offset:40992
    ds_read_b64_tr_b16 a[124:125], v69 offset:39976
    v_mfma_f32_16x16x32_bf16 v[140:143], a[76:79], a[148:151], v[140:143]
    ds_read_b64_tr_b16 a[126:127], v69 offset:41000
    ds_read_b128 a[180:183], v16 offset:49152
    v_mfma_f32_16x16x32_bf16 v[172:175], a[76:79], a[152:155], v[172:175]
    ds_read_b128 a[184:187], v17 offset:49152
    v_mfma_f32_16x16x32_bf16 v[204:207], a[76:79], a[156:159], v[204:207]
    ds_read_b128 a[188:191], v18 offset:49152
    v_mfma_f32_16x16x32_bf16 v[144:147], a[80:83], a[148:151], v[144:147]
    ds_read_b128 a[192:195], v19 offset:49152
    v_mfma_f32_16x16x32_bf16 v[176:179], a[80:83], a[152:155], v[176:179]
    buffer_load_dwordx4 v30, s[8:11], s33 offen offset:2048 nt lds
    v_mfma_f32_16x16x32_bf16 v[208:211], a[80:83], a[156:159], v[208:211]
    s_waitcnt lgkmcnt(10)
    ds_read_b128 a[196:199], v16 offset:53248
    v_mfma_f32_16x16x32_bf16 v[148:151], a[84:87], a[148:151], v[148:151]
    ds_read_b128 a[200:203], v17 offset:53248
    v_mfma_f32_16x16x32_bf16 v[180:183], a[84:87], a[152:155], v[180:183]
    ds_read_b128 a[204:207], v18 offset:53248
    v_mfma_f32_16x16x32_bf16 v[212:215], a[84:87], a[156:159], v[212:215]
    ds_read_b128 a[208:211], v19 offset:53248
    v_mfma_f32_16x16x32_bf16 v[152:155], a[88:91], a[148:151], v[152:155]
    buffer_load_dwordx4 v31, s[8:11], s33 offen offset:3072 nt lds
    v_mfma_f32_16x16x32_bf16 v[184:187], a[88:91], a[152:155], v[184:187]
    v_mfma_f32_16x16x32_bf16 v[216:219], a[88:91], a[156:159], v[216:219]
    v_mfma_f32_16x16x32_bf16 v[156:159], a[92:95], a[148:151], v[156:159]
    v_mfma_f32_16x16x32_bf16 v[188:191], a[92:95], a[152:155], v[188:191]
    v_mfma_f32_16x16x32_bf16 v[220:223], a[92:95], a[156:159], v[220:223]
    v_mfma_f32_16x16x32_bf16 v[128:131], a[96:99], a[164:167], v[128:131]
    v_add_u32 v64, 49152, v64
    v_add_u32 v65, 49152, v65
    v_mfma_f32_16x16x32_bf16 v[160:163], a[96:99], a[168:171], v[160:163]
    v_add_u32 v66, 49152, v66
    v_add_u32 v67, 49152, v67
    v_mfma_f32_16x16x32_bf16 v[192:195], a[96:99], a[172:175], v[192:195]
    v_add_u32 v68, 49152, v68
    v_add_u32 v69, 49152, v69
    v_mfma_f32_16x16x32_bf16 v[132:135], a[100:103], a[164:167], v[132:135]
    s_waitcnt vmcnt(8) lgkmcnt(0)
    s_barrier
    v_mfma_f32_16x16x32_bf16 v[164:167], a[100:103], a[168:171], v[164:167]
    s_add_u32 s34, s80, 0
    ds_read_b128 a[148:151], v64 offset:0
    ds_read_b128 a[152:155], v64 offset:2048
    v_mfma_f32_16x16x32_bf16 v[196:199], a[100:103], a[172:175], v[196:199]
    s_and_b32 s34, s34, 0x7ffff
    s_add_u32 m0, s30, 0
    ds_read_b128 a[156:159], v64 offset:4096
    ds_read_b64_tr_b16 a[64:65], v66 offset:31744
    v_lshlrev_b32 v8, 1, v4
    v_mfma_f32_16x16x32_bf16 v[136:139], a[104:107], a[164:167], v[136:139]
    buffer_load_dwordx4 v32, s[12:15], s34 offen offset:0 nt lds
    v_mfma_f32_16x16x32_bf16 v[168:171], a[104:107], a[168:171], v[168:171]
    ds_read_b64_tr_b16 a[66:67], v66 offset:32768
    ds_read_b64_tr_b16 a[68:69], v66 offset:31752
    v_xor_b32 v8, v8, v7
    v_mfma_f32_16x16x32_bf16 v[200:203], a[104:107], a[172:175], v[200:203]
    ds_read_b64_tr_b16 a[70:71], v66 offset:32776
    ds_read_b64_tr_b16 a[72:73], v67 offset:31744
    v_mul_u32_u24 v9, 1280, v6
    v_mfma_f32_16x16x32_bf16 v[140:143], a[108:111], a[164:167], v[140:143]
    buffer_load_dwordx4 v33, s[12:15], s34 offen offset:1024 nt lds
    v_mfma_f32_16x16x32_bf16 v[172:175], a[108:111], a[168:171], v[172:175]
    ds_read_b64_tr_b16 a[74:75], v67 offset:32768
    ds_read_b64_tr_b16 a[76:77], v67 offset:31752
    v_lshl_add_u32 v8, v8, 4, v9
    v_mfma_f32_16x16x32_bf16 v[204:207], a[108:111], a[172:175], v[204:207]
    ds_read_b64_tr_b16 a[78:79], v67 offset:32776
    ds_read_b64_tr_b16 a[80:81], v68 offset:31744
    v_add_u32 v36, 0, v8
    v_mfma_f32_16x16x32_bf16 v[144:147], a[112:115], a[164:167], v[144:147]
    ds_read_b64_tr_b16 a[82:83], v68 offset:32768
    ds_read_b64_tr_b16 a[84:85], v68 offset:31752
    v_add_u32 v37, 9216, v8
    v_mfma_f32_16x16x32_bf16 v[176:179], a[112:115], a[168:171], v[176:179]
    ds_read_b64_tr_b16 a[86:87], v68 offset:32776
    ds_read_b64_tr_b16 a[88:89], v69 offset:31744
    v_add_u32 v38, 18432, v8
    v_mfma_f32_16x16x32_bf16 v[208:211], a[112:115], a[172:175], v[208:211]
    buffer_load_dwordx4 v34, s[12:15], s34 offen offset:2048 nt lds
    v_mfma_f32_16x16x32_bf16 v[148:151], a[116:119], a[164:167], v[148:151]
    ds_read_b64_tr_b16 a[90:91], v69 offset:32768
    ds_read_b64_tr_b16 a[92:93], v69 offset:31752
    v_add_u32 v39, 27648, v8
    v_mfma_f32_16x16x32_bf16 v[180:183], a[116:119], a[168:171], v[180:183]
    ds_read_b64_tr_b16 a[94:95], v69 offset:32776
    ds_read_b64_tr_b16 a[96:97], v66 offset:39968
    v_lshrrev_b32 v12, 2, v3
    v_mfma_f32_16x16x32_bf16 v[212:215], a[116:119], a[172:175], v[212:215]
    ds_read_b64_tr_b16 a[98:99], v66 offset:40992
    ds_read_b64_tr_b16 a[100:101], v66 offset:39976
    v_lshlrev_b32 v12, 7, v12
    v_mfma_f32_16x16x32_bf16 v[152:155], a[120:123], a[164:167], v[152:155]
    ds_read_b64_tr_b16 a[102:103], v66 offset:41000
    v_and_b32 v15, 3, v3
    v_mfma_f32_16x16x32_bf16 v[184:187], a[120:123], a[168:171], v[184:187]
    buffer_load_dwordx4 v35, s[12:15], s34 offen offset:3072 nt lds
    v_mfma_f32_16x16x32_bf16 v[216:219], a[120:123], a[172:175], v[216:219]
    v_lshl_add_u32 v12, v15, 3, v12
    v_mfma_f32_16x16x32_bf16 v[156:159], a[124:127], a[164:167], v[156:159]
    v_add_u32 v12, s30, v12
    v_mfma_f32_16x16x32_bf16 v[188:191], a[124:127], a[168:171], v[188:191]
    s_add_u32 s34, s80, 16384
    v_bfe_u32 v15, v3, 3, 2
    v_mfma_f32_16x16x32_bf16 v[220:223], a[124:127], a[172:175], v[220:223]
    s_waitcnt lgkmcnt(10)
    s_and_b32 s34, s34, 0x7ffff
    s_add_u32 m0, s30, 16384
    v_xor_b32 v40, 0, v15
    v_mfma_f32_16x16x32_bf16 v[128:131], a[64:67], a[148:151], v[128:131]
    s_mov_b32 s81, s5
    buffer_load_dwordx4 v32, s[12:15], s34 offen offset:0 nt lds
    v_mfma_f32_16x16x32_bf16 v[160:163], a[64:67], a[152:155], v[160:163]
    s_lshr_b32 s4, s2, 3
    ds_read_b128 a[164:167], v65 offset:0
    ds_read_b128 a[168:171], v65 offset:2048
    v_lshl_add_u32 v40, v40, 5, v12
    v_mfma_f32_16x16x32_bf16 v[192:195], a[64:67], a[156:159], v[192:195]
    s_mul_i32 s4, s4, 52
    ds_read_b128 a[172:175], v65 offset:4096
    ds_read_b64_tr_b16 a[104:105], v67 offset:39968
    v_add_u32 v44, 0x10000, v40
    v_mfma_f32_16x16x32_bf16 v[132:135], a[68:71], a[148:151], v[132:135]
    s_lshr_b32 s4, s4, 8
    ds_read_b64_tr_b16 a[106:107], v67 offset:40992
    ds_read_b64_tr_b16 a[108:109], v67 offset:39976
    v_add_u32 v8, 0x20000, v40
    v_mfma_f32_16x16x32_bf16 v[164:167], a[68:71], a[152:155], v[164:167]
    s_lshl_b32 s38, s4, 1
    ds_read_b64_tr_b16 a[110:111], v67 offset:41000
    ds_read_b64_tr_b16 a[112:113], v68 offset:39968
    v_xor_b32 v41, 1, v15
    v_mfma_f32_16x16x32_bf16 v[196:199], a[68:71], a[156:159], v[196:199]
    s_add_u32 s38, s38, s82
    buffer_load_dwordx4 v33, s[12:15], s34 offen offset:1024 nt lds
    v_mfma_f32_16x16x32_bf16 v[136:139], a[72:75], a[148:151], v[136:139]
    s_add_u32 s6, s38, 14
    ds_read_b64_tr_b16 a[114:115], v68 offset:40992
    ds_read_b64_tr_b16 a[116:117], v68 offset:39976
    v_lshl_add_u32 v41, v41, 5, v12
    v_mfma_f32_16x16x32_bf16 v[168:171], a[72:75], a[152:155], v[168:171]
    s_and_b32 s6, s6, 31
    ds_read_b64_tr_b16 a[118:119], v68 offset:41000
    ds_read_b64_tr_b16 a[120:121], v69 offset:39968
    v_add_u32 v45, 0x10000, v41
    v_mfma_f32_16x16x32_bf16 v[200:203], a[72:75], a[156:159], v[200:203]
    s_mul_i32 s6, s6, 40960
    ds_read_b64_tr_b16 a[122:123], v69 offset:40992
    ds_read_b64_tr_b16 a[124:125], v69 offset:39976
    v_add_u32 v9, 0x20000, v41
    v_mfma_f32_16x16x32_bf16 v[140:143], a[76:79], a[148:151], v[140:143]
    s_add_u32 s7, s38, 26
    ds_read_b64_tr_b16 a[126:127], v69 offset:41000
    v_xor_b32 v42, 2, v15
    v_mfma_f32_16x16x32_bf16 v[172:175], a[76:79], a[152:155], v[172:175]
    s_and_b32 s7, s7, 31
    buffer_load_dwordx4 v34, s[12:15], s34 offen offset:2048 nt lds
    v_mfma_f32_16x16x32_bf16 v[204:207], a[76:79], a[156:159], v[204:207]
    s_mul_i32 s7, s7, 40960
    v_lshl_add_u32 v42, v42, 5, v12
    v_mfma_f32_16x16x32_bf16 v[144:147], a[80:83], a[148:151], v[144:147]
    s_cmp_ge_u32 s4, 3
    s_cselect_b32 s7, 0x7f000000, s7
    v_add_u32 v46, 0x10000, v42
    v_mfma_f32_16x16x32_bf16 v[176:179], a[80:83], a[152:155], v[176:179]
    s_mul_i32 s38, s2, 20480
    v_add_u32 v10, 0x20000, v42
    v_mfma_f32_16x16x32_bf16 v[208:211], a[80:83], a[156:159], v[208:211]
    s_waitcnt lgkmcnt(10)
    s_add_u32 s16, s92, s38
    s_addc_u32 s17, s93, 0
    v_xor_b32 v43, 3, v15
    v_mfma_f32_16x16x32_bf16 v[148:151], a[84:87], a[148:151], v[148:151]
    s_mov_b32 s18, 20480
    buffer_load_dwordx4 v35, s[12:15], s34 offen offset:3072 nt lds
    v_mfma_f32_16x16x32_bf16 v[180:183], a[84:87], a[152:155], v[180:183]
    s_mov_b32 s39, 0x3e0293ee
    v_lshl_add_u32 v43, v43, 5, v12
    v_mfma_f32_16x16x32_bf16 v[212:215], a[84:87], a[156:159], v[212:215]
    s_mov_b32 s32, 0x07060302
    v_add_u32 v47, 0x10000, v43
    v_mfma_f32_16x16x32_bf16 v[152:155], a[88:91], a[148:151], v[152:155]
    v_add_u32 v11, 0x20000, v43
    v_mfma_f32_16x16x32_bf16 v[184:187], a[88:91], a[152:155], v[184:187]
    v_mul_u32_u24 v14, 1280, v3
    v_mfma_f32_16x16x32_bf16 v[216:219], a[88:91], a[156:159], v[216:219]
    v_accvgpr_write_b32 a128, 0
    v_mfma_f32_16x16x32_bf16 v[156:159], a[92:95], a[148:151], v[156:159]
    v_accvgpr_write_b32 a129, 0
    v_mfma_f32_16x16x32_bf16 v[188:191], a[92:95], a[152:155], v[188:191]
    v_accvgpr_write_b32 a130, 0
    v_mfma_f32_16x16x32_bf16 v[220:223], a[92:95], a[156:159], v[220:223]
    v_accvgpr_write_b32 a131, 0
    v_accvgpr_write_b32 a132, 0
    v_accvgpr_write_b32 a133, 0
    v_accvgpr_write_b32 a134, 0
    v_accvgpr_write_b32 a135, 0
    v_accvgpr_write_b32 a136, 0
    v_accvgpr_write_b32 a137, 0
    v_accvgpr_write_b32 a138, 0
    v_accvgpr_write_b32 a139, 0
    v_accvgpr_write_b32 a140, 0
    v_accvgpr_write_b32 a141, 0
    v_accvgpr_write_b32 a142, 0
    v_accvgpr_write_b32 a143, 0
    s_waitcnt lgkmcnt(0)
    v_mfma_f32_16x16x32_bf16 v[128:131], a[96:99], a[164:167], v[128:131]
    ds_read_b128 a[64:67], v16 offset:57344
    v_mfma_f32_16x16x32_bf16 v[132:135], a[100:103], a[164:167], v[132:135]
    ds_read_b128 a[68:71], v17 offset:57344
    v_mfma_f32_16x16x32_bf16 v[136:139], a[104:107], a[164:167], v[136:139]
    ds_read_b128 a[72:75], v18 offset:57344
    v_mfma_f32_16x16x32_bf16 v[140:143], a[108:111], a[164:167], v[140:143]
    ds_read_b128 a[76:79], v19 offset:57344
    v_mfma_f32_16x16x32_bf16 v[144:147], a[112:115], a[164:167], v[144:147]
    ds_read_b128 a[80:83], v16 offset:61440
    v_mfma_f32_16x16x32_bf16 v[148:151], a[116:119], a[164:167], v[148:151]
    ds_read_b128 a[84:87], v17 offset:61440
    v_mfma_f32_16x16x32_bf16 v[152:155], a[120:123], a[164:167], v[152:155]
    ds_read_b128 a[88:91], v18 offset:61440
    v_mfma_f32_16x16x32_bf16 v[156:159], a[124:127], a[164:167], v[156:159]
    ds_read_b128 a[92:95], v19 offset:61440
    v_mfma_f32_16x16x32_bf16 v[160:163], a[96:99], a[168:171], v[160:163]
    v_mul_f32 v128, s39, v128
    v_mul_f32 v129, s39, v129
    v_mfma_f32_16x16x32_bf16 v[164:167], a[100:103], a[168:171], v[164:167]
    v_mul_f32 v130, s39, v130
    v_mul_f32 v131, s39, v131
    v_mfma_f32_16x16x32_bf16 v[168:171], a[104:107], a[168:171], v[168:171]
    v_mul_f32 v132, s39, v132
    v_mul_f32 v133, s39, v133
    v_mfma_f32_16x16x32_bf16 v[172:175], a[108:111], a[168:171], v[172:175]
    v_mul_f32 v134, s39, v134
    v_mul_f32 v135, s39, v135
    v_mfma_f32_16x16x32_bf16 v[176:179], a[112:115], a[168:171], v[176:179]
    v_cvt_pk_bf16_f32 v128, v128, v129
    v_cvt_pk_bf16_f32 v129, v130, v131
    v_mfma_f32_16x16x32_bf16 v[180:183], a[116:119], a[168:171], v[180:183]
    v_cvt_pk_bf16_f32 v130, v132, v133
    v_cvt_pk_bf16_f32 v131, v134, v135
    v_mfma_f32_16x16x32_bf16 v[184:187], a[120:123], a[168:171], v[184:187]
    v_accvgpr_write_b32 a0, v128
    v_accvgpr_write_b32 a1, v129
    v_mfma_f32_16x16x32_bf16 v[188:191], a[124:127], a[168:171], v[188:191]
    v_accvgpr_write_b32 a2, v130
    v_accvgpr_write_b32 a3, v131
    v_mfma_f32_16x16x32_bf16 v[192:195], a[96:99], a[172:175], v[192:195]
    v_mul_f32 v136, s39, v136
    v_mul_f32 v137, s39, v137
    v_mfma_f32_16x16x32_bf16 v[196:199], a[100:103], a[172:175], v[196:199]
    v_mul_f32 v138, s39, v138
    v_mul_f32 v139, s39, v139
    v_mfma_f32_16x16x32_bf16 v[200:203], a[104:107], a[172:175], v[200:203]
    v_mul_f32 v140, s39, v140
    v_mul_f32 v141, s39, v141
    v_mfma_f32_16x16x32_bf16 v[204:207], a[108:111], a[172:175], v[204:207]
    v_mul_f32 v142, s39, v142
    v_mul_f32 v143, s39, v143
    v_mfma_f32_16x16x32_bf16 v[208:211], a[112:115], a[172:175], v[208:211]
    v_cvt_pk_bf16_f32 v136, v136, v137
    v_cvt_pk_bf16_f32 v137, v138, v139
    v_mfma_f32_16x16x32_bf16 v[212:215], a[116:119], a[172:175], v[212:215]
    v_cvt_pk_bf16_f32 v138, v140, v141
    v_cvt_pk_bf16_f32 v139, v142, v143
    v_mfma_f32_16x16x32_bf16 v[216:219], a[120:123], a[172:175], v[216:219]
    v_accvgpr_write_b32 a4, v136
    v_accvgpr_write_b32 a5, v137
    v_mfma_f32_16x16x32_bf16 v[220:223], a[124:127], a[172:175], v[220:223]
    v_accvgpr_write_b32 a6, v138
    v_accvgpr_write_b32 a7, v139
    v_mul_f32 v144, s39, v144
    v_mul_f32 v145, s39, v145
    v_mul_f32 v146, s39, v146
    v_mul_f32 v147, s39, v147
    v_mul_f32 v148, s39, v148
    v_mul_f32 v149, s39, v149
    v_mul_f32 v150, s39, v150
    v_mul_f32 v151, s39, v151
    v_cvt_pk_bf16_f32 v144, v144, v145
    v_cvt_pk_bf16_f32 v145, v146, v147
    v_cvt_pk_bf16_f32 v146, v148, v149
    v_cvt_pk_bf16_f32 v147, v150, v151
    v_accvgpr_write_b32 a8, v144
    v_accvgpr_write_b32 a9, v145
    v_accvgpr_write_b32 a10, v146
    v_accvgpr_write_b32 a11, v147
    v_mul_f32 v152, s39, v152
    v_mul_f32 v153, s39, v153
    v_mul_f32 v154, s39, v154
    v_mul_f32 v155, s39, v155
    v_mul_f32 v156, s39, v156
    v_mul_f32 v157, s39, v157
    v_mul_f32 v158, s39, v158
    v_mul_f32 v159, s39, v159
    v_cvt_pk_bf16_f32 v152, v152, v153
    v_cvt_pk_bf16_f32 v153, v154, v155
    v_cvt_pk_bf16_f32 v154, v156, v157
    v_cvt_pk_bf16_f32 v155, v158, v159
    v_accvgpr_write_b32 a12, v152
    v_accvgpr_write_b32 a13, v153
    v_accvgpr_write_b32 a14, v154
    v_accvgpr_write_b32 a15, v155
    v_mul_f32 v160, s39, v160
    v_mul_f32 v161, s39, v161
    v_mfma_f32_16x16x32_bf16 v[64:67], a[180:183], a[0:3], 0
    v_mul_f32 v162, s39, v162
    v_mul_f32 v163, s39, v163
    v_mfma_f32_16x16x32_bf16 v[64:67], a[184:187], a[4:7], v[64:67]
    v_mul_f32 v164, s39, v164
    v_mul_f32 v165, s39, v165
    v_mfma_f32_16x16x32_bf16 v[64:67], a[188:191], a[8:11], v[64:67]
    v_mul_f32 v166, s39, v166
    v_mul_f32 v167, s39, v167
    v_mfma_f32_16x16x32_bf16 v[64:67], a[192:195], a[12:15], v[64:67]
    v_cvt_pk_bf16_f32 v160, v160, v161
    v_cvt_pk_bf16_f32 v161, v162, v163
    v_mfma_f32_16x16x32_bf16 v[68:71], a[196:199], a[0:3], 0
    v_cvt_pk_bf16_f32 v162, v164, v165
    v_cvt_pk_bf16_f32 v163, v166, v167
    v_mfma_f32_16x16x32_bf16 v[68:71], a[200:203], a[4:7], v[68:71]
    v_accvgpr_write_b32 a16, v160
    v_accvgpr_write_b32 a17, v161
    v_mfma_f32_16x16x32_bf16 v[68:71], a[204:207], a[8:11], v[68:71]
    v_accvgpr_write_b32 a18, v162
    v_accvgpr_write_b32 a19, v163
    v_mfma_f32_16x16x32_bf16 v[68:71], a[208:211], a[12:15], v[68:71]
    v_mul_f32 v168, s39, v168
    v_mul_f32 v169, s39, v169
    v_mfma_f32_32x32x16_bf16 v[128:143], a[128:131], a[128:131], 0
    v_mul_f32 v170, s39, v170
    v_mul_f32 v171, s39, v171
    v_mfma_f32_32x32x16_bf16 v[144:159], a[128:131], a[128:131], 0
    v_mul_f32 v172, s39, v172
    v_mul_f32 v173, s39, v173
    v_mul_f32 v174, s39, v174
    v_mul_f32 v175, s39, v175
    v_cvt_pk_bf16_f32 v168, v168, v169
    v_cvt_pk_bf16_f32 v169, v170, v171
    v_cvt_pk_bf16_f32 v170, v172, v173
    v_cvt_pk_bf16_f32 v171, v174, v175
    v_accvgpr_write_b32 a20, v168
    v_accvgpr_write_b32 a21, v169
    v_accvgpr_write_b32 a22, v170
    v_accvgpr_write_b32 a23, v171
    v_mul_f32 v176, s39, v176
    v_mul_f32 v177, s39, v177
    v_mul_f32 v178, s39, v178
    v_mul_f32 v179, s39, v179
    v_mul_f32 v180, s39, v180
    v_mul_f32 v181, s39, v181
    v_mul_f32 v182, s39, v182
    v_mul_f32 v183, s39, v183
    v_cvt_pk_bf16_f32 v176, v176, v177
    v_cvt_pk_bf16_f32 v177, v178, v179
    v_cvt_pk_bf16_f32 v178, v180, v181
    v_cvt_pk_bf16_f32 v179, v182, v183
    v_accvgpr_write_b32 a24, v176
    v_accvgpr_write_b32 a25, v177
    v_accvgpr_write_b32 a26, v178
    v_accvgpr_write_b32 a27, v179
    v_mul_f32 v184, s39, v184
    v_mul_f32 v185, s39, v185
    v_mul_f32 v186, s39, v186
    v_mul_f32 v187, s39, v187
    v_mul_f32 v188, s39, v188
    v_mul_f32 v189, s39, v189
    v_mul_f32 v190, s39, v190
    v_mul_f32 v191, s39, v191
    v_cvt_pk_bf16_f32 v184, v184, v185
    v_cvt_pk_bf16_f32 v185, v186, v187
    v_cvt_pk_bf16_f32 v186, v188, v189
    v_cvt_pk_bf16_f32 v187, v190, v191
    v_accvgpr_write_b32 a28, v184
    v_accvgpr_write_b32 a29, v185
    v_accvgpr_write_b32 a30, v186
    v_accvgpr_write_b32 a31, v187
    s_add_u32 s33, s80, 49152
    s_and_b32 s33, s33, 0x7ffff
    v_mfma_f32_16x16x32_bf16 v[72:75], a[180:183], a[16:19], 0
    s_add_u32 m0, s29, 32768
    s_nop 0
    buffer_load_dwordx4 v28, s[8:11], s33 offen offset:0 nt lds
    v_mfma_f32_16x16x32_bf16 v[72:75], a[184:187], a[20:23], v[72:75]
    buffer_load_dwordx4 v29, s[8:11], s33 offen offset:1024 nt lds
    v_mfma_f32_16x16x32_bf16 v[72:75], a[188:191], a[24:27], v[72:75]
    buffer_load_dwordx4 v30, s[8:11], s33 offen offset:2048 nt lds
    v_mfma_f32_16x16x32_bf16 v[72:75], a[192:195], a[28:31], v[72:75]
    buffer_load_dwordx4 v31, s[8:11], s33 offen offset:3072 nt lds
    v_mfma_f32_16x16x32_bf16 v[76:79], a[196:199], a[16:19], 0
    s_waitcnt lgkmcnt(0)
    v_mul_f32 v192, s39, v192
    v_mfma_f32_16x16x32_bf16 v[76:79], a[200:203], a[20:23], v[76:79]
    v_mul_f32 v193, s39, v193
    v_mul_f32 v194, s39, v194
    v_mfma_f32_16x16x32_bf16 v[76:79], a[204:207], a[24:27], v[76:79]
    v_mul_f32 v195, s39, v195
    v_mul_f32 v196, s39, v196
    v_mfma_f32_16x16x32_bf16 v[76:79], a[208:211], a[28:31], v[76:79]
    v_mul_f32 v197, s39, v197
    v_mul_f32 v198, s39, v198
    v_mfma_f32_32x32x16_bf16 v[160:175], a[128:131], a[128:131], 0
    v_mul_f32 v199, s39, v199
    v_cvt_pk_bf16_f32 v192, v192, v193
    v_mfma_f32_32x32x16_bf16 v[176:191], a[128:131], a[128:131], 0
    v_cvt_pk_bf16_f32 v193, v194, v195
    v_cvt_pk_bf16_f32 v194, v196, v197
    v_cvt_pk_bf16_f32 v195, v198, v199
    v_accvgpr_write_b32 a32, v192
    v_accvgpr_write_b32 a33, v193
    v_accvgpr_write_b32 a34, v194
    v_accvgpr_write_b32 a35, v195
    v_mul_f32 v200, s39, v200
    v_mul_f32 v201, s39, v201
    v_mul_f32 v202, s39, v202
    v_mul_f32 v203, s39, v203
    v_mul_f32 v204, s39, v204
    v_mul_f32 v205, s39, v205
    v_mul_f32 v206, s39, v206
    v_mul_f32 v207, s39, v207
    v_cvt_pk_bf16_f32 v200, v200, v201
    v_cvt_pk_bf16_f32 v201, v202, v203
    v_cvt_pk_bf16_f32 v202, v204, v205
    v_cvt_pk_bf16_f32 v203, v206, v207
    v_accvgpr_write_b32 a36, v200
    v_accvgpr_write_b32 a37, v201
    v_accvgpr_write_b32 a38, v202
    v_accvgpr_write_b32 a39, v203
    v_mul_f32 v208, s39, v208
    v_mul_f32 v209, s39, v209
    v_mul_f32 v210, s39, v210
    v_mul_f32 v211, s39, v211
    v_mul_f32 v212, s39, v212
    v_mul_f32 v213, s39, v213
    v_mul_f32 v214, s39, v214
    v_mul_f32 v215, s39, v215
    v_cvt_pk_bf16_f32 v208, v208, v209
    v_cvt_pk_bf16_f32 v209, v210, v211
    v_cvt_pk_bf16_f32 v210, v212, v213
    v_cvt_pk_bf16_f32 v211, v214, v215
    v_accvgpr_write_b32 a40, v208
    v_accvgpr_write_b32 a41, v209
    v_accvgpr_write_b32 a42, v210
    v_accvgpr_write_b32 a43, v211
    v_mul_f32 v216, s39, v216
    v_mul_f32 v217, s39, v217
    v_mul_f32 v218, s39, v218
    v_mul_f32 v219, s39, v219
    v_mul_f32 v220, s39, v220
    v_mul_f32 v221, s39, v221
    v_mul_f32 v222, s39, v222
    v_mul_f32 v223, s39, v223
    v_cvt_pk_bf16_f32 v216, v216, v217
    v_cvt_pk_bf16_f32 v217, v218, v219
    v_cvt_pk_bf16_f32 v218, v220, v221
    v_cvt_pk_bf16_f32 v219, v222, v223
    v_accvgpr_write_b32 a44, v216
    v_accvgpr_write_b32 a45, v217
    v_accvgpr_write_b32 a46, v218
    v_accvgpr_write_b32 a47, v219
    v_max3_f32 v48, v64, v65, v66
    v_max3_f32 v49, v67, v68, v69
    v_max3_f32 v48, v48, v70, v71
    v_mfma_f32_16x16x32_bf16 v[80:83], a[180:183], a[32:35], 0
    v_max_f32 v48, v48, v49
    v_max3_f32 v52, v72, v73, v74
    v_mfma_f32_16x16x32_bf16 v[80:83], a[184:187], a[36:39], v[80:83]
    v_max3_f32 v53, v75, v76, v77
    v_max3_f32 v52, v52, v78, v79
    v_mfma_f32_16x16x32_bf16 v[80:83], a[188:191], a[40:43], v[80:83]
    v_max_f32 v52, v52, v53
    v_mov_b32 v49, v48
    v_mfma_f32_16x16x32_bf16 v[80:83], a[192:195], a[44:47], v[80:83]
    v_mov_b32 v53, v52
    v_permlane32_swap_b32 v48, v49
    v_mfma_f32_16x16x32_bf16 v[84:87], a[196:199], a[32:35], 0
    v_permlane32_swap_b32 v52, v53
    v_max_f32 v48, v48, v49
    v_mfma_f32_16x16x32_bf16 v[84:87], a[200:203], a[36:39], v[84:87]
    v_max_f32 v52, v52, v53
    v_mov_b32 v49, v48
    v_mfma_f32_16x16x32_bf16 v[84:87], a[204:207], a[40:43], v[84:87]
    v_mov_b32 v53, v52
    v_permlane16_swap_b32 v48, v49
    v_mfma_f32_16x16x32_bf16 v[84:87], a[208:211], a[44:47], v[84:87]
    v_permlane16_swap_b32 v52, v53
    v_max_f32 v48, v48, v49
    v_mfma_f32_32x32x16_bf16 v[192:207], a[128:131], a[128:131], 0
    v_max_f32 v52, v52, v53
    v_sub_f32 v48, 0, v48
    v_mfma_f32_32x32x16_bf16 v[208:223], a[128:131], a[128:131], 0
    v_mov_b32 v49, v48
    v_mov_b32 v50, v48
    v_mov_b32 v51, v48
    v_add_f32 v64, v64, v48
    v_add_f32 v65, v65, v48
    v_add_f32 v66, v66, v48
    v_mfma_f32_16x16x32_bf16 v[96:99], a[64:67], a[0:3], v[48:51]
    v_add_f32 v67, v67, v48
    v_add_f32 v68, v68, v48
    v_mfma_f32_16x16x32_bf16 v[96:99], a[68:71], a[4:7], v[96:99]
    v_add_f32 v69, v69, v48
    v_add_f32 v70, v70, v48
    v_mfma_f32_16x16x32_bf16 v[96:99], a[72:75], a[8:11], v[96:99]
    v_add_f32 v71, v71, v48
    v_sub_f32 v52, 0, v52
    v_mfma_f32_16x16x32_bf16 v[96:99], a[76:79], a[12:15], v[96:99]
    v_mov_b32 v53, v52
    v_mov_b32 v54, v52
    v_mov_b32 v55, v52
    v_add_f32 v72, v72, v52
    v_add_f32 v73, v73, v52
    v_add_f32 v74, v74, v52
    v_mfma_f32_16x16x32_bf16 v[104:107], a[64:67], a[16:19], v[52:55]
    v_add_f32 v75, v75, v52
    v_add_f32 v76, v76, v52
    v_mfma_f32_16x16x32_bf16 v[104:107], a[68:71], a[20:23], v[104:107]
    v_add_f32 v77, v77, v52
    v_add_f32 v78, v78, v52
    v_mfma_f32_16x16x32_bf16 v[104:107], a[72:75], a[24:27], v[104:107]
    v_add_f32 v79, v79, v52
    v_lshlrev_b32 v12, 7, v0
    v_mfma_f32_16x16x32_bf16 v[104:107], a[76:79], a[28:31], v[104:107]
    buffer_load_dword v12, v12, s[16:19], 0 offen
    s_add_u32 s34, s80, 32768
    s_and_b32 s34, s34, 0x7ffff
    s_add_u32 m0, s30, 32768
    s_nop 0
    buffer_load_dwordx4 v32, s[12:15], s34 offen offset:0 nt lds
    buffer_load_dwordx4 v33, s[12:15], s34 offen offset:1024 nt lds
    buffer_load_dwordx4 v34, s[12:15], s34 offen offset:2048 nt lds
    buffer_load_dwordx4 v35, s[12:15], s34 offen offset:3072 nt lds
    v_exp_f32 v64, v64
    v_exp_f32 v65, v65
    v_exp_f32 v66, v66
    v_exp_f32 v67, v67
    v_exp_f32 v72, v72
    v_exp_f32 v73, v73
    v_exp_f32 v74, v74
    v_exp_f32 v75, v75
    v_exp_f32 v68, v68
    v_exp_f32 v69, v69
    v_exp_f32 v70, v70
    v_exp_f32 v71, v71
    v_exp_f32 v76, v76
    v_exp_f32 v77, v77
    v_exp_f32 v78, v78
    v_exp_f32 v79, v79
    v_cvt_pk_bf16_f32 v64, v64, v65
    v_cvt_pk_bf16_f32 v65, v66, v67
    v_cvt_pk_bf16_f32 v72, v72, v73
    v_cvt_pk_bf16_f32 v73, v74, v75
    v_cvt_pk_bf16_f32 v66, v68, v69
    v_cvt_pk_bf16_f32 v67, v70, v71
    v_cvt_pk_bf16_f32 v74, v76, v77
    v_cvt_pk_bf16_f32 v75, v78, v79
    v_max3_f32 v56, v80, v81, v82
    v_max3_f32 v57, v83, v84, v85
    v_max3_f32 v56, v56, v86, v87
    v_max_f32 v56, v56, v57
    v_mov_b32 v57, v56
    s_nop 0
    s_nop 0
    v_permlane32_swap_b32 v56, v57
    s_nop 0
    s_nop 0
    v_max_f32 v56, v56, v57
    v_mov_b32 v57, v56
    s_nop 0
    s_nop 0
    v_permlane16_swap_b32 v56, v57
    s_nop 0
    s_nop 0
    v_max_f32 v56, v56, v57
    v_sub_f32 v56, 0, v56
    v_mov_b32 v57, v56
    v_mov_b32 v58, v56
    v_mov_b32 v59, v56
    v_add_f32 v80, v80, v56
    v_add_f32 v81, v81, v56
    v_add_f32 v82, v82, v56
    v_mfma_f32_16x16x32_bf16 v[112:115], a[64:67], a[32:35], v[56:59]
    v_add_f32 v83, v83, v56
    v_add_f32 v84, v84, v56
    v_mfma_f32_16x16x32_bf16 v[112:115], a[68:71], a[36:39], v[112:115]
    v_add_f32 v85, v85, v56
    v_add_f32 v86, v86, v56
    v_mfma_f32_16x16x32_bf16 v[112:115], a[72:75], a[40:43], v[112:115]
    v_add_f32 v87, v87, v56
    v_exp_f32 v80, v80
    v_mfma_f32_16x16x32_bf16 v[112:115], a[76:79], a[44:47], v[112:115]
    v_exp_f32 v81, v81
    v_exp_f32 v82, v82
    v_exp_f32 v83, v83
    v_cvt_pk_bf16_f32 v80, v80, v81
    v_cvt_pk_bf16_f32 v81, v82, v83
    s_mov_b32 s35, 7
    v_subrev_u32 v28, 12288, v28
    v_subrev_u32 v29, 12288, v29
    v_subrev_u32 v30, 12288, v30
    v_subrev_u32 v31, 12288, v31
    v_subrev_u32 v32, 12288, v32
    v_subrev_u32 v33, 12288, v33
    v_subrev_u32 v34, 12288, v34
    v_subrev_u32 v35, 12288, v35
    s_waitcnt vmcnt(9)
    s_barrier
    .p2align 6
L_loopB:
    v_mfma_f32_16x16x32_bf16 v[100:103], a[80:83], a[0:3], v[48:51]
    ds_read_b64_tr_b16 a[96:97], v20 offset:0
    v_mfma_f32_16x16x32_bf16 v[100:103], a[84:87], a[4:7], v[100:103]
    ds_read_b64_tr_b16 a[98:99], v20 offset:4096
    v_mfma_f32_16x16x32_bf16 v[100:103], a[88:91], a[8:11], v[100:103]
    v_exp_f32 v84, v84
    v_mfma_f32_16x16x32_bf16 v[100:103], a[92:95], a[12:15], v[100:103]
    s_add_u32 s34, s34, 16384
    s_and_b32 s34, s34, 0x7ffff
    ds_read_b64_tr_b16 a[100:101], v21 offset:0
    v_exp_f32 v85, v85
    v_mfma_f32_16x16x32_bf16 v[108:111], a[92:95], a[28:31], v[52:55]
    s_add_u32 s4, s34, 0
    s_mov_b32 m0, 49152
    ds_read_b64_tr_b16 a[102:103], v21 offset:4096
    v_cvt_pk_bf16_f32 v82, v84, v85
    v_mfma_f32_16x16x32_bf16 v[108:111], a[88:91], a[24:27], v[108:111]
    buffer_load_dwordx4 v32, s[12:15], s4 offen offset:0 nt lds
    v_exp_f32 v86, v86
    v_mfma_f32_16x16x32_bf16 v[108:111], a[84:87], a[20:23], v[108:111]
    ds_read_b64_tr_b16 a[104:105], v22 offset:0
    v_mfma_f32_16x16x32_bf16 v[108:111], a[80:83], a[16:19], v[108:111]
    ds_read_b64_tr_b16 a[106:107], v22 offset:4096
    v_exp_f32 v87, v87
    v_mfma_f32_16x16x32_bf16 v[116:119], a[80:83], a[32:35], v[56:59]
    buffer_load_dwordx4 v33, s[12:15], s4 offen offset:1024 nt lds
    v_mfma_f32_16x16x32_bf16 v[116:119], a[84:87], a[36:39], v[116:119]
    ds_read_b64_tr_b16 a[108:109], v23 offset:0
    v_cvt_pk_bf16_f32 v83, v86, v87
    v_mfma_f32_16x16x32_bf16 v[116:119], a[88:91], a[40:43], v[116:119]
    ds_read_b64_tr_b16 a[110:111], v23 offset:4096
    v_mfma_f32_16x16x32_bf16 v[116:119], a[92:95], a[44:47], v[116:119]
    s_waitcnt lgkmcnt(6)
    buffer_load_dwordx4 v34, s[12:15], s4 offen offset:2048 nt lds
    v_mfma_f32_16x16x32_bf16 v[128:131], a[96:99], v[64:67], v[128:131]
    ds_read_b64_tr_b16 a[112:113], v24 offset:0
    v_mfma_f32_16x16x32_bf16 v[160:163], a[96:99], v[72:75], v[160:163]
    ds_read_b64_tr_b16 a[114:115], v24 offset:4096
    v_exp_f32 v96, v96
    v_mfma_f32_16x16x32_bf16 v[192:195], a[96:99], v[80:83], v[192:195]
    s_waitcnt lgkmcnt(6)
    buffer_load_dwordx4 v35, s[12:15], s4 offen offset:3072 nt lds
    v_exp_f32 v97, v97
    v_mfma_f32_16x16x32_bf16 v[196:199], a[100:103], v[80:83], v[196:199]
    ds_read_b64_tr_b16 a[116:117], v25 offset:0
    v_cvt_pk_bf16_f32 v96, v96, v97
    v_mfma_f32_16x16x32_bf16 v[164:167], a[100:103], v[72:75], v[164:167]
    s_add_u32 s4, s34, 4096
    s_mov_b32 m0, 53248
    ds_read_b64_tr_b16 a[118:119], v25 offset:4096
    v_exp_f32 v98, v98
    v_mfma_f32_16x16x32_bf16 v[132:135], a[100:103], v[64:67], v[132:135]
    s_waitcnt lgkmcnt(6)
    buffer_load_dwordx4 v32, s[12:15], s4 offen offset:0 nt lds
    v_mfma_f32_16x16x32_bf16 v[136:139], a[104:107], v[64:67], v[136:139]
    ds_read_b64_tr_b16 a[120:121], v26 offset:0
    v_exp_f32 v99, v99
    v_mfma_f32_16x16x32_bf16 v[168:171], a[104:107], v[72:75], v[168:171]
    ds_read_b64_tr_b16 a[122:123], v26 offset:4096
    v_cvt_pk_bf16_f32 v97, v98, v99
    v_mfma_f32_16x16x32_bf16 v[200:203], a[104:107], v[80:83], v[200:203]
    s_waitcnt lgkmcnt(6)
    buffer_load_dwordx4 v33, s[12:15], s4 offen offset:1024 nt lds
    v_exp_f32 v104, v104
    v_mfma_f32_16x16x32_bf16 v[204:207], a[108:111], v[80:83], v[204:207]
    ds_read_b64_tr_b16 a[124:125], v27 offset:0
    v_mfma_f32_16x16x32_bf16 v[172:175], a[108:111], v[72:75], v[172:175]
    ds_read_b64_tr_b16 a[126:127], v27 offset:4096
    v_exp_f32 v105, v105
    v_mfma_f32_16x16x32_bf16 v[140:143], a[108:111], v[64:67], v[140:143]
    s_waitcnt lgkmcnt(6)
    ds_read_b128 a[64:67], v16 offset:0
    v_cvt_pk_bf16_f32 v104, v104, v105
    v_mfma_f32_16x16x32_bf16 v[144:147], a[112:115], v[64:67], v[144:147]
    buffer_load_dwordx4 v34, s[12:15], s4 offen offset:2048 nt lds
    v_exp_f32 v106, v106
    v_mfma_f32_16x16x32_bf16 v[176:179], a[112:115], v[72:75], v[176:179]
    buffer_load_dwordx4 v35, s[12:15], s4 offen offset:3072 nt lds
    v_mfma_f32_16x16x32_bf16 v[208:211], a[112:115], v[80:83], v[208:211]
    s_waitcnt lgkmcnt(5)
    s_add_u32 s4, s34, 8192
    s_mov_b32 m0, 57344
    ds_read_b128 a[68:71], v17 offset:0
    v_exp_f32 v107, v107
    v_mfma_f32_16x16x32_bf16 v[212:215], a[116:119], v[80:83], v[212:215]
    buffer_load_dwordx4 v32, s[12:15], s4 offen offset:0 nt lds
    v_mfma_f32_16x16x32_bf16 v[180:183], a[116:119], v[72:75], v[180:183]
    buffer_load_dwordx4 v33, s[12:15], s4 offen offset:1024 nt lds
    v_mfma_f32_16x16x32_bf16 v[148:151], a[116:119], v[64:67], v[148:151]
    s_waitcnt lgkmcnt(4)
    ds_read_b128 a[72:75], v18 offset:0
    v_cvt_pk_bf16_f32 v105, v106, v107
    v_mfma_f32_16x16x32_bf16 v[152:155], a[120:123], v[64:67], v[152:155]
    buffer_load_dwordx4 v34, s[12:15], s4 offen offset:2048 nt lds
    v_mfma_f32_16x16x32_bf16 v[184:187], a[120:123], v[72:75], v[184:187]
    v_exp_f32 v112, v112
    v_exp_f32 v113, v113
    v_mfma_f32_16x16x32_bf16 v[216:219], a[120:123], v[80:83], v[216:219]
    s_waitcnt lgkmcnt(3)
    ds_read_b128 a[76:79], v19 offset:0
    v_cvt_pk_bf16_f32 v112, v112, v113
    v_mfma_f32_16x16x32_bf16 v[220:223], a[124:127], v[80:83], v[220:223]
    buffer_load_dwordx4 v35, s[12:15], s4 offen offset:3072 nt lds
    v_mfma_f32_16x16x32_bf16 v[188:191], a[124:127], v[72:75], v[188:191]
    v_exp_f32 v114, v114
    v_mfma_f32_16x16x32_bf16 v[156:159], a[124:127], v[64:67], v[156:159]
    s_add_u32 s4, s34, 12288
    s_mov_b32 m0, 61440
    ds_read_b128 a[80:83], v16 offset:4096
    v_mfma_f32_16x16x32_bf16 a[128:131], a[144:147], v[64:67], a[128:131]
    buffer_load_dwordx4 v32, s[12:15], s4 offen offset:0 nt lds
    v_mfma_f32_16x16x32_bf16 a[132:135], a[144:147], v[72:75], a[132:135]
    v_exp_f32 v115, v115
    v_exp_f32 v100, v100
    v_mfma_f32_16x16x32_bf16 a[136:139], a[144:147], v[80:83], a[136:139]
    s_waitcnt lgkmcnt(1)
    ds_read_b128 a[84:87], v17 offset:4096
    v_cvt_pk_bf16_f32 v113, v114, v115
    v_mfma_f32_16x16x32_bf16 v[64:67], a[64:67], a[0:3], v[48:51]
    buffer_load_dwordx4 v33, s[12:15], s4 offen offset:1024 nt lds
    v_mfma_f32_16x16x32_bf16 v[64:67], a[68:71], a[4:7], v[64:67]
    v_exp_f32 v101, v101
    v_exp_f32 v102, v102
    v_mfma_f32_16x16x32_bf16 v[64:67], a[72:75], a[8:11], v[64:67]
    ds_read_b128 a[88:91], v18 offset:4096
    v_cvt_pk_bf16_f32 v98, v100, v101
    v_mfma_f32_16x16x32_bf16 v[64:67], a[76:79], a[12:15], v[64:67]
    buffer_load_dwordx4 v34, s[12:15], s4 offen offset:2048 nt lds
    v_mfma_f32_16x16x32_bf16 v[72:75], a[76:79], a[28:31], v[52:55]
    v_exp_f32 v103, v103
    v_mfma_f32_16x16x32_bf16 v[72:75], a[72:75], a[24:27], v[72:75]
    ds_read_b128 a[92:95], v19 offset:4096
    v_cvt_pk_bf16_f32 v99, v102, v103
    v_mfma_f32_16x16x32_bf16 v[72:75], a[68:71], a[20:23], v[72:75]
    buffer_load_dwordx4 v35, s[12:15], s4 offen offset:3072 nt lds
    v_mfma_f32_16x16x32_bf16 v[72:75], a[64:67], a[16:19], v[72:75]
    v_exp_f32 v108, v108
    v_mfma_f32_16x16x32_bf16 v[80:83], a[64:67], a[32:35], v[56:59]
    v_exp_f32 v109, v109
    v_exp_f32 v110, v110
    v_mfma_f32_16x16x32_bf16 v[80:83], a[68:71], a[36:39], v[80:83]
    s_add_u32 s33, s33, 16384
    s_and_b32 s33, s33, 0x7ffff
    ds_read_b64_tr_b16 a[96:97], v20 offset:8192
    v_cvt_pk_bf16_f32 v106, v108, v109
    v_mfma_f32_16x16x32_bf16 v[80:83], a[72:75], a[40:43], v[80:83]
    s_add_u32 s4, s33, 0
    s_mov_b32 m0, 147456
    ds_read_b64_tr_b16 a[98:99], v20 offset:12288
    v_exp_f32 v111, v111
    v_mfma_f32_16x16x32_bf16 v[80:83], a[76:79], a[44:47], v[80:83]
    s_waitcnt lgkmcnt(2)
    buffer_load_dwordx4 v28, s[8:11], s4 offen offset:0 nt lds
    v_mfma_f32_16x16x32_bf16 v[68:71], a[80:83], a[0:3], v[48:51]
    ds_read_b64_tr_b16 a[100:101], v21 offset:8192
    v_exp_f32 v116, v116
    v_mfma_f32_16x16x32_bf16 v[68:71], a[84:87], a[4:7], v[68:71]
    ds_read_b64_tr_b16 a[102:103], v21 offset:12288
    v_cvt_pk_bf16_f32 v107, v110, v111
    v_mfma_f32_16x16x32_bf16 v[68:71], a[88:91], a[8:11], v[68:71]
    buffer_load_dwordx4 v29, s[8:11], s4 offen offset:1024 nt lds
    v_exp_f32 v117, v117
    v_mfma_f32_16x16x32_bf16 v[68:71], a[92:95], a[12:15], v[68:71]
    ds_read_b64_tr_b16 a[104:105], v22 offset:8192
    v_cvt_pk_bf16_f32 v114, v116, v117
    v_mfma_f32_16x16x32_bf16 v[76:79], a[92:95], a[28:31], v[52:55]
    ds_read_b64_tr_b16 a[106:107], v22 offset:12288
    v_exp_f32 v118, v118
    v_mfma_f32_16x16x32_bf16 v[76:79], a[88:91], a[24:27], v[76:79]
    buffer_load_dwordx4 v30, s[8:11], s4 offen offset:2048 nt lds
    v_mfma_f32_16x16x32_bf16 v[76:79], a[84:87], a[20:23], v[76:79]
    ds_read_b64_tr_b16 a[108:109], v23 offset:8192
    v_exp_f32 v119, v119
    v_mfma_f32_16x16x32_bf16 v[76:79], a[80:83], a[16:19], v[76:79]
    ds_read_b64_tr_b16 a[110:111], v23 offset:12288
    v_cvt_pk_bf16_f32 v115, v118, v119
    v_mfma_f32_16x16x32_bf16 v[84:87], a[80:83], a[32:35], v[56:59]
    buffer_load_dwordx4 v31, s[8:11], s4 offen offset:3072 nt lds
    v_mfma_f32_16x16x32_bf16 v[84:87], a[84:87], a[36:39], v[84:87]
    ds_read_b64_tr_b16 a[112:113], v24 offset:8192
    v_mfma_f32_16x16x32_bf16 v[84:87], a[88:91], a[40:43], v[84:87]
    s_add_u32 s4, s33, 4096
    s_mov_b32 m0, 151552
    ds_read_b64_tr_b16 a[114:115], v24 offset:12288
    v_mfma_f32_16x16x32_bf16 v[84:87], a[92:95], a[44:47], v[84:87]
    s_waitcnt lgkmcnt(8)
    buffer_load_dwordx4 v28, s[8:11], s4 offen offset:0 nt lds
    v_mfma_f32_16x16x32_bf16 v[128:131], a[96:99], v[96:99], v[128:131]
    ds_read_b64_tr_b16 a[116:117], v25 offset:8192
    v_mfma_f32_16x16x32_bf16 v[160:163], a[96:99], v[104:107], v[160:163]
    ds_read_b64_tr_b16 a[118:119], v25 offset:12288
    v_exp_f32 v64, v64
    v_mfma_f32_16x16x32_bf16 v[192:195], a[96:99], v[112:115], v[192:195]
    s_waitcnt lgkmcnt(8)
    buffer_load_dwordx4 v29, s[8:11], s4 offen offset:1024 nt lds
    v_exp_f32 v65, v65
    v_mfma_f32_16x16x32_bf16 v[196:199], a[100:103], v[112:115], v[196:199]
    ds_read_b64_tr_b16 a[120:121], v26 offset:8192
    v_cvt_pk_bf16_f32 v64, v64, v65
    v_mfma_f32_16x16x32_bf16 v[164:167], a[100:103], v[104:107], v[164:167]
    ds_read_b64_tr_b16 a[122:123], v26 offset:12288
    v_exp_f32 v66, v66
    v_mfma_f32_16x16x32_bf16 v[132:135], a[100:103], v[96:99], v[132:135]
    s_waitcnt lgkmcnt(8)
    buffer_load_dwordx4 v30, s[8:11], s4 offen offset:2048 nt lds
    v_mfma_f32_16x16x32_bf16 v[136:139], a[104:107], v[96:99], v[136:139]
    ds_read_b64_tr_b16 a[124:125], v27 offset:8192
    v_exp_f32 v67, v67
    v_mfma_f32_16x16x32_bf16 v[168:171], a[104:107], v[104:107], v[168:171]
    ds_read_b64_tr_b16 a[126:127], v27 offset:12288
    v_cvt_pk_bf16_f32 v65, v66, v67
    v_mfma_f32_16x16x32_bf16 v[200:203], a[104:107], v[112:115], v[200:203]
    s_waitcnt lgkmcnt(8)
    buffer_load_dwordx4 v31, s[8:11], s4 offen offset:3072 nt lds
    v_exp_f32 v72, v72
    v_mfma_f32_16x16x32_bf16 v[204:207], a[108:111], v[112:115], v[204:207]
    s_add_u32 s4, s33, 8192
    s_mov_b32 m0, 155648
    ds_read_b128 a[64:67], v16 offset:8192
    v_mfma_f32_16x16x32_bf16 v[172:175], a[108:111], v[104:107], v[172:175]
    buffer_load_dwordx4 v28, s[8:11], s4 offen offset:0 nt lds
    v_exp_f32 v73, v73
    v_mfma_f32_16x16x32_bf16 v[140:143], a[108:111], v[96:99], v[140:143]
    s_waitcnt lgkmcnt(7)
    buffer_load_dwordx4 v29, s[8:11], s4 offen offset:1024 nt lds
    v_mfma_f32_16x16x32_bf16 v[144:147], a[112:115], v[96:99], v[144:147]
    ds_read_b128 a[68:71], v17 offset:8192
    v_exp_f32 v74, v74
    v_mfma_f32_16x16x32_bf16 v[176:179], a[112:115], v[104:107], v[176:179]
    buffer_load_dwordx4 v30, s[8:11], s4 offen offset:2048 nt lds
    v_mfma_f32_16x16x32_bf16 v[208:211], a[112:115], v[112:115], v[208:211]
    s_waitcnt lgkmcnt(6)
    buffer_load_dwordx4 v31, s[8:11], s4 offen offset:3072 nt lds
    v_mfma_f32_16x16x32_bf16 v[212:215], a[116:119], v[112:115], v[212:215]
    ds_read_b128 a[72:75], v18 offset:8192
    v_cvt_pk_bf16_f32 v72, v72, v73
    v_mfma_f32_16x16x32_bf16 v[180:183], a[116:119], v[104:107], v[180:183]
    s_add_u32 s4, s33, 12288
    s_mov_b32 m0, 159744
    v_exp_f32 v75, v75
    v_mfma_f32_16x16x32_bf16 v[148:151], a[116:119], v[96:99], v[148:151]
    s_waitcnt lgkmcnt(5)
    buffer_load_dwordx4 v28, s[8:11], s4 offen offset:0 nt lds
    v_mfma_f32_16x16x32_bf16 v[152:155], a[120:123], v[96:99], v[152:155]
    ds_read_b128 a[76:79], v19 offset:8192
    v_cvt_pk_bf16_f32 v73, v74, v75
    v_mfma_f32_16x16x32_bf16 v[184:187], a[120:123], v[104:107], v[184:187]
    v_exp_f32 v80, v80
    v_exp_f32 v81, v81
    v_mfma_f32_16x16x32_bf16 v[216:219], a[120:123], v[112:115], v[216:219]
    s_waitcnt lgkmcnt(4)
    buffer_load_dwordx4 v29, s[8:11], s4 offen offset:1024 nt lds
    v_mfma_f32_16x16x32_bf16 v[220:223], a[124:127], v[112:115], v[220:223]
    ds_read_b128 a[80:83], v16 offset:12288
    v_cvt_pk_bf16_f32 v80, v80, v81
    v_mfma_f32_16x16x32_bf16 v[188:191], a[124:127], v[104:107], v[188:191]
    v_exp_f32 v82, v82
    v_mfma_f32_16x16x32_bf16 v[156:159], a[124:127], v[96:99], v[156:159]
    buffer_load_dwordx4 v30, s[8:11], s4 offen offset:2048 nt lds
    v_mfma_f32_16x16x32_bf16 a[128:131], a[144:147], v[96:99], a[128:131]
    ds_read_b128 a[84:87], v17 offset:12288
    v_mfma_f32_16x16x32_bf16 a[132:135], a[144:147], v[104:107], a[132:135]
    v_exp_f32 v83, v83
    v_exp_f32 v68, v68
    v_mfma_f32_16x16x32_bf16 a[136:139], a[144:147], v[112:115], a[136:139]
    s_waitcnt lgkmcnt(2)
    buffer_load_dwordx4 v31, s[8:11], s4 offen offset:3072 nt lds
    v_mfma_f32_16x16x32_bf16 v[96:99], a[64:67], a[0:3], v[48:51]
    ds_read_b128 a[88:91], v18 offset:12288
    v_cvt_pk_bf16_f32 v81, v82, v83
    v_mfma_f32_16x16x32_bf16 v[96:99], a[68:71], a[4:7], v[96:99]
    v_exp_f32 v69, v69
    v_mfma_f32_16x16x32_bf16 v[96:99], a[72:75], a[8:11], v[96:99]
    v_exp_f32 v70, v70
    v_mfma_f32_16x16x32_bf16 v[96:99], a[76:79], a[12:15], v[96:99]
    ds_read_b128 a[92:95], v19 offset:12288
    v_cvt_pk_bf16_f32 v66, v68, v69
    v_mfma_f32_16x16x32_bf16 v[104:107], a[76:79], a[28:31], v[52:55]
    v_exp_f32 v71, v71
    v_mfma_f32_16x16x32_bf16 v[104:107], a[72:75], a[24:27], v[104:107]
    v_exp_f32 v76, v76
    v_mfma_f32_16x16x32_bf16 v[104:107], a[68:71], a[20:23], v[104:107]
    v_exp_f32 v77, v77
    v_mfma_f32_16x16x32_bf16 v[104:107], a[64:67], a[16:19], v[104:107]
    v_cvt_pk_bf16_f32 v67, v70, v71
    v_cvt_pk_bf16_f32 v74, v76, v77
    v_mfma_f32_16x16x32_bf16 v[112:115], a[64:67], a[32:35], v[56:59]
    v_exp_f32 v78, v78
    v_mfma_f32_16x16x32_bf16 v[112:115], a[68:71], a[36:39], v[112:115]
    v_mfma_f32_16x16x32_bf16 v[112:115], a[72:75], a[40:43], v[112:115]
    v_exp_f32 v79, v79
    v_mfma_f32_16x16x32_bf16 v[112:115], a[76:79], a[44:47], v[112:115]
    v_cvt_pk_bf16_f32 v75, v78, v79
    s_waitcnt vmcnt(60) lgkmcnt(0)
    s_barrier
    v_mfma_f32_16x16x32_bf16 v[100:103], a[80:83], a[0:3], v[48:51]
    ds_read_b64_tr_b16 a[96:97], v20 offset:16384
    v_mfma_f32_16x16x32_bf16 v[100:103], a[84:87], a[4:7], v[100:103]
    ds_read_b64_tr_b16 a[98:99], v20 offset:20480
    v_mfma_f32_16x16x32_bf16 v[100:103], a[88:91], a[8:11], v[100:103]
    v_exp_f32 v84, v84
    v_mfma_f32_16x16x32_bf16 v[100:103], a[92:95], a[12:15], v[100:103]
    s_add_u32 s34, s34, 16384
    s_and_b32 s34, s34, 0x7ffff
    ds_read_b64_tr_b16 a[100:101], v21 offset:16384
    v_exp_f32 v85, v85
    v_mfma_f32_16x16x32_bf16 v[108:111], a[92:95], a[28:31], v[52:55]
    s_add_u32 s4, s34, 0
    s_mov_b32 m0, 0
    ds_read_b64_tr_b16 a[102:103], v21 offset:20480
    v_cvt_pk_bf16_f32 v82, v84, v85
    v_mfma_f32_16x16x32_bf16 v[108:111], a[88:91], a[24:27], v[108:111]
    buffer_load_dwordx4 v32, s[12:15], s4 offen offset:0 nt lds
    v_exp_f32 v86, v86
    v_mfma_f32_16x16x32_bf16 v[108:111], a[84:87], a[20:23], v[108:111]
    ds_read_b64_tr_b16 a[104:105], v22 offset:16384
    v_mfma_f32_16x16x32_bf16 v[108:111], a[80:83], a[16:19], v[108:111]
    ds_read_b64_tr_b16 a[106:107], v22 offset:20480
    v_exp_f32 v87, v87
    v_mfma_f32_16x16x32_bf16 v[116:119], a[80:83], a[32:35], v[56:59]
    buffer_load_dwordx4 v33, s[12:15], s4 offen offset:1024 nt lds
    v_mfma_f32_16x16x32_bf16 v[116:119], a[84:87], a[36:39], v[116:119]
    ds_read_b64_tr_b16 a[108:109], v23 offset:16384
    v_cvt_pk_bf16_f32 v83, v86, v87
    v_mfma_f32_16x16x32_bf16 v[116:119], a[88:91], a[40:43], v[116:119]
    ds_read_b64_tr_b16 a[110:111], v23 offset:20480
    v_mfma_f32_16x16x32_bf16 v[116:119], a[92:95], a[44:47], v[116:119]
    s_waitcnt lgkmcnt(6)
    buffer_load_dwordx4 v34, s[12:15], s4 offen offset:2048 nt lds
    v_mfma_f32_16x16x32_bf16 v[128:131], a[96:99], v[64:67], v[128:131]
    ds_read_b64_tr_b16 a[112:113], v24 offset:16384
    v_mfma_f32_16x16x32_bf16 v[160:163], a[96:99], v[72:75], v[160:163]
    ds_read_b64_tr_b16 a[114:115], v24 offset:20480
    v_exp_f32 v96, v96
    v_mfma_f32_16x16x32_bf16 v[192:195], a[96:99], v[80:83], v[192:195]
    s_waitcnt lgkmcnt(6)
    buffer_load_dwordx4 v35, s[12:15], s4 offen offset:3072 nt lds
    v_exp_f32 v97, v97
    v_mfma_f32_16x16x32_bf16 v[196:199], a[100:103], v[80:83], v[196:199]
    ds_read_b64_tr_b16 a[116:117], v25 offset:16384
    v_cvt_pk_bf16_f32 v96, v96, v97
    v_mfma_f32_16x16x32_bf16 v[164:167], a[100:103], v[72:75], v[164:167]
    s_add_u32 s4, s34, 4096
    s_mov_b32 m0, 4096
    ds_read_b64_tr_b16 a[118:119], v25 offset:20480
    v_exp_f32 v98, v98
    v_mfma_f32_16x16x32_bf16 v[132:135], a[100:103], v[64:67], v[132:135]
    s_waitcnt lgkmcnt(6)
    buffer_load_dwordx4 v32, s[12:15], s4 offen offset:0 nt lds
    v_mfma_f32_16x16x32_bf16 v[136:139], a[104:107], v[64:67], v[136:139]
    ds_read_b64_tr_b16 a[120:121], v26 offset:16384
    v_exp_f32 v99, v99
    v_mfma_f32_16x16x32_bf16 v[168:171], a[104:107], v[72:75], v[168:171]
    ds_read_b64_tr_b16 a[122:123], v26 offset:20480
    v_cvt_pk_bf16_f32 v97, v98, v99
    v_mfma_f32_16x16x32_bf16 v[200:203], a[104:107], v[80:83], v[200:203]
    s_waitcnt lgkmcnt(6)
    buffer_load_dwordx4 v33, s[12:15], s4 offen offset:1024 nt lds
    v_exp_f32 v104, v104
    v_mfma_f32_16x16x32_bf16 v[204:207], a[108:111], v[80:83], v[204:207]
    ds_read_b64_tr_b16 a[124:125], v27 offset:16384
    v_mfma_f32_16x16x32_bf16 v[172:175], a[108:111], v[72:75], v[172:175]
    ds_read_b64_tr_b16 a[126:127], v27 offset:20480
    v_exp_f32 v105, v105
    v_mfma_f32_16x16x32_bf16 v[140:143], a[108:111], v[64:67], v[140:143]
    s_waitcnt lgkmcnt(6)
    ds_read_b128 a[64:67], v16 offset:16384
    v_cvt_pk_bf16_f32 v104, v104, v105
    v_mfma_f32_16x16x32_bf16 v[144:147], a[112:115], v[64:67], v[144:147]
    buffer_load_dwordx4 v34, s[12:15], s4 offen offset:2048 nt lds
    v_exp_f32 v106, v106
    v_mfma_f32_16x16x32_bf16 v[176:179], a[112:115], v[72:75], v[176:179]
    buffer_load_dwordx4 v35, s[12:15], s4 offen offset:3072 nt lds
    v_mfma_f32_16x16x32_bf16 v[208:211], a[112:115], v[80:83], v[208:211]
    s_waitcnt lgkmcnt(5)
    s_add_u32 s4, s34, 8192
    s_mov_b32 m0, 8192
    ds_read_b128 a[68:71], v17 offset:16384
    v_exp_f32 v107, v107
    v_mfma_f32_16x16x32_bf16 v[212:215], a[116:119], v[80:83], v[212:215]
    buffer_load_dwordx4 v32, s[12:15], s4 offen offset:0 nt lds
    v_mfma_f32_16x16x32_bf16 v[180:183], a[116:119], v[72:75], v[180:183]
    buffer_load_dwordx4 v33, s[12:15], s4 offen offset:1024 nt lds
    v_mfma_f32_16x16x32_bf16 v[148:151], a[116:119], v[64:67], v[148:151]
    s_waitcnt lgkmcnt(4)
    ds_read_b128 a[72:75], v18 offset:16384
    v_cvt_pk_bf16_f32 v105, v106, v107
    v_mfma_f32_16x16x32_bf16 v[152:155], a[120:123], v[64:67], v[152:155]
    buffer_load_dwordx4 v34, s[12:15], s4 offen offset:2048 nt lds
    v_mfma_f32_16x16x32_bf16 v[184:187], a[120:123], v[72:75], v[184:187]
    v_exp_f32 v112, v112
    v_exp_f32 v113, v113
    v_mfma_f32_16x16x32_bf16 v[216:219], a[120:123], v[80:83], v[216:219]
    s_waitcnt lgkmcnt(3)
    ds_read_b128 a[76:79], v19 offset:16384
    v_cvt_pk_bf16_f32 v112, v112, v113
    v_mfma_f32_16x16x32_bf16 v[220:223], a[124:127], v[80:83], v[220:223]
    buffer_load_dwordx4 v35, s[12:15], s4 offen offset:3072 nt lds
    v_mfma_f32_16x16x32_bf16 v[188:191], a[124:127], v[72:75], v[188:191]
    v_exp_f32 v114, v114
    v_mfma_f32_16x16x32_bf16 v[156:159], a[124:127], v[64:67], v[156:159]
    s_add_u32 s4, s34, 12288
    s_mov_b32 m0, 12288
    ds_read_b128 a[80:83], v16 offset:20480
    v_mfma_f32_16x16x32_bf16 a[128:131], a[144:147], v[64:67], a[128:131]
    buffer_load_dwordx4 v32, s[12:15], s4 offen offset:0 nt lds
    v_mfma_f32_16x16x32_bf16 a[132:135], a[144:147], v[72:75], a[132:135]
    v_exp_f32 v115, v115
    v_exp_f32 v100, v100
    v_mfma_f32_16x16x32_bf16 a[136:139], a[144:147], v[80:83], a[136:139]
    s_waitcnt lgkmcnt(1)
    ds_read_b128 a[84:87], v17 offset:20480
    v_cvt_pk_bf16_f32 v113, v114, v115
    v_mfma_f32_16x16x32_bf16 v[64:67], a[64:67], a[0:3], v[48:51]
    buffer_load_dwordx4 v33, s[12:15], s4 offen offset:1024 nt lds
    v_mfma_f32_16x16x32_bf16 v[64:67], a[68:71], a[4:7], v[64:67]
    v_exp_f32 v101, v101
    v_exp_f32 v102, v102
    v_mfma_f32_16x16x32_bf16 v[64:67], a[72:75], a[8:11], v[64:67]
    ds_read_b128 a[88:91], v18 offset:20480
    v_cvt_pk_bf16_f32 v98, v100, v101
    v_mfma_f32_16x16x32_bf16 v[64:67], a[76:79], a[12:15], v[64:67]
    buffer_load_dwordx4 v34, s[12:15], s4 offen offset:2048 nt lds
    v_mfma_f32_16x16x32_bf16 v[72:75], a[76:79], a[28:31], v[52:55]
    v_exp_f32 v103, v103
    v_mfma_f32_16x16x32_bf16 v[72:75], a[72:75], a[24:27], v[72:75]
    ds_read_b128 a[92:95], v19 offset:20480
    v_cvt_pk_bf16_f32 v99, v102, v103
    v_mfma_f32_16x16x32_bf16 v[72:75], a[68:71], a[20:23], v[72:75]
    buffer_load_dwordx4 v35, s[12:15], s4 offen offset:3072 nt lds
    v_mfma_f32_16x16x32_bf16 v[72:75], a[64:67], a[16:19], v[72:75]
    v_exp_f32 v108, v108
    v_mfma_f32_16x16x32_bf16 v[80:83], a[64:67], a[32:35], v[56:59]
    v_exp_f32 v109, v109
    v_exp_f32 v110, v110
    v_mfma_f32_16x16x32_bf16 v[80:83], a[68:71], a[36:39], v[80:83]
    s_add_u32 s33, s33, 16384
    s_and_b32 s33, s33, 0x7ffff
    ds_read_b64_tr_b16 a[96:97], v20 offset:24576
    v_cvt_pk_bf16_f32 v106, v108, v109
    v_mfma_f32_16x16x32_bf16 v[80:83], a[72:75], a[40:43], v[80:83]
    s_add_u32 s4, s33, 0
    s_mov_b32 m0, 98304
    ds_read_b64_tr_b16 a[98:99], v20 offset:28672
    v_exp_f32 v111, v111
    v_mfma_f32_16x16x32_bf16 v[80:83], a[76:79], a[44:47], v[80:83]
    s_waitcnt lgkmcnt(2)
    buffer_load_dwordx4 v28, s[8:11], s4 offen offset:0 nt lds
    v_mfma_f32_16x16x32_bf16 v[68:71], a[80:83], a[0:3], v[48:51]
    ds_read_b64_tr_b16 a[100:101], v21 offset:24576
    v_exp_f32 v116, v116
    v_mfma_f32_16x16x32_bf16 v[68:71], a[84:87], a[4:7], v[68:71]
    ds_read_b64_tr_b16 a[102:103], v21 offset:28672
    v_cvt_pk_bf16_f32 v107, v110, v111
    v_mfma_f32_16x16x32_bf16 v[68:71], a[88:91], a[8:11], v[68:71]
    buffer_load_dwordx4 v29, s[8:11], s4 offen offset:1024 nt lds
    v_exp_f32 v117, v117
    v_mfma_f32_16x16x32_bf16 v[68:71], a[92:95], a[12:15], v[68:71]
    ds_read_b64_tr_b16 a[104:105], v22 offset:24576
    v_cvt_pk_bf16_f32 v114, v116, v117
    v_mfma_f32_16x16x32_bf16 v[76:79], a[92:95], a[28:31], v[52:55]
    ds_read_b64_tr_b16 a[106:107], v22 offset:28672
    v_exp_f32 v118, v118
    v_mfma_f32_16x16x32_bf16 v[76:79], a[88:91], a[24:27], v[76:79]
    buffer_load_dwordx4 v30, s[8:11], s4 offen offset:2048 nt lds
    v_mfma_f32_16x16x32_bf16 v[76:79], a[84:87], a[20:23], v[76:79]
    ds_read_b64_tr_b16 a[108:109], v23 offset:24576
    v_exp_f32 v119, v119
    v_mfma_f32_16x16x32_bf16 v[76:79], a[80:83], a[16:19], v[76:79]
    ds_read_b64_tr_b16 a[110:111], v23 offset:28672
    v_cvt_pk_bf16_f32 v115, v118, v119
    v_mfma_f32_16x16x32_bf16 v[84:87], a[80:83], a[32:35], v[56:59]
    buffer_load_dwordx4 v31, s[8:11], s4 offen offset:3072 nt lds
    v_mfma_f32_16x16x32_bf16 v[84:87], a[84:87], a[36:39], v[84:87]
    ds_read_b64_tr_b16 a[112:113], v24 offset:24576
    v_mfma_f32_16x16x32_bf16 v[84:87], a[88:91], a[40:43], v[84:87]
    s_add_u32 s4, s33, 4096
    s_mov_b32 m0, 102400
    ds_read_b64_tr_b16 a[114:115], v24 offset:28672
    v_mfma_f32_16x16x32_bf16 v[84:87], a[92:95], a[44:47], v[84:87]
    s_waitcnt lgkmcnt(8)
    buffer_load_dwordx4 v28, s[8:11], s4 offen offset:0 nt lds
    v_mfma_f32_16x16x32_bf16 v[128:131], a[96:99], v[96:99], v[128:131]
    ds_read_b64_tr_b16 a[116:117], v25 offset:24576
    v_mfma_f32_16x16x32_bf16 v[160:163], a[96:99], v[104:107], v[160:163]
    ds_read_b64_tr_b16 a[118:119], v25 offset:28672
    v_exp_f32 v64, v64
    v_mfma_f32_16x16x32_bf16 v[192:195], a[96:99], v[112:115], v[192:195]
    s_waitcnt lgkmcnt(8)
    buffer_load_dwordx4 v29, s[8:11], s4 offen offset:1024 nt lds
    v_exp_f32 v65, v65
    v_mfma_f32_16x16x32_bf16 v[196:199], a[100:103], v[112:115], v[196:199]
    ds_read_b64_tr_b16 a[120:121], v26 offset:24576
    v_cvt_pk_bf16_f32 v64, v64, v65
    v_mfma_f32_16x16x32_bf16 v[164:167], a[100:103], v[104:107], v[164:167]
    ds_read_b64_tr_b16 a[122:123], v26 offset:28672
    v_exp_f32 v66, v66
    v_mfma_f32_16x16x32_bf16 v[132:135], a[100:103], v[96:99], v[132:135]
    s_waitcnt lgkmcnt(8)
    buffer_load_dwordx4 v30, s[8:11], s4 offen offset:2048 nt lds
    v_mfma_f32_16x16x32_bf16 v[136:139], a[104:107], v[96:99], v[136:139]
    ds_read_b64_tr_b16 a[124:125], v27 offset:24576
    v_exp_f32 v67, v67
    v_mfma_f32_16x16x32_bf16 v[168:171], a[104:107], v[104:107], v[168:171]
    ds_read_b64_tr_b16 a[126:127], v27 offset:28672
    v_cvt_pk_bf16_f32 v65, v66, v67
    v_mfma_f32_16x16x32_bf16 v[200:203], a[104:107], v[112:115], v[200:203]
    s_waitcnt lgkmcnt(8)
    buffer_load_dwordx4 v31, s[8:11], s4 offen offset:3072 nt lds
    v_exp_f32 v72, v72
    v_mfma_f32_16x16x32_bf16 v[204:207], a[108:111], v[112:115], v[204:207]
    s_add_u32 s4, s33, 8192
    s_mov_b32 m0, 106496
    ds_read_b128 a[64:67], v16 offset:24576
    v_mfma_f32_16x16x32_bf16 v[172:175], a[108:111], v[104:107], v[172:175]
    buffer_load_dwordx4 v28, s[8:11], s4 offen offset:0 nt lds
    v_exp_f32 v73, v73
    v_mfma_f32_16x16x32_bf16 v[140:143], a[108:111], v[96:99], v[140:143]
    s_waitcnt lgkmcnt(7)
    buffer_load_dwordx4 v29, s[8:11], s4 offen offset:1024 nt lds
    v_mfma_f32_16x16x32_bf16 v[144:147], a[112:115], v[96:99], v[144:147]
    ds_read_b128 a[68:71], v17 offset:24576
    v_exp_f32 v74, v74
    v_mfma_f32_16x16x32_bf16 v[176:179], a[112:115], v[104:107], v[176:179]
    buffer_load_dwordx4 v30, s[8:11], s4 offen offset:2048 nt lds
    v_mfma_f32_16x16x32_bf16 v[208:211], a[112:115], v[112:115], v[208:211]
    s_waitcnt lgkmcnt(6)
    buffer_load_dwordx4 v31, s[8:11], s4 offen offset:3072 nt lds
    v_mfma_f32_16x16x32_bf16 v[212:215], a[116:119], v[112:115], v[212:215]
    ds_read_b128 a[72:75], v18 offset:24576
    v_cvt_pk_bf16_f32 v72, v72, v73
    v_mfma_f32_16x16x32_bf16 v[180:183], a[116:119], v[104:107], v[180:183]
    s_add_u32 s4, s33, 12288
    s_mov_b32 m0, 110592
    v_exp_f32 v75, v75
    v_mfma_f32_16x16x32_bf16 v[148:151], a[116:119], v[96:99], v[148:151]
    s_waitcnt lgkmcnt(5)
    buffer_load_dwordx4 v28, s[8:11], s4 offen offset:0 nt lds
    v_mfma_f32_16x16x32_bf16 v[152:155], a[120:123], v[96:99], v[152:155]
    ds_read_b128 a[76:79], v19 offset:24576
    v_cvt_pk_bf16_f32 v73, v74, v75
    v_mfma_f32_16x16x32_bf16 v[184:187], a[120:123], v[104:107], v[184:187]
    v_exp_f32 v80, v80
    v_exp_f32 v81, v81
    v_mfma_f32_16x16x32_bf16 v[216:219], a[120:123], v[112:115], v[216:219]
    s_waitcnt lgkmcnt(4)
    buffer_load_dwordx4 v29, s[8:11], s4 offen offset:1024 nt lds
    v_mfma_f32_16x16x32_bf16 v[220:223], a[124:127], v[112:115], v[220:223]
    ds_read_b128 a[80:83], v16 offset:28672
    v_cvt_pk_bf16_f32 v80, v80, v81
    v_mfma_f32_16x16x32_bf16 v[188:191], a[124:127], v[104:107], v[188:191]
    v_exp_f32 v82, v82
    v_mfma_f32_16x16x32_bf16 v[156:159], a[124:127], v[96:99], v[156:159]
    buffer_load_dwordx4 v30, s[8:11], s4 offen offset:2048 nt lds
    v_mfma_f32_16x16x32_bf16 a[128:131], a[144:147], v[96:99], a[128:131]
    ds_read_b128 a[84:87], v17 offset:28672
    v_mfma_f32_16x16x32_bf16 a[132:135], a[144:147], v[104:107], a[132:135]
    v_exp_f32 v83, v83
    v_exp_f32 v68, v68
    v_mfma_f32_16x16x32_bf16 a[136:139], a[144:147], v[112:115], a[136:139]
    s_waitcnt lgkmcnt(2)
    buffer_load_dwordx4 v31, s[8:11], s4 offen offset:3072 nt lds
    v_mfma_f32_16x16x32_bf16 v[96:99], a[64:67], a[0:3], v[48:51]
    ds_read_b128 a[88:91], v18 offset:28672
    v_cvt_pk_bf16_f32 v81, v82, v83
    v_mfma_f32_16x16x32_bf16 v[96:99], a[68:71], a[4:7], v[96:99]
    v_exp_f32 v69, v69
    v_mfma_f32_16x16x32_bf16 v[96:99], a[72:75], a[8:11], v[96:99]
    v_exp_f32 v70, v70
    v_mfma_f32_16x16x32_bf16 v[96:99], a[76:79], a[12:15], v[96:99]
    ds_read_b128 a[92:95], v19 offset:28672
    v_cvt_pk_bf16_f32 v66, v68, v69
    v_mfma_f32_16x16x32_bf16 v[104:107], a[76:79], a[28:31], v[52:55]
    v_exp_f32 v71, v71
    v_mfma_f32_16x16x32_bf16 v[104:107], a[72:75], a[24:27], v[104:107]
    v_exp_f32 v76, v76
    v_mfma_f32_16x16x32_bf16 v[104:107], a[68:71], a[20:23], v[104:107]
    v_exp_f32 v77, v77
    v_mfma_f32_16x16x32_bf16 v[104:107], a[64:67], a[16:19], v[104:107]
    v_cvt_pk_bf16_f32 v67, v70, v71
    v_cvt_pk_bf16_f32 v74, v76, v77
    v_mfma_f32_16x16x32_bf16 v[112:115], a[64:67], a[32:35], v[56:59]
    v_exp_f32 v78, v78
    v_mfma_f32_16x16x32_bf16 v[112:115], a[68:71], a[36:39], v[112:115]
    v_mfma_f32_16x16x32_bf16 v[112:115], a[72:75], a[40:43], v[112:115]
    v_exp_f32 v79, v79
    v_mfma_f32_16x16x32_bf16 v[112:115], a[76:79], a[44:47], v[112:115]
    v_cvt_pk_bf16_f32 v75, v78, v79
    s_waitcnt vmcnt(60) lgkmcnt(0)
    s_barrier
    v_mfma_f32_16x16x32_bf16 v[100:103], a[80:83], a[0:3], v[48:51]
    ds_read_b64_tr_b16 a[96:97], v20 offset:32768
    v_mfma_f32_16x16x32_bf16 v[100:103], a[84:87], a[4:7], v[100:103]
    ds_read_b64_tr_b16 a[98:99], v20 offset:36864
    v_mfma_f32_16x16x32_bf16 v[100:103], a[88:91], a[8:11], v[100:103]
    v_exp_f32 v84, v84
    v_mfma_f32_16x16x32_bf16 v[100:103], a[92:95], a[12:15], v[100:103]
    s_add_u32 s34, s34, 16384
    s_and_b32 s34, s34, 0x7ffff
    ds_read_b64_tr_b16 a[100:101], v21 offset:32768
    v_exp_f32 v85, v85
    v_mfma_f32_16x16x32_bf16 v[108:111], a[92:95], a[28:31], v[52:55]
    s_add_u32 s4, s34, 0
    s_mov_b32 m0, 16384
    ds_read_b64_tr_b16 a[102:103], v21 offset:36864
    v_cvt_pk_bf16_f32 v82, v84, v85
    v_mfma_f32_16x16x32_bf16 v[108:111], a[88:91], a[24:27], v[108:111]
    buffer_load_dwordx4 v32, s[12:15], s4 offen offset:0 nt lds
    v_exp_f32 v86, v86
    v_mfma_f32_16x16x32_bf16 v[108:111], a[84:87], a[20:23], v[108:111]
    ds_read_b64_tr_b16 a[104:105], v22 offset:32768
    v_mfma_f32_16x16x32_bf16 v[108:111], a[80:83], a[16:19], v[108:111]
    ds_read_b64_tr_b16 a[106:107], v22 offset:36864
    v_exp_f32 v87, v87
    v_mfma_f32_16x16x32_bf16 v[116:119], a[80:83], a[32:35], v[56:59]
    buffer_load_dwordx4 v33, s[12:15], s4 offen offset:1024 nt lds
    v_mfma_f32_16x16x32_bf16 v[116:119], a[84:87], a[36:39], v[116:119]
    ds_read_b64_tr_b16 a[108:109], v23 offset:32768
    v_cvt_pk_bf16_f32 v83, v86, v87
    v_mfma_f32_16x16x32_bf16 v[116:119], a[88:91], a[40:43], v[116:119]
    ds_read_b64_tr_b16 a[110:111], v23 offset:36864
    v_mfma_f32_16x16x32_bf16 v[116:119], a[92:95], a[44:47], v[116:119]
    s_waitcnt lgkmcnt(6)
    buffer_load_dwordx4 v34, s[12:15], s4 offen offset:2048 nt lds
    v_mfma_f32_16x16x32_bf16 v[128:131], a[96:99], v[64:67], v[128:131]
    ds_read_b64_tr_b16 a[112:113], v24 offset:32768
    v_mfma_f32_16x16x32_bf16 v[160:163], a[96:99], v[72:75], v[160:163]
    ds_read_b64_tr_b16 a[114:115], v24 offset:36864
    v_exp_f32 v96, v96
    v_mfma_f32_16x16x32_bf16 v[192:195], a[96:99], v[80:83], v[192:195]
    s_waitcnt lgkmcnt(6)
    buffer_load_dwordx4 v35, s[12:15], s4 offen offset:3072 nt lds
    v_exp_f32 v97, v97
    v_mfma_f32_16x16x32_bf16 v[196:199], a[100:103], v[80:83], v[196:199]
    ds_read_b64_tr_b16 a[116:117], v25 offset:32768
    v_cvt_pk_bf16_f32 v96, v96, v97
    v_mfma_f32_16x16x32_bf16 v[164:167], a[100:103], v[72:75], v[164:167]
    s_add_u32 s4, s34, 4096
    s_mov_b32 m0, 20480
    ds_read_b64_tr_b16 a[118:119], v25 offset:36864
    v_exp_f32 v98, v98
    v_mfma_f32_16x16x32_bf16 v[132:135], a[100:103], v[64:67], v[132:135]
    s_waitcnt lgkmcnt(6)
    buffer_load_dwordx4 v32, s[12:15], s4 offen offset:0 nt lds
    v_mfma_f32_16x16x32_bf16 v[136:139], a[104:107], v[64:67], v[136:139]
    ds_read_b64_tr_b16 a[120:121], v26 offset:32768
    v_exp_f32 v99, v99
    v_mfma_f32_16x16x32_bf16 v[168:171], a[104:107], v[72:75], v[168:171]
    ds_read_b64_tr_b16 a[122:123], v26 offset:36864
    v_cvt_pk_bf16_f32 v97, v98, v99
    v_mfma_f32_16x16x32_bf16 v[200:203], a[104:107], v[80:83], v[200:203]
    s_waitcnt lgkmcnt(6)
    buffer_load_dwordx4 v33, s[12:15], s4 offen offset:1024 nt lds
    v_exp_f32 v104, v104
    v_mfma_f32_16x16x32_bf16 v[204:207], a[108:111], v[80:83], v[204:207]
    ds_read_b64_tr_b16 a[124:125], v27 offset:32768
    v_mfma_f32_16x16x32_bf16 v[172:175], a[108:111], v[72:75], v[172:175]
    ds_read_b64_tr_b16 a[126:127], v27 offset:36864
    v_exp_f32 v105, v105
    v_mfma_f32_16x16x32_bf16 v[140:143], a[108:111], v[64:67], v[140:143]
    s_waitcnt lgkmcnt(6)
    ds_read_b128 a[64:67], v16 offset:32768
    v_cvt_pk_bf16_f32 v104, v104, v105
    v_mfma_f32_16x16x32_bf16 v[144:147], a[112:115], v[64:67], v[144:147]
    buffer_load_dwordx4 v34, s[12:15], s4 offen offset:2048 nt lds
    v_exp_f32 v106, v106
    v_mfma_f32_16x16x32_bf16 v[176:179], a[112:115], v[72:75], v[176:179]
    buffer_load_dwordx4 v35, s[12:15], s4 offen offset:3072 nt lds
    v_mfma_f32_16x16x32_bf16 v[208:211], a[112:115], v[80:83], v[208:211]
    s_waitcnt lgkmcnt(5)
    s_add_u32 s4, s34, 8192
    s_mov_b32 m0, 24576
    ds_read_b128 a[68:71], v17 offset:32768
    v_exp_f32 v107, v107
    v_mfma_f32_16x16x32_bf16 v[212:215], a[116:119], v[80:83], v[212:215]
    buffer_load_dwordx4 v32, s[12:15], s4 offen offset:0 nt lds
    v_mfma_f32_16x16x32_bf16 v[180:183], a[116:119], v[72:75], v[180:183]
    buffer_load_dwordx4 v33, s[12:15], s4 offen offset:1024 nt lds
    v_mfma_f32_16x16x32_bf16 v[148:151], a[116:119], v[64:67], v[148:151]
    s_waitcnt lgkmcnt(4)
    ds_read_b128 a[72:75], v18 offset:32768
    v_cvt_pk_bf16_f32 v105, v106, v107
    v_mfma_f32_16x16x32_bf16 v[152:155], a[120:123], v[64:67], v[152:155]
    buffer_load_dwordx4 v34, s[12:15], s4 offen offset:2048 nt lds
    v_mfma_f32_16x16x32_bf16 v[184:187], a[120:123], v[72:75], v[184:187]
    v_exp_f32 v112, v112
    v_exp_f32 v113, v113
    v_mfma_f32_16x16x32_bf16 v[216:219], a[120:123], v[80:83], v[216:219]
    s_waitcnt lgkmcnt(3)
    ds_read_b128 a[76:79], v19 offset:32768
    v_cvt_pk_bf16_f32 v112, v112, v113
    v_mfma_f32_16x16x32_bf16 v[220:223], a[124:127], v[80:83], v[220:223]
    buffer_load_dwordx4 v35, s[12:15], s4 offen offset:3072 nt lds
    v_mfma_f32_16x16x32_bf16 v[188:191], a[124:127], v[72:75], v[188:191]
    v_exp_f32 v114, v114
    v_mfma_f32_16x16x32_bf16 v[156:159], a[124:127], v[64:67], v[156:159]
    s_add_u32 s4, s34, 12288
    s_mov_b32 m0, 28672
    ds_read_b128 a[80:83], v16 offset:36864
    v_mfma_f32_16x16x32_bf16 a[128:131], a[144:147], v[64:67], a[128:131]
    buffer_load_dwordx4 v32, s[12:15], s4 offen offset:0 nt lds
    v_mfma_f32_16x16x32_bf16 a[132:135], a[144:147], v[72:75], a[132:135]
    v_exp_f32 v115, v115
    v_exp_f32 v100, v100
    v_mfma_f32_16x16x32_bf16 a[136:139], a[144:147], v[80:83], a[136:139]
    s_waitcnt lgkmcnt(1)
    ds_read_b128 a[84:87], v17 offset:36864
    v_cvt_pk_bf16_f32 v113, v114, v115
    v_mfma_f32_16x16x32_bf16 v[64:67], a[64:67], a[0:3], v[48:51]
    buffer_load_dwordx4 v33, s[12:15], s4 offen offset:1024 nt lds
    v_mfma_f32_16x16x32_bf16 v[64:67], a[68:71], a[4:7], v[64:67]
    v_exp_f32 v101, v101
    v_exp_f32 v102, v102
    v_mfma_f32_16x16x32_bf16 v[64:67], a[72:75], a[8:11], v[64:67]
    ds_read_b128 a[88:91], v18 offset:36864
    v_cvt_pk_bf16_f32 v98, v100, v101
    v_mfma_f32_16x16x32_bf16 v[64:67], a[76:79], a[12:15], v[64:67]
    buffer_load_dwordx4 v34, s[12:15], s4 offen offset:2048 nt lds
    v_mfma_f32_16x16x32_bf16 v[72:75], a[76:79], a[28:31], v[52:55]
    v_exp_f32 v103, v103
    v_mfma_f32_16x16x32_bf16 v[72:75], a[72:75], a[24:27], v[72:75]
    ds_read_b128 a[92:95], v19 offset:36864
    v_cvt_pk_bf16_f32 v99, v102, v103
    v_mfma_f32_16x16x32_bf16 v[72:75], a[68:71], a[20:23], v[72:75]
    buffer_load_dwordx4 v35, s[12:15], s4 offen offset:3072 nt lds
    v_mfma_f32_16x16x32_bf16 v[72:75], a[64:67], a[16:19], v[72:75]
    v_exp_f32 v108, v108
    v_mfma_f32_16x16x32_bf16 v[80:83], a[64:67], a[32:35], v[56:59]
    v_exp_f32 v109, v109
    v_exp_f32 v110, v110
    v_mfma_f32_16x16x32_bf16 v[80:83], a[68:71], a[36:39], v[80:83]
    s_add_u32 s33, s33, 16384
    s_and_b32 s33, s33, 0x7ffff
    ds_read_b64_tr_b16 a[96:97], v20 offset:40960
    v_cvt_pk_bf16_f32 v106, v108, v109
    v_mfma_f32_16x16x32_bf16 v[80:83], a[72:75], a[40:43], v[80:83]
    s_add_u32 s4, s33, 0
    s_mov_b32 m0, 114688
    ds_read_b64_tr_b16 a[98:99], v20 offset:45056
    v_exp_f32 v111, v111
    v_mfma_f32_16x16x32_bf16 v[80:83], a[76:79], a[44:47], v[80:83]
    s_waitcnt lgkmcnt(2)
    buffer_load_dwordx4 v28, s[8:11], s4 offen offset:0 nt lds
    v_mfma_f32_16x16x32_bf16 v[68:71], a[80:83], a[0:3], v[48:51]
    ds_read_b64_tr_b16 a[100:101], v21 offset:40960
    v_exp_f32 v116, v116
    v_mfma_f32_16x16x32_bf16 v[68:71], a[84:87], a[4:7], v[68:71]
    ds_read_b64_tr_b16 a[102:103], v21 offset:45056
    v_cvt_pk_bf16_f32 v107, v110, v111
    v_mfma_f32_16x16x32_bf16 v[68:71], a[88:91], a[8:11], v[68:71]
    buffer_load_dwordx4 v29, s[8:11], s4 offen offset:1024 nt lds
    v_exp_f32 v117, v117
    v_mfma_f32_16x16x32_bf16 v[68:71], a[92:95], a[12:15], v[68:71]
    ds_read_b64_tr_b16 a[104:105], v22 offset:40960
    v_cvt_pk_bf16_f32 v114, v116, v117
    v_mfma_f32_16x16x32_bf16 v[76:79], a[92:95], a[28:31], v[52:55]
    ds_read_b64_tr_b16 a[106:107], v22 offset:45056
    v_exp_f32 v118, v118
    v_mfma_f32_16x16x32_bf16 v[76:79], a[88:91], a[24:27], v[76:79]
    buffer_load_dwordx4 v30, s[8:11], s4 offen offset:2048 nt lds
    v_mfma_f32_16x16x32_bf16 v[76:79], a[84:87], a[20:23], v[76:79]
    ds_read_b64_tr_b16 a[108:109], v23 offset:40960
    v_exp_f32 v119, v119
    v_mfma_f32_16x16x32_bf16 v[76:79], a[80:83], a[16:19], v[76:79]
    ds_read_b64_tr_b16 a[110:111], v23 offset:45056
    v_cvt_pk_bf16_f32 v115, v118, v119
    v_mfma_f32_16x16x32_bf16 v[84:87], a[80:83], a[32:35], v[56:59]
    buffer_load_dwordx4 v31, s[8:11], s4 offen offset:3072 nt lds
    v_mfma_f32_16x16x32_bf16 v[84:87], a[84:87], a[36:39], v[84:87]
    ds_read_b64_tr_b16 a[112:113], v24 offset:40960
    v_mfma_f32_16x16x32_bf16 v[84:87], a[88:91], a[40:43], v[84:87]
    s_add_u32 s4, s33, 4096
    s_mov_b32 m0, 118784
    ds_read_b64_tr_b16 a[114:115], v24 offset:45056
    v_mfma_f32_16x16x32_bf16 v[84:87], a[92:95], a[44:47], v[84:87]
    s_waitcnt lgkmcnt(8)
    buffer_load_dwordx4 v28, s[8:11], s4 offen offset:0 nt lds
    v_mfma_f32_16x16x32_bf16 v[128:131], a[96:99], v[96:99], v[128:131]
    ds_read_b64_tr_b16 a[116:117], v25 offset:40960
    v_mfma_f32_16x16x32_bf16 v[160:163], a[96:99], v[104:107], v[160:163]
    ds_read_b64_tr_b16 a[118:119], v25 offset:45056
    v_exp_f32 v64, v64
    v_mfma_f32_16x16x32_bf16 v[192:195], a[96:99], v[112:115], v[192:195]
    s_waitcnt lgkmcnt(8)
    buffer_load_dwordx4 v29, s[8:11], s4 offen offset:1024 nt lds
    v_exp_f32 v65, v65
    v_mfma_f32_16x16x32_bf16 v[196:199], a[100:103], v[112:115], v[196:199]
    ds_read_b64_tr_b16 a[120:121], v26 offset:40960
    v_cvt_pk_bf16_f32 v64, v64, v65
    v_mfma_f32_16x16x32_bf16 v[164:167], a[100:103], v[104:107], v[164:167]
    ds_read_b64_tr_b16 a[122:123], v26 offset:45056
    v_exp_f32 v66, v66
    v_mfma_f32_16x16x32_bf16 v[132:135], a[100:103], v[96:99], v[132:135]
    s_waitcnt lgkmcnt(8)
    buffer_load_dwordx4 v30, s[8:11], s4 offen offset:2048 nt lds
    v_mfma_f32_16x16x32_bf16 v[136:139], a[104:107], v[96:99], v[136:139]
    ds_read_b64_tr_b16 a[124:125], v27 offset:40960
    v_exp_f32 v67, v67
    v_mfma_f32_16x16x32_bf16 v[168:171], a[104:107], v[104:107], v[168:171]
    ds_read_b64_tr_b16 a[126:127], v27 offset:45056
    v_cvt_pk_bf16_f32 v65, v66, v67
    v_mfma_f32_16x16x32_bf16 v[200:203], a[104:107], v[112:115], v[200:203]
    s_waitcnt lgkmcnt(8)
    buffer_load_dwordx4 v31, s[8:11], s4 offen offset:3072 nt lds
    v_exp_f32 v72, v72
    v_mfma_f32_16x16x32_bf16 v[204:207], a[108:111], v[112:115], v[204:207]
    s_add_u32 s4, s33, 8192
    s_mov_b32 m0, 122880
    ds_read_b128 a[64:67], v16 offset:40960
    v_mfma_f32_16x16x32_bf16 v[172:175], a[108:111], v[104:107], v[172:175]
    buffer_load_dwordx4 v28, s[8:11], s4 offen offset:0 nt lds
    v_exp_f32 v73, v73
    v_mfma_f32_16x16x32_bf16 v[140:143], a[108:111], v[96:99], v[140:143]
    s_waitcnt lgkmcnt(7)
    buffer_load_dwordx4 v29, s[8:11], s4 offen offset:1024 nt lds
    v_mfma_f32_16x16x32_bf16 v[144:147], a[112:115], v[96:99], v[144:147]
    ds_read_b128 a[68:71], v17 offset:40960
    v_exp_f32 v74, v74
    v_mfma_f32_16x16x32_bf16 v[176:179], a[112:115], v[104:107], v[176:179]
    buffer_load_dwordx4 v30, s[8:11], s4 offen offset:2048 nt lds
    v_mfma_f32_16x16x32_bf16 v[208:211], a[112:115], v[112:115], v[208:211]
    s_waitcnt lgkmcnt(6)
    buffer_load_dwordx4 v31, s[8:11], s4 offen offset:3072 nt lds
    v_mfma_f32_16x16x32_bf16 v[212:215], a[116:119], v[112:115], v[212:215]
    ds_read_b128 a[72:75], v18 offset:40960
    v_cvt_pk_bf16_f32 v72, v72, v73
    v_mfma_f32_16x16x32_bf16 v[180:183], a[116:119], v[104:107], v[180:183]
    s_add_u32 s4, s33, 12288
    s_mov_b32 m0, 126976
    v_exp_f32 v75, v75
    v_mfma_f32_16x16x32_bf16 v[148:151], a[116:119], v[96:99], v[148:151]
    s_waitcnt lgkmcnt(5)
    buffer_load_dwordx4 v28, s[8:11], s4 offen offset:0 nt lds
    v_mfma_f32_16x16x32_bf16 v[152:155], a[120:123], v[96:99], v[152:155]
    ds_read_b128 a[76:79], v19 offset:40960
    v_cvt_pk_bf16_f32 v73, v74, v75
    v_mfma_f32_16x16x32_bf16 v[184:187], a[120:123], v[104:107], v[184:187]
    v_exp_f32 v80, v80
    v_exp_f32 v81, v81
    v_mfma_f32_16x16x32_bf16 v[216:219], a[120:123], v[112:115], v[216:219]
    s_waitcnt lgkmcnt(4)
    buffer_load_dwordx4 v29, s[8:11], s4 offen offset:1024 nt lds
    v_mfma_f32_16x16x32_bf16 v[220:223], a[124:127], v[112:115], v[220:223]
    ds_read_b128 a[80:83], v16 offset:45056
    v_cvt_pk_bf16_f32 v80, v80, v81
    v_mfma_f32_16x16x32_bf16 v[188:191], a[124:127], v[104:107], v[188:191]
    v_exp_f32 v82, v82
    v_mfma_f32_16x16x32_bf16 v[156:159], a[124:127], v[96:99], v[156:159]
    buffer_load_dwordx4 v30, s[8:11], s4 offen offset:2048 nt lds
    v_mfma_f32_16x16x32_bf16 a[128:131], a[144:147], v[96:99], a[128:131]
    ds_read_b128 a[84:87], v17 offset:45056
    v_mfma_f32_16x16x32_bf16 a[132:135], a[144:147], v[104:107], a[132:135]
    v_exp_f32 v83, v83
    v_exp_f32 v68, v68
    v_mfma_f32_16x16x32_bf16 a[136:139], a[144:147], v[112:115], a[136:139]
    s_waitcnt lgkmcnt(2)
    buffer_load_dwordx4 v31, s[8:11], s4 offen offset:3072 nt lds
    v_mfma_f32_16x16x32_bf16 v[96:99], a[64:67], a[0:3], v[48:51]
    ds_read_b128 a[88:91], v18 offset:45056
    v_cvt_pk_bf16_f32 v81, v82, v83
    v_mfma_f32_16x16x32_bf16 v[96:99], a[68:71], a[4:7], v[96:99]
    v_exp_f32 v69, v69
    v_mfma_f32_16x16x32_bf16 v[96:99], a[72:75], a[8:11], v[96:99]
    v_exp_f32 v70, v70
    v_mfma_f32_16x16x32_bf16 v[96:99], a[76:79], a[12:15], v[96:99]
    ds_read_b128 a[92:95], v19 offset:45056
    v_cvt_pk_bf16_f32 v66, v68, v69
    v_mfma_f32_16x16x32_bf16 v[104:107], a[76:79], a[28:31], v[52:55]
    v_exp_f32 v71, v71
    v_mfma_f32_16x16x32_bf16 v[104:107], a[72:75], a[24:27], v[104:107]
    v_exp_f32 v76, v76
    v_mfma_f32_16x16x32_bf16 v[104:107], a[68:71], a[20:23], v[104:107]
    v_exp_f32 v77, v77
    v_mfma_f32_16x16x32_bf16 v[104:107], a[64:67], a[16:19], v[104:107]
    v_cvt_pk_bf16_f32 v67, v70, v71
    v_cvt_pk_bf16_f32 v74, v76, v77
    v_mfma_f32_16x16x32_bf16 v[112:115], a[64:67], a[32:35], v[56:59]
    v_exp_f32 v78, v78
    v_mfma_f32_16x16x32_bf16 v[112:115], a[68:71], a[36:39], v[112:115]
    v_mfma_f32_16x16x32_bf16 v[112:115], a[72:75], a[40:43], v[112:115]
    v_exp_f32 v79, v79
    v_mfma_f32_16x16x32_bf16 v[112:115], a[76:79], a[44:47], v[112:115]
    v_cvt_pk_bf16_f32 v75, v78, v79
    s_waitcnt vmcnt(60) lgkmcnt(0)
    s_barrier
    v_mfma_f32_16x16x32_bf16 v[100:103], a[80:83], a[0:3], v[48:51]
    ds_read_b64_tr_b16 a[96:97], v20 offset:49152
    v_mfma_f32_16x16x32_bf16 v[100:103], a[84:87], a[4:7], v[100:103]
    ds_read_b64_tr_b16 a[98:99], v20 offset:53248
    v_mfma_f32_16x16x32_bf16 v[100:103], a[88:91], a[8:11], v[100:103]
    v_exp_f32 v84, v84
    v_mfma_f32_16x16x32_bf16 v[100:103], a[92:95], a[12:15], v[100:103]
    s_add_u32 s34, s34, 16384
    s_and_b32 s34, s34, 0x7ffff
    ds_read_b64_tr_b16 a[100:101], v21 offset:49152
    v_exp_f32 v85, v85
    v_mfma_f32_16x16x32_bf16 v[108:111], a[92:95], a[28:31], v[52:55]
    s_add_u32 s4, s34, 0
    s_mov_b32 m0, 32768
    ds_read_b64_tr_b16 a[102:103], v21 offset:53248
    v_cvt_pk_bf16_f32 v82, v84, v85
    v_mfma_f32_16x16x32_bf16 v[108:111], a[88:91], a[24:27], v[108:111]
    buffer_load_dwordx4 v32, s[12:15], s4 offen offset:0 nt lds
    v_exp_f32 v86, v86
    v_mfma_f32_16x16x32_bf16 v[108:111], a[84:87], a[20:23], v[108:111]
    ds_read_b64_tr_b16 a[104:105], v22 offset:49152
    v_mfma_f32_16x16x32_bf16 v[108:111], a[80:83], a[16:19], v[108:111]
    ds_read_b64_tr_b16 a[106:107], v22 offset:53248
    v_exp_f32 v87, v87
    v_mfma_f32_16x16x32_bf16 v[116:119], a[80:83], a[32:35], v[56:59]
    buffer_load_dwordx4 v33, s[12:15], s4 offen offset:1024 nt lds
    v_mfma_f32_16x16x32_bf16 v[116:119], a[84:87], a[36:39], v[116:119]
    ds_read_b64_tr_b16 a[108:109], v23 offset:49152
    v_cvt_pk_bf16_f32 v83, v86, v87
    v_mfma_f32_16x16x32_bf16 v[116:119], a[88:91], a[40:43], v[116:119]
    ds_read_b64_tr_b16 a[110:111], v23 offset:53248
    v_mfma_f32_16x16x32_bf16 v[116:119], a[92:95], a[44:47], v[116:119]
    s_waitcnt lgkmcnt(6)
    buffer_load_dwordx4 v34, s[12:15], s4 offen offset:2048 nt lds
    v_mfma_f32_16x16x32_bf16 v[128:131], a[96:99], v[64:67], v[128:131]
    ds_read_b64_tr_b16 a[112:113], v24 offset:49152
    v_mfma_f32_16x16x32_bf16 v[160:163], a[96:99], v[72:75], v[160:163]
    ds_read_b64_tr_b16 a[114:115], v24 offset:53248
    v_exp_f32 v96, v96
    v_mfma_f32_16x16x32_bf16 v[192:195], a[96:99], v[80:83], v[192:195]
    s_waitcnt lgkmcnt(6)
    buffer_load_dwordx4 v35, s[12:15], s4 offen offset:3072 nt lds
    v_exp_f32 v97, v97
    v_mfma_f32_16x16x32_bf16 v[196:199], a[100:103], v[80:83], v[196:199]
    ds_read_b64_tr_b16 a[116:117], v25 offset:49152
    v_cvt_pk_bf16_f32 v96, v96, v97
    v_mfma_f32_16x16x32_bf16 v[164:167], a[100:103], v[72:75], v[164:167]
    s_add_u32 s4, s34, 4096
    s_mov_b32 m0, 36864
    ds_read_b64_tr_b16 a[118:119], v25 offset:53248
    v_exp_f32 v98, v98
    v_mfma_f32_16x16x32_bf16 v[132:135], a[100:103], v[64:67], v[132:135]
    s_waitcnt lgkmcnt(6)
    buffer_load_dwordx4 v32, s[12:15], s4 offen offset:0 nt lds
    v_mfma_f32_16x16x32_bf16 v[136:139], a[104:107], v[64:67], v[136:139]
    ds_read_b64_tr_b16 a[120:121], v26 offset:49152
    v_exp_f32 v99, v99
    v_mfma_f32_16x16x32_bf16 v[168:171], a[104:107], v[72:75], v[168:171]
    ds_read_b64_tr_b16 a[122:123], v26 offset:53248
    v_cvt_pk_bf16_f32 v97, v98, v99
    v_mfma_f32_16x16x32_bf16 v[200:203], a[104:107], v[80:83], v[200:203]
    s_waitcnt lgkmcnt(6)
    buffer_load_dwordx4 v33, s[12:15], s4 offen offset:1024 nt lds
    v_exp_f32 v104, v104
    v_mfma_f32_16x16x32_bf16 v[204:207], a[108:111], v[80:83], v[204:207]
    ds_read_b64_tr_b16 a[124:125], v27 offset:49152
    v_mfma_f32_16x16x32_bf16 v[172:175], a[108:111], v[72:75], v[172:175]
    ds_read_b64_tr_b16 a[126:127], v27 offset:53248
    v_exp_f32 v105, v105
    v_mfma_f32_16x16x32_bf16 v[140:143], a[108:111], v[64:67], v[140:143]
    s_waitcnt lgkmcnt(6)
    ds_read_b128 a[64:67], v16 offset:49152
    v_cvt_pk_bf16_f32 v104, v104, v105
    v_mfma_f32_16x16x32_bf16 v[144:147], a[112:115], v[64:67], v[144:147]
    buffer_load_dwordx4 v34, s[12:15], s4 offen offset:2048 nt lds
    v_exp_f32 v106, v106
    v_mfma_f32_16x16x32_bf16 v[176:179], a[112:115], v[72:75], v[176:179]
    buffer_load_dwordx4 v35, s[12:15], s4 offen offset:3072 nt lds
    v_mfma_f32_16x16x32_bf16 v[208:211], a[112:115], v[80:83], v[208:211]
    s_waitcnt lgkmcnt(5)
    s_add_u32 s4, s34, 8192
    s_mov_b32 m0, 40960
    ds_read_b128 a[68:71], v17 offset:49152
    v_exp_f32 v107, v107
    v_mfma_f32_16x16x32_bf16 v[212:215], a[116:119], v[80:83], v[212:215]
    buffer_load_dwordx4 v32, s[12:15], s4 offen offset:0 nt lds
    v_mfma_f32_16x16x32_bf16 v[180:183], a[116:119], v[72:75], v[180:183]
    buffer_load_dwordx4 v33, s[12:15], s4 offen offset:1024 nt lds
    v_mfma_f32_16x16x32_bf16 v[148:151], a[116:119], v[64:67], v[148:151]
    s_waitcnt lgkmcnt(4)
    ds_read_b128 a[72:75], v18 offset:49152
    v_cvt_pk_bf16_f32 v105, v106, v107
    v_mfma_f32_16x16x32_bf16 v[152:155], a[120:123], v[64:67], v[152:155]
    buffer_load_dwordx4 v34, s[12:15], s4 offen offset:2048 nt lds
    v_mfma_f32_16x16x32_bf16 v[184:187], a[120:123], v[72:75], v[184:187]
    v_exp_f32 v112, v112
    v_exp_f32 v113, v113
    v_mfma_f32_16x16x32_bf16 v[216:219], a[120:123], v[80:83], v[216:219]
    s_waitcnt lgkmcnt(3)
    ds_read_b128 a[76:79], v19 offset:49152
    v_cvt_pk_bf16_f32 v112, v112, v113
    v_mfma_f32_16x16x32_bf16 v[220:223], a[124:127], v[80:83], v[220:223]
    buffer_load_dwordx4 v35, s[12:15], s4 offen offset:3072 nt lds
    v_mfma_f32_16x16x32_bf16 v[188:191], a[124:127], v[72:75], v[188:191]
    v_exp_f32 v114, v114
    v_mfma_f32_16x16x32_bf16 v[156:159], a[124:127], v[64:67], v[156:159]
    s_add_u32 s4, s34, 12288
    s_mov_b32 m0, 45056
    ds_read_b128 a[80:83], v16 offset:53248
    v_mfma_f32_16x16x32_bf16 a[128:131], a[144:147], v[64:67], a[128:131]
    buffer_load_dwordx4 v32, s[12:15], s4 offen offset:0 nt lds
    v_mfma_f32_16x16x32_bf16 a[132:135], a[144:147], v[72:75], a[132:135]
    v_exp_f32 v115, v115
    v_exp_f32 v100, v100
    v_mfma_f32_16x16x32_bf16 a[136:139], a[144:147], v[80:83], a[136:139]
    s_waitcnt lgkmcnt(1)
    ds_read_b128 a[84:87], v17 offset:53248
    v_cvt_pk_bf16_f32 v113, v114, v115
    v_mfma_f32_16x16x32_bf16 v[64:67], a[64:67], a[0:3], v[48:51]
    buffer_load_dwordx4 v33, s[12:15], s4 offen offset:1024 nt lds
    v_mfma_f32_16x16x32_bf16 v[64:67], a[68:71], a[4:7], v[64:67]
    v_exp_f32 v101, v101
    v_exp_f32 v102, v102
    v_mfma_f32_16x16x32_bf16 v[64:67], a[72:75], a[8:11], v[64:67]
    ds_read_b128 a[88:91], v18 offset:53248
    v_cvt_pk_bf16_f32 v98, v100, v101
    v_mfma_f32_16x16x32_bf16 v[64:67], a[76:79], a[12:15], v[64:67]
    buffer_load_dwordx4 v34, s[12:15], s4 offen offset:2048 nt lds
    v_mfma_f32_16x16x32_bf16 v[72:75], a[76:79], a[28:31], v[52:55]
    v_exp_f32 v103, v103
    v_mfma_f32_16x16x32_bf16 v[72:75], a[72:75], a[24:27], v[72:75]
    ds_read_b128 a[92:95], v19 offset:53248
    v_cvt_pk_bf16_f32 v99, v102, v103
    v_mfma_f32_16x16x32_bf16 v[72:75], a[68:71], a[20:23], v[72:75]
    buffer_load_dwordx4 v35, s[12:15], s4 offen offset:3072 nt lds
    v_mfma_f32_16x16x32_bf16 v[72:75], a[64:67], a[16:19], v[72:75]
    v_exp_f32 v108, v108
    v_mfma_f32_16x16x32_bf16 v[80:83], a[64:67], a[32:35], v[56:59]
    v_exp_f32 v109, v109
    v_exp_f32 v110, v110
    v_mfma_f32_16x16x32_bf16 v[80:83], a[68:71], a[36:39], v[80:83]
    s_add_u32 s33, s33, 16384
    s_and_b32 s33, s33, 0x7ffff
    ds_read_b64_tr_b16 a[96:97], v20 offset:57344
    v_cvt_pk_bf16_f32 v106, v108, v109
    v_mfma_f32_16x16x32_bf16 v[80:83], a[72:75], a[40:43], v[80:83]
    s_add_u32 s4, s33, 0
    s_mov_b32 m0, 131072
    ds_read_b64_tr_b16 a[98:99], v20 offset:61440
    v_exp_f32 v111, v111
    v_mfma_f32_16x16x32_bf16 v[80:83], a[76:79], a[44:47], v[80:83]
    s_waitcnt lgkmcnt(2)
    buffer_load_dwordx4 v28, s[8:11], s4 offen offset:0 nt lds
    v_mfma_f32_16x16x32_bf16 v[68:71], a[80:83], a[0:3], v[48:51]
    ds_read_b64_tr_b16 a[100:101], v21 offset:57344
    v_exp_f32 v116, v116
    v_mfma_f32_16x16x32_bf16 v[68:71], a[84:87], a[4:7], v[68:71]
    ds_read_b64_tr_b16 a[102:103], v21 offset:61440
    v_cvt_pk_bf16_f32 v107, v110, v111
    v_mfma_f32_16x16x32_bf16 v[68:71], a[88:91], a[8:11], v[68:71]
    buffer_load_dwordx4 v29, s[8:11], s4 offen offset:1024 nt lds
    v_exp_f32 v117, v117
    v_mfma_f32_16x16x32_bf16 v[68:71], a[92:95], a[12:15], v[68:71]
    ds_read_b64_tr_b16 a[104:105], v22 offset:57344
    v_cvt_pk_bf16_f32 v114, v116, v117
    v_mfma_f32_16x16x32_bf16 v[76:79], a[92:95], a[28:31], v[52:55]
    ds_read_b64_tr_b16 a[106:107], v22 offset:61440
    v_exp_f32 v118, v118
    v_mfma_f32_16x16x32_bf16 v[76:79], a[88:91], a[24:27], v[76:79]
    buffer_load_dwordx4 v30, s[8:11], s4 offen offset:2048 nt lds
    v_mfma_f32_16x16x32_bf16 v[76:79], a[84:87], a[20:23], v[76:79]
    ds_read_b64_tr_b16 a[108:109], v23 offset:57344
    v_exp_f32 v119, v119
    v_mfma_f32_16x16x32_bf16 v[76:79], a[80:83], a[16:19], v[76:79]
    ds_read_b64_tr_b16 a[110:111], v23 offset:61440
    v_cvt_pk_bf16_f32 v115, v118, v119
    v_mfma_f32_16x16x32_bf16 v[84:87], a[80:83], a[32:35], v[56:59]
    buffer_load_dwordx4 v31, s[8:11], s4 offen offset:3072 nt lds
    v_mfma_f32_16x16x32_bf16 v[84:87], a[84:87], a[36:39], v[84:87]
    ds_read_b64_tr_b16 a[112:113], v24 offset:57344
    v_mfma_f32_16x16x32_bf16 v[84:87], a[88:91], a[40:43], v[84:87]
    s_add_u32 s4, s33, 4096
    s_mov_b32 m0, 135168
    ds_read_b64_tr_b16 a[114:115], v24 offset:61440
    v_mfma_f32_16x16x32_bf16 v[84:87], a[92:95], a[44:47], v[84:87]
    s_waitcnt lgkmcnt(8)
    buffer_load_dwordx4 v28, s[8:11], s4 offen offset:0 nt lds
    v_mfma_f32_16x16x32_bf16 v[128:131], a[96:99], v[96:99], v[128:131]
    ds_read_b64_tr_b16 a[116:117], v25 offset:57344
    v_mfma_f32_16x16x32_bf16 v[160:163], a[96:99], v[104:107], v[160:163]
    ds_read_b64_tr_b16 a[118:119], v25 offset:61440
    v_exp_f32 v64, v64
    v_mfma_f32_16x16x32_bf16 v[192:195], a[96:99], v[112:115], v[192:195]
    s_waitcnt lgkmcnt(8)
    buffer_load_dwordx4 v29, s[8:11], s4 offen offset:1024 nt lds
    v_exp_f32 v65, v65
    v_mfma_f32_16x16x32_bf16 v[196:199], a[100:103], v[112:115], v[196:199]
    ds_read_b64_tr_b16 a[120:121], v26 offset:57344
    v_cvt_pk_bf16_f32 v64, v64, v65
    v_mfma_f32_16x16x32_bf16 v[164:167], a[100:103], v[104:107], v[164:167]
    ds_read_b64_tr_b16 a[122:123], v26 offset:61440
    v_exp_f32 v66, v66
    v_mfma_f32_16x16x32_bf16 v[132:135], a[100:103], v[96:99], v[132:135]
    s_waitcnt lgkmcnt(8)
    buffer_load_dwordx4 v30, s[8:11], s4 offen offset:2048 nt lds
    v_mfma_f32_16x16x32_bf16 v[136:139], a[104:107], v[96:99], v[136:139]
    ds_read_b64_tr_b16 a[124:125], v27 offset:57344
    v_exp_f32 v67, v67
    v_mfma_f32_16x16x32_bf16 v[168:171], a[104:107], v[104:107], v[168:171]
    ds_read_b64_tr_b16 a[126:127], v27 offset:61440
    v_cvt_pk_bf16_f32 v65, v66, v67
    v_mfma_f32_16x16x32_bf16 v[200:203], a[104:107], v[112:115], v[200:203]
    s_waitcnt lgkmcnt(8)
    buffer_load_dwordx4 v31, s[8:11], s4 offen offset:3072 nt lds
    v_exp_f32 v72, v72
    v_mfma_f32_16x16x32_bf16 v[204:207], a[108:111], v[112:115], v[204:207]
    s_add_u32 s4, s33, 8192
    s_mov_b32 m0, 139264
    ds_read_b128 a[64:67], v16 offset:57344
    v_mfma_f32_16x16x32_bf16 v[172:175], a[108:111], v[104:107], v[172:175]
    buffer_load_dwordx4 v28, s[8:11], s4 offen offset:0 nt lds
    v_exp_f32 v73, v73
    v_mfma_f32_16x16x32_bf16 v[140:143], a[108:111], v[96:99], v[140:143]
    s_waitcnt lgkmcnt(7)
    buffer_load_dwordx4 v29, s[8:11], s4 offen offset:1024 nt lds
    v_mfma_f32_16x16x32_bf16 v[144:147], a[112:115], v[96:99], v[144:147]
    ds_read_b128 a[68:71], v17 offset:57344
    v_exp_f32 v74, v74
    v_mfma_f32_16x16x32_bf16 v[176:179], a[112:115], v[104:107], v[176:179]
    buffer_load_dwordx4 v30, s[8:11], s4 offen offset:2048 nt lds
    v_mfma_f32_16x16x32_bf16 v[208:211], a[112:115], v[112:115], v[208:211]
    s_waitcnt lgkmcnt(6)
    buffer_load_dwordx4 v31, s[8:11], s4 offen offset:3072 nt lds
    v_mfma_f32_16x16x32_bf16 v[212:215], a[116:119], v[112:115], v[212:215]
    ds_read_b128 a[72:75], v18 offset:57344
    v_cvt_pk_bf16_f32 v72, v72, v73
    v_mfma_f32_16x16x32_bf16 v[180:183], a[116:119], v[104:107], v[180:183]
    s_add_u32 s4, s33, 12288
    s_mov_b32 m0, 143360
    v_exp_f32 v75, v75
    v_mfma_f32_16x16x32_bf16 v[148:151], a[116:119], v[96:99], v[148:151]
    s_waitcnt lgkmcnt(5)
    buffer_load_dwordx4 v28, s[8:11], s4 offen offset:0 nt lds
    v_mfma_f32_16x16x32_bf16 v[152:155], a[120:123], v[96:99], v[152:155]
    ds_read_b128 a[76:79], v19 offset:57344
    v_cvt_pk_bf16_f32 v73, v74, v75
    v_mfma_f32_16x16x32_bf16 v[184:187], a[120:123], v[104:107], v[184:187]
    v_exp_f32 v80, v80
    v_exp_f32 v81, v81
    v_mfma_f32_16x16x32_bf16 v[216:219], a[120:123], v[112:115], v[216:219]
    s_waitcnt lgkmcnt(4)
    buffer_load_dwordx4 v29, s[8:11], s4 offen offset:1024 nt lds
    v_mfma_f32_16x16x32_bf16 v[220:223], a[124:127], v[112:115], v[220:223]
    ds_read_b128 a[80:83], v16 offset:61440
    v_cvt_pk_bf16_f32 v80, v80, v81
    v_mfma_f32_16x16x32_bf16 v[188:191], a[124:127], v[104:107], v[188:191]
    v_exp_f32 v82, v82
    v_mfma_f32_16x16x32_bf16 v[156:159], a[124:127], v[96:99], v[156:159]
    buffer_load_dwordx4 v30, s[8:11], s4 offen offset:2048 nt lds
    v_mfma_f32_16x16x32_bf16 a[128:131], a[144:147], v[96:99], a[128:131]
    ds_read_b128 a[84:87], v17 offset:61440
    v_mfma_f32_16x16x32_bf16 a[132:135], a[144:147], v[104:107], a[132:135]
    v_exp_f32 v83, v83
    v_exp_f32 v68, v68
    v_mfma_f32_16x16x32_bf16 a[136:139], a[144:147], v[112:115], a[136:139]
    s_waitcnt lgkmcnt(2)
    buffer_load_dwordx4 v31, s[8:11], s4 offen offset:3072 nt lds
    v_mfma_f32_16x16x32_bf16 v[96:99], a[64:67], a[0:3], v[48:51]
    ds_read_b128 a[88:91], v18 offset:61440
    v_cvt_pk_bf16_f32 v81, v82, v83
    v_mfma_f32_16x16x32_bf16 v[96:99], a[68:71], a[4:7], v[96:99]
    v_exp_f32 v69, v69
    v_mfma_f32_16x16x32_bf16 v[96:99], a[72:75], a[8:11], v[96:99]
    v_exp_f32 v70, v70
    v_mfma_f32_16x16x32_bf16 v[96:99], a[76:79], a[12:15], v[96:99]
    ds_read_b128 a[92:95], v19 offset:61440
    v_cvt_pk_bf16_f32 v66, v68, v69
    v_mfma_f32_16x16x32_bf16 v[104:107], a[76:79], a[28:31], v[52:55]
    s_sub_u32 s35, s35, 1
    v_exp_f32 v71, v71
    v_mfma_f32_16x16x32_bf16 v[104:107], a[72:75], a[24:27], v[104:107]
    v_exp_f32 v76, v76
    v_mfma_f32_16x16x32_bf16 v[104:107], a[68:71], a[20:23], v[104:107]
    v_exp_f32 v77, v77
    v_mfma_f32_16x16x32_bf16 v[104:107], a[64:67], a[16:19], v[104:107]
    v_cvt_pk_bf16_f32 v67, v70, v71
    v_cvt_pk_bf16_f32 v74, v76, v77
    v_mfma_f32_16x16x32_bf16 v[112:115], a[64:67], a[32:35], v[56:59]
    s_cmp_gt_u32 s35, 1
    v_exp_f32 v78, v78
    v_mfma_f32_16x16x32_bf16 v[112:115], a[68:71], a[36:39], v[112:115]
    v_mfma_f32_16x16x32_bf16 v[112:115], a[72:75], a[40:43], v[112:115]
    v_exp_f32 v79, v79
    v_mfma_f32_16x16x32_bf16 v[112:115], a[76:79], a[44:47], v[112:115]
    v_cvt_pk_bf16_f32 v75, v78, v79
    s_waitcnt vmcnt(60) lgkmcnt(0)
    s_barrier
    s_cbranch_scc1 L_loopB
    s_cmp_eq_u32 s35, 0
    s_cbranch_scc1 L_tailB
    s_add_u32 m0, s30, 65536
    s_mov_b32 s38, 0
    buffer_load_dwordx4 v36, s[76:79], s38 offen offset:0 lds
    buffer_load_dwordx4 v37, s[76:79], s38 offen offset:1024 lds
    buffer_load_dwordx4 v38, s[76:79], s38 offen offset:2048 lds
    buffer_load_dwordx4 v39, s[76:79], s38 offen offset:3072 lds
    s_add_u32 m0, s30, 81920
    s_mov_b32 s38, 40960
    buffer_load_dwordx4 v36, s[76:79], s38 offen offset:0 lds
    buffer_load_dwordx4 v37, s[76:79], s38 offen offset:1024 lds
    buffer_load_dwordx4 v38, s[76:79], s38 offen offset:2048 lds
    buffer_load_dwordx4 v39, s[76:79], s38 offen offset:3072 lds
    s_branch L_loopB
L_tailB:
    v_mfma_f32_16x16x32_bf16 v[100:103], a[80:83], a[0:3], v[48:51]
    ds_read_b64_tr_b16 a[96:97], v20 offset:0
    v_mfma_f32_16x16x32_bf16 v[100:103], a[84:87], a[4:7], v[100:103]
    ds_read_b64_tr_b16 a[98:99], v20 offset:4096
    v_mfma_f32_16x16x32_bf16 v[100:103], a[88:91], a[8:11], v[100:103]
    v_exp_f32 v84, v84
    v_mfma_f32_16x16x32_bf16 v[100:103], a[92:95], a[12:15], v[100:103]
    s_add_u32 s34, s34, 16384
    s_and_b32 s34, s34, 0x7ffff
    ds_read_b64_tr_b16 a[100:101], v21 offset:0
    v_exp_f32 v85, v85
    v_mfma_f32_16x16x32_bf16 v[108:111], a[92:95], a[28:31], v[52:55]
    s_add_u32 s4, s34, 0
    s_mov_b32 m0, 49152
    ds_read_b64_tr_b16 a[102:103], v21 offset:4096
    v_cvt_pk_bf16_f32 v82, v84, v85
    v_mfma_f32_16x16x32_bf16 v[108:111], a[88:91], a[24:27], v[108:111]
    buffer_load_dwordx4 v32, s[12:15], s4 offen offset:0 nt lds
    v_exp_f32 v86, v86
    v_mfma_f32_16x16x32_bf16 v[108:111], a[84:87], a[20:23], v[108:111]
    ds_read_b64_tr_b16 a[104:105], v22 offset:0
    v_mfma_f32_16x16x32_bf16 v[108:111], a[80:83], a[16:19], v[108:111]
    ds_read_b64_tr_b16 a[106:107], v22 offset:4096
    v_exp_f32 v87, v87
    v_mfma_f32_16x16x32_bf16 v[116:119], a[80:83], a[32:35], v[56:59]
    buffer_load_dwordx4 v33, s[12:15], s4 offen offset:1024 nt lds
    v_mfma_f32_16x16x32_bf16 v[116:119], a[84:87], a[36:39], v[116:119]
    ds_read_b64_tr_b16 a[108:109], v23 offset:0
    v_cvt_pk_bf16_f32 v83, v86, v87
    v_mfma_f32_16x16x32_bf16 v[116:119], a[88:91], a[40:43], v[116:119]
    ds_read_b64_tr_b16 a[110:111], v23 offset:4096
    v_mfma_f32_16x16x32_bf16 v[116:119], a[92:95], a[44:47], v[116:119]
    s_waitcnt lgkmcnt(6)
    buffer_load_dwordx4 v34, s[12:15], s4 offen offset:2048 nt lds
    v_mfma_f32_16x16x32_bf16 v[128:131], a[96:99], v[64:67], v[128:131]
    ds_read_b64_tr_b16 a[112:113], v24 offset:0
    v_mfma_f32_16x16x32_bf16 v[160:163], a[96:99], v[72:75], v[160:163]
    ds_read_b64_tr_b16 a[114:115], v24 offset:4096
    v_exp_f32 v96, v96
    v_mfma_f32_16x16x32_bf16 v[192:195], a[96:99], v[80:83], v[192:195]
    s_waitcnt lgkmcnt(6)
    buffer_load_dwordx4 v35, s[12:15], s4 offen offset:3072 nt lds
    v_exp_f32 v97, v97
    v_mfma_f32_16x16x32_bf16 v[196:199], a[100:103], v[80:83], v[196:199]
    ds_read_b64_tr_b16 a[116:117], v25 offset:0
    v_cvt_pk_bf16_f32 v96, v96, v97
    v_mfma_f32_16x16x32_bf16 v[164:167], a[100:103], v[72:75], v[164:167]
    s_add_u32 s4, s34, 4096
    s_mov_b32 m0, 53248
    ds_read_b64_tr_b16 a[118:119], v25 offset:4096
    v_exp_f32 v98, v98
    v_mfma_f32_16x16x32_bf16 v[132:135], a[100:103], v[64:67], v[132:135]
    s_waitcnt lgkmcnt(6)
    buffer_load_dwordx4 v32, s[12:15], s4 offen offset:0 nt lds
    v_mfma_f32_16x16x32_bf16 v[136:139], a[104:107], v[64:67], v[136:139]
    ds_read_b64_tr_b16 a[120:121], v26 offset:0
    v_exp_f32 v99, v99
    v_mfma_f32_16x16x32_bf16 v[168:171], a[104:107], v[72:75], v[168:171]
    ds_read_b64_tr_b16 a[122:123], v26 offset:4096
    v_cvt_pk_bf16_f32 v97, v98, v99
    v_mfma_f32_16x16x32_bf16 v[200:203], a[104:107], v[80:83], v[200:203]
    s_waitcnt lgkmcnt(6)
    buffer_load_dwordx4 v33, s[12:15], s4 offen offset:1024 nt lds
    v_exp_f32 v104, v104
    v_mfma_f32_16x16x32_bf16 v[204:207], a[108:111], v[80:83], v[204:207]
    ds_read_b64_tr_b16 a[124:125], v27 offset:0
    v_mfma_f32_16x16x32_bf16 v[172:175], a[108:111], v[72:75], v[172:175]
    ds_read_b64_tr_b16 a[126:127], v27 offset:4096
    ds_read_b64_tr_b16 a[160:161], v44 offset:0
    v_mfma_f32_16x16x32_bf16 v[140:143], a[108:111], v[64:67], v[140:143]
    s_waitcnt lgkmcnt(7)
    ds_read_b128 a[64:67], v16 offset:0
    v_exp_f32 v105, v105
    v_mfma_f32_16x16x32_bf16 v[144:147], a[112:115], v[64:67], v[144:147]
    buffer_load_dwordx4 v34, s[12:15], s4 offen offset:2048 nt lds
    ds_read_b64_tr_b16 a[162:163], v44 offset:2048
    v_cvt_pk_bf16_f32 v104, v104, v105
    v_mfma_f32_16x16x32_bf16 v[176:179], a[112:115], v[72:75], v[176:179]
    buffer_load_dwordx4 v35, s[12:15], s4 offen offset:3072 nt lds
    v_exp_f32 v106, v106
    v_mfma_f32_16x16x32_bf16 v[208:211], a[112:115], v[80:83], v[208:211]
    s_waitcnt lgkmcnt(7)
    s_add_u32 s4, s34, 8192
    s_mov_b32 m0, 57344
    ds_read_b128 a[68:71], v17 offset:0
    ds_read_b64_tr_b16 a[164:165], v45 offset:0
    v_mfma_f32_16x16x32_bf16 v[212:215], a[116:119], v[80:83], v[212:215]
    buffer_load_dwordx4 v32, s[12:15], s4 offen offset:0 nt lds
    v_exp_f32 v107, v107
    v_mfma_f32_16x16x32_bf16 v[180:183], a[116:119], v[72:75], v[180:183]
    buffer_load_dwordx4 v33, s[12:15], s4 offen offset:1024 nt lds
    ds_read_b64_tr_b16 a[166:167], v45 offset:2048
    v_cvt_pk_bf16_f32 v105, v106, v107
    v_mfma_f32_16x16x32_bf16 v[148:151], a[116:119], v[64:67], v[148:151]
    s_waitcnt lgkmcnt(8)
    ds_read_b128 a[72:75], v18 offset:0
    v_exp_f32 v112, v112
    v_mfma_f32_16x16x32_bf16 v[152:155], a[120:123], v[64:67], v[152:155]
    buffer_load_dwordx4 v34, s[12:15], s4 offen offset:2048 nt lds
    ds_read_b64_tr_b16 a[168:169], v46 offset:0
    v_mfma_f32_16x16x32_bf16 v[184:187], a[120:123], v[72:75], v[184:187]
    buffer_load_dwordx4 v35, s[12:15], s4 offen offset:3072 nt lds
    v_exp_f32 v113, v113
    v_mfma_f32_16x16x32_bf16 v[216:219], a[120:123], v[80:83], v[216:219]
    s_waitcnt lgkmcnt(8)
    s_add_u32 s4, s34, 12288
    s_mov_b32 m0, 61440
    ds_read_b128 a[76:79], v19 offset:0
    ds_read_b64_tr_b16 a[170:171], v46 offset:2048
    v_mfma_f32_16x16x32_bf16 v[220:223], a[124:127], v[80:83], v[220:223]
    buffer_load_dwordx4 v32, s[12:15], s4 offen offset:0 nt lds
    v_exp_f32 v114, v114
    v_mfma_f32_16x16x32_bf16 v[188:191], a[124:127], v[72:75], v[188:191]
    buffer_load_dwordx4 v33, s[12:15], s4 offen offset:1024 nt lds
    v_exp_f32 v115, v115
    v_mfma_f32_16x16x32_bf16 v[156:159], a[124:127], v[64:67], v[156:159]
    ds_read_b128 a[80:83], v16 offset:4096
    v_cvt_pk_bf16_f32 v112, v112, v113
    v_mfma_f32_16x16x32_bf16 a[128:131], a[144:147], v[64:67], a[128:131]
    ds_read_b64_tr_b16 a[172:173], v47 offset:0
    v_exp_f32 v100, v100
    v_mfma_f32_16x16x32_bf16 a[132:135], a[144:147], v[72:75], a[132:135]
    buffer_load_dwordx4 v34, s[12:15], s4 offen offset:2048 nt lds
    v_exp_f32 v101, v101
    v_mfma_f32_16x16x32_bf16 a[136:139], a[144:147], v[80:83], a[136:139]
    s_waitcnt lgkmcnt(3)
    ds_read_b128 a[84:87], v17 offset:4096
    v_cvt_pk_bf16_f32 v113, v114, v115
    v_mfma_f32_16x16x32_bf16 v[64:67], a[64:67], a[0:3], v[48:51]
    buffer_load_dwordx4 v35, s[12:15], s4 offen offset:3072 nt lds
    v_exp_f32 v102, v102
    v_mfma_f32_16x16x32_bf16 v[64:67], a[68:71], a[4:7], v[64:67]
    ds_read_b64_tr_b16 a[174:175], v47 offset:2048
    v_cvt_pk_bf16_f32 v98, v100, v101
    v_mfma_f32_16x16x32_bf16 v[64:67], a[72:75], a[8:11], v[64:67]
    ds_read_b128 a[88:91], v18 offset:4096
    v_exp_f32 v103, v103
    v_mfma_f32_16x16x32_bf16 v[64:67], a[76:79], a[12:15], v[64:67]
    s_add_u32 m0, s30, 147456
    s_mov_b32 s38, 81920
    ds_read_b64_tr_b16 a[176:177], v44 offset:16384
    v_cvt_pk_bf16_f32 v99, v102, v103
    v_mfma_f32_16x16x32_bf16 v[72:75], a[76:79], a[28:31], v[52:55]
    buffer_load_dwordx4 v36, s[76:79], s38 offen offset:0 lds
    v_exp_f32 v108, v108
    v_mfma_f32_16x16x32_bf16 v[72:75], a[72:75], a[24:27], v[72:75]
    ds_read_b128 a[92:95], v19 offset:4096
    v_mfma_f32_16x16x32_bf16 v[72:75], a[68:71], a[20:23], v[72:75]
    ds_read_b64_tr_b16 a[178:179], v44 offset:18432
    v_exp_f32 v109, v109
    v_mfma_f32_16x16x32_bf16 v[72:75], a[64:67], a[16:19], v[72:75]
    buffer_load_dwordx4 v37, s[76:79], s38 offen offset:1024 lds
    v_mfma_f32_16x16x32_bf16 v[80:83], a[64:67], a[32:35], v[56:59]
    ds_read_b64_tr_b16 a[180:181], v45 offset:16384
    v_exp_f32 v110, v110
    v_mfma_f32_16x16x32_bf16 v[80:83], a[68:71], a[36:39], v[80:83]
    ds_read_b64_tr_b16 a[96:97], v20 offset:8192
    v_cvt_pk_bf16_f32 v106, v108, v109
    v_mfma_f32_16x16x32_bf16 v[80:83], a[72:75], a[40:43], v[80:83]
    ds_read_b64_tr_b16 a[98:99], v20 offset:12288
    v_exp_f32 v111, v111
    v_mfma_f32_16x16x32_bf16 v[80:83], a[76:79], a[44:47], v[80:83]
    s_waitcnt lgkmcnt(4)
    ds_read_b64_tr_b16 a[182:183], v45 offset:18432
    v_cvt_pk_bf16_f32 v107, v110, v111
    v_mfma_f32_16x16x32_bf16 v[68:71], a[80:83], a[0:3], v[48:51]
    ds_read_b64_tr_b16 a[100:101], v21 offset:8192
    buffer_load_dwordx4 v38, s[76:79], s38 offen offset:2048 lds
    v_mfma_f32_16x16x32_bf16 v[68:71], a[84:87], a[4:7], v[68:71]
    ds_read_b64_tr_b16 a[102:103], v21 offset:12288
    v_exp_f32 v116, v116
    v_mfma_f32_16x16x32_bf16 v[68:71], a[88:91], a[8:11], v[68:71]
    ds_read_b64_tr_b16 a[184:185], v46 offset:16384
    v_exp_f32 v117, v117
    v_mfma_f32_16x16x32_bf16 v[68:71], a[92:95], a[12:15], v[68:71]
    ds_read_b64_tr_b16 a[104:105], v22 offset:8192
    v_cvt_pk_bf16_f32 v114, v116, v117
    v_mfma_f32_16x16x32_bf16 v[76:79], a[92:95], a[28:31], v[52:55]
    ds_read_b64_tr_b16 a[106:107], v22 offset:12288
    buffer_load_dwordx4 v39, s[76:79], s38 offen offset:3072 lds
    v_mfma_f32_16x16x32_bf16 v[76:79], a[88:91], a[24:27], v[76:79]
    ds_read_b64_tr_b16 a[186:187], v46 offset:18432
    v_exp_f32 v118, v118
    v_mfma_f32_16x16x32_bf16 v[76:79], a[84:87], a[20:23], v[76:79]
    s_add_u32 m0, s30, 65536
    s_mov_b32 s38, 122880
    ds_read_b64_tr_b16 a[108:109], v23 offset:8192
    v_exp_f32 v119, v119
    v_mfma_f32_16x16x32_bf16 v[76:79], a[80:83], a[16:19], v[76:79]
    ds_read_b64_tr_b16 a[110:111], v23 offset:12288
    buffer_load_dwordx4 v36, s[76:79], s38 offen offset:0 lds
    v_mfma_f32_16x16x32_bf16 v[84:87], a[80:83], a[32:35], v[56:59]
    ds_read_b64_tr_b16 a[188:189], v47 offset:16384
    v_cvt_pk_bf16_f32 v115, v118, v119
    v_mfma_f32_16x16x32_bf16 v[84:87], a[84:87], a[36:39], v[84:87]
    ds_read_b64_tr_b16 a[112:113], v24 offset:8192
    v_mfma_f32_16x16x32_bf16 v[84:87], a[88:91], a[40:43], v[84:87]
    ds_read_b64_tr_b16 a[114:115], v24 offset:12288
    v_mfma_f32_16x16x32_bf16 v[84:87], a[92:95], a[44:47], v[84:87]
    s_waitcnt lgkmcnt(10)
    ds_read_b64_tr_b16 a[190:191], v47 offset:18432
    v_mfma_f32_16x16x32_bf16 v[128:131], a[96:99], v[96:99], v[128:131]
    ds_read_b64_tr_b16 a[116:117], v25 offset:8192
    v_mfma_f32_16x16x32_bf16 v[160:163], a[96:99], v[104:107], v[160:163]
    ds_read_b64_tr_b16 a[118:119], v25 offset:12288
    v_exp_f32 v64, v64
    v_mfma_f32_16x16x32_bf16 v[192:195], a[96:99], v[112:115], v[192:195]
    s_waitcnt lgkmcnt(10)
    buffer_load_dwordx4 v37, s[76:79], s38 offen offset:1024 lds
    v_exp_f32 v65, v65
    v_mfma_f32_16x16x32_bf16 v[196:199], a[100:103], v[112:115], v[196:199]
    ds_read_b64_tr_b16 a[120:121], v26 offset:8192
    v_cvt_pk_bf16_f32 v64, v64, v65
    v_mfma_f32_16x16x32_bf16 v[164:167], a[100:103], v[104:107], v[164:167]
    ds_read_b64_tr_b16 a[122:123], v26 offset:12288
    v_exp_f32 v66, v66
    v_mfma_f32_16x16x32_bf16 v[132:135], a[100:103], v[96:99], v[132:135]
    s_waitcnt lgkmcnt(10)
    buffer_load_dwordx4 v38, s[76:79], s38 offen offset:2048 lds
    v_mfma_f32_16x16x32_bf16 v[136:139], a[104:107], v[96:99], v[136:139]
    ds_read_b64_tr_b16 a[124:125], v27 offset:8192
    v_exp_f32 v67, v67
    v_mfma_f32_16x16x32_bf16 v[168:171], a[104:107], v[104:107], v[168:171]
    ds_read_b64_tr_b16 a[126:127], v27 offset:12288
    v_cvt_pk_bf16_f32 v65, v66, v67
    v_mfma_f32_16x16x32_bf16 v[200:203], a[104:107], v[112:115], v[200:203]
    s_waitcnt lgkmcnt(10)
    buffer_load_dwordx4 v39, s[76:79], s38 offen offset:3072 lds
    v_mfma_f32_16x16x32_bf16 v[204:207], a[108:111], v[112:115], v[204:207]
    ds_read_b128 a[64:67], v16 offset:8192
    v_mfma_f32_16x16x32_bf16 v[172:175], a[108:111], v[104:107], v[172:175]
    s_add_u32 m0, s30, 81920
    s_mov_b32 s38, 163840
    v_exp_f32 v72, v72
    v_mfma_f32_16x16x32_bf16 v[140:143], a[108:111], v[96:99], v[140:143]
    s_waitcnt lgkmcnt(8)
    s_waitcnt lgkmcnt(7)
    buffer_load_dwordx4 v36, s[76:79], s38 offen offset:0 lds
    v_mfma_f32_16x16x32_bf16 v[144:147], a[112:115], v[96:99], v[144:147]
    ds_read_b128 a[68:71], v17 offset:8192
    v_mfma_f32_16x16x32_bf16 v[176:179], a[112:115], v[104:107], v[176:179]
    v_exp_f32 v73, v73
    v_mfma_f32_16x16x32_bf16 v[208:211], a[112:115], v[112:115], v[208:211]
    s_waitcnt lgkmcnt(6)
    v_exp_f32 v74, v74
    v_mfma_f32_16x16x32_bf16 v[212:215], a[116:119], v[112:115], v[212:215]
    ds_read_b128 a[72:75], v18 offset:8192
    v_cvt_pk_bf16_f32 v72, v72, v73
    v_mfma_f32_16x16x32_bf16 v[180:183], a[116:119], v[104:107], v[180:183]
    buffer_load_dwordx4 v37, s[76:79], s38 offen offset:1024 lds
    v_mfma_f32_16x16x32_bf16 v[148:151], a[116:119], v[96:99], v[148:151]
    s_waitcnt lgkmcnt(5)
    v_exp_f32 v75, v75
    v_mfma_f32_16x16x32_bf16 v[152:155], a[120:123], v[96:99], v[152:155]
    ds_read_b128 a[76:79], v19 offset:8192
    v_cvt_pk_bf16_f32 v73, v74, v75
    v_mfma_f32_16x16x32_bf16 v[184:187], a[120:123], v[104:107], v[184:187]
    v_exp_f32 v80, v80
    v_exp_f32 v81, v81
    v_mfma_f32_16x16x32_bf16 v[216:219], a[120:123], v[112:115], v[216:219]
    s_waitcnt lgkmcnt(4)
    buffer_load_dwordx4 v38, s[76:79], s38 offen offset:2048 lds
    v_mfma_f32_16x16x32_bf16 v[220:223], a[124:127], v[112:115], v[220:223]
    ds_read_b128 a[80:83], v16 offset:12288
    v_cvt_pk_bf16_f32 v80, v80, v81
    v_mfma_f32_16x16x32_bf16 v[188:191], a[124:127], v[104:107], v[188:191]
    v_exp_f32 v82, v82
    v_mfma_f32_16x16x32_bf16 v[156:159], a[124:127], v[96:99], v[156:159]
    v_exp_f32 v83, v83
    v_mfma_f32_16x16x32_bf16 a[128:131], a[144:147], v[96:99], a[128:131]
    ds_read_b128 a[84:87], v17 offset:12288
    v_cvt_pk_bf16_f32 v81, v82, v83
    v_mfma_f32_16x16x32_bf16 a[132:135], a[144:147], v[104:107], a[132:135]
    buffer_load_dwordx4 v39, s[76:79], s38 offen offset:3072 lds
    v_mfma_f32_16x16x32_bf16 a[136:139], a[144:147], v[112:115], a[136:139]
    s_waitcnt lgkmcnt(2)
    v_exp_f32 v68, v68
    v_mfma_f32_16x16x32_bf16 v[96:99], a[64:67], a[0:3], v[48:51]
    ds_read_b128 a[88:91], v18 offset:12288
    v_mfma_f32_16x16x32_bf16 v[96:99], a[68:71], a[4:7], v[96:99]
    v_exp_f32 v69, v69
    v_mfma_f32_16x16x32_bf16 v[96:99], a[72:75], a[8:11], v[96:99]
    v_exp_f32 v70, v70
    v_mfma_f32_16x16x32_bf16 v[96:99], a[76:79], a[12:15], v[96:99]
    ds_read_b128 a[92:95], v19 offset:12288
    v_cvt_pk_bf16_f32 v66, v68, v69
    v_mfma_f32_16x16x32_bf16 v[104:107], a[76:79], a[28:31], v[52:55]
    v_exp_f32 v71, v71
    v_mfma_f32_16x16x32_bf16 v[104:107], a[72:75], a[24:27], v[104:107]
    v_exp_f32 v76, v76
    v_mfma_f32_16x16x32_bf16 v[104:107], a[68:71], a[20:23], v[104:107]
    v_exp_f32 v77, v77
    v_mfma_f32_16x16x32_bf16 v[104:107], a[64:67], a[16:19], v[104:107]
    v_cvt_pk_bf16_f32 v67, v70, v71
    v_cvt_pk_bf16_f32 v74, v76, v77
    v_mfma_f32_16x16x32_bf16 v[112:115], a[64:67], a[32:35], v[56:59]
    v_exp_f32 v78, v78
    v_mfma_f32_16x16x32_bf16 v[112:115], a[68:71], a[36:39], v[112:115]
    v_mfma_f32_16x16x32_bf16 v[112:115], a[72:75], a[40:43], v[112:115]
    v_exp_f32 v79, v79
    v_mfma_f32_16x16x32_bf16 v[112:115], a[76:79], a[44:47], v[112:115]
    v_cvt_pk_bf16_f32 v75, v78, v79
    s_waitcnt vmcnt(60) lgkmcnt(0)
    s_barrier
    v_mfma_f32_16x16x32_bf16 v[100:103], a[80:83], a[0:3], v[48:51]
    ds_read_b64_tr_b16 a[96:97], v20 offset:16384
    v_mfma_f32_16x16x32_bf16 v[100:103], a[84:87], a[4:7], v[100:103]
    s_add_u32 m0, s30, 98304
    s_mov_b32 s38, 204800
    ds_read_b64_tr_b16 a[98:99], v20 offset:20480
    v_exp_f32 v84, v84
    v_mfma_f32_16x16x32_bf16 v[100:103], a[88:91], a[8:11], v[100:103]
    buffer_load_dwordx4 v36, s[76:79], s38 offen offset:0 lds
    v_mfma_f32_16x16x32_bf16 v[100:103], a[92:95], a[12:15], v[100:103]
    ds_read_b64_tr_b16 a[100:101], v21 offset:16384
    v_mfma_f32_16x16x32_bf16 v[108:111], a[92:95], a[28:31], v[52:55]
    ds_read_b64_tr_b16 a[102:103], v21 offset:20480
    v_mfma_f32_16x16x32_bf16 v[108:111], a[88:91], a[24:27], v[108:111]
    v_exp_f32 v85, v85
    v_exp_f32 v86, v86
    v_mfma_f32_16x16x32_bf16 v[108:111], a[84:87], a[20:23], v[108:111]
    ds_read_b64_tr_b16 a[104:105], v22 offset:16384
    v_cvt_pk_bf16_f32 v82, v84, v85
    v_mfma_f32_16x16x32_bf16 v[108:111], a[80:83], a[16:19], v[108:111]
    ds_read_b64_tr_b16 a[106:107], v22 offset:20480
    v_exp_f32 v87, v87
    v_mfma_f32_16x16x32_bf16 v[116:119], a[80:83], a[32:35], v[56:59]
    buffer_load_dwordx4 v37, s[76:79], s38 offen offset:1024 lds
    v_mfma_f32_16x16x32_bf16 v[116:119], a[84:87], a[36:39], v[116:119]
    ds_read_b64_tr_b16 a[108:109], v23 offset:16384
    v_cvt_pk_bf16_f32 v83, v86, v87
    v_mfma_f32_16x16x32_bf16 v[116:119], a[88:91], a[40:43], v[116:119]
    ds_read_b64_tr_b16 a[110:111], v23 offset:20480
    v_mfma_f32_16x16x32_bf16 v[116:119], a[92:95], a[44:47], v[116:119]
    s_waitcnt lgkmcnt(6)
    buffer_load_dwordx4 v38, s[76:79], s38 offen offset:2048 lds
    v_mfma_f32_16x16x32_bf16 v[128:131], a[96:99], v[64:67], v[128:131]
    ds_read_b64_tr_b16 a[112:113], v24 offset:16384
    v_mfma_f32_16x16x32_bf16 v[160:163], a[96:99], v[72:75], v[160:163]
    ds_read_b64_tr_b16 a[114:115], v24 offset:20480
    v_mfma_f32_16x16x32_bf16 v[192:195], a[96:99], v[80:83], v[192:195]
    s_waitcnt lgkmcnt(6)
    v_exp_f32 v96, v96
    v_exp_f32 v97, v97
    v_mfma_f32_16x16x32_bf16 v[196:199], a[100:103], v[80:83], v[196:199]
    ds_read_b64_tr_b16 a[116:117], v25 offset:16384
    v_cvt_pk_bf16_f32 v96, v96, v97
    v_mfma_f32_16x16x32_bf16 v[164:167], a[100:103], v[72:75], v[164:167]
    ds_read_b64_tr_b16 a[118:119], v25 offset:20480
    v_exp_f32 v98, v98
    v_mfma_f32_16x16x32_bf16 v[132:135], a[100:103], v[64:67], v[132:135]
    s_waitcnt lgkmcnt(6)
    buffer_load_dwordx4 v39, s[76:79], s38 offen offset:3072 lds
    v_mfma_f32_16x16x32_bf16 v[136:139], a[104:107], v[64:67], v[136:139]
    ds_read_b64_tr_b16 a[120:121], v26 offset:16384
    v_exp_f32 v99, v99
    v_mfma_f32_16x16x32_bf16 v[168:171], a[104:107], v[72:75], v[168:171]
    s_add_u32 m0, s30, 0
    s_mov_b32 s38, 245760
    ds_read_b64_tr_b16 a[122:123], v26 offset:20480
    v_cvt_pk_bf16_f32 v97, v98, v99
    v_mfma_f32_16x16x32_bf16 v[200:203], a[104:107], v[80:83], v[200:203]
    s_waitcnt lgkmcnt(6)
    buffer_load_dwordx4 v36, s[76:79], s38 offen offset:0 lds
    v_exp_f32 v104, v104
    v_mfma_f32_16x16x32_bf16 v[204:207], a[108:111], v[80:83], v[204:207]
    ds_read_b64_tr_b16 a[124:125], v27 offset:16384
    v_mfma_f32_16x16x32_bf16 v[172:175], a[108:111], v[72:75], v[172:175]
    ds_read_b64_tr_b16 a[126:127], v27 offset:20480
    v_exp_f32 v105, v105
    v_mfma_f32_16x16x32_bf16 v[140:143], a[108:111], v[64:67], v[140:143]
    s_waitcnt lgkmcnt(6)
    ds_read_b128 a[64:67], v16 offset:16384
    v_cvt_pk_bf16_f32 v104, v104, v105
    v_mfma_f32_16x16x32_bf16 v[144:147], a[112:115], v[64:67], v[144:147]
    s_waitcnt vmcnt(13)
    ds_read_b64_tr_b16 a[192:193], v8 offset:16384
    v_exp_f32 v106, v106
    v_mfma_f32_16x16x32_bf16 v[176:179], a[112:115], v[72:75], v[176:179]
    buffer_load_dwordx4 v37, s[76:79], s38 offen offset:1024 lds
    v_mfma_f32_16x16x32_bf16 v[208:211], a[112:115], v[80:83], v[208:211]
    s_waitcnt lgkmcnt(6)
    ds_read_b128 a[68:71], v17 offset:16384
    v_mfma_f32_16x16x32_bf16 v[212:215], a[116:119], v[80:83], v[212:215]
    ds_read_b64_tr_b16 a[194:195], v8 offset:18432
    v_mfma_f32_16x16x32_bf16 v[180:183], a[116:119], v[72:75], v[180:183]
    v_exp_f32 v107, v107
    v_exp_f32 v112, v112
    v_mfma_f32_16x16x32_bf16 v[148:151], a[116:119], v[64:67], v[148:151]
    s_waitcnt lgkmcnt(6)
    ds_read_b128 a[72:75], v18 offset:16384
    v_cvt_pk_bf16_f32 v105, v106, v107
    v_mfma_f32_16x16x32_bf16 v[152:155], a[120:123], v[64:67], v[152:155]
    ds_read_b64_tr_b16 a[196:197], v9 offset:16384
    v_exp_f32 v113, v113
    v_mfma_f32_16x16x32_bf16 v[184:187], a[120:123], v[72:75], v[184:187]
    buffer_load_dwordx4 v38, s[76:79], s38 offen offset:2048 lds
    v_mfma_f32_16x16x32_bf16 v[216:219], a[120:123], v[80:83], v[216:219]
    s_waitcnt lgkmcnt(6)
    ds_read_b128 a[76:79], v19 offset:16384
    v_exp_f32 v114, v114
    v_mfma_f32_16x16x32_bf16 v[220:223], a[124:127], v[80:83], v[220:223]
    ds_read_b64_tr_b16 a[198:199], v9 offset:18432
    v_cvt_pk_bf16_f32 v112, v112, v113
    v_mfma_f32_16x16x32_bf16 v[188:191], a[124:127], v[72:75], v[188:191]
    buffer_load_dwordx4 v39, s[76:79], s38 offen offset:3072 lds
    v_mfma_f32_16x16x32_bf16 v[156:159], a[124:127], v[64:67], v[156:159]
    ds_read_b128 a[80:83], v16 offset:20480
    v_mfma_f32_16x16x32_bf16 a[128:131], a[144:147], v[64:67], a[128:131]
    ds_read_b64_tr_b16 a[200:201], v10 offset:16384
    v_mfma_f32_16x16x32_bf16 a[132:135], a[144:147], v[72:75], a[132:135]
    v_exp_f32 v115, v115
    v_exp_f32 v100, v100
    v_mfma_f32_16x16x32_bf16 a[136:139], a[144:147], v[80:83], a[136:139]
    s_waitcnt lgkmcnt(3)
    ds_read_b128 a[84:87], v17 offset:20480
    v_cvt_pk_bf16_f32 v113, v114, v115
    v_mfma_f32_16x16x32_bf16 v[64:67], a[64:67], a[0:3], v[48:51]
    ds_read_b64_tr_b16 a[202:203], v10 offset:18432
    v_mfma_f32_16x16x32_bf16 v[64:67], a[68:71], a[4:7], v[64:67]
    v_exp_f32 v101, v101
    v_exp_f32 v102, v102
    v_mfma_f32_16x16x32_bf16 v[64:67], a[72:75], a[8:11], v[64:67]
    ds_read_b128 a[88:91], v18 offset:20480
    v_exp_f32 v103, v103
    v_mfma_f32_16x16x32_bf16 v[64:67], a[76:79], a[12:15], v[64:67]
    ds_read_b64_tr_b16 a[204:205], v11 offset:16384
    v_cvt_pk_bf16_f32 v98, v100, v101
    v_mfma_f32_16x16x32_bf16 v[72:75], a[76:79], a[28:31], v[52:55]
    buffer_load_dword v13, v14, s[76:79], s6 offen
    v_mfma_f32_16x16x32_bf16 v[72:75], a[72:75], a[24:27], v[72:75]
    ds_read_b128 a[92:95], v19 offset:20480
    v_cvt_pk_bf16_f32 v99, v102, v103
    v_mfma_f32_16x16x32_bf16 v[72:75], a[68:71], a[20:23], v[72:75]
    ds_read_b64_tr_b16 a[206:207], v11 offset:18432
    v_mfma_f32_16x16x32_bf16 v[72:75], a[64:67], a[16:19], v[72:75]
    v_exp_f32 v108, v108
    v_exp_f32 v109, v109
    v_mfma_f32_16x16x32_bf16 v[80:83], a[64:67], a[32:35], v[56:59]
    s_waitcnt vmcnt(13)
    ds_read_b64_tr_b16 a[208:209], v44 offset:0
    v_exp_f32 v110, v110
    v_mfma_f32_16x16x32_bf16 v[80:83], a[68:71], a[36:39], v[80:83]
    ds_read_b64_tr_b16 a[96:97], v20 offset:24576
    v_cvt_pk_bf16_f32 v106, v108, v109
    v_mfma_f32_16x16x32_bf16 v[80:83], a[72:75], a[40:43], v[80:83]
    ds_read_b64_tr_b16 a[98:99], v20 offset:28672
    v_exp_f32 v111, v111
    v_mfma_f32_16x16x32_bf16 v[80:83], a[76:79], a[44:47], v[80:83]
    s_waitcnt lgkmcnt(4)
    ds_read_b64_tr_b16 a[210:211], v44 offset:2048
    v_cvt_pk_bf16_f32 v107, v110, v111
    v_mfma_f32_16x16x32_bf16 v[68:71], a[80:83], a[0:3], v[48:51]
    ds_read_b64_tr_b16 a[100:101], v21 offset:24576
    v_exp_f32 v116, v116
    v_mfma_f32_16x16x32_bf16 v[68:71], a[84:87], a[4:7], v[68:71]
    ds_read_b64_tr_b16 a[102:103], v21 offset:28672
    v_mfma_f32_16x16x32_bf16 v[68:71], a[88:91], a[8:11], v[68:71]
    ds_read_b64_tr_b16 a[212:213], v45 offset:0
    v_exp_f32 v117, v117
    v_mfma_f32_16x16x32_bf16 v[68:71], a[92:95], a[12:15], v[68:71]
    ds_read_b64_tr_b16 a[104:105], v22 offset:24576
    v_cvt_pk_bf16_f32 v114, v116, v117
    v_mfma_f32_16x16x32_bf16 v[76:79], a[92:95], a[28:31], v[52:55]
    ds_read_b64_tr_b16 a[106:107], v22 offset:28672
    v_exp_f32 v118, v118
    v_mfma_f32_16x16x32_bf16 v[76:79], a[88:91], a[24:27], v[76:79]
    s_add_u32 m0, s30, 147456
    s_mov_b32 s38, 286720
    ds_read_b64_tr_b16 a[214:215], v45 offset:2048
    v_mfma_f32_16x16x32_bf16 v[76:79], a[84:87], a[20:23], v[76:79]
    ds_read_b64_tr_b16 a[108:109], v23 offset:24576
    s_waitcnt lgkmcnt(10)
    buffer_load_dwordx4 v36, s[76:79], s38 offen offset:0 lds
    v_mfma_f32_16x16x32_bf16 v[76:79], a[80:83], a[16:19], v[76:79]
    ds_read_b64_tr_b16 a[110:111], v23 offset:28672
    v_exp_f32 v119, v119
    v_mfma_f32_16x16x32_bf16 v[84:87], a[80:83], a[32:35], v[56:59]
    ds_read_b64_tr_b16 a[216:217], v46 offset:0
    v_cvt_pk_bf16_f32 v115, v118, v119
    v_mfma_f32_16x16x32_bf16 v[84:87], a[84:87], a[36:39], v[84:87]
    ds_read_b64_tr_b16 a[112:113], v24 offset:24576
    v_mfma_f32_16x16x32_bf16 v[84:87], a[88:91], a[40:43], v[84:87]
    ds_read_b64_tr_b16 a[114:115], v24 offset:28672
    buffer_load_dwordx4 v37, s[76:79], s38 offen offset:1024 lds
    v_mfma_f32_16x16x32_bf16 v[84:87], a[92:95], a[44:47], v[84:87]
    s_waitcnt lgkmcnt(10)
    ds_read_b64_tr_b16 a[218:219], v46 offset:2048
    v_mfma_f32_16x16x32_bf16 v[128:131], a[96:99], v[96:99], v[128:131]
    ds_read_b64_tr_b16 a[116:117], v25 offset:24576
    v_mfma_f32_16x16x32_bf16 v[160:163], a[96:99], v[104:107], v[160:163]
    ds_read_b64_tr_b16 a[118:119], v25 offset:28672
    v_exp_f32 v64, v64
    v_mfma_f32_16x16x32_bf16 v[192:195], a[96:99], v[112:115], v[192:195]
    s_waitcnt lgkmcnt(10)
    ds_read_b64_tr_b16 a[220:221], v47 offset:0
    v_exp_f32 v65, v65
    v_mfma_f32_16x16x32_bf16 v[196:199], a[100:103], v[112:115], v[196:199]
    ds_read_b64_tr_b16 a[120:121], v26 offset:24576
    buffer_load_dwordx4 v38, s[76:79], s38 offen offset:2048 lds
    v_mfma_f32_16x16x32_bf16 v[164:167], a[100:103], v[104:107], v[164:167]
    ds_read_b64_tr_b16 a[122:123], v26 offset:28672
    v_exp_f32 v66, v66
    v_mfma_f32_16x16x32_bf16 v[132:135], a[100:103], v[96:99], v[132:135]
    s_waitcnt lgkmcnt(10)
    ds_read_b64_tr_b16 a[222:223], v47 offset:2048
    v_cvt_pk_bf16_f32 v64, v64, v65
    v_mfma_f32_16x16x32_bf16 v[136:139], a[104:107], v[96:99], v[136:139]
    ds_read_b64_tr_b16 a[124:125], v27 offset:24576
    v_exp_f32 v67, v67
    v_mfma_f32_16x16x32_bf16 v[168:171], a[104:107], v[104:107], v[168:171]
    ds_read_b64_tr_b16 a[126:127], v27 offset:28672
    v_cvt_pk_bf16_f32 v65, v66, v67
    v_mfma_f32_16x16x32_bf16 v[200:203], a[104:107], v[112:115], v[200:203]
    s_waitcnt lgkmcnt(10)
    buffer_load_dwordx4 v39, s[76:79], s38 offen offset:3072 lds
    v_mfma_f32_16x16x32_bf16 v[204:207], a[108:111], v[112:115], v[204:207]
    ds_read_b128 a[64:67], v16 offset:24576
    v_mfma_f32_16x16x32_bf16 v[172:175], a[108:111], v[104:107], v[172:175]
    s_add_u32 m0, s30, 65536
    s_mov_b32 s38, 327680
    v_exp_f32 v72, v72
    v_mfma_f32_16x16x32_bf16 v[140:143], a[108:111], v[96:99], v[140:143]
    s_waitcnt lgkmcnt(10)
    s_waitcnt lgkmcnt(3)
    buffer_load_dwordx4 v36, s[76:79], s38 offen offset:0 lds
    v_mfma_f32_16x16x32_bf16 v[144:147], a[112:115], v[96:99], v[144:147]
    ds_read_b128 a[68:71], v17 offset:24576
    v_mfma_f32_16x16x32_bf16 v[176:179], a[112:115], v[104:107], v[176:179]
    v_exp_f32 v73, v73
    v_mfma_f32_16x16x32_bf16 v[208:211], a[112:115], v[112:115], v[208:211]
    v_exp_f32 v74, v74
    v_mfma_f32_16x16x32_bf16 v[212:215], a[116:119], v[112:115], v[212:215]
    ds_read_b128 a[72:75], v18 offset:24576
    v_cvt_pk_bf16_f32 v72, v72, v73
    v_mfma_f32_16x16x32_bf16 v[180:183], a[116:119], v[104:107], v[180:183]
    buffer_load_dwordx4 v37, s[76:79], s38 offen offset:1024 lds
    v_mfma_f32_16x16x32_bf16 v[148:151], a[116:119], v[96:99], v[148:151]
    v_exp_f32 v75, v75
    v_mfma_f32_16x16x32_bf16 v[152:155], a[120:123], v[96:99], v[152:155]
    ds_read_b128 a[76:79], v19 offset:24576
    v_cvt_pk_bf16_f32 v73, v74, v75
    v_mfma_f32_16x16x32_bf16 v[184:187], a[120:123], v[104:107], v[184:187]
    v_exp_f32 v80, v80
    v_exp_f32 v81, v81
    v_mfma_f32_16x16x32_bf16 v[216:219], a[120:123], v[112:115], v[216:219]
    s_waitcnt lgkmcnt(4)
    buffer_load_dwordx4 v38, s[76:79], s38 offen offset:2048 lds
    v_mfma_f32_16x16x32_bf16 v[220:223], a[124:127], v[112:115], v[220:223]
    ds_read_b128 a[80:83], v16 offset:28672
    v_cvt_pk_bf16_f32 v80, v80, v81
    v_mfma_f32_16x16x32_bf16 v[188:191], a[124:127], v[104:107], v[188:191]
    v_exp_f32 v82, v82
    v_mfma_f32_16x16x32_bf16 v[156:159], a[124:127], v[96:99], v[156:159]
    v_exp_f32 v83, v83
    v_mfma_f32_16x16x32_bf16 a[128:131], a[144:147], v[96:99], a[128:131]
    ds_read_b128 a[84:87], v17 offset:28672
    v_cvt_pk_bf16_f32 v81, v82, v83
    v_mfma_f32_16x16x32_bf16 a[132:135], a[144:147], v[104:107], a[132:135]
    buffer_load_dwordx4 v39, s[76:79], s38 offen offset:3072 lds
    v_mfma_f32_16x16x32_bf16 a[136:139], a[144:147], v[112:115], a[136:139]
    s_waitcnt lgkmcnt(2)
    v_exp_f32 v68, v68
    v_mfma_f32_16x16x32_bf16 v[96:99], a[64:67], a[0:3], v[48:51]
    ds_read_b128 a[88:91], v18 offset:28672
    v_mfma_f32_16x16x32_bf16 v[96:99], a[68:71], a[4:7], v[96:99]
    v_exp_f32 v69, v69
    v_mfma_f32_16x16x32_bf16 v[96:99], a[72:75], a[8:11], v[96:99]
    v_exp_f32 v70, v70
    v_mfma_f32_16x16x32_bf16 v[96:99], a[76:79], a[12:15], v[96:99]
    ds_read_b128 a[92:95], v19 offset:28672
    v_cvt_pk_bf16_f32 v66, v68, v69
    v_mfma_f32_16x16x32_bf16 v[104:107], a[76:79], a[28:31], v[52:55]
    v_exp_f32 v71, v71
    v_mfma_f32_16x16x32_bf16 v[104:107], a[72:75], a[24:27], v[104:107]
    v_exp_f32 v76, v76
    v_mfma_f32_16x16x32_bf16 v[104:107], a[68:71], a[20:23], v[104:107]
    v_exp_f32 v77, v77
    v_mfma_f32_16x16x32_bf16 v[104:107], a[64:67], a[16:19], v[104:107]
    v_cvt_pk_bf16_f32 v67, v70, v71
    v_cvt_pk_bf16_f32 v74, v76, v77
    v_mfma_f32_16x16x32_bf16 v[112:115], a[64:67], a[32:35], v[56:59]
    v_exp_f32 v78, v78
    v_mfma_f32_16x16x32_bf16 v[112:115], a[68:71], a[36:39], v[112:115]
    v_mfma_f32_16x16x32_bf16 v[112:115], a[72:75], a[40:43], v[112:115]
    v_exp_f32 v79, v79
    v_mfma_f32_16x16x32_bf16 v[112:115], a[76:79], a[44:47], v[112:115]
    v_cvt_pk_bf16_f32 v75, v78, v79
    s_waitcnt vmcnt(45) lgkmcnt(0)
    s_barrier
    v_mfma_f32_16x16x32_bf16 v[100:103], a[80:83], a[0:3], v[48:51]
    ds_read_b64_tr_b16 a[96:97], v20 offset:32768
    v_mfma_f32_16x16x32_bf16 v[100:103], a[84:87], a[4:7], v[100:103]
    s_add_u32 m0, s30, 114688
    s_mov_b32 s38, 368640
    ds_read_b64_tr_b16 a[98:99], v20 offset:36864
    v_exp_f32 v84, v84
    v_mfma_f32_16x16x32_bf16 v[100:103], a[88:91], a[8:11], v[100:103]
    buffer_load_dwordx4 v36, s[76:79], s38 offen offset:0 lds
    v_mfma_f32_16x16x32_bf16 v[100:103], a[92:95], a[12:15], v[100:103]
    ds_read_b64_tr_b16 a[100:101], v21 offset:32768
    v_mfma_f32_16x16x32_bf16 v[108:111], a[92:95], a[28:31], v[52:55]
    ds_read_b64_tr_b16 a[102:103], v21 offset:36864
    v_mfma_f32_16x16x32_bf16 v[108:111], a[88:91], a[24:27], v[108:111]
    v_exp_f32 v85, v85
    v_exp_f32 v86, v86
    v_mfma_f32_16x16x32_bf16 v[108:111], a[84:87], a[20:23], v[108:111]
    ds_read_b64_tr_b16 a[104:105], v22 offset:32768
    v_cvt_pk_bf16_f32 v82, v84, v85
    v_mfma_f32_16x16x32_bf16 v[108:111], a[80:83], a[16:19], v[108:111]
    ds_read_b64_tr_b16 a[106:107], v22 offset:36864
    v_exp_f32 v87, v87
    v_mfma_f32_16x16x32_bf16 v[116:119], a[80:83], a[32:35], v[56:59]
    buffer_load_dwordx4 v37, s[76:79], s38 offen offset:1024 lds
    v_mfma_f32_16x16x32_bf16 v[116:119], a[84:87], a[36:39], v[116:119]
    ds_read_b64_tr_b16 a[108:109], v23 offset:32768
    v_cvt_pk_bf16_f32 v83, v86, v87
    v_mfma_f32_16x16x32_bf16 v[116:119], a[88:91], a[40:43], v[116:119]
    ds_read_b64_tr_b16 a[110:111], v23 offset:36864
    v_mfma_f32_16x16x32_bf16 v[116:119], a[92:95], a[44:47], v[116:119]
    s_waitcnt lgkmcnt(6)
    buffer_load_dwordx4 v38, s[76:79], s38 offen offset:2048 lds
    v_mfma_f32_16x16x32_bf16 v[128:131], a[96:99], v[64:67], v[128:131]
    ds_read_b64_tr_b16 a[112:113], v24 offset:32768
    v_mfma_f32_16x16x32_bf16 v[160:163], a[96:99], v[72:75], v[160:163]
    ds_read_b64_tr_b16 a[114:115], v24 offset:36864
    v_mfma_f32_16x16x32_bf16 v[192:195], a[96:99], v[80:83], v[192:195]
    s_waitcnt lgkmcnt(6)
    v_exp_f32 v96, v96
    v_exp_f32 v97, v97
    v_mfma_f32_16x16x32_bf16 v[196:199], a[100:103], v[80:83], v[196:199]
    ds_read_b64_tr_b16 a[116:117], v25 offset:32768
    v_cvt_pk_bf16_f32 v96, v96, v97
    v_mfma_f32_16x16x32_bf16 v[164:167], a[100:103], v[72:75], v[164:167]
    ds_read_b64_tr_b16 a[118:119], v25 offset:36864
    v_exp_f32 v98, v98
    v_mfma_f32_16x16x32_bf16 v[132:135], a[100:103], v[64:67], v[132:135]
    s_waitcnt lgkmcnt(6)
    buffer_load_dwordx4 v39, s[76:79], s38 offen offset:3072 lds
    v_mfma_f32_16x16x32_bf16 v[136:139], a[104:107], v[64:67], v[136:139]
    ds_read_b64_tr_b16 a[120:121], v26 offset:32768
    v_exp_f32 v99, v99
    v_mfma_f32_16x16x32_bf16 v[168:171], a[104:107], v[72:75], v[168:171]
    s_add_u32 m0, s30, 16384
    s_mov_b32 s38, 409600
    ds_read_b64_tr_b16 a[122:123], v26 offset:36864
    v_cvt_pk_bf16_f32 v97, v98, v99
    v_mfma_f32_16x16x32_bf16 v[200:203], a[104:107], v[80:83], v[200:203]
    s_waitcnt lgkmcnt(6)
    buffer_load_dwordx4 v36, s[76:79], s38 offen offset:0 lds
    v_exp_f32 v104, v104
    v_mfma_f32_16x16x32_bf16 v[204:207], a[108:111], v[80:83], v[204:207]
    ds_read_b64_tr_b16 a[124:125], v27 offset:32768
    v_mfma_f32_16x16x32_bf16 v[172:175], a[108:111], v[72:75], v[172:175]
    ds_read_b64_tr_b16 a[126:127], v27 offset:36864
    v_exp_f32 v105, v105
    v_mfma_f32_16x16x32_bf16 v[140:143], a[108:111], v[64:67], v[140:143]
    s_waitcnt lgkmcnt(6)
    ds_read_b128 a[64:67], v16 offset:32768
    v_cvt_pk_bf16_f32 v104, v104, v105
    v_mfma_f32_16x16x32_bf16 v[144:147], a[112:115], v[64:67], v[144:147]
    s_waitcnt vmcnt(22)
    ds_read_b64_tr_b16 a[224:225], v44 offset:16384
    v_exp_f32 v106, v106
    v_mfma_f32_16x16x32_bf16 v[176:179], a[112:115], v[72:75], v[176:179]
    buffer_load_dwordx4 v37, s[76:79], s38 offen offset:1024 lds
    v_mfma_f32_16x16x32_bf16 v[208:211], a[112:115], v[80:83], v[208:211]
    s_waitcnt lgkmcnt(6)
    ds_read_b128 a[68:71], v17 offset:32768
    v_mfma_f32_16x16x32_bf16 v[212:215], a[116:119], v[80:83], v[212:215]
    ds_read_b64_tr_b16 a[226:227], v44 offset:18432
    v_mfma_f32_16x16x32_bf16 v[180:183], a[116:119], v[72:75], v[180:183]
    v_exp_f32 v107, v107
    v_exp_f32 v112, v112
    v_mfma_f32_16x16x32_bf16 v[148:151], a[116:119], v[64:67], v[148:151]
    s_waitcnt lgkmcnt(6)
    ds_read_b128 a[72:75], v18 offset:32768
    v_cvt_pk_bf16_f32 v105, v106, v107
    v_mfma_f32_16x16x32_bf16 v[152:155], a[120:123], v[64:67], v[152:155]
    ds_read_b64_tr_b16 a[228:229], v45 offset:16384
    v_exp_f32 v113, v113
    v_mfma_f32_16x16x32_bf16 v[184:187], a[120:123], v[72:75], v[184:187]
    buffer_load_dwordx4 v38, s[76:79], s38 offen offset:2048 lds
    v_mfma_f32_16x16x32_bf16 v[216:219], a[120:123], v[80:83], v[216:219]
    s_waitcnt lgkmcnt(6)
    ds_read_b128 a[76:79], v19 offset:32768
    v_exp_f32 v114, v114
    v_mfma_f32_16x16x32_bf16 v[220:223], a[124:127], v[80:83], v[220:223]
    ds_read_b64_tr_b16 a[230:231], v45 offset:18432
    v_cvt_pk_bf16_f32 v112, v112, v113
    v_mfma_f32_16x16x32_bf16 v[188:191], a[124:127], v[72:75], v[188:191]
    buffer_load_dwordx4 v39, s[76:79], s38 offen offset:3072 lds
    v_mfma_f32_16x16x32_bf16 v[156:159], a[124:127], v[64:67], v[156:159]
    ds_read_b128 a[80:83], v16 offset:36864
    v_mfma_f32_16x16x32_bf16 a[128:131], a[144:147], v[64:67], a[128:131]
    ds_read_b64_tr_b16 a[232:233], v46 offset:16384
    v_mfma_f32_16x16x32_bf16 a[132:135], a[144:147], v[72:75], a[132:135]
    v_exp_f32 v115, v115
    v_exp_f32 v100, v100
    v_mfma_f32_16x16x32_bf16 a[136:139], a[144:147], v[80:83], a[136:139]
    s_waitcnt lgkmcnt(3)
    ds_read_b128 a[84:87], v17 offset:36864
    v_cvt_pk_bf16_f32 v113, v114, v115
    v_mfma_f32_16x16x32_bf16 v[64:67], a[64:67], a[0:3], v[48:51]
    ds_read_b64_tr_b16 a[234:235], v46 offset:18432
    v_mfma_f32_16x16x32_bf16 v[64:67], a[68:71], a[4:7], v[64:67]
    v_exp_f32 v101, v101
    v_exp_f32 v102, v102
    v_mfma_f32_16x16x32_bf16 v[64:67], a[72:75], a[8:11], v[64:67]
    ds_read_b128 a[88:91], v18 offset:36864
    v_exp_f32 v103, v103
    v_mfma_f32_16x16x32_bf16 v[64:67], a[76:79], a[12:15], v[64:67]
    ds_read_b64_tr_b16 a[236:237], v47 offset:16384
    v_cvt_pk_bf16_f32 v98, v100, v101
    v_mfma_f32_16x16x32_bf16 v[72:75], a[76:79], a[28:31], v[52:55]
    buffer_load_dword v13, v14, s[76:79], s7 offen
    v_mfma_f32_16x16x32_bf16 v[72:75], a[72:75], a[24:27], v[72:75]
    ds_read_b128 a[92:95], v19 offset:36864
    v_cvt_pk_bf16_f32 v99, v102, v103
    v_mfma_f32_16x16x32_bf16 v[72:75], a[68:71], a[20:23], v[72:75]
    ds_read_b64_tr_b16 a[238:239], v47 offset:18432
    v_mfma_f32_16x16x32_bf16 v[72:75], a[64:67], a[16:19], v[72:75]
    v_exp_f32 v108, v108
    v_exp_f32 v109, v109
    v_mfma_f32_16x16x32_bf16 v[80:83], a[64:67], a[32:35], v[56:59]
    s_waitcnt vmcnt(22)
    ds_read_b64_tr_b16 a[240:241], v44 offset:32768
    v_exp_f32 v110, v110
    v_mfma_f32_16x16x32_bf16 v[80:83], a[68:71], a[36:39], v[80:83]
    ds_read_b64_tr_b16 a[96:97], v20 offset:40960
    v_cvt_pk_bf16_f32 v106, v108, v109
    v_mfma_f32_16x16x32_bf16 v[80:83], a[72:75], a[40:43], v[80:83]
    ds_read_b64_tr_b16 a[98:99], v20 offset:45056
    v_exp_f32 v111, v111
    v_mfma_f32_16x16x32_bf16 v[80:83], a[76:79], a[44:47], v[80:83]
    s_waitcnt lgkmcnt(4)
    ds_read_b64_tr_b16 a[242:243], v44 offset:34816
    v_cvt_pk_bf16_f32 v107, v110, v111
    v_mfma_f32_16x16x32_bf16 v[68:71], a[80:83], a[0:3], v[48:51]
    ds_read_b64_tr_b16 a[100:101], v21 offset:40960
    v_exp_f32 v116, v116
    v_mfma_f32_16x16x32_bf16 v[68:71], a[84:87], a[4:7], v[68:71]
    ds_read_b64_tr_b16 a[102:103], v21 offset:45056
    v_mfma_f32_16x16x32_bf16 v[68:71], a[88:91], a[8:11], v[68:71]
    ds_read_b64_tr_b16 a[244:245], v45 offset:32768
    v_exp_f32 v117, v117
    v_mfma_f32_16x16x32_bf16 v[68:71], a[92:95], a[12:15], v[68:71]
    ds_read_b64_tr_b16 a[104:105], v22 offset:40960
    v_cvt_pk_bf16_f32 v114, v116, v117
    v_mfma_f32_16x16x32_bf16 v[76:79], a[92:95], a[28:31], v[52:55]
    ds_read_b64_tr_b16 a[106:107], v22 offset:45056
    v_exp_f32 v118, v118
    v_mfma_f32_16x16x32_bf16 v[76:79], a[88:91], a[24:27], v[76:79]
    s_add_u32 m0, s30, 81920
    s_mov_b32 s38, 450560
    ds_read_b64_tr_b16 a[246:247], v45 offset:34816
    v_mfma_f32_16x16x32_bf16 v[76:79], a[84:87], a[20:23], v[76:79]
    ds_read_b64_tr_b16 a[108:109], v23 offset:40960
    s_waitcnt lgkmcnt(10)
    buffer_load_dwordx4 v36, s[76:79], s38 offen offset:0 lds
    v_mfma_f32_16x16x32_bf16 v[76:79], a[80:83], a[16:19], v[76:79]
    ds_read_b64_tr_b16 a[110:111], v23 offset:45056
    v_exp_f32 v119, v119
    v_mfma_f32_16x16x32_bf16 v[84:87], a[80:83], a[32:35], v[56:59]
    ds_read_b64_tr_b16 a[248:249], v46 offset:32768
    v_cvt_pk_bf16_f32 v115, v118, v119
    v_mfma_f32_16x16x32_bf16 v[84:87], a[84:87], a[36:39], v[84:87]
    ds_read_b64_tr_b16 a[112:113], v24 offset:40960
    v_mfma_f32_16x16x32_bf16 v[84:87], a[88:91], a[40:43], v[84:87]
    ds_read_b64_tr_b16 a[114:115], v24 offset:45056
    buffer_load_dwordx4 v37, s[76:79], s38 offen offset:1024 lds
    v_mfma_f32_16x16x32_bf16 v[84:87], a[92:95], a[44:47], v[84:87]
    s_waitcnt lgkmcnt(10)
    ds_read_b64_tr_b16 a[250:251], v46 offset:34816
    v_mfma_f32_16x16x32_bf16 v[128:131], a[96:99], v[96:99], v[128:131]
    ds_read_b64_tr_b16 a[116:117], v25 offset:40960
    v_mfma_f32_16x16x32_bf16 v[160:163], a[96:99], v[104:107], v[160:163]
    ds_read_b64_tr_b16 a[118:119], v25 offset:45056
    v_exp_f32 v64, v64
    v_mfma_f32_16x16x32_bf16 v[192:195], a[96:99], v[112:115], v[192:195]
    s_waitcnt lgkmcnt(10)
    ds_read_b64_tr_b16 a[252:253], v47 offset:32768
    v_exp_f32 v65, v65
    v_mfma_f32_16x16x32_bf16 v[196:199], a[100:103], v[112:115], v[196:199]
    ds_read_b64_tr_b16 a[120:121], v26 offset:40960
    buffer_load_dwordx4 v38, s[76:79], s38 offen offset:2048 lds
    v_mfma_f32_16x16x32_bf16 v[164:167], a[100:103], v[104:107], v[164:167]
    ds_read_b64_tr_b16 a[122:123], v26 offset:45056
    v_exp_f32 v66, v66
    v_mfma_f32_16x16x32_bf16 v[132:135], a[100:103], v[96:99], v[132:135]
    s_waitcnt lgkmcnt(10)
    ds_read_b64_tr_b16 a[254:255], v47 offset:34816
    v_cvt_pk_bf16_f32 v64, v64, v65
    v_mfma_f32_16x16x32_bf16 v[136:139], a[104:107], v[96:99], v[136:139]
    ds_read_b64_tr_b16 a[124:125], v27 offset:40960
    v_exp_f32 v67, v67
    v_mfma_f32_16x16x32_bf16 v[168:171], a[104:107], v[104:107], v[168:171]
    ds_read_b64_tr_b16 a[126:127], v27 offset:45056
    v_cvt_pk_bf16_f32 v65, v66, v67
    v_mfma_f32_16x16x32_bf16 v[200:203], a[104:107], v[112:115], v[200:203]
    s_waitcnt lgkmcnt(10)
    buffer_load_dwordx4 v39, s[76:79], s38 offen offset:3072 lds
    v_mfma_f32_16x16x32_bf16 v[204:207], a[108:111], v[112:115], v[204:207]
    ds_read_b128 a[64:67], v16 offset:40960
    v_mfma_f32_16x16x32_bf16 v[172:175], a[108:111], v[104:107], v[172:175]
    s_add_u32 m0, s30, 98304
    s_mov_b32 s38, 491520
    v_exp_f32 v72, v72
    v_mfma_f32_16x16x32_bf16 v[140:143], a[108:111], v[96:99], v[140:143]
    s_waitcnt lgkmcnt(10)
    s_waitcnt lgkmcnt(3)
    buffer_load_dwordx4 v36, s[76:79], s38 offen offset:0 lds
    v_mfma_f32_16x16x32_bf16 v[144:147], a[112:115], v[96:99], v[144:147]
    ds_read_b128 a[68:71], v17 offset:40960
    v_mfma_f32_16x16x32_bf16 v[176:179], a[112:115], v[104:107], v[176:179]
    v_exp_f32 v73, v73
    v_mfma_f32_16x16x32_bf16 v[208:211], a[112:115], v[112:115], v[208:211]
    v_exp_f32 v74, v74
    v_mfma_f32_16x16x32_bf16 v[212:215], a[116:119], v[112:115], v[212:215]
    ds_read_b128 a[72:75], v18 offset:40960
    v_cvt_pk_bf16_f32 v72, v72, v73
    v_mfma_f32_16x16x32_bf16 v[180:183], a[116:119], v[104:107], v[180:183]
    buffer_load_dwordx4 v37, s[76:79], s38 offen offset:1024 lds
    v_mfma_f32_16x16x32_bf16 v[148:151], a[116:119], v[96:99], v[148:151]
    v_exp_f32 v75, v75
    v_mfma_f32_16x16x32_bf16 v[152:155], a[120:123], v[96:99], v[152:155]
    ds_read_b128 a[76:79], v19 offset:40960
    v_cvt_pk_bf16_f32 v73, v74, v75
    v_mfma_f32_16x16x32_bf16 v[184:187], a[120:123], v[104:107], v[184:187]
    v_exp_f32 v80, v80
    v_exp_f32 v81, v81
    v_mfma_f32_16x16x32_bf16 v[216:219], a[120:123], v[112:115], v[216:219]
    s_waitcnt lgkmcnt(4)
    buffer_load_dwordx4 v38, s[76:79], s38 offen offset:2048 lds
    v_mfma_f32_16x16x32_bf16 v[220:223], a[124:127], v[112:115], v[220:223]
    ds_read_b128 a[80:83], v16 offset:45056
    v_cvt_pk_bf16_f32 v80, v80, v81
    v_mfma_f32_16x16x32_bf16 v[188:191], a[124:127], v[104:107], v[188:191]
    v_exp_f32 v82, v82
    v_mfma_f32_16x16x32_bf16 v[156:159], a[124:127], v[96:99], v[156:159]
    v_exp_f32 v83, v83
    v_mfma_f32_16x16x32_bf16 a[128:131], a[144:147], v[96:99], a[128:131]
    ds_read_b128 a[84:87], v17 offset:45056
    v_cvt_pk_bf16_f32 v81, v82, v83
    v_mfma_f32_16x16x32_bf16 a[132:135], a[144:147], v[104:107], a[132:135]
    buffer_load_dwordx4 v39, s[76:79], s38 offen offset:3072 lds
    v_mfma_f32_16x16x32_bf16 a[136:139], a[144:147], v[112:115], a[136:139]
    s_waitcnt lgkmcnt(2)
    v_exp_f32 v68, v68
    v_mfma_f32_16x16x32_bf16 v[96:99], a[64:67], a[0:3], v[48:51]
    ds_read_b128 a[88:91], v18 offset:45056
    v_mfma_f32_16x16x32_bf16 v[96:99], a[68:71], a[4:7], v[96:99]
    v_exp_f32 v69, v69
    v_mfma_f32_16x16x32_bf16 v[96:99], a[72:75], a[8:11], v[96:99]
    v_exp_f32 v70, v70
    v_mfma_f32_16x16x32_bf16 v[96:99], a[76:79], a[12:15], v[96:99]
    ds_read_b128 a[92:95], v19 offset:45056
    v_cvt_pk_bf16_f32 v66, v68, v69
    v_mfma_f32_16x16x32_bf16 v[104:107], a[76:79], a[28:31], v[52:55]
    v_exp_f32 v71, v71
    v_mfma_f32_16x16x32_bf16 v[104:107], a[72:75], a[24:27], v[104:107]
    v_exp_f32 v76, v76
    v_mfma_f32_16x16x32_bf16 v[104:107], a[68:71], a[20:23], v[104:107]
    v_exp_f32 v77, v77
    v_mfma_f32_16x16x32_bf16 v[104:107], a[64:67], a[16:19], v[104:107]
    v_cvt_pk_bf16_f32 v67, v70, v71
    v_cvt_pk_bf16_f32 v74, v76, v77
    v_mfma_f32_16x16x32_bf16 v[112:115], a[64:67], a[32:35], v[56:59]
    v_exp_f32 v78, v78
    v_mfma_f32_16x16x32_bf16 v[112:115], a[68:71], a[36:39], v[112:115]
    v_mfma_f32_16x16x32_bf16 v[112:115], a[72:75], a[40:43], v[112:115]
    v_exp_f32 v79, v79
    v_mfma_f32_16x16x32_bf16 v[112:115], a[76:79], a[44:47], v[112:115]
    v_cvt_pk_bf16_f32 v75, v78, v79
    s_waitcnt vmcnt(46) lgkmcnt(0)
    s_barrier
    v_mfma_f32_16x16x32_bf16 v[100:103], a[80:83], a[0:3], v[48:51]
    ds_read_b64_tr_b16 a[96:97], v20 offset:49152
    v_mfma_f32_16x16x32_bf16 v[100:103], a[84:87], a[4:7], v[100:103]
    s_add_u32 m0, s30, 131072
    s_mov_b32 s38, 532480
    ds_read_b64_tr_b16 a[98:99], v20 offset:53248
    v_exp_f32 v84, v84
    v_mfma_f32_16x16x32_bf16 v[100:103], a[88:91], a[8:11], v[100:103]
    buffer_load_dwordx4 v36, s[76:79], s38 offen offset:0 lds
    v_mfma_f32_16x16x32_bf16 v[100:103], a[92:95], a[12:15], v[100:103]
    ds_read_b64_tr_b16 a[100:101], v21 offset:49152
    v_exp_f32 v85, v85
    v_mfma_f32_16x16x32_bf16 v[108:111], a[92:95], a[28:31], v[52:55]
    ds_read_b64_tr_b16 a[102:103], v21 offset:53248
    v_cvt_pk_bf16_f32 v82, v84, v85
    v_mfma_f32_16x16x32_bf16 v[108:111], a[88:91], a[24:27], v[108:111]
    buffer_load_dwordx4 v37, s[76:79], s38 offen offset:1024 lds
    v_exp_f32 v86, v86
    v_mfma_f32_16x16x32_bf16 v[108:111], a[84:87], a[20:23], v[108:111]
    ds_read_b64_tr_b16 a[104:105], v22 offset:49152
    v_mfma_f32_16x16x32_bf16 v[108:111], a[80:83], a[16:19], v[108:111]
    ds_read_b64_tr_b16 a[106:107], v22 offset:53248
    v_exp_f32 v87, v87
    v_mfma_f32_16x16x32_bf16 v[116:119], a[80:83], a[32:35], v[56:59]
    buffer_load_dwordx4 v38, s[76:79], s38 offen offset:2048 lds
    v_mfma_f32_16x16x32_bf16 v[116:119], a[84:87], a[36:39], v[116:119]
    ds_read_b64_tr_b16 a[108:109], v23 offset:49152
    v_cvt_pk_bf16_f32 v83, v86, v87
    v_mfma_f32_16x16x32_bf16 v[116:119], a[88:91], a[40:43], v[116:119]
    ds_read_b64_tr_b16 a[110:111], v23 offset:53248
    v_mfma_f32_16x16x32_bf16 v[116:119], a[92:95], a[44:47], v[116:119]
    s_waitcnt lgkmcnt(6)
    buffer_load_dwordx4 v39, s[76:79], s38 offen offset:3072 lds
    v_mfma_f32_16x16x32_bf16 v[128:131], a[96:99], v[64:67], v[128:131]
    ds_read_b64_tr_b16 a[112:113], v24 offset:49152
    v_mfma_f32_16x16x32_bf16 v[160:163], a[96:99], v[72:75], v[160:163]
    s_add_u32 m0, s30, 32768
    s_mov_b32 s38, 573440
    ds_read_b64_tr_b16 a[114:115], v24 offset:53248
    v_exp_f32 v96, v96
    v_mfma_f32_16x16x32_bf16 v[192:195], a[96:99], v[80:83], v[192:195]
    s_waitcnt lgkmcnt(6)
    buffer_load_dwordx4 v36, s[76:79], s38 offen offset:0 lds
    v_exp_f32 v97, v97
    v_mfma_f32_16x16x32_bf16 v[196:199], a[100:103], v[80:83], v[196:199]
    ds_read_b64_tr_b16 a[116:117], v25 offset:49152
    v_exp_f32 v98, v98
    v_cvt_pk_bf16_f32 v96, v96, v97
    v_mfma_f32_16x16x32_bf16 v[164:167], a[100:103], v[72:75], v[164:167]
    ds_read_b64_tr_b16 a[118:119], v25 offset:53248
    v_exp_f32 v99, v99
    v_mfma_f32_16x16x32_bf16 v[132:135], a[100:103], v[64:67], v[132:135]
    s_waitcnt lgkmcnt(6)
    buffer_load_dwordx4 v37, s[76:79], s38 offen offset:1024 lds
    v_exp_f32 v104, v104
    v_cvt_pk_bf16_f32 v97, v98, v99
    v_mfma_f32_16x16x32_bf16 v[136:139], a[104:107], v[64:67], v[136:139]
    ds_read_b64_tr_b16 a[120:121], v26 offset:49152
    v_exp_f32 v105, v105
    v_mfma_f32_16x16x32_bf16 v[168:171], a[104:107], v[72:75], v[168:171]
    ds_read_b64_tr_b16 a[122:123], v26 offset:53248
    v_exp_f32 v106, v106
    v_cvt_pk_bf16_f32 v104, v104, v105
    v_mfma_f32_16x16x32_bf16 v[200:203], a[104:107], v[80:83], v[200:203]
    s_waitcnt lgkmcnt(6)
    buffer_load_dwordx4 v38, s[76:79], s38 offen offset:2048 lds
    v_exp_f32 v107, v107
    v_mfma_f32_16x16x32_bf16 v[204:207], a[108:111], v[80:83], v[204:207]
    ds_read_b64_tr_b16 a[124:125], v27 offset:49152
    v_exp_f32 v112, v112
    v_mfma_f32_16x16x32_bf16 v[172:175], a[108:111], v[72:75], v[172:175]
    ds_read_b64_tr_b16 a[126:127], v27 offset:53248
    v_exp_f32 v113, v113
    v_mfma_f32_16x16x32_bf16 v[140:143], a[108:111], v[64:67], v[140:143]
    s_waitcnt lgkmcnt(6)
    buffer_load_dwordx4 v39, s[76:79], s38 offen offset:3072 lds
    v_exp_f32 v114, v114
    v_mfma_f32_16x16x32_bf16 v[144:147], a[112:115], v[64:67], v[144:147]
    ds_read_b64_tr_b16 a[96:97], v20 offset:57344
    v_cvt_pk_bf16_f32 v105, v106, v107
    v_mfma_f32_16x16x32_bf16 v[176:179], a[112:115], v[72:75], v[176:179]
    ds_read_b64_tr_b16 a[98:99], v20 offset:61440
    v_cvt_pk_bf16_f32 v112, v112, v113
    v_mfma_f32_16x16x32_bf16 v[208:211], a[112:115], v[80:83], v[208:211]
    s_waitcnt lgkmcnt(6)
    v_exp_f32 v115, v115
    v_exp_f32 v100, v100
    v_mfma_f32_16x16x32_bf16 v[212:215], a[116:119], v[80:83], v[212:215]
    ds_read_b64_tr_b16 a[100:101], v21 offset:57344
    v_exp_f32 v101, v101
    v_mfma_f32_16x16x32_bf16 v[180:183], a[116:119], v[72:75], v[180:183]
    ds_read_b64_tr_b16 a[102:103], v21 offset:61440
    v_exp_f32 v102, v102
    v_mfma_f32_16x16x32_bf16 v[148:151], a[116:119], v[64:67], v[148:151]
    s_waitcnt lgkmcnt(6)
    v_exp_f32 v103, v103
    v_exp_f32 v108, v108
    v_mfma_f32_16x16x32_bf16 v[152:155], a[120:123], v[64:67], v[152:155]
    ds_read_b64_tr_b16 a[104:105], v22 offset:57344
    v_exp_f32 v109, v109
    v_mfma_f32_16x16x32_bf16 v[184:187], a[120:123], v[72:75], v[184:187]
    ds_read_b64_tr_b16 a[106:107], v22 offset:61440
    v_cvt_pk_bf16_f32 v113, v114, v115
    v_cvt_pk_bf16_f32 v98, v100, v101
    v_mfma_f32_16x16x32_bf16 v[216:219], a[120:123], v[80:83], v[216:219]
    s_waitcnt lgkmcnt(6)
    v_exp_f32 v110, v110
    v_exp_f32 v111, v111
    v_mfma_f32_16x16x32_bf16 v[220:223], a[124:127], v[80:83], v[220:223]
    ds_read_b64_tr_b16 a[108:109], v23 offset:57344
    v_exp_f32 v116, v116
    v_mfma_f32_16x16x32_bf16 v[188:191], a[124:127], v[72:75], v[188:191]
    ds_read_b64_tr_b16 a[110:111], v23 offset:61440
    v_cvt_pk_bf16_f32 v99, v102, v103
    v_cvt_pk_bf16_f32 v106, v108, v109
    v_mfma_f32_16x16x32_bf16 v[156:159], a[124:127], v[64:67], v[156:159]
    v_exp_f32 v117, v117
    v_exp_f32 v118, v118
    v_exp_f32 v119, v119
    v_mfma_f32_16x16x32_bf16 a[128:131], a[144:147], v[64:67], a[128:131]
    ds_read_b64_tr_b16 a[112:113], v24 offset:57344
    v_cvt_pk_bf16_f32 v107, v110, v111
    v_mfma_f32_16x16x32_bf16 a[132:135], a[144:147], v[72:75], a[132:135]
    ds_read_b64_tr_b16 a[114:115], v24 offset:61440
    v_cvt_pk_bf16_f32 v114, v116, v117
    v_mfma_f32_16x16x32_bf16 a[136:139], a[144:147], v[80:83], a[136:139]
    s_waitcnt lgkmcnt(8)
    v_cvt_pk_bf16_f32 v115, v118, v119
    v_mfma_f32_16x16x32_bf16 v[128:131], a[96:99], v[96:99], v[128:131]
    ds_read_b64_tr_b16 a[116:117], v25 offset:57344
    v_mfma_f32_16x16x32_bf16 v[160:163], a[96:99], v[104:107], v[160:163]
    ds_read_b64_tr_b16 a[118:119], v25 offset:61440
    v_mfma_f32_16x16x32_bf16 v[192:195], a[96:99], v[112:115], v[192:195]
    s_waitcnt lgkmcnt(8)
    v_mfma_f32_16x16x32_bf16 v[196:199], a[100:103], v[112:115], v[196:199]
    ds_read_b64_tr_b16 a[120:121], v26 offset:57344
    v_mfma_f32_16x16x32_bf16 v[164:167], a[100:103], v[104:107], v[164:167]
    ds_read_b64_tr_b16 a[122:123], v26 offset:61440
    v_mfma_f32_16x16x32_bf16 v[132:135], a[100:103], v[96:99], v[132:135]
    s_waitcnt lgkmcnt(8)
    v_mfma_f32_16x16x32_bf16 v[136:139], a[104:107], v[96:99], v[136:139]
    ds_read_b64_tr_b16 a[124:125], v27 offset:57344
    v_mfma_f32_16x16x32_bf16 v[168:171], a[104:107], v[104:107], v[168:171]
    ds_read_b64_tr_b16 a[126:127], v27 offset:61440
    v_mfma_f32_16x16x32_bf16 v[200:203], a[104:107], v[112:115], v[200:203]
    s_waitcnt lgkmcnt(8)
    v_mfma_f32_16x16x32_bf16 v[204:207], a[108:111], v[112:115], v[204:207]
    v_mfma_f32_16x16x32_bf16 v[172:175], a[108:111], v[104:107], v[172:175]
    v_mfma_f32_16x16x32_bf16 v[140:143], a[108:111], v[96:99], v[140:143]
    s_waitcnt lgkmcnt(6)
    v_mfma_f32_16x16x32_bf16 v[144:147], a[112:115], v[96:99], v[144:147]
    v_mfma_f32_16x16x32_bf16 v[176:179], a[112:115], v[104:107], v[176:179]
    v_mfma_f32_16x16x32_bf16 v[208:211], a[112:115], v[112:115], v[208:211]
    s_waitcnt lgkmcnt(4)
    v_mfma_f32_16x16x32_bf16 v[212:215], a[116:119], v[112:115], v[212:215]
    v_mfma_f32_16x16x32_bf16 v[180:183], a[116:119], v[104:107], v[180:183]
    v_mfma_f32_16x16x32_bf16 v[148:151], a[116:119], v[96:99], v[148:151]
    s_waitcnt lgkmcnt(2)
    v_mfma_f32_16x16x32_bf16 v[152:155], a[120:123], v[96:99], v[152:155]
    v_mfma_f32_16x16x32_bf16 v[184:187], a[120:123], v[104:107], v[184:187]
    v_mfma_f32_16x16x32_bf16 v[216:219], a[120:123], v[112:115], v[216:219]
    s_waitcnt lgkmcnt(0)
    v_mfma_f32_16x16x32_bf16 v[220:223], a[124:127], v[112:115], v[220:223]
    v_mfma_f32_16x16x32_bf16 v[188:191], a[124:127], v[104:107], v[188:191]
    v_mfma_f32_16x16x32_bf16 v[156:159], a[124:127], v[96:99], v[156:159]
    v_mfma_f32_16x16x32_bf16 a[128:131], a[144:147], v[96:99], a[128:131]
    v_mfma_f32_16x16x32_bf16 a[132:135], a[144:147], v[104:107], a[132:135]
    v_mfma_f32_16x16x32_bf16 a[136:139], a[144:147], v[112:115], a[136:139]
    s_nop 7
    v_accvgpr_read_b32 v48, a128
    v_accvgpr_read_b32 v52, a132
    v_accvgpr_read_b32 v56, a136
    v_mov_b32 v49, v48
    v_mov_b32 v53, v52
    v_mov_b32 v57, v56
    s_nop 1
    v_permlane32_swap_b32 v48, v49
    v_permlane32_swap_b32 v52, v53
    v_permlane32_swap_b32 v56, v57
    s_nop 1
    v_add_f32 v48, v48, v49
    v_add_f32 v52, v52, v53
    v_add_f32 v56, v56, v57
    v_mov_b32 v49, v48
    v_mov_b32 v53, v52
    v_mov_b32 v57, v56
    s_nop 1
    v_permlane16_swap_b32 v48, v49
    v_permlane16_swap_b32 v52, v53
    v_permlane16_swap_b32 v56, v57
    s_nop 1
    v_add_f32 v48, v48, v49
    v_add_f32 v52, v52, v53
    v_add_f32 v56, v56, v57
    s_mov_b32 s38, 0x5f800000
    s_mov_b64 s[4:5], 0
    v_cmp_ngt_f32 vcc, s38, v48
    s_or_b64 s[4:5], s[4:5], vcc
    v_cmp_ngt_f32 vcc, s38, v52
    s_or_b64 s[4:5], s[4:5], vcc
    v_cmp_ngt_f32 vcc, s38, v56
    s_or_b64 s[4:5], s[4:5], vcc
    s_cbranch_scc1 L_safeB
L_epiB:
    v_rcp_f32 v48, v48
    v_rcp_f32 v52, v52
    v_rcp_f32 v56, v56
    s_lshl_b32 s38, s28, 2
    s_add_u32 s38, s38, 0
    s_mul_i32 s39, s38, 52
    s_lshr_b32 s39, s39, 8
    s_mul_i32 s39, s39, 634880
    s_lshl_b32 s38, s38, 12
    s_add_u32 s38, s38, s39
    s_add_u32 s38, s38, s3
    v_pk_mul_f32 v[128:129], v[128:129], v[48:49] op_sel_hi:[1,0]
    v_pk_mul_f32 v[130:131], v[130:131], v[48:49] op_sel_hi:[1,0]
    v_pk_mul_f32 v[132:133], v[132:133], v[48:49] op_sel_hi:[1,0]
    v_pk_mul_f32 v[134:135], v[134:135], v[48:49] op_sel_hi:[1,0]
    v_cvt_pk_bf16_f32 v128, v128, v129
    v_cvt_pk_bf16_f32 v129, v130, v131
    v_cvt_pk_bf16_f32 v130, v132, v133
    v_cvt_pk_bf16_f32 v131, v134, v135
    buffer_store_dwordx4 v[128:131], v2, s[24:27], s38 offen offset:0 sc0 sc1
    v_pk_mul_f32 v[136:137], v[136:137], v[48:49] op_sel_hi:[1,0]
    v_pk_mul_f32 v[138:139], v[138:139], v[48:49] op_sel_hi:[1,0]
    v_pk_mul_f32 v[140:141], v[140:141], v[48:49] op_sel_hi:[1,0]
    v_pk_mul_f32 v[142:143], v[142:143], v[48:49] op_sel_hi:[1,0]
    v_cvt_pk_bf16_f32 v136, v136, v137
    v_cvt_pk_bf16_f32 v137, v138, v139
    v_cvt_pk_bf16_f32 v138, v140, v141
    v_cvt_pk_bf16_f32 v139, v142, v143
    buffer_store_dwordx4 v[136:139], v2, s[24:27], s38 offen offset:1024 sc0 sc1
    v_pk_mul_f32 v[144:145], v[144:145], v[48:49] op_sel_hi:[1,0]
    v_pk_mul_f32 v[146:147], v[146:147], v[48:49] op_sel_hi:[1,0]
    v_pk_mul_f32 v[148:149], v[148:149], v[48:49] op_sel_hi:[1,0]
    v_pk_mul_f32 v[150:151], v[150:151], v[48:49] op_sel_hi:[1,0]
    v_cvt_pk_bf16_f32 v144, v144, v145
    v_cvt_pk_bf16_f32 v145, v146, v147
    v_cvt_pk_bf16_f32 v146, v148, v149
    v_cvt_pk_bf16_f32 v147, v150, v151
    buffer_store_dwordx4 v[144:147], v2, s[24:27], s38 offen offset:2048 sc0 sc1
    v_pk_mul_f32 v[152:153], v[152:153], v[48:49] op_sel_hi:[1,0]
    v_pk_mul_f32 v[154:155], v[154:155], v[48:49] op_sel_hi:[1,0]
    v_pk_mul_f32 v[156:157], v[156:157], v[48:49] op_sel_hi:[1,0]
    v_pk_mul_f32 v[158:159], v[158:159], v[48:49] op_sel_hi:[1,0]
    v_cvt_pk_bf16_f32 v152, v152, v153
    v_cvt_pk_bf16_f32 v153, v154, v155
    v_cvt_pk_bf16_f32 v154, v156, v157
    v_cvt_pk_bf16_f32 v155, v158, v159
    buffer_store_dwordx4 v[152:155], v2, s[24:27], s38 offen offset:3072 sc0 sc1
    s_lshl_b32 s38, s28, 2
    s_add_u32 s38, s38, 1
    s_mul_i32 s39, s38, 52
    s_lshr_b32 s39, s39, 8
    s_mul_i32 s39, s39, 634880
    s_lshl_b32 s38, s38, 12
    s_add_u32 s38, s38, s39
    s_add_u32 s38, s38, s3
    v_pk_mul_f32 v[160:161], v[160:161], v[52:53] op_sel_hi:[1,0]
    v_pk_mul_f32 v[162:163], v[162:163], v[52:53] op_sel_hi:[1,0]
    v_pk_mul_f32 v[164:165], v[164:165], v[52:53] op_sel_hi:[1,0]
    v_pk_mul_f32 v[166:167], v[166:167], v[52:53] op_sel_hi:[1,0]
    v_cvt_pk_bf16_f32 v160, v160, v161
    v_cvt_pk_bf16_f32 v161, v162, v163
    v_cvt_pk_bf16_f32 v162, v164, v165
    v_cvt_pk_bf16_f32 v163, v166, v167
    buffer_store_dwordx4 v[160:163], v2, s[24:27], s38 offen offset:0 sc0 sc1
    v_pk_mul_f32 v[168:169], v[168:169], v[52:53] op_sel_hi:[1,0]
    v_pk_mul_f32 v[170:171], v[170:171], v[52:53] op_sel_hi:[1,0]
    v_pk_mul_f32 v[172:173], v[172:173], v[52:53] op_sel_hi:[1,0]
    v_pk_mul_f32 v[174:175], v[174:175], v[52:53] op_sel_hi:[1,0]
    v_cvt_pk_bf16_f32 v168, v168, v169
    v_cvt_pk_bf16_f32 v169, v170, v171
    v_cvt_pk_bf16_f32 v170, v172, v173
    v_cvt_pk_bf16_f32 v171, v174, v175
    buffer_store_dwordx4 v[168:171], v2, s[24:27], s38 offen offset:1024 sc0 sc1
    v_pk_mul_f32 v[176:177], v[176:177], v[52:53] op_sel_hi:[1,0]
    v_pk_mul_f32 v[178:179], v[178:179], v[52:53] op_sel_hi:[1,0]
    v_pk_mul_f32 v[180:181], v[180:181], v[52:53] op_sel_hi:[1,0]
    v_pk_mul_f32 v[182:183], v[182:183], v[52:53] op_sel_hi:[1,0]
    v_cvt_pk_bf16_f32 v176, v176, v177
    v_cvt_pk_bf16_f32 v177, v178, v179
    v_cvt_pk_bf16_f32 v178, v180, v181
    v_cvt_pk_bf16_f32 v179, v182, v183
    buffer_store_dwordx4 v[176:179], v2, s[24:27], s38 offen offset:2048 sc0 sc1
    v_pk_mul_f32 v[184:185], v[184:185], v[52:53] op_sel_hi:[1,0]
    v_pk_mul_f32 v[186:187], v[186:187], v[52:53] op_sel_hi:[1,0]
    v_pk_mul_f32 v[188:189], v[188:189], v[52:53] op_sel_hi:[1,0]
    v_pk_mul_f32 v[190:191], v[190:191], v[52:53] op_sel_hi:[1,0]
    v_cvt_pk_bf16_f32 v184, v184, v185
    v_cvt_pk_bf16_f32 v185, v186, v187
    v_cvt_pk_bf16_f32 v186, v188, v189
    v_cvt_pk_bf16_f32 v187, v190, v191
    buffer_store_dwordx4 v[184:187], v2, s[24:27], s38 offen offset:3072 sc0 sc1
    s_lshl_b32 s38, s28, 2
    s_add_u32 s38, s38, 2
    s_mul_i32 s39, s38, 52
    s_lshr_b32 s39, s39, 8
    s_mul_i32 s39, s39, 634880
    s_lshl_b32 s38, s38, 12
    s_add_u32 s38, s38, s39
    s_add_u32 s38, s38, s3
    v_pk_mul_f32 v[192:193], v[192:193], v[56:57] op_sel_hi:[1,0]
    v_pk_mul_f32 v[194:195], v[194:195], v[56:57] op_sel_hi:[1,0]
    v_pk_mul_f32 v[196:197], v[196:197], v[56:57] op_sel_hi:[1,0]
    v_pk_mul_f32 v[198:199], v[198:199], v[56:57] op_sel_hi:[1,0]
    v_cvt_pk_bf16_f32 v192, v192, v193
    v_cvt_pk_bf16_f32 v193, v194, v195
    v_cvt_pk_bf16_f32 v194, v196, v197
    v_cvt_pk_bf16_f32 v195, v198, v199
    buffer_store_dwordx4 v[192:195], v2, s[24:27], s38 offen offset:0 sc0 sc1
    v_pk_mul_f32 v[200:201], v[200:201], v[56:57] op_sel_hi:[1,0]
    v_pk_mul_f32 v[202:203], v[202:203], v[56:57] op_sel_hi:[1,0]
    v_pk_mul_f32 v[204:205], v[204:205], v[56:57] op_sel_hi:[1,0]
    v_pk_mul_f32 v[206:207], v[206:207], v[56:57] op_sel_hi:[1,0]
    v_cvt_pk_bf16_f32 v200, v200, v201
    v_cvt_pk_bf16_f32 v201, v202, v203
    v_cvt_pk_bf16_f32 v202, v204, v205
    v_cvt_pk_bf16_f32 v203, v206, v207
    buffer_store_dwordx4 v[200:203], v2, s[24:27], s38 offen offset:1024 sc0 sc1
    v_pk_mul_f32 v[208:209], v[208:209], v[56:57] op_sel_hi:[1,0]
    v_pk_mul_f32 v[210:211], v[210:211], v[56:57] op_sel_hi:[1,0]
    v_pk_mul_f32 v[212:213], v[212:213], v[56:57] op_sel_hi:[1,0]
    v_pk_mul_f32 v[214:215], v[214:215], v[56:57] op_sel_hi:[1,0]
    v_cvt_pk_bf16_f32 v208, v208, v209
    v_cvt_pk_bf16_f32 v209, v210, v211
    v_cvt_pk_bf16_f32 v210, v212, v213
    v_cvt_pk_bf16_f32 v211, v214, v215
    buffer_store_dwordx4 v[208:211], v2, s[24:27], s38 offen offset:2048 sc0 sc1
    v_pk_mul_f32 v[216:217], v[216:217], v[56:57] op_sel_hi:[1,0]
    v_pk_mul_f32 v[218:219], v[218:219], v[56:57] op_sel_hi:[1,0]
    v_pk_mul_f32 v[220:221], v[220:221], v[56:57] op_sel_hi:[1,0]
    v_pk_mul_f32 v[222:223], v[222:223], v[56:57] op_sel_hi:[1,0]
    v_cvt_pk_bf16_f32 v216, v216, v217
    v_cvt_pk_bf16_f32 v217, v218, v219
    v_cvt_pk_bf16_f32 v218, v220, v221
    v_cvt_pk_bf16_f32 v219, v222, v223
    buffer_store_dwordx4 v[216:219], v2, s[24:27], s38 offen offset:3072 sc0 sc1
    s_waitcnt vmcnt(20)
    s_branch L_common
L_safeB:
    s_waitcnt vmcnt(0) lgkmcnt(0)
    v_mov_b32 v128, 0
    v_mov_b32 v129, 0
    v_mov_b32 v130, 0
    v_mov_b32 v131, 0
    v_mov_b32 v132, 0
    v_mov_b32 v133, 0
    v_mov_b32 v134, 0
    v_mov_b32 v135, 0
    v_mov_b32 v136, 0
    v_mov_b32 v137, 0
    v_mov_b32 v138, 0
    v_mov_b32 v139, 0
    v_mov_b32 v140, 0
    v_mov_b32 v141, 0
    v_mov_b32 v142, 0
    v_mov_b32 v143, 0
    v_mov_b32 v144, 0
    v_mov_b32 v145, 0
    v_mov_b32 v146, 0
    v_mov_b32 v147, 0
    v_mov_b32 v148, 0
    v_mov_b32 v149, 0
    v_mov_b32 v150, 0
    v_mov_b32 v151, 0
    v_mov_b32 v152, 0
    v_mov_b32 v153, 0
    v_mov_b32 v154, 0
    v_mov_b32 v155, 0
    v_mov_b32 v156, 0
    v_mov_b32 v157, 0
    v_mov_b32 v158, 0
    v_mov_b32 v159, 0
    v_mov_b32 v160, 0
    v_mov_b32 v161, 0
    v_mov_b32 v162, 0
    v_mov_b32 v163, 0
    v_mov_b32 v164, 0
    v_mov_b32 v165, 0
    v_mov_b32 v166, 0
    v_mov_b32 v167, 0
    v_mov_b32 v168, 0
    v_mov_b32 v169, 0
    v_mov_b32 v170, 0
    v_mov_b32 v171, 0
    v_mov_b32 v172, 0
    v_mov_b32 v173, 0
    v_mov_b32 v174, 0
    v_mov_b32 v175, 0
    v_mov_b32 v176, 0
    v_mov_b32 v177, 0
    v_mov_b32 v178, 0
    v_mov_b32 v179, 0
    v_mov_b32 v180, 0
    v_mov_b32 v181, 0
    v_mov_b32 v182, 0
    v_mov_b32 v183, 0
    v_mov_b32 v184, 0
    v_mov_b32 v185, 0
    v_mov_b32 v186, 0
    v_mov_b32 v187, 0
    v_mov_b32 v188, 0
    v_mov_b32 v189, 0
    v_mov_b32 v190, 0
    v_mov_b32 v191, 0
    v_mov_b32 v192, 0
    v_mov_b32 v193, 0
    v_mov_b32 v194, 0
    v_mov_b32 v195, 0
    v_mov_b32 v196, 0
    v_mov_b32 v197, 0
    v_mov_b32 v198, 0
    v_mov_b32 v199, 0
    v_mov_b32 v200, 0
    v_mov_b32 v201, 0
    v_mov_b32 v202, 0
    v_mov_b32 v203, 0
    v_mov_b32 v204, 0
    v_mov_b32 v205, 0
    v_mov_b32 v206, 0
    v_mov_b32 v207, 0
    v_mov_b32 v208, 0
    v_mov_b32 v209, 0
    v_mov_b32 v210, 0
    v_mov_b32 v211, 0
    v_mov_b32 v212, 0
    v_mov_b32 v213, 0
    v_mov_b32 v214, 0
    v_mov_b32 v215, 0
    v_mov_b32 v216, 0
    v_mov_b32 v217, 0
    v_mov_b32 v218, 0
    v_mov_b32 v219, 0
    v_mov_b32 v220, 0
    v_mov_b32 v221, 0
    v_mov_b32 v222, 0
    v_mov_b32 v223, 0
    v_mov_b32 v48, 0xff800000
    v_mov_b32 v51, 0
    v_mov_b32 v52, 0xff800000
    v_mov_b32 v55, 0
    v_mov_b32 v56, 0xff800000
    v_mov_b32 v59, 0
    v_lshlrev_b32 v8, 8, v4
    v_xor_b32 v9, v5, v4
    v_xor_b32 v10, 0, v9
    v_lshl_add_u32 v28, v10, 4, v8
    v_xor_b32 v10, 4, v9
    v_lshl_add_u32 v29, v10, 4, v8
    v_xor_b32 v10, 8, v9
    v_lshl_add_u32 v30, v10, 4, v8
    v_xor_b32 v10, 12, v9
    v_lshl_add_u32 v31, v10, 4, v8
    v_lshlrev_b32 v9, 1, v4
    v_xor_b32 v9, v9, v5
    v_xor_b32 v10, 0, v9
    v_lshl_add_u32 v32, v10, 4, v8
    v_mov_b32 v34, v32
    v_xor_b32 v10, 8, v9
    v_lshl_add_u32 v33, v10, 4, v8
    v_mov_b32 v35, v33
    s_lshl_b32 s38, s36, 5
    s_add_u32 s38, s38, s37
    s_lshl_b32 s38, s38, 19
    s_add_u32 s8, s86, s38
    s_addc_u32 s9, s87, 0
    s_mov_b32 s10, 524288
    s_mov_b32 s11, 0x20000
    s_add_u32 s12, s88, s38
    s_addc_u32 s13, s89, 0
    s_mov_b32 s14, 524288
    s_mov_b32 s15, 0x20000
    s_add_u32 s29, s30, 65536
    s_sub_u32 s38, s29, 98304
    v_add_u32 v16, s38, v16
    v_add_u32 v17, s38, v17
    v_add_u32 v18, s38, v18
    v_add_u32 v19, s38, v19
    v_add_u32 v20, s29, v20
    v_add_u32 v21, s29, v21
    v_add_u32 v22, s29, v22
    v_add_u32 v23, s29, v23
    v_add_u32 v24, s29, v24
    v_add_u32 v25, s29, v25
    v_add_u32 v26, s29, v26
    v_add_u32 v27, s29, v27
    s_mov_b32 s33, 0
L_sloopB:
    s_add_u32 m0, s29, 0
    s_add_u32 s34, s33, 0
    buffer_load_dwordx4 v28, s[8:11], s34 offen offset:0 lds
    buffer_load_dwordx4 v29, s[8:11], s34 offen offset:1024 lds
    buffer_load_dwordx4 v30, s[8:11], s34 offen offset:2048 lds
    buffer_load_dwordx4 v31, s[8:11], s34 offen offset:3072 lds
    s_add_u32 m0, s29, 16384
    s_add_u32 s34, s33, 4096
    buffer_load_dwordx4 v28, s[8:11], s34 offen offset:0 lds
    buffer_load_dwordx4 v29, s[8:11], s34 offen offset:1024 lds
    buffer_load_dwordx4 v30, s[8:11], s34 offen offset:2048 lds
    buffer_load_dwordx4 v31, s[8:11], s34 offen offset:3072 lds
    s_waitcnt vmcnt(0)
    ds_read_b128 a[64:67], v16 offset:0
    ds_read_b128 a[68:71], v17 offset:0
    ds_read_b128 a[72:75], v18 offset:0
    ds_read_b128 a[76:79], v19 offset:0
    ds_read_b128 a[80:83], v16 offset:16384
    ds_read_b128 a[84:87], v17 offset:16384
    ds_read_b128 a[88:91], v18 offset:16384
    ds_read_b128 a[92:95], v19 offset:16384
    s_waitcnt lgkmcnt(0)
    s_add_u32 m0, s29, 0
    s_add_u32 s34, s33, 0
    buffer_load_dwordx4 v32, s[12:15], s34 offen offset:0 lds
    buffer_load_dwordx4 v33, s[12:15], s34 offen offset:1024 lds
    buffer_load_dwordx4 v34, s[12:15], s34 offen offset:2048 lds
    buffer_load_dwordx4 v35, s[12:15], s34 offen offset:3072 lds
    s_add_u32 m0, s29, 16384
    s_add_u32 s34, s33, 4096
    buffer_load_dwordx4 v32, s[12:15], s34 offen offset:0 lds
    buffer_load_dwordx4 v33, s[12:15], s34 offen offset:1024 lds
    buffer_load_dwordx4 v34, s[12:15], s34 offen offset:2048 lds
    buffer_load_dwordx4 v35, s[12:15], s34 offen offset:3072 lds
    v_mfma_f32_16x16x32_bf16 v[64:67], a[64:67], a[0:3], 0
    v_mfma_f32_16x16x32_bf16 v[72:75], a[64:67], a[16:19], 0
    v_mfma_f32_16x16x32_bf16 v[80:83], a[64:67], a[32:35], 0
    v_mfma_f32_16x16x32_bf16 v[64:67], a[68:71], a[4:7], v[64:67]
    v_mfma_f32_16x16x32_bf16 v[72:75], a[68:71], a[20:23], v[72:75]
    v_mfma_f32_16x16x32_bf16 v[80:83], a[68:71], a[36:39], v[80:83]
    v_mfma_f32_16x16x32_bf16 v[64:67], a[72:75], a[8:11], v[64:67]
    v_mfma_f32_16x16x32_bf16 v[72:75], a[72:75], a[24:27], v[72:75]
    v_mfma_f32_16x16x32_bf16 v[80:83], a[72:75], a[40:43], v[80:83]
    v_mfma_f32_16x16x32_bf16 v[64:67], a[76:79], a[12:15], v[64:67]
    v_mfma_f32_16x16x32_bf16 v[72:75], a[76:79], a[28:31], v[72:75]
    v_mfma_f32_16x16x32_bf16 v[80:83], a[76:79], a[44:47], v[80:83]
    v_mfma_f32_16x16x32_bf16 v[68:71], a[80:83], a[0:3], 0
    v_mfma_f32_16x16x32_bf16 v[76:79], a[80:83], a[16:19], 0
    v_mfma_f32_16x16x32_bf16 v[84:87], a[80:83], a[32:35], 0
    v_mfma_f32_16x16x32_bf16 v[68:71], a[84:87], a[4:7], v[68:71]
    v_mfma_f32_16x16x32_bf16 v[76:79], a[84:87], a[20:23], v[76:79]
    v_mfma_f32_16x16x32_bf16 v[84:87], a[84:87], a[36:39], v[84:87]
    v_mfma_f32_16x16x32_bf16 v[68:71], a[88:91], a[8:11], v[68:71]
    v_mfma_f32_16x16x32_bf16 v[76:79], a[88:91], a[24:27], v[76:79]
    v_mfma_f32_16x16x32_bf16 v[84:87], a[88:91], a[40:43], v[84:87]
    v_mfma_f32_16x16x32_bf16 v[68:71], a[92:95], a[12:15], v[68:71]
    v_mfma_f32_16x16x32_bf16 v[76:79], a[92:95], a[28:31], v[76:79]
    v_mfma_f32_16x16x32_bf16 v[84:87], a[92:95], a[44:47], v[84:87]
    s_nop 7
    v_max3_f32 v96, v64, v65, v66
    v_max3_f32 v97, v67, v68, v69
    v_max3_f32 v96, v96, v70, v71
    v_max3_f32 v96, v96, v97, v48
    v_max3_f32 v98, v72, v73, v74
    v_max3_f32 v99, v75, v76, v77
    v_max3_f32 v98, v98, v78, v79
    v_max3_f32 v98, v98, v99, v52
    v_max3_f32 v100, v80, v81, v82
    v_max3_f32 v101, v83, v84, v85
    v_max3_f32 v100, v100, v86, v87
    v_max3_f32 v100, v100, v101, v56
    v_mov_b32 v97, v96
    v_mov_b32 v99, v98
    v_mov_b32 v101, v100
    s_nop 1
    v_permlane32_swap_b32 v96, v97
    v_permlane32_swap_b32 v98, v99
    v_permlane32_swap_b32 v100, v101
    s_nop 1
    v_max_f32 v96, v96, v97
    v_max_f32 v98, v98, v99
    v_max_f32 v100, v100, v101
    v_mov_b32 v97, v96
    v_mov_b32 v99, v98
    v_mov_b32 v101, v100
    s_nop 1
    v_permlane16_swap_b32 v96, v97
    v_permlane16_swap_b32 v98, v99
    v_permlane16_swap_b32 v100, v101
    s_nop 1
    v_max_f32 v96, v96, v97
    v_max_f32 v98, v98, v99
    v_max_f32 v100, v100, v101
    v_sub_f32 v50, v48, v96
    v_exp_f32 v50, v50
    v_mov_b32 v48, v96
    v_sub_f32 v64, v64, v48
    v_sub_f32 v65, v65, v48
    v_sub_f32 v66, v66, v48
    v_sub_f32 v67, v67, v48
    v_sub_f32 v68, v68, v48
    v_sub_f32 v69, v69, v48
    v_sub_f32 v70, v70, v48
    v_sub_f32 v71, v71, v48
    v_exp_f32 v64, v64
    v_exp_f32 v65, v65
    v_exp_f32 v66, v66
    v_exp_f32 v67, v67
    v_exp_f32 v68, v68
    v_exp_f32 v69, v69
    v_exp_f32 v70, v70
    v_exp_f32 v71, v71
    v_mul_f32 v51, v51, v50
    v_mul_f32 v128, v128, v50
    v_mul_f32 v129, v129, v50
    v_mul_f32 v130, v130, v50
    v_mul_f32 v131, v131, v50
    v_mul_f32 v132, v132, v50
    v_mul_f32 v133, v133, v50
    v_mul_f32 v134, v134, v50
    v_mul_f32 v135, v135, v50
    v_mul_f32 v136, v136, v50
    v_mul_f32 v137, v137, v50
    v_mul_f32 v138, v138, v50
    v_mul_f32 v139, v139, v50
    v_mul_f32 v140, v140, v50
    v_mul_f32 v141, v141, v50
    v_mul_f32 v142, v142, v50
    v_mul_f32 v143, v143, v50
    v_mul_f32 v144, v144, v50
    v_mul_f32 v145, v145, v50
    v_mul_f32 v146, v146, v50
    v_mul_f32 v147, v147, v50
    v_mul_f32 v148, v148, v50
    v_mul_f32 v149, v149, v50
    v_mul_f32 v150, v150, v50
    v_mul_f32 v151, v151, v50
    v_mul_f32 v152, v152, v50
    v_mul_f32 v153, v153, v50
    v_mul_f32 v154, v154, v50
    v_mul_f32 v155, v155, v50
    v_mul_f32 v156, v156, v50
    v_mul_f32 v157, v157, v50
    v_mul_f32 v158, v158, v50
    v_mul_f32 v159, v159, v50
    v_cvt_pk_bf16_f32 v64, v64, v65
    v_cvt_pk_bf16_f32 v65, v66, v67
    v_cvt_pk_bf16_f32 v66, v68, v69
    v_cvt_pk_bf16_f32 v67, v70, v71
    v_lshlrev_b32 v68, 16, v64
    v_and_b32 v69, 0xffff0000, v64
    v_add_f32 v51, v51, v68
    v_add_f32 v51, v51, v69
    v_lshlrev_b32 v68, 16, v65
    v_and_b32 v69, 0xffff0000, v65
    v_add_f32 v51, v51, v68
    v_add_f32 v51, v51, v69
    v_lshlrev_b32 v68, 16, v66
    v_and_b32 v69, 0xffff0000, v66
    v_add_f32 v51, v51, v68
    v_add_f32 v51, v51, v69
    v_lshlrev_b32 v68, 16, v67
    v_and_b32 v69, 0xffff0000, v67
    v_add_f32 v51, v51, v68
    v_add_f32 v51, v51, v69
    v_sub_f32 v54, v52, v98
    v_exp_f32 v54, v54
    v_mov_b32 v52, v98
    v_sub_f32 v72, v72, v52
    v_sub_f32 v73, v73, v52
    v_sub_f32 v74, v74, v52
    v_sub_f32 v75, v75, v52
    v_sub_f32 v76, v76, v52
    v_sub_f32 v77, v77, v52
    v_sub_f32 v78, v78, v52
    v_sub_f32 v79, v79, v52
    v_exp_f32 v72, v72
    v_exp_f32 v73, v73
    v_exp_f32 v74, v74
    v_exp_f32 v75, v75
    v_exp_f32 v76, v76
    v_exp_f32 v77, v77
    v_exp_f32 v78, v78
    v_exp_f32 v79, v79
    v_mul_f32 v55, v55, v54
    v_mul_f32 v160, v160, v54
    v_mul_f32 v161, v161, v54
    v_mul_f32 v162, v162, v54
    v_mul_f32 v163, v163, v54
    v_mul_f32 v164, v164, v54
    v_mul_f32 v165, v165, v54
    v_mul_f32 v166, v166, v54
    v_mul_f32 v167, v167, v54
    v_mul_f32 v168, v168, v54
    v_mul_f32 v169, v169, v54
    v_mul_f32 v170, v170, v54
    v_mul_f32 v171, v171, v54
    v_mul_f32 v172, v172, v54
    v_mul_f32 v173, v173, v54
    v_mul_f32 v174, v174, v54
    v_mul_f32 v175, v175, v54
    v_mul_f32 v176, v176, v54
    v_mul_f32 v177, v177, v54
    v_mul_f32 v178, v178, v54
    v_mul_f32 v179, v179, v54
    v_mul_f32 v180, v180, v54
    v_mul_f32 v181, v181, v54
    v_mul_f32 v182, v182, v54
    v_mul_f32 v183, v183, v54
    v_mul_f32 v184, v184, v54
    v_mul_f32 v185, v185, v54
    v_mul_f32 v186, v186, v54
    v_mul_f32 v187, v187, v54
    v_mul_f32 v188, v188, v54
    v_mul_f32 v189, v189, v54
    v_mul_f32 v190, v190, v54
    v_mul_f32 v191, v191, v54
    v_cvt_pk_bf16_f32 v72, v72, v73
    v_cvt_pk_bf16_f32 v73, v74, v75
    v_cvt_pk_bf16_f32 v74, v76, v77
    v_cvt_pk_bf16_f32 v75, v78, v79
    v_lshlrev_b32 v76, 16, v72
    v_and_b32 v77, 0xffff0000, v72
    v_add_f32 v55, v55, v76
    v_add_f32 v55, v55, v77
    v_lshlrev_b32 v76, 16, v73
    v_and_b32 v77, 0xffff0000, v73
    v_add_f32 v55, v55, v76
    v_add_f32 v55, v55, v77
    v_lshlrev_b32 v76, 16, v74
    v_and_b32 v77, 0xffff0000, v74
    v_add_f32 v55, v55, v76
    v_add_f32 v55, v55, v77
    v_lshlrev_b32 v76, 16, v75
    v_and_b32 v77, 0xffff0000, v75
    v_add_f32 v55, v55, v76
    v_add_f32 v55, v55, v77
    v_sub_f32 v58, v56, v100
    v_exp_f32 v58, v58
    v_mov_b32 v56, v100
    v_sub_f32 v80, v80, v56
    v_sub_f32 v81, v81, v56
    v_sub_f32 v82, v82, v56
    v_sub_f32 v83, v83, v56
    v_sub_f32 v84, v84, v56
    v_sub_f32 v85, v85, v56
    v_sub_f32 v86, v86, v56
    v_sub_f32 v87, v87, v56
    v_exp_f32 v80, v80
    v_exp_f32 v81, v81
    v_exp_f32 v82, v82
    v_exp_f32 v83, v83
    v_exp_f32 v84, v84
    v_exp_f32 v85, v85
    v_exp_f32 v86, v86
    v_exp_f32 v87, v87
    v_mul_f32 v59, v59, v58
    v_mul_f32 v192, v192, v58
    v_mul_f32 v193, v193, v58
    v_mul_f32 v194, v194, v58
    v_mul_f32 v195, v195, v58
    v_mul_f32 v196, v196, v58
    v_mul_f32 v197, v197, v58
    v_mul_f32 v198, v198, v58
    v_mul_f32 v199, v199, v58
    v_mul_f32 v200, v200, v58
    v_mul_f32 v201, v201, v58
    v_mul_f32 v202, v202, v58
    v_mul_f32 v203, v203, v58
    v_mul_f32 v204, v204, v58
    v_mul_f32 v205, v205, v58
    v_mul_f32 v206, v206, v58
    v_mul_f32 v207, v207, v58
    v_mul_f32 v208, v208, v58
    v_mul_f32 v209, v209, v58
    v_mul_f32 v210, v210, v58
    v_mul_f32 v211, v211, v58
    v_mul_f32 v212, v212, v58
    v_mul_f32 v213, v213, v58
    v_mul_f32 v214, v214, v58
    v_mul_f32 v215, v215, v58
    v_mul_f32 v216, v216, v58
    v_mul_f32 v217, v217, v58
    v_mul_f32 v218, v218, v58
    v_mul_f32 v219, v219, v58
    v_mul_f32 v220, v220, v58
    v_mul_f32 v221, v221, v58
    v_mul_f32 v222, v222, v58
    v_mul_f32 v223, v223, v58
    v_cvt_pk_bf16_f32 v80, v80, v81
    v_cvt_pk_bf16_f32 v81, v82, v83
    v_cvt_pk_bf16_f32 v82, v84, v85
    v_cvt_pk_bf16_f32 v83, v86, v87
    v_lshlrev_b32 v84, 16, v80
    v_and_b32 v85, 0xffff0000, v80
    v_add_f32 v59, v59, v84
    v_add_f32 v59, v59, v85
    v_lshlrev_b32 v84, 16, v81
    v_and_b32 v85, 0xffff0000, v81
    v_add_f32 v59, v59, v84
    v_add_f32 v59, v59, v85
    v_lshlrev_b32 v84, 16, v82
    v_and_b32 v85, 0xffff0000, v82
    v_add_f32 v59, v59, v84
    v_add_f32 v59, v59, v85
    v_lshlrev_b32 v84, 16, v83
    v_and_b32 v85, 0xffff0000, v83
    v_add_f32 v59, v59, v84
    v_add_f32 v59, v59, v85
    s_waitcnt vmcnt(0)
    ds_read_b64_tr_b16 a[96:97], v20 offset:0
    ds_read_b64_tr_b16 a[98:99], v20 offset:16384
    ds_read_b64_tr_b16 a[100:101], v21 offset:0
    ds_read_b64_tr_b16 a[102:103], v21 offset:16384
    ds_read_b64_tr_b16 a[104:105], v22 offset:0
    ds_read_b64_tr_b16 a[106:107], v22 offset:16384
    ds_read_b64_tr_b16 a[108:109], v23 offset:0
    ds_read_b64_tr_b16 a[110:111], v23 offset:16384
    s_waitcnt lgkmcnt(0)
    ds_read_b64_tr_b16 a[112:113], v24 offset:0
    ds_read_b64_tr_b16 a[114:115], v24 offset:16384
    ds_read_b64_tr_b16 a[116:117], v25 offset:0
    ds_read_b64_tr_b16 a[118:119], v25 offset:16384
    ds_read_b64_tr_b16 a[120:121], v26 offset:0
    ds_read_b64_tr_b16 a[122:123], v26 offset:16384
    ds_read_b64_tr_b16 a[124:125], v27 offset:0
    ds_read_b64_tr_b16 a[126:127], v27 offset:16384
    s_waitcnt lgkmcnt(0)
    v_mfma_f32_16x16x32_bf16 v[128:131], a[96:99], v[64:67], v[128:131]
    v_mfma_f32_16x16x32_bf16 v[160:163], a[96:99], v[72:75], v[160:163]
    v_mfma_f32_16x16x32_bf16 v[192:195], a[96:99], v[80:83], v[192:195]
    v_mfma_f32_16x16x32_bf16 v[132:135], a[100:103], v[64:67], v[132:135]
    v_mfma_f32_16x16x32_bf16 v[164:167], a[100:103], v[72:75], v[164:167]
    v_mfma_f32_16x16x32_bf16 v[196:199], a[100:103], v[80:83], v[196:199]
    v_mfma_f32_16x16x32_bf16 v[136:139], a[104:107], v[64:67], v[136:139]
    v_mfma_f32_16x16x32_bf16 v[168:171], a[104:107], v[72:75], v[168:171]
    v_mfma_f32_16x16x32_bf16 v[200:203], a[104:107], v[80:83], v[200:203]
    v_mfma_f32_16x16x32_bf16 v[140:143], a[108:111], v[64:67], v[140:143]
    v_mfma_f32_16x16x32_bf16 v[172:175], a[108:111], v[72:75], v[172:175]
    v_mfma_f32_16x16x32_bf16 v[204:207], a[108:111], v[80:83], v[204:207]
    v_mfma_f32_16x16x32_bf16 v[144:147], a[112:115], v[64:67], v[144:147]
    v_mfma_f32_16x16x32_bf16 v[176:179], a[112:115], v[72:75], v[176:179]
    v_mfma_f32_16x16x32_bf16 v[208:211], a[112:115], v[80:83], v[208:211]
    v_mfma_f32_16x16x32_bf16 v[148:151], a[116:119], v[64:67], v[148:151]
    v_mfma_f32_16x16x32_bf16 v[180:183], a[116:119], v[72:75], v[180:183]
    v_mfma_f32_16x16x32_bf16 v[212:215], a[116:119], v[80:83], v[212:215]
    v_mfma_f32_16x16x32_bf16 v[152:155], a[120:123], v[64:67], v[152:155]
    v_mfma_f32_16x16x32_bf16 v[184:187], a[120:123], v[72:75], v[184:187]
    v_mfma_f32_16x16x32_bf16 v[216:219], a[120:123], v[80:83], v[216:219]
    v_mfma_f32_16x16x32_bf16 v[156:159], a[124:127], v[64:67], v[156:159]
    v_mfma_f32_16x16x32_bf16 v[188:191], a[124:127], v[72:75], v[188:191]
    v_mfma_f32_16x16x32_bf16 v[220:223], a[124:127], v[80:83], v[220:223]
    s_nop 7
    s_add_u32 s33, s33, 8192
    s_cmp_lt_u32 s33, 524288
    s_cbranch_scc1 L_sloopB
    v_mov_b32 v49, v51
    v_mov_b32 v53, v55
    v_mov_b32 v57, v59
    s_nop 1
    v_permlane32_swap_b32 v51, v49
    v_permlane32_swap_b32 v55, v53
    v_permlane32_swap_b32 v59, v57
    s_nop 1
    v_add_f32 v51, v51, v49
    v_add_f32 v55, v55, v53
    v_add_f32 v59, v59, v57
    v_mov_b32 v49, v51
    v_mov_b32 v53, v55
    v_mov_b32 v57, v59
    s_nop 1
    v_permlane16_swap_b32 v51, v49
    v_permlane16_swap_b32 v55, v53
    v_permlane16_swap_b32 v59, v57
    s_nop 1
    v_add_f32 v51, v51, v49
    v_add_f32 v55, v55, v53
    v_add_f32 v59, v59, v57
    v_mov_b32 v48, v51
    v_mov_b32 v52, v55
    v_mov_b32 v56, v59
    v_lshrrev_b32 v12, 2, v3
    v_lshlrev_b32 v12, 7, v12
    v_and_b32 v15, 3, v3
    v_lshl_add_u32 v12, v15, 3, v12
    v_add_u32 v12, s30, v12
    v_bfe_u32 v15, v3, 3, 2
    v_xor_b32 v40, 0, v15
    v_lshl_add_u32 v40, v40, 5, v12
    v_add_u32 v44, 0x10000, v40
    v_add_u32 v8, 0x20000, v40
    v_xor_b32 v41, 1, v15
    v_lshl_add_u32 v41, v41, 5, v12
    v_add_u32 v45, 0x10000, v41
    v_add_u32 v9, 0x20000, v41
    v_xor_b32 v42, 2, v15
    v_lshl_add_u32 v42, v42, 5, v12
    v_add_u32 v46, 0x10000, v42
    v_add_u32 v10, 0x20000, v42
    v_xor_b32 v43, 3, v15
    v_lshl_add_u32 v43, v43, 5, v12
    v_add_u32 v47, 0x10000, v43
    v_add_u32 v11, 0x20000, v43
    v_mul_u32_u24 v14, 1280, v3
    s_add_u32 m0, s30, 65536
    s_mov_b32 s38, 327680
    buffer_load_dwordx4 v36, s[76:79], s38 offen offset:0 lds
    buffer_load_dwordx4 v37, s[76:79], s38 offen offset:1024 lds
    buffer_load_dwordx4 v38, s[76:79], s38 offen offset:2048 lds
    buffer_load_dwordx4 v39, s[76:79], s38 offen offset:3072 lds
    s_add_u32 m0, s30, 81920
    s_mov_b32 s38, 450560
    buffer_load_dwordx4 v36, s[76:79], s38 offen offset:0 lds
    buffer_load_dwordx4 v37, s[76:79], s38 offen offset:1024 lds
    buffer_load_dwordx4 v38, s[76:79], s38 offen offset:2048 lds
    buffer_load_dwordx4 v39, s[76:79], s38 offen offset:3072 lds
    s_waitcnt vmcnt(0)
    s_branch L_epiB
L_common:
    ds_read_b64_tr_b16 a[0:1], v40 offset:0
    ds_read_b64_tr_b16 a[2:3], v40 offset:2048
    ds_read_b64_tr_b16 a[4:5], v41 offset:0
    ds_read_b64_tr_b16 a[6:7], v41 offset:2048
    ds_read_b64_tr_b16 a[8:9], v42 offset:0
    ds_read_b64_tr_b16 a[10:11], v42 offset:2048
    ds_read_b64_tr_b16 a[12:13], v43 offset:0
    ds_read_b64_tr_b16 a[14:15], v43 offset:2048
    ds_read_b64_tr_b16 a[16:17], v8 offset:16384
    ds_read_b64_tr_b16 a[18:19], v8 offset:18432
    ds_read_b64_tr_b16 a[20:21], v9 offset:16384
    ds_read_b64_tr_b16 a[22:23], v9 offset:18432
    ds_read_b64_tr_b16 a[24:25], v10 offset:16384
    ds_read_b64_tr_b16 a[26:27], v10 offset:18432
    ds_read_b64_tr_b16 a[28:29], v11 offset:16384
    ds_read_b64_tr_b16 a[30:31], v11 offset:18432
    ds_read_b64_tr_b16 a[32:33], v44 offset:0
    ds_read_b64_tr_b16 a[34:35], v44 offset:2048
    ds_read_b64_tr_b16 a[36:37], v45 offset:0
    ds_read_b64_tr_b16 a[38:39], v45 offset:2048
    ds_read_b64_tr_b16 a[40:41], v46 offset:0
    ds_read_b64_tr_b16 a[42:43], v46 offset:2048
    ds_read_b64_tr_b16 a[44:45], v47 offset:0
    ds_read_b64_tr_b16 a[46:47], v47 offset:2048
    s_waitcnt lgkmcnt(8)
    s_add_u32 m0, s30, 0
    s_mov_b32 s38, 614400
    buffer_load_dwordx4 v36, s[76:79], s38 offen offset:0 lds
    buffer_load_dwordx4 v37, s[76:79], s38 offen offset:1024 lds
    buffer_load_dwordx4 v38, s[76:79], s38 offen offset:2048 lds
    buffer_load_dwordx4 v39, s[76:79], s38 offen offset:3072 lds
    s_add_u32 m0, s30, 147456
    s_mov_b32 s38, 655360
    buffer_load_dwordx4 v36, s[76:79], s38 offen offset:0 lds
    buffer_load_dwordx4 v37, s[76:79], s38 offen offset:1024 lds
    buffer_load_dwordx4 v38, s[76:79], s38 offen offset:2048 lds
    buffer_load_dwordx4 v39, s[76:79], s38 offen offset:3072 lds
    ds_read_b64_tr_b16 a[48:49], v44 offset:49152
    ds_read_b64_tr_b16 a[50:51], v44 offset:51200
    ds_read_b64_tr_b16 a[52:53], v45 offset:49152
    ds_read_b64_tr_b16 a[54:55], v45 offset:51200
    ds_read_b64_tr_b16 a[56:57], v46 offset:49152
    ds_read_b64_tr_b16 a[58:59], v46 offset:51200
    ds_read_b64_tr_b16 a[60:61], v47 offset:49152
    ds_read_b64_tr_b16 a[62:63], v47 offset:51200
    ds_read_b64_tr_b16 a[64:65], v40 offset:16384
    ds_read_b64_tr_b16 a[66:67], v40 offset:18432
    ds_read_b64_tr_b16 a[68:69], v41 offset:16384
    ds_read_b64_tr_b16 a[70:71], v41 offset:18432
    ds_read_b64_tr_b16 a[72:73], v42 offset:16384
    ds_read_b64_tr_b16 a[74:75], v42 offset:18432
    ds_read_b64_tr_b16 a[76:77], v43 offset:16384
    ds_read_b64_tr_b16 a[78:79], v43 offset:18432
    ds_read_b64_tr_b16 a[80:81], v44 offset:16384
    ds_read_b64_tr_b16 a[82:83], v44 offset:18432
    ds_read_b64_tr_b16 a[84:85], v45 offset:16384
    ds_read_b64_tr_b16 a[86:87], v45 offset:18432
    ds_read_b64_tr_b16 a[88:89], v46 offset:16384
    ds_read_b64_tr_b16 a[90:91], v46 offset:18432
    ds_read_b64_tr_b16 a[92:93], v47 offset:16384
    ds_read_b64_tr_b16 a[94:95], v47 offset:18432
    ds_read_b64_tr_b16 a[96:97], v44 offset:32768
    ds_read_b64_tr_b16 a[98:99], v44 offset:34816
    ds_read_b64_tr_b16 a[100:101], v45 offset:32768
    ds_read_b64_tr_b16 a[102:103], v45 offset:34816
    ds_read_b64_tr_b16 a[104:105], v46 offset:32768
    ds_read_b64_tr_b16 a[106:107], v46 offset:34816
    ds_read_b64_tr_b16 a[108:109], v47 offset:32768
    ds_read_b64_tr_b16 a[110:111], v47 offset:34816
    s_lshl_b32 s38, s83, 2
    s_add_u32 s38, s38, s28
    s_mul_i32 s38, s38, 163840
    s_add_u32 s16, s98, s38
    s_addc_u32 s17, s99, 0
    s_mov_b32 s18, 163840
    s_mov_b32 s20, s96
    s_mov_b32 s21, s97
    s_mov_b32 s22, 256
    v_mov_b32 v12, 1
    v_mov_b32 v15, 0
    s_waitcnt vmcnt(8) lgkmcnt(0)
    s_barrier
    s_cmp_lg_u32 s28, 0
    s_cbranch_scc1 L_nosig
    s_lshl_b32 s38, s36, 5
    s_mov_b64 exec, 1
    buffer_atomic_add v12, v15, s[20:23], s38 offen sc1
    s_mov_b64 exec, -1
L_nosig:
    s_cmp_ge_u32 s2, 240
    s_cbranch_scc1 L_exit
    ds_read_b64_tr_b16 a[112:113], v8 offset:0
    ds_read_b64_tr_b16 a[114:115], v8 offset:2048
    ds_read_b64_tr_b16 a[116:117], v9 offset:0
    ds_read_b64_tr_b16 a[118:119], v9 offset:2048
    ds_read_b64_tr_b16 a[120:121], v10 offset:0
    ds_read_b64_tr_b16 a[122:123], v10 offset:2048
    ds_read_b64_tr_b16 a[124:125], v11 offset:0
    ds_read_b64_tr_b16 a[126:127], v11 offset:2048
    ds_read_b64_tr_b16 a[128:129], v40 offset:32768
    ds_read_b64_tr_b16 a[130:131], v40 offset:34816
    ds_read_b64_tr_b16 a[132:133], v41 offset:32768
    ds_read_b64_tr_b16 a[134:135], v41 offset:34816
    ds_read_b64_tr_b16 a[136:137], v42 offset:32768
    ds_read_b64_tr_b16 a[138:139], v42 offset:34816
    ds_read_b64_tr_b16 a[140:141], v43 offset:32768
    ds_read_b64_tr_b16 a[142:143], v43 offset:34816
    s_add_u32 m0, s30, 65536
    s_mov_b32 s38, 696320
    buffer_load_dwordx4 v36, s[76:79], s38 offen offset:0 lds
    buffer_load_dwordx4 v37, s[76:79], s38 offen offset:1024 lds
    buffer_load_dwordx4 v38, s[76:79], s38 offen offset:2048 lds
    buffer_load_dwordx4 v39, s[76:79], s38 offen offset:3072 lds
    s_add_u32 m0, s30, 114688
    s_mov_b32 s38, 737280
    buffer_load_dwordx4 v36, s[76:79], s38 offen offset:0 lds
    buffer_load_dwordx4 v37, s[76:79], s38 offen offset:1024 lds
    buffer_load_dwordx4 v38, s[76:79], s38 offen offset:2048 lds
    buffer_load_dwordx4 v39, s[76:79], s38 offen offset:3072 lds
    s_add_u32 m0, s30, 16384
    s_mov_b32 s38, 778240
    buffer_load_dwordx4 v36, s[76:79], s38 offen offset:0 lds
    buffer_load_dwordx4 v37, s[76:79], s38 offen offset:1024 lds
    buffer_load_dwordx4 v38, s[76:79], s38 offen offset:2048 lds
    buffer_load_dwordx4 v39, s[76:79], s38 offen offset:3072 lds
    s_add_u32 m0, s30, 81920
    s_mov_b32 s38, 819200
    buffer_load_dwordx4 v36, s[76:79], s38 offen offset:0 lds
    buffer_load_dwordx4 v37, s[76:79], s38 offen offset:1024 lds
    buffer_load_dwordx4 v38, s[76:79], s38 offen offset:2048 lds
    buffer_load_dwordx4 v39, s[76:79], s38 offen offset:3072 lds
    s_add_u32 m0, s30, 98304
    s_mov_b32 s38, 860160
    buffer_load_dwordx4 v36, s[76:79], s38 offen offset:0 lds
    buffer_load_dwordx4 v37, s[76:79], s38 offen offset:1024 lds
    buffer_load_dwordx4 v38, s[76:79], s38 offen offset:2048 lds
    buffer_load_dwordx4 v39, s[76:79], s38 offen offset:3072 lds
    s_mul_i32 s39, s83, 86
    s_lshr_b32 s39, s39, 8
    s_lshl_b32 s39, s39, 5
    s_add_u32 m0, s30, 49152
    s_mov_b32 s38, 901120
    buffer_load_dwordx4 v36, s[76:79], s38 offen offset:0 lds
    buffer_load_dwordx4 v37, s[76:79], s38 offen offset:1024 lds
    buffer_load_dwordx4 v38, s[76:79], s38 offen offset:2048 lds
    buffer_load_dwordx4 v39, s[76:79], s38 offen offset:3072 lds
    s_waitcnt vmcnt(28) lgkmcnt(0)
    ds_read_b64_tr_b16 a[144:145], v40 offset:0
    ds_read_b64_tr_b16 a[146:147], v40 offset:2048
    ds_read_b64_tr_b16 a[148:149], v41 offset:0
    ds_read_b64_tr_b16 a[150:151], v41 offset:2048
    ds_read_b64_tr_b16 a[152:153], v42 offset:0
    ds_read_b64_tr_b16 a[154:155], v42 offset:2048
    ds_read_b64_tr_b16 a[156:157], v43 offset:0
    ds_read_b64_tr_b16 a[158:159], v43 offset:2048
    s_add_u32 m0, s30, 131072
    s_mov_b32 s38, 942080
    buffer_load_dwordx4 v36, s[76:79], s38 offen offset:0 lds
    buffer_load_dwordx4 v37, s[76:79], s38 offen offset:1024 lds
    buffer_load_dwordx4 v38, s[76:79], s38 offen offset:2048 lds
    buffer_load_dwordx4 v39, s[76:79], s38 offen offset:3072 lds
    s_add_u32 m0, s30, 32768
    s_mov_b32 s38, 983040
    buffer_load_dwordx4 v36, s[76:79], s38 offen offset:0 lds
    buffer_load_dwordx4 v37, s[76:79], s38 offen offset:1024 lds
    buffer_load_dwordx4 v38, s[76:79], s38 offen offset:2048 lds
    buffer_load_dwordx4 v39, s[76:79], s38 offen offset:3072 lds
    s_waitcnt vmcnt(32) lgkmcnt(0)
    ds_read_b64_tr_b16 v[20:21], v8 offset:16384
    ds_read_b64_tr_b16 v[22:23], v8 offset:18432
    ds_read_b64_tr_b16 v[24:25], v9 offset:16384
    ds_read_b64_tr_b16 v[26:27], v9 offset:18432
    ds_read_b64_tr_b16 v[28:29], v10 offset:16384
    ds_read_b64_tr_b16 v[30:31], v10 offset:18432
    ds_read_b64_tr_b16 v[32:33], v11 offset:16384
    ds_read_b64_tr_b16 v[34:35], v11 offset:18432
    s_add_u32 m0, s30, 0
    s_mov_b32 s38, 1024000
    buffer_load_dwordx4 v36, s[76:79], s38 offen offset:0 lds
    buffer_load_dwordx4 v37, s[76:79], s38 offen offset:1024 lds
    buffer_load_dwordx4 v38, s[76:79], s38 offen offset:2048 lds
    buffer_load_dwordx4 v39, s[76:79], s38 offen offset:3072 lds
    s_waitcnt vmcnt(32) lgkmcnt(0)
    ds_read_b64_tr_b16 v[48:49], v44 offset:0
    ds_read_b64_tr_b16 v[50:51], v44 offset:2048
    ds_read_b64_tr_b16 v[52:53], v45 offset:0
    ds_read_b64_tr_b16 v[54:55], v45 offset:2048
    ds_read_b64_tr_b16 v[56:57], v46 offset:0
    ds_read_b64_tr_b16 v[58:59], v46 offset:2048
    ds_read_b64_tr_b16 v[60:61], v47 offset:0
    ds_read_b64_tr_b16 v[62:63], v47 offset:2048
    s_add_u32 m0, s30, 147456
    s_mov_b32 s38, 1064960
    buffer_load_dwordx4 v36, s[76:79], s38 offen offset:0 lds
    buffer_load_dwordx4 v37, s[76:79], s38 offen offset:1024 lds
    buffer_load_dwordx4 v38, s[76:79], s38 offen offset:2048 lds
    buffer_load_dwordx4 v39, s[76:79], s38 offen offset:3072 lds
    s_waitcnt vmcnt(32) lgkmcnt(0)
    ds_read_b64_tr_b16 v[64:65], v44 offset:49152
    ds_read_b64_tr_b16 v[66:67], v44 offset:51200
    ds_read_b64_tr_b16 v[68:69], v45 offset:49152
    ds_read_b64_tr_b16 v[70:71], v45 offset:51200
    ds_read_b64_tr_b16 v[72:73], v46 offset:49152
    ds_read_b64_tr_b16 v[74:75], v46 offset:51200
    ds_read_b64_tr_b16 v[76:77], v47 offset:49152
    ds_read_b64_tr_b16 v[78:79], v47 offset:51200
    s_add_u32 m0, s30, 65536
    s_mov_b32 s38, 1105920
    buffer_load_dwordx4 v36, s[76:79], s38 offen offset:0 lds
    buffer_load_dwordx4 v37, s[76:79], s38 offen offset:1024 lds
    buffer_load_dwordx4 v38, s[76:79], s38 offen offset:2048 lds
    buffer_load_dwordx4 v39, s[76:79], s38 offen offset:3072 lds
    s_waitcnt vmcnt(32) lgkmcnt(0)
    ds_read_b64_tr_b16 v[80:81], v40 offset:16384
    ds_read_b64_tr_b16 v[82:83], v40 offset:18432
    ds_read_b64_tr_b16 v[84:85], v41 offset:16384
    ds_read_b64_tr_b16 v[86:87], v41 offset:18432
    ds_read_b64_tr_b16 v[88:89], v42 offset:16384
    ds_read_b64_tr_b16 v[90:91], v42 offset:18432
    ds_read_b64_tr_b16 v[92:93], v43 offset:16384
    ds_read_b64_tr_b16 v[94:95], v43 offset:18432
    s_add_u32 m0, s30, 114688
    s_mov_b32 s38, 1146880
    buffer_load_dwordx4 v36, s[76:79], s38 offen offset:0 lds
    buffer_load_dwordx4 v37, s[76:79], s38 offen offset:1024 lds
    buffer_load_dwordx4 v38, s[76:79], s38 offen offset:2048 lds
    buffer_load_dwordx4 v39, s[76:79], s38 offen offset:3072 lds
    s_waitcnt vmcnt(32) lgkmcnt(0)
    ds_read_b64_tr_b16 v[96:97], v44 offset:16384
    ds_read_b64_tr_b16 v[98:99], v44 offset:18432
    ds_read_b64_tr_b16 v[100:101], v45 offset:16384
    ds_read_b64_tr_b16 v[102:103], v45 offset:18432
    ds_read_b64_tr_b16 v[104:105], v46 offset:16384
    ds_read_b64_tr_b16 v[106:107], v46 offset:18432
    ds_read_b64_tr_b16 v[108:109], v47 offset:16384
    ds_read_b64_tr_b16 v[110:111], v47 offset:18432
    buffer_load_dword v12, v15, s[20:23], s39 offen sc0 sc1
    s_add_u32 m0, s30, 16384
    s_mov_b32 s38, 1187840
    buffer_load_dwordx4 v36, s[76:79], s38 offen offset:0 lds
    buffer_load_dwordx4 v37, s[76:79], s38 offen offset:1024 lds
    buffer_load_dwordx4 v38, s[76:79], s38 offen offset:2048 lds
    buffer_load_dwordx4 v39, s[76:79], s38 offen offset:3072 lds
    s_waitcnt vmcnt(33) lgkmcnt(0)
    ds_read_b64_tr_b16 v[112:113], v44 offset:32768
    ds_read_b64_tr_b16 v[114:115], v44 offset:34816
    ds_read_b64_tr_b16 v[116:117], v45 offset:32768
    ds_read_b64_tr_b16 v[118:119], v45 offset:34816
    ds_read_b64_tr_b16 v[120:121], v46 offset:32768
    ds_read_b64_tr_b16 v[122:123], v46 offset:34816
    ds_read_b64_tr_b16 v[124:125], v47 offset:32768
    ds_read_b64_tr_b16 v[126:127], v47 offset:34816
    s_add_u32 m0, s30, 81920
    s_mov_b32 s38, 1228800
    buffer_load_dwordx4 v36, s[76:79], s38 offen offset:0 lds
    buffer_load_dwordx4 v37, s[76:79], s38 offen offset:1024 lds
    buffer_load_dwordx4 v38, s[76:79], s38 offen offset:2048 lds
    buffer_load_dwordx4 v39, s[76:79], s38 offen offset:3072 lds
    s_waitcnt lgkmcnt(0)
    s_add_u32 m0, s30, 98304
    s_mov_b32 s38, 1269760
    buffer_load_dwordx4 v36, s[76:79], s38 offen offset:0 lds
    buffer_load_dwordx4 v37, s[76:79], s38 offen offset:1024 lds
    buffer_load_dwordx4 v38, s[76:79], s38 offen offset:2048 lds
    buffer_load_dwordx4 v39, s[76:79], s38 offen offset:3072 lds
    s_cmp_lg_u32 s28, 0
    s_cbranch_scc1 L_go
    s_waitcnt vmcnt(12)
    s_mov_b32 s35, 65536
L_poll:
    v_readfirstlane_b32 s38, v12
    s_sub_u32 s35, s35, 1
    s_cbranch_scc1 L_go
    s_cmp_ge_u32 s38, 32
    s_cbranch_scc1 L_go
    buffer_load_dword v12, v15, s[20:23], s39 offen sc0 sc1
    s_waitcnt vmcnt(0)
    s_branch L_poll
L_go:
    s_barrier
    s_mov_b32 s39, 0
    buffer_load_dwordx4 v[208:211], v2, s[16:19], s39 offen offset:0 sc1
    buffer_load_dwordx4 v[212:215], v2, s[16:19], s39 offen offset:1024 sc1
    buffer_load_dwordx4 v[216:219], v2, s[16:19], s39 offen offset:2048 sc1
    buffer_load_dwordx4 v[220:223], v2, s[16:19], s39 offen offset:3072 sc1
    s_mov_b32 s39, 4096
    buffer_load_dwordx4 v[224:227], v2, s[16:19], s39 offen offset:0 sc1
    buffer_load_dwordx4 v[228:231], v2, s[16:19], s39 offen offset:1024 sc1
    buffer_load_dwordx4 v[232:235], v2, s[16:19], s39 offen offset:2048 sc1
    buffer_load_dwordx4 v[236:239], v2, s[16:19], s39 offen offset:3072 sc1
    s_mov_b32 s39, 8192
    buffer_load_dwordx4 v[240:243], v2, s[16:19], s39 offen offset:0 sc1
    buffer_load_dwordx4 v[244:247], v2, s[16:19], s39 offen offset:1024 sc1
    buffer_load_dwordx4 v[248:251], v2, s[16:19], s39 offen offset:2048 sc1
    buffer_load_dwordx4 v[252:255], v2, s[16:19], s39 offen offset:3072 sc1
    s_mov_b32 s39, 12288
    buffer_load_dwordx4 v[36:39], v2, s[16:19], s39 offen offset:0 sc1
    buffer_load_dwordx4 v[16:19], v2, s[16:19], s39 offen offset:1024 sc1
    buffer_load_dwordx4 v[4:7], v2, s[16:19], s39 offen offset:2048 sc1
    buffer_load_dwordx4 v[12:15], v2, s[16:19], s39 offen offset:3072 sc1
    s_waitcnt vmcnt(15)
    v_mfma_f32_16x16x32_bf16 v[128:131], a[160:163], v[208:211], 0
    s_waitcnt vmcnt(14)
    v_mfma_f32_16x16x32_bf16 v[128:131], a[176:179], v[212:215], v[128:131]
    s_waitcnt vmcnt(13)
    s_mul_i32 s33, s28, 20480
    v_mfma_f32_16x16x32_bf16 v[128:131], a[192:195], v[216:219], v[128:131]
    s_waitcnt vmcnt(12)
    v_mfma_f32_16x16x32_bf16 v[128:131], a[208:211], v[220:223], v[128:131]
    v_mfma_f32_16x16x32_bf16 v[132:135], a[212:215], v[220:223], 0
    v_mfma_f32_16x16x32_bf16 v[132:135], a[196:199], v[216:219], v[132:135]
    s_mul_i32 s34, s28, 20
    v_mfma_f32_16x16x32_bf16 v[132:135], a[180:183], v[212:215], v[132:135]
    v_mfma_f32_16x16x32_bf16 v[132:135], a[164:167], v[208:211], v[132:135]
    v_mfma_f32_16x16x32_bf16 v[136:139], a[168:171], v[208:211], 0
    v_mfma_f32_16x16x32_bf16 v[136:139], a[184:187], v[212:215], v[136:139]
    s_mov_b32 s20, s94
    v_mfma_f32_16x16x32_bf16 v[136:139], a[200:203], v[216:219], v[136:139]
    v_mfma_f32_16x16x32_bf16 v[136:139], a[216:219], v[220:223], v[136:139]
    v_mfma_f32_16x16x32_bf16 v[140:143], a[220:223], v[220:223], 0
    v_mfma_f32_16x16x32_bf16 v[140:143], a[204:207], v[216:219], v[140:143]
    s_mov_b32 s21, s95
    v_mfma_f32_16x16x32_bf16 v[140:143], a[188:191], v[212:215], v[140:143]
    s_mov_b32 s39, 16384
    v_mfma_f32_16x16x32_bf16 v[140:143], a[172:175], v[208:211], v[140:143]
    s_waitcnt vmcnt(11)
    buffer_load_dwordx4 v[208:211], v2, s[16:19], s39 offen offset:0 sc1
    v_mfma_f32_16x16x32_bf16 v[144:147], a[160:163], v[224:227], 0
    s_waitcnt vmcnt(11)
    v_mfma_f32_16x16x32_bf16 v[144:147], a[176:179], v[228:231], v[144:147]
    s_waitcnt vmcnt(10)
    s_mov_b32 s22, 2457600
    buffer_load_dwordx4 v[212:215], v2, s[16:19], s39 offen offset:1024 sc1
    v_mfma_f32_16x16x32_bf16 v[144:147], a[192:195], v[232:235], v[144:147]
    s_waitcnt vmcnt(10)
    v_mfma_f32_16x16x32_bf16 v[144:147], a[208:211], v[236:239], v[144:147]
    buffer_load_dwordx4 v[216:219], v2, s[16:19], s39 offen offset:2048 sc1
    v_mfma_f32_16x16x32_bf16 v[148:151], a[212:215], v[236:239], 0
    v_mfma_f32_16x16x32_bf16 v[148:151], a[196:199], v[232:235], v[148:151]
    s_mul_i32 s38, s83, 102400
    buffer_load_dwordx4 v[220:223], v2, s[16:19], s39 offen offset:3072 sc1
    v_mfma_f32_16x16x32_bf16 v[148:151], a[180:183], v[228:231], v[148:151]
    v_mfma_f32_16x16x32_bf16 v[148:151], a[164:167], v[224:227], v[148:151]
    v_mfma_f32_16x16x32_bf16 v[152:155], a[168:171], v[224:227], 0
    v_mfma_f32_16x16x32_bf16 v[152:155], a[184:187], v[228:231], v[152:155]
    s_lshl_b32 s4, s81, 7
    v_mfma_f32_16x16x32_bf16 v[152:155], a[200:203], v[232:235], v[152:155]
    v_mfma_f32_16x16x32_bf16 v[152:155], a[216:219], v[236:239], v[152:155]
    v_mfma_f32_16x16x32_bf16 v[156:159], a[220:223], v[236:239], 0
    v_mfma_f32_16x16x32_bf16 v[156:159], a[204:207], v[232:235], v[156:159]
    s_add_u32 s38, s38, s4
    v_mfma_f32_16x16x32_bf16 v[156:159], a[188:191], v[228:231], v[156:159]
    s_mov_b32 s39, 20480
    v_mfma_f32_16x16x32_bf16 v[156:159], a[172:175], v[224:227], v[156:159]
    s_waitcnt vmcnt(11)
    buffer_load_dwordx4 v[224:227], v2, s[16:19], s39 offen offset:0 sc1
    v_mfma_f32_16x16x32_bf16 v[160:163], a[160:163], v[240:243], 0
    s_waitcnt vmcnt(11)
    v_mfma_f32_16x16x32_bf16 v[160:163], a[176:179], v[244:247], v[160:163]
    s_waitcnt vmcnt(10)
    buffer_load_dwordx4 v[228:231], v2, s[16:19], s39 offen offset:1024 sc1
    v_mfma_f32_16x16x32_bf16 v[160:163], a[192:195], v[248:251], v[160:163]
    s_waitcnt vmcnt(10)
    v_mfma_f32_16x16x32_bf16 v[160:163], a[208:211], v[252:255], v[160:163]
    buffer_load_dwordx4 v[232:235], v2, s[16:19], s39 offen offset:2048 sc1
    v_mfma_f32_16x16x32_bf16 v[164:167], a[212:215], v[252:255], 0
    v_mfma_f32_16x16x32_bf16 v[164:167], a[196:199], v[248:251], v[164:167]
    buffer_load_dwordx4 v[236:239], v2, s[16:19], s39 offen offset:3072 sc1
    v_mfma_f32_16x16x32_bf16 v[164:167], a[180:183], v[244:247], v[164:167]
    v_mfma_f32_16x16x32_bf16 v[164:167], a[164:167], v[240:243], v[164:167]
    v_mfma_f32_16x16x32_bf16 v[168:171], a[168:171], v[240:243], 0
    v_mfma_f32_16x16x32_bf16 v[168:171], a[184:187], v[244:247], v[168:171]
    v_mfma_f32_16x16x32_bf16 v[168:171], a[200:203], v[248:251], v[168:171]
    v_mfma_f32_16x16x32_bf16 v[168:171], a[216:219], v[252:255], v[168:171]
    v_mfma_f32_16x16x32_bf16 v[172:175], a[220:223], v[252:255], 0
    v_mfma_f32_16x16x32_bf16 v[172:175], a[204:207], v[248:251], v[172:175]
    v_mfma_f32_16x16x32_bf16 v[172:175], a[188:191], v[244:247], v[172:175]
    s_mov_b32 s39, 24576
    v_mfma_f32_16x16x32_bf16 v[172:175], a[172:175], v[240:243], v[172:175]
    s_waitcnt vmcnt(11)
    buffer_load_dwordx4 v[240:243], v2, s[16:19], s39 offen offset:0 sc1
    v_mfma_f32_16x16x32_bf16 v[176:179], a[160:163], v[36:39], 0
    s_waitcnt vmcnt(11)
    v_mfma_f32_16x16x32_bf16 v[176:179], a[176:179], v[16:19], v[176:179]
    s_waitcnt vmcnt(10)
    buffer_load_dwordx4 v[244:247], v2, s[16:19], s39 offen offset:1024 sc1
    v_mfma_f32_16x16x32_bf16 v[176:179], a[192:195], v[4:7], v[176:179]
    s_waitcnt vmcnt(10)
    v_mfma_f32_16x16x32_bf16 v[176:179], a[208:211], v[12:15], v[176:179]
    buffer_load_dwordx4 v[248:251], v2, s[16:19], s39 offen offset:2048 sc1
    v_mfma_f32_16x16x32_bf16 v[180:183], a[212:215], v[12:15], 0
    v_mfma_f32_16x16x32_bf16 v[180:183], a[196:199], v[4:7], v[180:183]
    buffer_load_dwordx4 v[252:255], v2, s[16:19], s39 offen offset:3072 sc1
    v_mfma_f32_16x16x32_bf16 v[180:183], a[180:183], v[16:19], v[180:183]
    v_mfma_f32_16x16x32_bf16 v[180:183], a[164:167], v[36:39], v[180:183]
    v_mfma_f32_16x16x32_bf16 v[184:187], a[168:171], v[36:39], 0
    v_mfma_f32_16x16x32_bf16 v[184:187], a[184:187], v[16:19], v[184:187]
    v_mfma_f32_16x16x32_bf16 v[184:187], a[200:203], v[4:7], v[184:187]
    v_mfma_f32_16x16x32_bf16 v[184:187], a[216:219], v[12:15], v[184:187]
    v_mfma_f32_16x16x32_bf16 v[188:191], a[220:223], v[12:15], 0
    v_mfma_f32_16x16x32_bf16 v[188:191], a[204:207], v[4:7], v[188:191]
    v_mfma_f32_16x16x32_bf16 v[188:191], a[188:191], v[16:19], v[188:191]
    s_mov_b32 s39, 28672
    v_mfma_f32_16x16x32_bf16 v[188:191], a[172:175], v[36:39], v[188:191]
    s_waitcnt vmcnt(11)
    buffer_load_dwordx4 v[36:39], v2, s[16:19], s39 offen offset:0 sc1
    v_mfma_f32_16x16x32_bf16 v[192:195], a[160:163], v[208:211], 0
    s_waitcnt vmcnt(11)
    v_mfma_f32_16x16x32_bf16 v[192:195], a[176:179], v[212:215], v[192:195]
    s_waitcnt vmcnt(10)
    buffer_load_dwordx4 v[16:19], v2, s[16:19], s39 offen offset:1024 sc1
    v_mfma_f32_16x16x32_bf16 v[192:195], a[192:195], v[216:219], v[192:195]
    s_waitcnt vmcnt(10)
    v_mfma_f32_16x16x32_bf16 v[192:195], a[208:211], v[220:223], v[192:195]
    buffer_load_dwordx4 v[4:7], v2, s[16:19], s39 offen offset:2048 sc1
    v_mfma_f32_16x16x32_bf16 v[196:199], a[212:215], v[220:223], 0
    v_mfma_f32_16x16x32_bf16 v[196:199], a[196:199], v[216:219], v[196:199]
    buffer_load_dwordx4 v[12:15], v2, s[16:19], s39 offen offset:3072 sc1
    v_mfma_f32_16x16x32_bf16 v[196:199], a[180:183], v[212:215], v[196:199]
    v_mfma_f32_16x16x32_bf16 v[196:199], a[164:167], v[208:211], v[196:199]
    v_mfma_f32_16x16x32_bf16 v[200:203], a[168:171], v[208:211], 0
    v_mfma_f32_16x16x32_bf16 v[200:203], a[184:187], v[212:215], v[200:203]
    v_mfma_f32_16x16x32_bf16 v[200:203], a[200:203], v[216:219], v[200:203]
    v_mfma_f32_16x16x32_bf16 v[200:203], a[216:219], v[220:223], v[200:203]
    v_mfma_f32_16x16x32_bf16 v[204:207], a[220:223], v[220:223], 0
    v_mfma_f32_16x16x32_bf16 v[204:207], a[204:207], v[216:219], v[204:207]
    v_mfma_f32_16x16x32_bf16 v[204:207], a[188:191], v[212:215], v[204:207]
    s_mov_b32 s39, 32768
    v_mfma_f32_16x16x32_bf16 v[204:207], a[172:175], v[208:211], v[204:207]
    s_waitcnt vmcnt(11)
    buffer_load_dwordx4 v[208:211], v2, s[16:19], s39 offen offset:0 sc1
    v_mfma_f32_16x16x32_bf16 v[128:131], a[224:227], v[224:227], v[128:131]
    s_waitcnt vmcnt(11)
    ds_read_b64_tr_b16 a[160:161], v40 offset:49152
    v_mfma_f32_16x16x32_bf16 v[128:131], a[240:243], v[228:231], v[128:131]
    s_waitcnt vmcnt(10)
    buffer_load_dwordx4 v[212:215], v2, s[16:19], s39 offen offset:1024 sc1
    v_mfma_f32_16x16x32_bf16 v[128:131], a[0:3], v[232:235], v[128:131]
    s_waitcnt vmcnt(10)
    ds_read_b64_tr_b16 a[162:163], v40 offset:51200
    v_mfma_f32_16x16x32_bf16 v[128:131], a[16:19], v[236:239], v[128:131]
    buffer_load_dwordx4 v[216:219], v2, s[16:19], s39 offen offset:2048 sc1
    v_mfma_f32_16x16x32_bf16 v[132:135], a[20:23], v[236:239], v[132:135]
    ds_read_b64_tr_b16 a[164:165], v41 offset:49152
    v_mfma_f32_16x16x32_bf16 v[132:135], a[4:7], v[232:235], v[132:135]
    buffer_load_dwordx4 v[220:223], v2, s[16:19], s39 offen offset:3072 sc1
    v_mfma_f32_16x16x32_bf16 v[132:135], a[244:247], v[228:231], v[132:135]
    ds_read_b64_tr_b16 a[166:167], v41 offset:51200
    v_mfma_f32_16x16x32_bf16 v[132:135], a[228:231], v[224:227], v[132:135]
    ds_read_b64_tr_b16 a[168:169], v42 offset:49152
    v_mfma_f32_16x16x32_bf16 v[136:139], a[232:235], v[224:227], v[136:139]
    ds_read_b64_tr_b16 a[170:171], v42 offset:51200
    v_mfma_f32_16x16x32_bf16 v[136:139], a[248:251], v[228:231], v[136:139]
    ds_read_b64_tr_b16 a[172:173], v43 offset:49152
    v_mfma_f32_16x16x32_bf16 v[136:139], a[8:11], v[232:235], v[136:139]
    ds_read_b64_tr_b16 a[174:175], v43 offset:51200
    v_mfma_f32_16x16x32_bf16 v[136:139], a[24:27], v[236:239], v[136:139]
    ds_read_b64_tr_b16 a[176:177], v8 offset:0
    v_mfma_f32_16x16x32_bf16 v[140:143], a[28:31], v[236:239], v[140:143]
    ds_read_b64_tr_b16 a[178:179], v8 offset:2048
    v_mfma_f32_16x16x32_bf16 v[140:143], a[12:15], v[232:235], v[140:143]
    ds_read_b64_tr_b16 a[180:181], v9 offset:0
    v_mfma_f32_16x16x32_bf16 v[140:143], a[252:255], v[228:231], v[140:143]
    s_mov_b32 s39, 36864
    ds_read_b64_tr_b16 a[182:183], v9 offset:2048
    v_mfma_f32_16x16x32_bf16 v[140:143], a[236:239], v[224:227], v[140:143]
    s_waitcnt vmcnt(11)
    buffer_load_dwordx4 v[224:227], v2, s[16:19], s39 offen offset:0 sc1
    v_mfma_f32_16x16x32_bf16 v[144:147], a[224:227], v[240:243], v[144:147]
    s_waitcnt vmcnt(11)
    ds_read_b64_tr_b16 a[184:185], v10 offset:0
    v_mfma_f32_16x16x32_bf16 v[144:147], a[240:243], v[244:247], v[144:147]
    s_waitcnt vmcnt(10)
    buffer_load_dwordx4 v[228:231], v2, s[16:19], s39 offen offset:1024 sc1
    v_mfma_f32_16x16x32_bf16 v[144:147], a[0:3], v[248:251], v[144:147]
    s_waitcnt vmcnt(10)
    ds_read_b64_tr_b16 a[186:187], v10 offset:2048
    v_mfma_f32_16x16x32_bf16 v[144:147], a[16:19], v[252:255], v[144:147]
    buffer_load_dwordx4 v[232:235], v2, s[16:19], s39 offen offset:2048 sc1
    v_mfma_f32_16x16x32_bf16 v[148:151], a[20:23], v[252:255], v[148:151]
    ds_read_b64_tr_b16 a[188:189], v11 offset:0
    v_mfma_f32_16x16x32_bf16 v[148:151], a[4:7], v[248:251], v[148:151]
    buffer_load_dwordx4 v[236:239], v2, s[16:19], s39 offen offset:3072 sc1
    v_mfma_f32_16x16x32_bf16 v[148:151], a[244:247], v[244:247], v[148:151]
    ds_read_b64_tr_b16 a[190:191], v11 offset:2048
    v_mfma_f32_16x16x32_bf16 v[148:151], a[228:231], v[240:243], v[148:151]
    ds_read_b64_tr_b16 a[192:193], v40 offset:32768
    v_mfma_f32_16x16x32_bf16 v[152:155], a[232:235], v[240:243], v[152:155]
    ds_read_b64_tr_b16 a[194:195], v40 offset:34816
    v_mfma_f32_16x16x32_bf16 v[152:155], a[248:251], v[244:247], v[152:155]
    ds_read_b64_tr_b16 a[196:197], v41 offset:32768
    v_mfma_f32_16x16x32_bf16 v[152:155], a[8:11], v[248:251], v[152:155]
    ds_read_b64_tr_b16 a[198:199], v41 offset:34816
    v_mfma_f32_16x16x32_bf16 v[152:155], a[24:27], v[252:255], v[152:155]
    ds_read_b64_tr_b16 a[200:201], v42 offset:32768
    v_mfma_f32_16x16x32_bf16 v[156:159], a[28:31], v[252:255], v[156:159]
    ds_read_b64_tr_b16 a[202:203], v42 offset:34816
    v_mfma_f32_16x16x32_bf16 v[156:159], a[12:15], v[248:251], v[156:159]
    ds_read_b64_tr_b16 a[204:205], v43 offset:32768
    v_mfma_f32_16x16x32_bf16 v[156:159], a[252:255], v[244:247], v[156:159]
    s_mov_b32 s39, 40960
    ds_read_b64_tr_b16 a[206:207], v43 offset:34816
    v_mfma_f32_16x16x32_bf16 v[156:159], a[236:239], v[240:243], v[156:159]
    s_waitcnt vmcnt(11)
    buffer_load_dwordx4 v[240:243], v2, s[16:19], s39 offen offset:0 sc1
    v_mfma_f32_16x16x32_bf16 v[160:163], a[224:227], v[36:39], v[160:163]
    s_waitcnt vmcnt(11)
    ds_read_b64_tr_b16 a[208:209], v40 offset:0
    v_mfma_f32_16x16x32_bf16 v[160:163], a[240:243], v[16:19], v[160:163]
    s_waitcnt vmcnt(10)
    buffer_load_dwordx4 v[244:247], v2, s[16:19], s39 offen offset:1024 sc1
    v_mfma_f32_16x16x32_bf16 v[160:163], a[0:3], v[4:7], v[160:163]
    s_waitcnt vmcnt(10)
    ds_read_b64_tr_b16 a[210:211], v40 offset:2048
    v_mfma_f32_16x16x32_bf16 v[160:163], a[16:19], v[12:15], v[160:163]
    buffer_load_dwordx4 v[248:251], v2, s[16:19], s39 offen offset:2048 sc1
    v_mfma_f32_16x16x32_bf16 v[164:167], a[20:23], v[12:15], v[164:167]
    ds_read_b64_tr_b16 a[212:213], v41 offset:0
    v_mfma_f32_16x16x32_bf16 v[164:167], a[4:7], v[4:7], v[164:167]
    buffer_load_dwordx4 v[252:255], v2, s[16:19], s39 offen offset:3072 sc1
    v_mfma_f32_16x16x32_bf16 v[164:167], a[244:247], v[16:19], v[164:167]
    ds_read_b64_tr_b16 a[214:215], v41 offset:2048
    v_mfma_f32_16x16x32_bf16 v[164:167], a[228:231], v[36:39], v[164:167]
    ds_read_b64_tr_b16 a[216:217], v42 offset:0
    v_mfma_f32_16x16x32_bf16 v[168:171], a[232:235], v[36:39], v[168:171]
    ds_read_b64_tr_b16 a[218:219], v42 offset:2048
    v_mfma_f32_16x16x32_bf16 v[168:171], a[248:251], v[16:19], v[168:171]
    ds_read_b64_tr_b16 a[220:221], v43 offset:0
    v_mfma_f32_16x16x32_bf16 v[168:171], a[8:11], v[4:7], v[168:171]
    ds_read_b64_tr_b16 a[222:223], v43 offset:2048
    v_mfma_f32_16x16x32_bf16 v[168:171], a[24:27], v[12:15], v[168:171]
    v_mfma_f32_16x16x32_bf16 v[172:175], a[28:31], v[12:15], v[172:175]
    v_mfma_f32_16x16x32_bf16 v[172:175], a[12:15], v[4:7], v[172:175]
    v_mfma_f32_16x16x32_bf16 v[172:175], a[252:255], v[16:19], v[172:175]
    s_mov_b32 s39, 45056
    v_mfma_f32_16x16x32_bf16 v[172:175], a[236:239], v[36:39], v[172:175]
    s_waitcnt vmcnt(11)
    buffer_load_dwordx4 v[36:39], v2, s[16:19], s39 offen offset:0 sc1
    v_mfma_f32_16x16x32_bf16 v[176:179], a[224:227], v[208:211], v[176:179]
    s_waitcnt vmcnt(11)
    v_mfma_f32_16x16x32_bf16 v[176:179], a[240:243], v[212:215], v[176:179]
    s_waitcnt vmcnt(10)
    buffer_load_dwordx4 v[16:19], v2, s[16:19], s39 offen offset:1024 sc1
    v_mfma_f32_16x16x32_bf16 v[176:179], a[0:3], v[216:219], v[176:179]
    s_waitcnt vmcnt(10)
    v_mfma_f32_16x16x32_bf16 v[176:179], a[16:19], v[220:223], v[176:179]
    buffer_load_dwordx4 v[4:7], v2, s[16:19], s39 offen offset:2048 sc1
    v_mfma_f32_16x16x32_bf16 v[180:183], a[20:23], v[220:223], v[180:183]
    v_mfma_f32_16x16x32_bf16 v[180:183], a[4:7], v[216:219], v[180:183]
    buffer_load_dwordx4 v[12:15], v2, s[16:19], s39 offen offset:3072 sc1
    v_mfma_f32_16x16x32_bf16 v[180:183], a[244:247], v[212:215], v[180:183]
    v_mfma_f32_16x16x32_bf16 v[180:183], a[228:231], v[208:211], v[180:183]
    v_mfma_f32_16x16x32_bf16 v[184:187], a[232:235], v[208:211], v[184:187]
    v_mfma_f32_16x16x32_bf16 v[184:187], a[248:251], v[212:215], v[184:187]
    v_mfma_f32_16x16x32_bf16 v[184:187], a[8:11], v[216:219], v[184:187]
    v_mfma_f32_16x16x32_bf16 v[184:187], a[24:27], v[220:223], v[184:187]
    v_mfma_f32_16x16x32_bf16 v[188:191], a[28:31], v[220:223], v[188:191]
    v_mfma_f32_16x16x32_bf16 v[188:191], a[12:15], v[216:219], v[188:191]
    v_mfma_f32_16x16x32_bf16 v[188:191], a[252:255], v[212:215], v[188:191]
    s_mov_b32 s39, 49152
    v_mfma_f32_16x16x32_bf16 v[188:191], a[236:239], v[208:211], v[188:191]
    s_waitcnt vmcnt(11)
    buffer_load_dwordx4 v[208:211], v2, s[16:19], s39 offen offset:0 sc1
    v_mfma_f32_16x16x32_bf16 v[192:195], a[224:227], v[224:227], v[192:195]
    s_waitcnt vmcnt(11)
    v_mfma_f32_16x16x32_bf16 v[192:195], a[240:243], v[228:231], v[192:195]
    s_waitcnt vmcnt(10)
    buffer_load_dwordx4 v[212:215], v2, s[16:19], s39 offen offset:1024 sc1
    v_mfma_f32_16x16x32_bf16 v[192:195], a[0:3], v[232:235], v[192:195]
    s_waitcnt vmcnt(10)
    v_mfma_f32_16x16x32_bf16 v[192:195], a[16:19], v[236:239], v[192:195]
    buffer_load_dwordx4 v[216:219], v2, s[16:19], s39 offen offset:2048 sc1
    v_mfma_f32_16x16x32_bf16 v[196:199], a[20:23], v[236:239], v[196:199]
    v_mfma_f32_16x16x32_bf16 v[196:199], a[4:7], v[232:235], v[196:199]
    buffer_load_dwordx4 v[220:223], v2, s[16:19], s39 offen offset:3072 sc1
    v_mfma_f32_16x16x32_bf16 v[196:199], a[244:247], v[228:231], v[196:199]
    v_mfma_f32_16x16x32_bf16 v[196:199], a[228:231], v[224:227], v[196:199]
    v_mfma_f32_16x16x32_bf16 v[200:203], a[232:235], v[224:227], v[200:203]
    v_mfma_f32_16x16x32_bf16 v[200:203], a[248:251], v[228:231], v[200:203]
    v_mfma_f32_16x16x32_bf16 v[200:203], a[8:11], v[232:235], v[200:203]
    v_mfma_f32_16x16x32_bf16 v[200:203], a[24:27], v[236:239], v[200:203]
    v_mfma_f32_16x16x32_bf16 v[204:207], a[28:31], v[236:239], v[204:207]
    v_mfma_f32_16x16x32_bf16 v[204:207], a[12:15], v[232:235], v[204:207]
    v_mfma_f32_16x16x32_bf16 v[204:207], a[252:255], v[228:231], v[204:207]
    s_mov_b32 s39, 53248
    v_mfma_f32_16x16x32_bf16 v[204:207], a[236:239], v[224:227], v[204:207]
    s_waitcnt vmcnt(11)
    buffer_load_dwordx4 v[224:227], v2, s[16:19], s39 offen offset:0 sc1
    v_mfma_f32_16x16x32_bf16 v[128:131], a[32:35], v[240:243], v[128:131]
    s_waitcnt vmcnt(11)
    ds_read_b64_tr_b16 a[224:225], v8 offset:16384
    v_mfma_f32_16x16x32_bf16 v[128:131], a[48:51], v[244:247], v[128:131]
    s_waitcnt vmcnt(10)
    buffer_load_dwordx4 v[228:231], v2, s[16:19], s39 offen offset:1024 sc1
    v_mfma_f32_16x16x32_bf16 v[128:131], a[64:67], v[248:251], v[128:131]
    s_waitcnt vmcnt(10)
    ds_read_b64_tr_b16 a[226:227], v8 offset:18432
    v_mfma_f32_16x16x32_bf16 v[128:131], a[80:83], v[252:255], v[128:131]
    buffer_load_dwordx4 v[232:235], v2, s[16:19], s39 offen offset:2048 sc1
    v_mfma_f32_16x16x32_bf16 v[132:135], a[84:87], v[252:255], v[132:135]
    ds_read_b64_tr_b16 a[228:229], v9 offset:16384
    v_mfma_f32_16x16x32_bf16 v[132:135], a[68:71], v[248:251], v[132:135]
    buffer_load_dwordx4 v[236:239], v2, s[16:19], s39 offen offset:3072 sc1
    v_mfma_f32_16x16x32_bf16 v[132:135], a[52:55], v[244:247], v[132:135]
    ds_read_b64_tr_b16 a[230:231], v9 offset:18432
    v_mfma_f32_16x16x32_bf16 v[132:135], a[36:39], v[240:243], v[132:135]
    ds_read_b64_tr_b16 a[232:233], v10 offset:16384
    v_mfma_f32_16x16x32_bf16 v[136:139], a[40:43], v[240:243], v[136:139]
    ds_read_b64_tr_b16 a[234:235], v10 offset:18432
    v_mfma_f32_16x16x32_bf16 v[136:139], a[56:59], v[244:247], v[136:139]
    ds_read_b64_tr_b16 a[236:237], v11 offset:16384
    v_mfma_f32_16x16x32_bf16 v[136:139], a[72:75], v[248:251], v[136:139]
    ds_read_b64_tr_b16 a[238:239], v11 offset:18432
    v_mfma_f32_16x16x32_bf16 v[136:139], a[88:91], v[252:255], v[136:139]
    ds_read_b64_tr_b16 a[240:241], v44 offset:0
    v_mfma_f32_16x16x32_bf16 v[140:143], a[92:95], v[252:255], v[140:143]
    ds_read_b64_tr_b16 a[242:243], v44 offset:2048
    v_mfma_f32_16x16x32_bf16 v[140:143], a[76:79], v[248:251], v[140:143]
    ds_read_b64_tr_b16 a[244:245], v45 offset:0
    v_mfma_f32_16x16x32_bf16 v[140:143], a[60:63], v[244:247], v[140:143]
    s_mov_b32 s39, 57344
    ds_read_b64_tr_b16 a[246:247], v45 offset:2048
    v_mfma_f32_16x16x32_bf16 v[140:143], a[44:47], v[240:243], v[140:143]
    s_waitcnt vmcnt(11)
    buffer_load_dwordx4 v[240:243], v2, s[16:19], s39 offen offset:0 sc1
    v_mfma_f32_16x16x32_bf16 v[144:147], a[32:35], v[36:39], v[144:147]
    s_waitcnt vmcnt(11)
    ds_read_b64_tr_b16 a[248:249], v46 offset:0
    v_mfma_f32_16x16x32_bf16 v[144:147], a[48:51], v[16:19], v[144:147]
    s_waitcnt vmcnt(10)
    buffer_load_dwordx4 v[244:247], v2, s[16:19], s39 offen offset:1024 sc1
    v_mfma_f32_16x16x32_bf16 v[144:147], a[64:67], v[4:7], v[144:147]
    s_waitcnt vmcnt(10)
    ds_read_b64_tr_b16 a[250:251], v46 offset:2048
    v_mfma_f32_16x16x32_bf16 v[144:147], a[80:83], v[12:15], v[144:147]
    buffer_load_dwordx4 v[248:251], v2, s[16:19], s39 offen offset:2048 sc1
    v_mfma_f32_16x16x32_bf16 v[148:151], a[84:87], v[12:15], v[148:151]
    ds_read_b64_tr_b16 a[252:253], v47 offset:0
    v_mfma_f32_16x16x32_bf16 v[148:151], a[68:71], v[4:7], v[148:151]
    buffer_load_dwordx4 v[252:255], v2, s[16:19], s39 offen offset:3072 sc1
    v_mfma_f32_16x16x32_bf16 v[148:151], a[52:55], v[16:19], v[148:151]
    ds_read_b64_tr_b16 a[254:255], v47 offset:2048
    v_mfma_f32_16x16x32_bf16 v[148:151], a[36:39], v[36:39], v[148:151]
    ds_read_b64_tr_b16 a[0:1], v44 offset:49152
    v_mfma_f32_16x16x32_bf16 v[152:155], a[40:43], v[36:39], v[152:155]
    ds_read_b64_tr_b16 a[2:3], v44 offset:51200
    v_mfma_f32_16x16x32_bf16 v[152:155], a[56:59], v[16:19], v[152:155]
    ds_read_b64_tr_b16 a[4:5], v45 offset:49152
    v_mfma_f32_16x16x32_bf16 v[152:155], a[72:75], v[4:7], v[152:155]
    ds_read_b64_tr_b16 a[6:7], v45 offset:51200
    v_mfma_f32_16x16x32_bf16 v[152:155], a[88:91], v[12:15], v[152:155]
    ds_read_b64_tr_b16 a[8:9], v46 offset:49152
    v_mfma_f32_16x16x32_bf16 v[156:159], a[92:95], v[12:15], v[156:159]
    ds_read_b64_tr_b16 a[10:11], v46 offset:51200
    v_mfma_f32_16x16x32_bf16 v[156:159], a[76:79], v[4:7], v[156:159]
    ds_read_b64_tr_b16 a[12:13], v47 offset:49152
    v_mfma_f32_16x16x32_bf16 v[156:159], a[60:63], v[16:19], v[156:159]
    s_mov_b32 s39, 61440
    ds_read_b64_tr_b16 a[14:15], v47 offset:51200
    v_mfma_f32_16x16x32_bf16 v[156:159], a[44:47], v[36:39], v[156:159]
    s_waitcnt vmcnt(11)
    buffer_load_dwordx4 v[36:39], v2, s[16:19], s39 offen offset:0 sc1
    v_mfma_f32_16x16x32_bf16 v[160:163], a[32:35], v[208:211], v[160:163]
    s_waitcnt vmcnt(11)
    ds_read_b64_tr_b16 a[16:17], v40 offset:16384
    v_mfma_f32_16x16x32_bf16 v[160:163], a[48:51], v[212:215], v[160:163]
    s_waitcnt vmcnt(10)
    buffer_load_dwordx4 v[16:19], v2, s[16:19], s39 offen offset:1024 sc1
    v_mfma_f32_16x16x32_bf16 v[160:163], a[64:67], v[216:219], v[160:163]
    s_waitcnt vmcnt(10)
    ds_read_b64_tr_b16 a[18:19], v40 offset:18432
    v_mfma_f32_16x16x32_bf16 v[160:163], a[80:83], v[220:223], v[160:163]
    buffer_load_dwordx4 v[4:7], v2, s[16:19], s39 offen offset:2048 sc1
    v_mfma_f32_16x16x32_bf16 v[164:167], a[84:87], v[220:223], v[164:167]
    ds_read_b64_tr_b16 a[20:21], v41 offset:16384
    v_mfma_f32_16x16x32_bf16 v[164:167], a[68:71], v[216:219], v[164:167]
    buffer_load_dwordx4 v[12:15], v2, s[16:19], s39 offen offset:3072 sc1
    v_mfma_f32_16x16x32_bf16 v[164:167], a[52:55], v[212:215], v[164:167]
    ds_read_b64_tr_b16 a[22:23], v41 offset:18432
    v_mfma_f32_16x16x32_bf16 v[164:167], a[36:39], v[208:211], v[164:167]
    ds_read_b64_tr_b16 a[24:25], v42 offset:16384
    v_mfma_f32_16x16x32_bf16 v[168:171], a[40:43], v[208:211], v[168:171]
    ds_read_b64_tr_b16 a[26:27], v42 offset:18432
    v_mfma_f32_16x16x32_bf16 v[168:171], a[56:59], v[212:215], v[168:171]
    ds_read_b64_tr_b16 a[28:29], v43 offset:16384
    v_mfma_f32_16x16x32_bf16 v[168:171], a[72:75], v[216:219], v[168:171]
    ds_read_b64_tr_b16 a[30:31], v43 offset:18432
    v_mfma_f32_16x16x32_bf16 v[168:171], a[88:91], v[220:223], v[168:171]
    v_mfma_f32_16x16x32_bf16 v[172:175], a[92:95], v[220:223], v[172:175]
    v_mfma_f32_16x16x32_bf16 v[172:175], a[76:79], v[216:219], v[172:175]
    v_mfma_f32_16x16x32_bf16 v[172:175], a[60:63], v[212:215], v[172:175]
    s_mov_b32 s39, 65536
    v_mfma_f32_16x16x32_bf16 v[172:175], a[44:47], v[208:211], v[172:175]
    s_waitcnt vmcnt(11)
    buffer_load_dwordx4 v[208:211], v2, s[16:19], s39 offen offset:0 sc1
    v_mfma_f32_16x16x32_bf16 v[176:179], a[32:35], v[224:227], v[176:179]
    s_waitcnt vmcnt(11)
    v_mfma_f32_16x16x32_bf16 v[176:179], a[48:51], v[228:231], v[176:179]
    s_waitcnt vmcnt(10)
    buffer_load_dwordx4 v[212:215], v2, s[16:19], s39 offen offset:1024 sc1
    v_mfma_f32_16x16x32_bf16 v[176:179], a[64:67], v[232:235], v[176:179]
    s_waitcnt vmcnt(10)
    v_mfma_f32_16x16x32_bf16 v[176:179], a[80:83], v[236:239], v[176:179]
    buffer_load_dwordx4 v[216:219], v2, s[16:19], s39 offen offset:2048 sc1
    v_mfma_f32_16x16x32_bf16 v[180:183], a[84:87], v[236:239], v[180:183]
    v_mfma_f32_16x16x32_bf16 v[180:183], a[68:71], v[232:235], v[180:183]
    buffer_load_dwordx4 v[220:223], v2, s[16:19], s39 offen offset:3072 sc1
    v_mfma_f32_16x16x32_bf16 v[180:183], a[52:55], v[228:231], v[180:183]
    v_mfma_f32_16x16x32_bf16 v[180:183], a[36:39], v[224:227], v[180:183]
    v_mfma_f32_16x16x32_bf16 v[184:187], a[40:43], v[224:227], v[184:187]
    v_mfma_f32_16x16x32_bf16 v[184:187], a[56:59], v[228:231], v[184:187]
    v_mfma_f32_16x16x32_bf16 v[184:187], a[72:75], v[232:235], v[184:187]
    v_mfma_f32_16x16x32_bf16 v[184:187], a[88:91], v[236:239], v[184:187]
    v_mfma_f32_16x16x32_bf16 v[188:191], a[92:95], v[236:239], v[188:191]
    v_mfma_f32_16x16x32_bf16 v[188:191], a[76:79], v[232:235], v[188:191]
    v_mfma_f32_16x16x32_bf16 v[188:191], a[60:63], v[228:231], v[188:191]
    s_mov_b32 s39, 69632
    v_mfma_f32_16x16x32_bf16 v[188:191], a[44:47], v[224:227], v[188:191]
    s_waitcnt vmcnt(11)
    buffer_load_dwordx4 v[224:227], v2, s[16:19], s39 offen offset:0 sc1
    v_mfma_f32_16x16x32_bf16 v[192:195], a[32:35], v[240:243], v[192:195]
    s_waitcnt vmcnt(11)
    v_mfma_f32_16x16x32_bf16 v[192:195], a[48:51], v[244:247], v[192:195]
    s_waitcnt vmcnt(10)
    buffer_load_dwordx4 v[228:231], v2, s[16:19], s39 offen offset:1024 sc1
    v_mfma_f32_16x16x32_bf16 v[192:195], a[64:67], v[248:251], v[192:195]
    s_waitcnt vmcnt(10)
    v_mfma_f32_16x16x32_bf16 v[192:195], a[80:83], v[252:255], v[192:195]
    buffer_load_dwordx4 v[232:235], v2, s[16:19], s39 offen offset:2048 sc1
    v_mfma_f32_16x16x32_bf16 v[196:199], a[84:87], v[252:255], v[196:199]
    v_mfma_f32_16x16x32_bf16 v[196:199], a[68:71], v[248:251], v[196:199]
    buffer_load_dwordx4 v[236:239], v2, s[16:19], s39 offen offset:3072 sc1
    v_mfma_f32_16x16x32_bf16 v[196:199], a[52:55], v[244:247], v[196:199]
    v_mfma_f32_16x16x32_bf16 v[196:199], a[36:39], v[240:243], v[196:199]
    v_mfma_f32_16x16x32_bf16 v[200:203], a[40:43], v[240:243], v[200:203]
    v_mfma_f32_16x16x32_bf16 v[200:203], a[56:59], v[244:247], v[200:203]
    v_mfma_f32_16x16x32_bf16 v[200:203], a[72:75], v[248:251], v[200:203]
    v_mfma_f32_16x16x32_bf16 v[200:203], a[88:91], v[252:255], v[200:203]
    v_mfma_f32_16x16x32_bf16 v[204:207], a[92:95], v[252:255], v[204:207]
    v_mfma_f32_16x16x32_bf16 v[204:207], a[76:79], v[248:251], v[204:207]
    v_mfma_f32_16x16x32_bf16 v[204:207], a[60:63], v[244:247], v[204:207]
    s_mov_b32 s39, 73728
    v_mfma_f32_16x16x32_bf16 v[204:207], a[44:47], v[240:243], v[204:207]
    s_waitcnt vmcnt(11)
    buffer_load_dwordx4 v[240:243], v2, s[16:19], s39 offen offset:0 sc1
    v_mfma_f32_16x16x32_bf16 v[128:131], a[96:99], v[36:39], v[128:131]
    s_waitcnt vmcnt(11)
    ds_read_b64_tr_b16 a[32:33], v44 offset:16384
    v_mfma_f32_16x16x32_bf16 v[128:131], a[112:115], v[16:19], v[128:131]
    s_waitcnt vmcnt(10)
    buffer_load_dwordx4 v[244:247], v2, s[16:19], s39 offen offset:1024 sc1
    v_mfma_f32_16x16x32_bf16 v[128:131], a[128:131], v[4:7], v[128:131]
    s_waitcnt vmcnt(10)
    ds_read_b64_tr_b16 a[34:35], v44 offset:18432
    v_mfma_f32_16x16x32_bf16 v[128:131], a[144:147], v[12:15], v[128:131]
    buffer_load_dwordx4 v[248:251], v2, s[16:19], s39 offen offset:2048 sc1
    v_mfma_f32_16x16x32_bf16 v[132:135], a[148:151], v[12:15], v[132:135]
    ds_read_b64_tr_b16 a[36:37], v45 offset:16384
    v_mfma_f32_16x16x32_bf16 v[132:135], a[132:135], v[4:7], v[132:135]
    buffer_load_dwordx4 v[252:255], v2, s[16:19], s39 offen offset:3072 sc1
    v_mfma_f32_16x16x32_bf16 v[132:135], a[116:119], v[16:19], v[132:135]
    ds_read_b64_tr_b16 a[38:39], v45 offset:18432
    v_mfma_f32_16x16x32_bf16 v[132:135], a[100:103], v[36:39], v[132:135]
    ds_read_b64_tr_b16 a[40:41], v46 offset:16384
    v_mfma_f32_16x16x32_bf16 v[136:139], a[104:107], v[36:39], v[136:139]
    ds_read_b64_tr_b16 a[42:43], v46 offset:18432
    v_mfma_f32_16x16x32_bf16 v[136:139], a[120:123], v[16:19], v[136:139]
    ds_read_b64_tr_b16 a[44:45], v47 offset:16384
    v_mfma_f32_16x16x32_bf16 v[136:139], a[136:139], v[4:7], v[136:139]
    ds_read_b64_tr_b16 a[46:47], v47 offset:18432
    v_mfma_f32_16x16x32_bf16 v[136:139], a[152:155], v[12:15], v[136:139]
    ds_read_b64_tr_b16 a[48:49], v44 offset:32768
    v_mfma_f32_16x16x32_bf16 v[140:143], a[156:159], v[12:15], v[140:143]
    ds_read_b64_tr_b16 a[50:51], v44 offset:34816
    v_mfma_f32_16x16x32_bf16 v[140:143], a[140:143], v[4:7], v[140:143]
    ds_read_b64_tr_b16 a[52:53], v45 offset:32768
    v_mfma_f32_16x16x32_bf16 v[140:143], a[124:127], v[16:19], v[140:143]
    s_mov_b32 s39, 77824
    ds_read_b64_tr_b16 a[54:55], v45 offset:34816
    v_mfma_f32_16x16x32_bf16 v[140:143], a[108:111], v[36:39], v[140:143]
    s_waitcnt vmcnt(11)
    buffer_load_dwordx4 v[36:39], v2, s[16:19], s39 offen offset:0 sc1
    v_mfma_f32_16x16x32_bf16 v[144:147], a[96:99], v[208:211], v[144:147]
    s_waitcnt vmcnt(11)
    ds_read_b64_tr_b16 a[56:57], v46 offset:32768
    v_mfma_f32_16x16x32_bf16 v[144:147], a[112:115], v[212:215], v[144:147]
    s_waitcnt vmcnt(10)
    buffer_load_dwordx4 v[16:19], v2, s[16:19], s39 offen offset:1024 sc1
    v_mfma_f32_16x16x32_bf16 v[144:147], a[128:131], v[216:219], v[144:147]
    s_waitcnt vmcnt(10)
    ds_read_b64_tr_b16 a[58:59], v46 offset:34816
    v_mfma_f32_16x16x32_bf16 v[144:147], a[144:147], v[220:223], v[144:147]
    buffer_load_dwordx4 v[4:7], v2, s[16:19], s39 offen offset:2048 sc1
    v_mfma_f32_16x16x32_bf16 v[148:151], a[148:151], v[220:223], v[148:151]
    ds_read_b64_tr_b16 a[60:61], v47 offset:32768
    v_mfma_f32_16x16x32_bf16 v[148:151], a[132:135], v[216:219], v[148:151]
    buffer_load_dwordx4 v[12:15], v2, s[16:19], s39 offen offset:3072 sc1
    v_mfma_f32_16x16x32_bf16 v[148:151], a[116:119], v[212:215], v[148:151]
    ds_read_b64_tr_b16 a[62:63], v47 offset:34816
    v_mfma_f32_16x16x32_bf16 v[148:151], a[100:103], v[208:211], v[148:151]
    v_mfma_f32_16x16x32_bf16 v[152:155], a[104:107], v[208:211], v[152:155]
    v_mfma_f32_16x16x32_bf16 v[152:155], a[120:123], v[212:215], v[152:155]
    v_mfma_f32_16x16x32_bf16 v[152:155], a[136:139], v[216:219], v[152:155]
    v_mfma_f32_16x16x32_bf16 v[152:155], a[152:155], v[220:223], v[152:155]
    v_mfma_f32_16x16x32_bf16 v[156:159], a[156:159], v[220:223], v[156:159]
    v_mfma_f32_16x16x32_bf16 v[156:159], a[140:143], v[216:219], v[156:159]
    v_mfma_f32_16x16x32_bf16 v[156:159], a[124:127], v[212:215], v[156:159]
    s_mov_b32 s39, 81920
    v_mfma_f32_16x16x32_bf16 v[156:159], a[108:111], v[208:211], v[156:159]
    s_waitcnt vmcnt(11)
    buffer_load_dwordx4 v[208:211], v2, s[16:19], s39 offen offset:0 sc1
    v_mfma_f32_16x16x32_bf16 v[160:163], a[96:99], v[224:227], v[160:163]
    s_waitcnt vmcnt(11)
    v_mfma_f32_16x16x32_bf16 v[160:163], a[112:115], v[228:231], v[160:163]
    s_waitcnt vmcnt(10)
    buffer_load_dwordx4 v[212:215], v2, s[16:19], s39 offen offset:1024 sc1
    v_mfma_f32_16x16x32_bf16 v[160:163], a[128:131], v[232:235], v[160:163]
    s_waitcnt vmcnt(10)
    s_waitcnt lgkmcnt(0)
    s_barrier
    v_mfma_f32_16x16x32_bf16 v[160:163], a[144:147], v[236:239], v[160:163]
    buffer_load_dwordx4 v[216:219], v2, s[16:19], s39 offen offset:2048 sc1
    v_mfma_f32_16x16x32_bf16 v[164:167], a[148:151], v[236:239], v[164:167]
    v_lshrrev_b32 v43, 4, v3
    v_mfma_f32_16x16x32_bf16 v[164:167], a[132:135], v[232:235], v[164:167]
    buffer_load_dwordx4 v[220:223], v2, s[16:19], s39 offen offset:3072 sc1
    v_mfma_f32_16x16x32_bf16 v[164:167], a[116:119], v[228:231], v[164:167]
    v_lshlrev_b32 v47, 8, v43
    v_mfma_f32_16x16x32_bf16 v[164:167], a[100:103], v[224:227], v[164:167]
    v_add_u32 v47, s33, v47
    v_mfma_f32_16x16x32_bf16 v[168:171], a[104:107], v[224:227], v[168:171]
    v_and_b32 v43, 2, v43
    v_mfma_f32_16x16x32_bf16 v[168:171], a[120:123], v[228:231], v[168:171]
    v_and_b32 v40, 15, v3
    v_mfma_f32_16x16x32_bf16 v[168:171], a[136:139], v[232:235], v[168:171]
    v_xor_b32 v43, v43, v40
    v_mfma_f32_16x16x32_bf16 v[168:171], a[152:155], v[236:239], v[168:171]
    v_xor_b32 v8, 0, v43
    v_mfma_f32_16x16x32_bf16 v[172:175], a[156:159], v[236:239], v[172:175]
    v_lshl_add_u32 v8, v8, 4, v47
    v_mfma_f32_16x16x32_bf16 v[172:175], a[140:143], v[232:235], v[172:175]
    v_xor_b32 v9, 4, v43
    v_mfma_f32_16x16x32_bf16 v[172:175], a[124:127], v[228:231], v[172:175]
    s_mov_b32 s39, 86016
    v_lshl_add_u32 v9, v9, 4, v47
    v_mfma_f32_16x16x32_bf16 v[172:175], a[108:111], v[224:227], v[172:175]
    s_waitcnt vmcnt(11)
    buffer_load_dwordx4 v[224:227], v2, s[16:19], s39 offen offset:0 sc1
    v_mfma_f32_16x16x32_bf16 v[176:179], a[96:99], v[240:243], v[176:179]
    s_waitcnt vmcnt(11)
    v_xor_b32 v10, 8, v43
    v_mfma_f32_16x16x32_bf16 v[176:179], a[112:115], v[244:247], v[176:179]
    s_waitcnt vmcnt(10)
    buffer_load_dwordx4 v[228:231], v2, s[16:19], s39 offen offset:1024 sc1
    v_mfma_f32_16x16x32_bf16 v[176:179], a[128:131], v[248:251], v[176:179]
    s_waitcnt vmcnt(10)
    v_lshl_add_u32 v10, v10, 4, v47
    v_mfma_f32_16x16x32_bf16 v[176:179], a[144:147], v[252:255], v[176:179]
    buffer_load_dwordx4 v[232:235], v2, s[16:19], s39 offen offset:2048 sc1
    v_mfma_f32_16x16x32_bf16 v[180:183], a[148:151], v[252:255], v[180:183]
    v_xor_b32 v11, 12, v43
    v_mfma_f32_16x16x32_bf16 v[180:183], a[132:135], v[248:251], v[180:183]
    buffer_load_dwordx4 v[236:239], v2, s[16:19], s39 offen offset:3072 sc1
    v_mfma_f32_16x16x32_bf16 v[180:183], a[116:119], v[244:247], v[180:183]
    v_lshl_add_u32 v11, v11, 4, v47
    v_mfma_f32_16x16x32_bf16 v[180:183], a[100:103], v[240:243], v[180:183]
    v_and_b32 v1, 7, v3
    v_mfma_f32_16x16x32_bf16 v[184:187], a[104:107], v[240:243], v[184:187]
    v_lshrrev_b32 v43, 3, v3
    v_mfma_f32_16x16x32_bf16 v[184:187], a[120:123], v[244:247], v[184:187]
    v_add_u32 v43, s34, v43
    v_mfma_f32_16x16x32_bf16 v[184:187], a[136:139], v[248:251], v[184:187]
    v_add_u32 v43, 0, v43
    v_mfma_f32_16x16x32_bf16 v[184:187], a[152:155], v[252:255], v[184:187]
    v_lshrrev_b32 v47, 4, v43
    v_mfma_f32_16x16x32_bf16 v[188:191], a[156:159], v[252:255], v[188:191]
    v_lshlrev_b32 v47, 12, v47
    v_mfma_f32_16x16x32_bf16 v[188:191], a[140:143], v[248:251], v[188:191]
    v_lshl_add_u32 v47, v1, 9, v47
    v_mfma_f32_16x16x32_bf16 v[188:191], a[124:127], v[244:247], v[188:191]
    s_mov_b32 s39, 90112
    v_and_b32 v40, 15, v43
    v_mfma_f32_16x16x32_bf16 v[188:191], a[108:111], v[240:243], v[188:191]
    s_waitcnt vmcnt(11)
    buffer_load_dwordx4 v[240:243], v2, s[16:19], s39 offen offset:0 sc1
    v_mfma_f32_16x16x32_bf16 v[192:195], a[96:99], v[36:39], v[192:195]
    s_waitcnt vmcnt(11)
    v_lshlrev_b32 v44, 1, v1
    v_mfma_f32_16x16x32_bf16 v[192:195], a[112:115], v[16:19], v[192:195]
    s_waitcnt vmcnt(10)
    buffer_load_dwordx4 v[244:247], v2, s[16:19], s39 offen offset:1024 sc1
    v_mfma_f32_16x16x32_bf16 v[192:195], a[128:131], v[4:7], v[192:195]
    s_waitcnt vmcnt(10)
    v_xor_b32 v40, v40, v44
    v_mfma_f32_16x16x32_bf16 v[192:195], a[144:147], v[12:15], v[192:195]
    buffer_load_dwordx4 v[248:251], v2, s[16:19], s39 offen offset:2048 sc1
    v_mfma_f32_16x16x32_bf16 v[196:199], a[148:151], v[12:15], v[196:199]
    v_lshl_add_u32 v40, v40, 4, v47
    v_mfma_f32_16x16x32_bf16 v[196:199], a[132:135], v[4:7], v[196:199]
    buffer_load_dwordx4 v[252:255], v2, s[16:19], s39 offen offset:3072 sc1
    v_mfma_f32_16x16x32_bf16 v[196:199], a[116:119], v[16:19], v[196:199]
    v_mul_u32_u24 v43, 1280, v43
    v_mfma_f32_16x16x32_bf16 v[196:199], a[100:103], v[36:39], v[196:199]
    v_lshl_add_u32 v44, v1, 4, v43
    v_mfma_f32_16x16x32_bf16 v[200:203], a[104:107], v[36:39], v[200:203]
    v_lshrrev_b32 v43, 3, v3
    v_mfma_f32_16x16x32_bf16 v[200:203], a[120:123], v[16:19], v[200:203]
    v_add_u32 v43, s34, v43
    v_mfma_f32_16x16x32_bf16 v[200:203], a[136:139], v[4:7], v[200:203]
    v_add_u32 v43, 8, v43
    v_mfma_f32_16x16x32_bf16 v[200:203], a[152:155], v[12:15], v[200:203]
    v_lshrrev_b32 v47, 4, v43
    v_mfma_f32_16x16x32_bf16 v[204:207], a[156:159], v[12:15], v[204:207]
    v_lshlrev_b32 v47, 12, v47
    v_mfma_f32_16x16x32_bf16 v[204:207], a[140:143], v[4:7], v[204:207]
    v_lshl_add_u32 v47, v1, 9, v47
    v_mfma_f32_16x16x32_bf16 v[204:207], a[124:127], v[16:19], v[204:207]
    s_mov_b32 s39, 94208
    v_and_b32 v41, 15, v43
    v_mfma_f32_16x16x32_bf16 v[204:207], a[108:111], v[36:39], v[204:207]
    s_waitcnt vmcnt(11)
    buffer_load_dwordx4 v[36:39], v2, s[16:19], s39 offen offset:0 sc1
    v_mfma_f32_16x16x32_bf16 v[128:131], v[20:23], v[208:211], v[128:131]
    s_waitcnt vmcnt(11)
    v_lshlrev_b32 v45, 1, v1
    v_mfma_f32_16x16x32_bf16 v[128:131], v[48:51], v[212:215], v[128:131]
    s_waitcnt vmcnt(10)
    buffer_load_dwordx4 v[16:19], v2, s[16:19], s39 offen offset:1024 sc1
    v_mfma_f32_16x16x32_bf16 v[128:131], v[64:67], v[216:219], v[128:131]
    s_waitcnt vmcnt(10)
    v_xor_b32 v41, v41, v45
    v_mfma_f32_16x16x32_bf16 v[128:131], v[80:83], v[220:223], v[128:131]
    buffer_load_dwordx4 v[4:7], v2, s[16:19], s39 offen offset:2048 sc1
    v_mfma_f32_16x16x32_bf16 v[132:135], v[84:87], v[220:223], v[132:135]
    v_lshl_add_u32 v41, v41, 4, v47
    v_mfma_f32_16x16x32_bf16 v[132:135], v[68:71], v[216:219], v[132:135]
    buffer_load_dwordx4 v[12:15], v2, s[16:19], s39 offen offset:3072 sc1
    v_mfma_f32_16x16x32_bf16 v[132:135], v[52:55], v[212:215], v[132:135]
    v_mul_u32_u24 v43, 1280, v43
    v_mfma_f32_16x16x32_bf16 v[132:135], v[24:27], v[208:211], v[132:135]
    v_lshl_add_u32 v45, v1, 4, v43
    v_mfma_f32_16x16x32_bf16 v[136:139], v[28:31], v[208:211], v[136:139]
    v_lshrrev_b32 v43, 3, v3
    v_mfma_f32_16x16x32_bf16 v[136:139], v[56:59], v[212:215], v[136:139]
    v_add_u32 v43, s34, v43
    v_mfma_f32_16x16x32_bf16 v[136:139], v[72:75], v[216:219], v[136:139]
    v_add_u32 v43, 16, v43
    v_mfma_f32_16x16x32_bf16 v[136:139], v[88:91], v[220:223], v[136:139]
    v_lshrrev_b32 v47, 4, v43
    v_mfma_f32_16x16x32_bf16 v[140:143], v[92:95], v[220:223], v[140:143]
    v_lshlrev_b32 v47, 12, v47
    v_mfma_f32_16x16x32_bf16 v[140:143], v[76:79], v[216:219], v[140:143]
    v_lshl_add_u32 v47, v1, 9, v47
    v_mfma_f32_16x16x32_bf16 v[140:143], v[60:63], v[212:215], v[140:143]
    s_mov_b32 s39, 98304
    v_and_b32 v42, 15, v43
    v_mfma_f32_16x16x32_bf16 v[140:143], v[32:35], v[208:211], v[140:143]
    s_waitcnt vmcnt(11)
    buffer_load_dwordx4 v[208:211], v2, s[16:19], s39 offen offset:0 sc1
    v_mfma_f32_16x16x32_bf16 v[144:147], v[20:23], v[224:227], v[144:147]
    s_waitcnt vmcnt(11)
    v_lshlrev_b32 v46, 1, v1
    v_mfma_f32_16x16x32_bf16 v[144:147], v[48:51], v[228:231], v[144:147]
    s_waitcnt vmcnt(10)
    buffer_load_dwordx4 v[212:215], v2, s[16:19], s39 offen offset:1024 sc1
    v_mfma_f32_16x16x32_bf16 v[144:147], v[64:67], v[232:235], v[144:147]
    s_waitcnt vmcnt(10)
    v_xor_b32 v42, v42, v46
    v_mfma_f32_16x16x32_bf16 v[144:147], v[80:83], v[236:239], v[144:147]
    buffer_load_dwordx4 v[216:219], v2, s[16:19], s39 offen offset:2048 sc1
    v_mfma_f32_16x16x32_bf16 v[148:151], v[84:87], v[236:239], v[148:151]
    v_lshl_add_u32 v42, v42, 4, v47
    v_mfma_f32_16x16x32_bf16 v[148:151], v[68:71], v[232:235], v[148:151]
    buffer_load_dwordx4 v[220:223], v2, s[16:19], s39 offen offset:3072 sc1
    v_mfma_f32_16x16x32_bf16 v[148:151], v[52:55], v[228:231], v[148:151]
    v_mul_u32_u24 v43, 1280, v43
    v_mfma_f32_16x16x32_bf16 v[148:151], v[24:27], v[224:227], v[148:151]
    v_lshl_add_u32 v46, v1, 4, v43
    v_mfma_f32_16x16x32_bf16 v[152:155], v[28:31], v[224:227], v[152:155]
    v_cmp_gt_u32 vcc, 32, v3
    v_mfma_f32_16x16x32_bf16 v[152:155], v[56:59], v[228:231], v[152:155]
    v_mov_b32 v43, 0x7f000000
    v_mfma_f32_16x16x32_bf16 v[152:155], v[72:75], v[232:235], v[152:155]
    v_mov_b32 v47, 0
    v_mfma_f32_16x16x32_bf16 v[152:155], v[88:91], v[236:239], v[152:155]
    v_cndmask_b32 v46, v43, v46, vcc
    v_mfma_f32_16x16x32_bf16 v[156:159], v[92:95], v[236:239], v[156:159]
    v_cndmask_b32 v42, v47, v42, vcc
    v_mfma_f32_16x16x32_bf16 v[156:159], v[76:79], v[232:235], v[156:159]
    v_mfma_f32_16x16x32_bf16 v[156:159], v[60:63], v[228:231], v[156:159]
    s_mov_b32 s39, 102400
    v_mfma_f32_16x16x32_bf16 v[156:159], v[32:35], v[224:227], v[156:159]
    s_waitcnt vmcnt(11)
    buffer_load_dwordx4 v[224:227], v2, s[16:19], s39 offen offset:0 sc1
    v_mfma_f32_16x16x32_bf16 v[160:163], v[20:23], v[240:243], v[160:163]
    s_waitcnt vmcnt(11)
    v_mfma_f32_16x16x32_bf16 v[160:163], v[48:51], v[244:247], v[160:163]
    s_waitcnt vmcnt(10)
    buffer_load_dwordx4 v[228:231], v2, s[16:19], s39 offen offset:1024 sc1
    v_mfma_f32_16x16x32_bf16 v[160:163], v[64:67], v[248:251], v[160:163]
    s_waitcnt vmcnt(10)
    v_mfma_f32_16x16x32_bf16 v[160:163], v[80:83], v[252:255], v[160:163]
    buffer_load_dwordx4 v[232:235], v2, s[16:19], s39 offen offset:2048 sc1
    v_mfma_f32_16x16x32_bf16 v[164:167], v[84:87], v[252:255], v[164:167]
    v_mfma_f32_16x16x32_bf16 v[164:167], v[68:71], v[248:251], v[164:167]
    buffer_load_dwordx4 v[236:239], v2, s[16:19], s39 offen offset:3072 sc1
    v_mfma_f32_16x16x32_bf16 v[164:167], v[52:55], v[244:247], v[164:167]
    v_mfma_f32_16x16x32_bf16 v[164:167], v[24:27], v[240:243], v[164:167]
    v_mfma_f32_16x16x32_bf16 v[168:171], v[28:31], v[240:243], v[168:171]
    v_mfma_f32_16x16x32_bf16 v[168:171], v[56:59], v[244:247], v[168:171]
    v_mfma_f32_16x16x32_bf16 v[168:171], v[72:75], v[248:251], v[168:171]
    v_mfma_f32_16x16x32_bf16 v[168:171], v[88:91], v[252:255], v[168:171]
    v_mfma_f32_16x16x32_bf16 v[172:175], v[92:95], v[252:255], v[172:175]
    v_mfma_f32_16x16x32_bf16 v[172:175], v[76:79], v[248:251], v[172:175]
    v_mfma_f32_16x16x32_bf16 v[172:175], v[60:63], v[244:247], v[172:175]
    s_mov_b32 s39, 106496
    v_mfma_f32_16x16x32_bf16 v[172:175], v[32:35], v[240:243], v[172:175]
    s_waitcnt vmcnt(11)
    buffer_load_dwordx4 v[240:243], v2, s[16:19], s39 offen offset:0 sc1
    v_mfma_f32_16x16x32_bf16 v[176:179], v[20:23], v[36:39], v[176:179]
    s_waitcnt vmcnt(11)
    v_mfma_f32_16x16x32_bf16 v[176:179], v[48:51], v[16:19], v[176:179]
    s_waitcnt vmcnt(10)
    buffer_load_dwordx4 v[244:247], v2, s[16:19], s39 offen offset:1024 sc1
    v_mfma_f32_16x16x32_bf16 v[176:179], v[64:67], v[4:7], v[176:179]
    s_waitcnt vmcnt(10)
    v_mfma_f32_16x16x32_bf16 v[176:179], v[80:83], v[12:15], v[176:179]
    buffer_load_dwordx4 v[248:251], v2, s[16:19], s39 offen offset:2048 sc1
    v_mfma_f32_16x16x32_bf16 v[180:183], v[84:87], v[12:15], v[180:183]
    v_mfma_f32_16x16x32_bf16 v[180:183], v[68:71], v[4:7], v[180:183]
    buffer_load_dwordx4 v[252:255], v2, s[16:19], s39 offen offset:3072 sc1
    v_mfma_f32_16x16x32_bf16 v[180:183], v[52:55], v[16:19], v[180:183]
    v_mfma_f32_16x16x32_bf16 v[180:183], v[24:27], v[36:39], v[180:183]
    v_mfma_f32_16x16x32_bf16 v[184:187], v[28:31], v[36:39], v[184:187]
    v_mfma_f32_16x16x32_bf16 v[184:187], v[56:59], v[16:19], v[184:187]
    v_mfma_f32_16x16x32_bf16 v[184:187], v[72:75], v[4:7], v[184:187]
    v_mfma_f32_16x16x32_bf16 v[184:187], v[88:91], v[12:15], v[184:187]
    v_mfma_f32_16x16x32_bf16 v[188:191], v[92:95], v[12:15], v[188:191]
    v_mfma_f32_16x16x32_bf16 v[188:191], v[76:79], v[4:7], v[188:191]
    v_mfma_f32_16x16x32_bf16 v[188:191], v[60:63], v[16:19], v[188:191]
    s_mov_b32 s39, 110592
    v_mfma_f32_16x16x32_bf16 v[188:191], v[32:35], v[36:39], v[188:191]
    s_waitcnt vmcnt(11)
    buffer_load_dwordx4 v[36:39], v2, s[16:19], s39 offen offset:0 sc1
    v_mfma_f32_16x16x32_bf16 v[192:195], v[20:23], v[208:211], v[192:195]
    s_waitcnt vmcnt(11)
    v_mfma_f32_16x16x32_bf16 v[192:195], v[48:51], v[212:215], v[192:195]
    s_waitcnt vmcnt(10)
    buffer_load_dwordx4 v[16:19], v2, s[16:19], s39 offen offset:1024 sc1
    v_mfma_f32_16x16x32_bf16 v[192:195], v[64:67], v[216:219], v[192:195]
    s_waitcnt vmcnt(10)
    v_mfma_f32_16x16x32_bf16 v[192:195], v[80:83], v[220:223], v[192:195]
    buffer_load_dwordx4 v[4:7], v2, s[16:19], s39 offen offset:2048 sc1
    v_mfma_f32_16x16x32_bf16 v[196:199], v[84:87], v[220:223], v[196:199]
    v_mfma_f32_16x16x32_bf16 v[196:199], v[68:71], v[216:219], v[196:199]
    buffer_load_dwordx4 v[12:15], v2, s[16:19], s39 offen offset:3072 sc1
    v_mfma_f32_16x16x32_bf16 v[196:199], v[52:55], v[212:215], v[196:199]
    v_mfma_f32_16x16x32_bf16 v[196:199], v[24:27], v[208:211], v[196:199]
    v_mfma_f32_16x16x32_bf16 v[200:203], v[28:31], v[208:211], v[200:203]
    v_mfma_f32_16x16x32_bf16 v[200:203], v[56:59], v[212:215], v[200:203]
    v_mfma_f32_16x16x32_bf16 v[200:203], v[72:75], v[216:219], v[200:203]
    v_mfma_f32_16x16x32_bf16 v[200:203], v[88:91], v[220:223], v[200:203]
    v_mfma_f32_16x16x32_bf16 v[204:207], v[92:95], v[220:223], v[204:207]
    v_mfma_f32_16x16x32_bf16 v[204:207], v[76:79], v[216:219], v[204:207]
    v_mfma_f32_16x16x32_bf16 v[204:207], v[60:63], v[212:215], v[204:207]
    s_mov_b32 s39, 114688
    v_mfma_f32_16x16x32_bf16 v[204:207], v[32:35], v[208:211], v[204:207]
    s_waitcnt vmcnt(11)
    buffer_load_dwordx4 v[208:211], v2, s[16:19], s39 offen offset:0 sc1
    v_mfma_f32_16x16x32_bf16 v[128:131], v[96:99], v[224:227], v[128:131]
    s_waitcnt vmcnt(11)
    v_mfma_f32_16x16x32_bf16 v[128:131], v[112:115], v[228:231], v[128:131]
    s_waitcnt vmcnt(10)
    buffer_load_dwordx4 v[212:215], v2, s[16:19], s39 offen offset:1024 sc1
    v_mfma_f32_16x16x32_bf16 v[128:131], a[160:163], v[232:235], v[128:131]
    s_waitcnt vmcnt(10)
    v_mfma_f32_16x16x32_bf16 v[128:131], a[176:179], v[236:239], v[128:131]
    buffer_load_dwordx4 v[216:219], v2, s[16:19], s39 offen offset:2048 sc1
    v_mfma_f32_16x16x32_bf16 v[132:135], a[180:183], v[236:239], v[132:135]
    v_mfma_f32_16x16x32_bf16 v[132:135], a[164:167], v[232:235], v[132:135]
    buffer_load_dwordx4 v[220:223], v2, s[16:19], s39 offen offset:3072 sc1
    v_mfma_f32_16x16x32_bf16 v[132:135], v[116:119], v[228:231], v[132:135]
    v_mfma_f32_16x16x32_bf16 v[132:135], v[100:103], v[224:227], v[132:135]
    v_mfma_f32_16x16x32_bf16 v[136:139], v[104:107], v[224:227], v[136:139]
    v_mfma_f32_16x16x32_bf16 v[136:139], v[120:123], v[228:231], v[136:139]
    v_mfma_f32_16x16x32_bf16 v[136:139], a[168:171], v[232:235], v[136:139]
    v_mfma_f32_16x16x32_bf16 v[136:139], a[184:187], v[236:239], v[136:139]
    v_mfma_f32_16x16x32_bf16 v[140:143], a[188:191], v[236:239], v[140:143]
    v_mfma_f32_16x16x32_bf16 v[140:143], a[172:175], v[232:235], v[140:143]
    v_mfma_f32_16x16x32_bf16 v[140:143], v[124:127], v[228:231], v[140:143]
    s_mov_b32 s39, 118784
    v_mfma_f32_16x16x32_bf16 v[140:143], v[108:111], v[224:227], v[140:143]
    s_waitcnt vmcnt(11)
    buffer_load_dwordx4 v[224:227], v2, s[16:19], s39 offen offset:0 sc1
    v_mfma_f32_16x16x32_bf16 v[144:147], v[96:99], v[240:243], v[144:147]
    s_waitcnt vmcnt(11)
    v_mfma_f32_16x16x32_bf16 v[144:147], v[112:115], v[244:247], v[144:147]
    s_waitcnt vmcnt(10)
    buffer_load_dwordx4 v[228:231], v2, s[16:19], s39 offen offset:1024 sc1
    v_mfma_f32_16x16x32_bf16 v[144:147], a[160:163], v[248:251], v[144:147]
    s_waitcnt vmcnt(10)
    v_mfma_f32_16x16x32_bf16 v[144:147], a[176:179], v[252:255], v[144:147]
    buffer_load_dwordx4 v[232:235], v2, s[16:19], s39 offen offset:2048 sc1
    v_mfma_f32_16x16x32_bf16 v[148:151], a[180:183], v[252:255], v[148:151]
    v_mfma_f32_16x16x32_bf16 v[148:151], a[164:167], v[248:251], v[148:151]
    buffer_load_dwordx4 v[236:239], v2, s[16:19], s39 offen offset:3072 sc1
    v_mfma_f32_16x16x32_bf16 v[148:151], v[116:119], v[244:247], v[148:151]
    v_mfma_f32_16x16x32_bf16 v[148:151], v[100:103], v[240:243], v[148:151]
    v_mfma_f32_16x16x32_bf16 v[152:155], v[104:107], v[240:243], v[152:155]
    v_mfma_f32_16x16x32_bf16 v[152:155], v[120:123], v[244:247], v[152:155]
    v_mfma_f32_16x16x32_bf16 v[152:155], a[168:171], v[248:251], v[152:155]
    v_mfma_f32_16x16x32_bf16 v[152:155], a[184:187], v[252:255], v[152:155]
    v_mfma_f32_16x16x32_bf16 v[156:159], a[188:191], v[252:255], v[156:159]
    v_mfma_f32_16x16x32_bf16 v[156:159], a[172:175], v[248:251], v[156:159]
    v_mfma_f32_16x16x32_bf16 v[156:159], v[124:127], v[244:247], v[156:159]
    s_mov_b32 s39, 122880
    v_mfma_f32_16x16x32_bf16 v[156:159], v[108:111], v[240:243], v[156:159]
    s_waitcnt vmcnt(11)
    buffer_load_dwordx4 v[240:243], v2, s[16:19], s39 offen offset:0 sc1
    v_mfma_f32_16x16x32_bf16 v[160:163], v[96:99], v[36:39], v[160:163]
    s_waitcnt vmcnt(11)
    v_mfma_f32_16x16x32_bf16 v[160:163], v[112:115], v[16:19], v[160:163]
    s_waitcnt vmcnt(10)
    buffer_load_dwordx4 v[244:247], v2, s[16:19], s39 offen offset:1024 sc1
    v_mfma_f32_16x16x32_bf16 v[160:163], a[160:163], v[4:7], v[160:163]
    s_waitcnt vmcnt(10)
    v_mfma_f32_16x16x32_bf16 v[160:163], a[176:179], v[12:15], v[160:163]
    buffer_load_dwordx4 v[248:251], v2, s[16:19], s39 offen offset:2048 sc1
    v_mfma_f32_16x16x32_bf16 v[164:167], a[180:183], v[12:15], v[164:167]
    v_mfma_f32_16x16x32_bf16 v[164:167], a[164:167], v[4:7], v[164:167]
    buffer_load_dwordx4 v[252:255], v2, s[16:19], s39 offen offset:3072 sc1
    v_mfma_f32_16x16x32_bf16 v[164:167], v[116:119], v[16:19], v[164:167]
    v_mfma_f32_16x16x32_bf16 v[164:167], v[100:103], v[36:39], v[164:167]
    v_mfma_f32_16x16x32_bf16 v[168:171], v[104:107], v[36:39], v[168:171]
    v_mfma_f32_16x16x32_bf16 v[168:171], v[120:123], v[16:19], v[168:171]
    v_mfma_f32_16x16x32_bf16 v[168:171], a[168:171], v[4:7], v[168:171]
    v_mfma_f32_16x16x32_bf16 v[168:171], a[184:187], v[12:15], v[168:171]
    v_mfma_f32_16x16x32_bf16 v[172:175], a[188:191], v[12:15], v[172:175]
    v_mfma_f32_16x16x32_bf16 v[172:175], a[172:175], v[4:7], v[172:175]
    v_mfma_f32_16x16x32_bf16 v[172:175], v[124:127], v[16:19], v[172:175]
    s_mov_b32 s39, 126976
    v_mfma_f32_16x16x32_bf16 v[172:175], v[108:111], v[36:39], v[172:175]
    s_waitcnt vmcnt(11)
    buffer_load_dwordx4 v[36:39], v2, s[16:19], s39 offen offset:0 sc1
    v_mfma_f32_16x16x32_bf16 v[176:179], v[96:99], v[208:211], v[176:179]
    s_waitcnt vmcnt(11)
    v_mfma_f32_16x16x32_bf16 v[176:179], v[112:115], v[212:215], v[176:179]
    s_waitcnt vmcnt(10)
    buffer_load_dwordx4 v[16:19], v2, s[16:19], s39 offen offset:1024 sc1
    v_mfma_f32_16x16x32_bf16 v[176:179], a[160:163], v[216:219], v[176:179]
    s_waitcnt vmcnt(10)
    v_mfma_f32_16x16x32_bf16 v[176:179], a[176:179], v[220:223], v[176:179]
    buffer_load_dwordx4 v[4:7], v2, s[16:19], s39 offen offset:2048 sc1
    v_mfma_f32_16x16x32_bf16 v[180:183], a[180:183], v[220:223], v[180:183]
    v_mfma_f32_16x16x32_bf16 v[180:183], a[164:167], v[216:219], v[180:183]
    buffer_load_dwordx4 v[12:15], v2, s[16:19], s39 offen offset:3072 sc1
    v_mfma_f32_16x16x32_bf16 v[180:183], v[116:119], v[212:215], v[180:183]
    v_mfma_f32_16x16x32_bf16 v[180:183], v[100:103], v[208:211], v[180:183]
    v_mfma_f32_16x16x32_bf16 v[184:187], v[104:107], v[208:211], v[184:187]
    v_mfma_f32_16x16x32_bf16 v[184:187], v[120:123], v[212:215], v[184:187]
    v_mfma_f32_16x16x32_bf16 v[184:187], a[168:171], v[216:219], v[184:187]
    v_mfma_f32_16x16x32_bf16 v[184:187], a[184:187], v[220:223], v[184:187]
    v_mfma_f32_16x16x32_bf16 v[188:191], a[188:191], v[220:223], v[188:191]
    v_mfma_f32_16x16x32_bf16 v[188:191], a[172:175], v[216:219], v[188:191]
    v_mfma_f32_16x16x32_bf16 v[188:191], v[124:127], v[212:215], v[188:191]
    s_mov_b32 s39, 131072
    v_mfma_f32_16x16x32_bf16 v[188:191], v[108:111], v[208:211], v[188:191]
    s_waitcnt vmcnt(11)
    buffer_load_dwordx4 v[208:211], v2, s[16:19], s39 offen offset:0 sc1
    v_mfma_f32_16x16x32_bf16 v[192:195], v[96:99], v[224:227], v[192:195]
    s_waitcnt vmcnt(11)
    v_mfma_f32_16x16x32_bf16 v[192:195], v[112:115], v[228:231], v[192:195]
    s_waitcnt vmcnt(10)
    buffer_load_dwordx4 v[212:215], v2, s[16:19], s39 offen offset:1024 sc1
    v_mfma_f32_16x16x32_bf16 v[192:195], a[160:163], v[232:235], v[192:195]
    s_waitcnt vmcnt(10)
    v_mfma_f32_16x16x32_bf16 v[192:195], a[176:179], v[236:239], v[192:195]
    buffer_load_dwordx4 v[216:219], v2, s[16:19], s39 offen offset:2048 sc1
    v_mfma_f32_16x16x32_bf16 v[196:199], a[180:183], v[236:239], v[196:199]
    v_mfma_f32_16x16x32_bf16 v[196:199], a[164:167], v[232:235], v[196:199]
    buffer_load_dwordx4 v[220:223], v2, s[16:19], s39 offen offset:3072 sc1
    v_mfma_f32_16x16x32_bf16 v[196:199], v[116:119], v[228:231], v[196:199]
    v_mfma_f32_16x16x32_bf16 v[196:199], v[100:103], v[224:227], v[196:199]
    v_mfma_f32_16x16x32_bf16 v[200:203], v[104:107], v[224:227], v[200:203]
    v_mfma_f32_16x16x32_bf16 v[200:203], v[120:123], v[228:231], v[200:203]
    v_mfma_f32_16x16x32_bf16 v[200:203], a[168:171], v[232:235], v[200:203]
    v_mfma_f32_16x16x32_bf16 v[200:203], a[184:187], v[236:239], v[200:203]
    v_mfma_f32_16x16x32_bf16 v[204:207], a[188:191], v[236:239], v[204:207]
    v_mfma_f32_16x16x32_bf16 v[204:207], a[172:175], v[232:235], v[204:207]
    v_mfma_f32_16x16x32_bf16 v[204:207], v[124:127], v[228:231], v[204:207]
    s_mov_b32 s39, 135168
    v_mfma_f32_16x16x32_bf16 v[204:207], v[108:111], v[224:227], v[204:207]
    s_waitcnt vmcnt(11)
    buffer_load_dwordx4 v[224:227], v2, s[16:19], s39 offen offset:0 sc1
    v_mfma_f32_16x16x32_bf16 v[128:131], a[192:195], v[240:243], v[128:131]
    s_waitcnt vmcnt(11)
    v_mfma_f32_16x16x32_bf16 v[128:131], a[208:211], v[244:247], v[128:131]
    s_waitcnt vmcnt(10)
    buffer_load_dwordx4 v[228:231], v2, s[16:19], s39 offen offset:1024 sc1
    v_mfma_f32_16x16x32_bf16 v[128:131], a[224:227], v[248:251], v[128:131]
    s_waitcnt vmcnt(10)
    v_mfma_f32_16x16x32_bf16 v[128:131], a[240:243], v[252:255], v[128:131]
    buffer_load_dwordx4 v[232:235], v2, s[16:19], s39 offen offset:2048 sc1
    v_mfma_f32_16x16x32_bf16 v[132:135], a[244:247], v[252:255], v[132:135]
    v_mfma_f32_16x16x32_bf16 v[132:135], a[228:231], v[248:251], v[132:135]
    buffer_load_dwordx4 v[236:239], v2, s[16:19], s39 offen offset:3072 sc1
    v_mfma_f32_16x16x32_bf16 v[132:135], a[212:215], v[244:247], v[132:135]
    v_mfma_f32_16x16x32_bf16 v[132:135], a[196:199], v[240:243], v[132:135]
    v_mfma_f32_16x16x32_bf16 v[136:139], a[200:203], v[240:243], v[136:139]
    v_mfma_f32_16x16x32_bf16 v[136:139], a[216:219], v[244:247], v[136:139]
    v_mfma_f32_16x16x32_bf16 v[136:139], a[232:235], v[248:251], v[136:139]
    v_mfma_f32_16x16x32_bf16 v[136:139], a[248:251], v[252:255], v[136:139]
    v_mfma_f32_16x16x32_bf16 v[140:143], a[252:255], v[252:255], v[140:143]
    v_mfma_f32_16x16x32_bf16 v[140:143], a[236:239], v[248:251], v[140:143]
    v_mfma_f32_16x16x32_bf16 v[140:143], a[220:223], v[244:247], v[140:143]
    s_mov_b32 s39, 139264
    v_mfma_f32_16x16x32_bf16 v[140:143], a[204:207], v[240:243], v[140:143]
    s_waitcnt vmcnt(11)
    buffer_load_dwordx4 v[240:243], v2, s[16:19], s39 offen offset:0 sc1
    v_mfma_f32_16x16x32_bf16 v[144:147], a[192:195], v[36:39], v[144:147]
    s_waitcnt vmcnt(11)
    v_mfma_f32_16x16x32_bf16 v[144:147], a[208:211], v[16:19], v[144:147]
    s_waitcnt vmcnt(10)
    buffer_load_dwordx4 v[244:247], v2, s[16:19], s39 offen offset:1024 sc1
    v_mfma_f32_16x16x32_bf16 v[144:147], a[224:227], v[4:7], v[144:147]
    s_waitcnt vmcnt(10)
    v_mfma_f32_16x16x32_bf16 v[144:147], a[240:243], v[12:15], v[144:147]
    buffer_load_dwordx4 v[248:251], v2, s[16:19], s39 offen offset:2048 sc1
    v_mfma_f32_16x16x32_bf16 v[148:151], a[244:247], v[12:15], v[148:151]
    v_mfma_f32_16x16x32_bf16 v[148:151], a[228:231], v[4:7], v[148:151]
    buffer_load_dwordx4 v[252:255], v2, s[16:19], s39 offen offset:3072 sc1
    v_mfma_f32_16x16x32_bf16 v[148:151], a[212:215], v[16:19], v[148:151]
    v_mfma_f32_16x16x32_bf16 v[148:151], a[196:199], v[36:39], v[148:151]
    v_mfma_f32_16x16x32_bf16 v[152:155], a[200:203], v[36:39], v[152:155]
    v_mfma_f32_16x16x32_bf16 v[152:155], a[216:219], v[16:19], v[152:155]
    v_mfma_f32_16x16x32_bf16 v[152:155], a[232:235], v[4:7], v[152:155]
    v_mfma_f32_16x16x32_bf16 v[152:155], a[248:251], v[12:15], v[152:155]
    v_mfma_f32_16x16x32_bf16 v[156:159], a[252:255], v[12:15], v[156:159]
    v_mfma_f32_16x16x32_bf16 v[156:159], a[236:239], v[4:7], v[156:159]
    v_mfma_f32_16x16x32_bf16 v[156:159], a[220:223], v[16:19], v[156:159]
    s_mov_b32 s39, 143360
    v_mfma_f32_16x16x32_bf16 v[156:159], a[204:207], v[36:39], v[156:159]
    s_waitcnt vmcnt(11)
    buffer_load_dwordx4 v[36:39], v2, s[16:19], s39 offen offset:0 sc1
    v_mfma_f32_16x16x32_bf16 v[160:163], a[192:195], v[208:211], v[160:163]
    s_waitcnt vmcnt(11)
    v_mfma_f32_16x16x32_bf16 v[160:163], a[208:211], v[212:215], v[160:163]
    s_waitcnt vmcnt(10)
    buffer_load_dwordx4 v[16:19], v2, s[16:19], s39 offen offset:1024 sc1
    v_mfma_f32_16x16x32_bf16 v[160:163], a[224:227], v[216:219], v[160:163]
    s_waitcnt vmcnt(10)
    v_mfma_f32_16x16x32_bf16 v[160:163], a[240:243], v[220:223], v[160:163]
    buffer_load_dwordx4 v[4:7], v2, s[16:19], s39 offen offset:2048 sc1
    v_mfma_f32_16x16x32_bf16 v[164:167], a[244:247], v[220:223], v[164:167]
    v_mfma_f32_16x16x32_bf16 v[164:167], a[228:231], v[216:219], v[164:167]
    buffer_load_dwordx4 v[12:15], v2, s[16:19], s39 offen offset:3072 sc1
    v_mfma_f32_16x16x32_bf16 v[164:167], a[212:215], v[212:215], v[164:167]
    v_mfma_f32_16x16x32_bf16 v[164:167], a[196:199], v[208:211], v[164:167]
    v_mfma_f32_16x16x32_bf16 v[168:171], a[200:203], v[208:211], v[168:171]
    v_mfma_f32_16x16x32_bf16 v[168:171], a[216:219], v[212:215], v[168:171]
    v_mfma_f32_16x16x32_bf16 v[168:171], a[232:235], v[216:219], v[168:171]
    v_mfma_f32_16x16x32_bf16 v[168:171], a[248:251], v[220:223], v[168:171]
    v_mfma_f32_16x16x32_bf16 v[172:175], a[252:255], v[220:223], v[172:175]
    v_mfma_f32_16x16x32_bf16 v[172:175], a[236:239], v[216:219], v[172:175]
    v_mfma_f32_16x16x32_bf16 v[172:175], a[220:223], v[212:215], v[172:175]
    s_mov_b32 s39, 147456
    v_mfma_f32_16x16x32_bf16 v[172:175], a[204:207], v[208:211], v[172:175]
    s_waitcnt vmcnt(11)
    buffer_load_dwordx4 v[208:211], v2, s[16:19], s39 offen offset:0 sc1
    v_mfma_f32_16x16x32_bf16 v[176:179], a[192:195], v[224:227], v[176:179]
    s_waitcnt vmcnt(11)
    v_mfma_f32_16x16x32_bf16 v[176:179], a[208:211], v[228:231], v[176:179]
    s_waitcnt vmcnt(10)
    buffer_load_dwordx4 v[212:215], v2, s[16:19], s39 offen offset:1024 sc1
    v_mfma_f32_16x16x32_bf16 v[176:179], a[224:227], v[232:235], v[176:179]
    s_waitcnt vmcnt(10)
    v_mfma_f32_16x16x32_bf16 v[176:179], a[240:243], v[236:239], v[176:179]
    buffer_load_dwordx4 v[216:219], v2, s[16:19], s39 offen offset:2048 sc1
    v_mfma_f32_16x16x32_bf16 v[180:183], a[244:247], v[236:239], v[180:183]
    v_mfma_f32_16x16x32_bf16 v[180:183], a[228:231], v[232:235], v[180:183]
    buffer_load_dwordx4 v[220:223], v2, s[16:19], s39 offen offset:3072 sc1
    v_mfma_f32_16x16x32_bf16 v[180:183], a[212:215], v[228:231], v[180:183]
    v_mfma_f32_16x16x32_bf16 v[180:183], a[196:199], v[224:227], v[180:183]
    v_mfma_f32_16x16x32_bf16 v[184:187], a[200:203], v[224:227], v[184:187]
    v_mfma_f32_16x16x32_bf16 v[184:187], a[216:219], v[228:231], v[184:187]
    v_mfma_f32_16x16x32_bf16 v[184:187], a[232:235], v[232:235], v[184:187]
    v_mfma_f32_16x16x32_bf16 v[184:187], a[248:251], v[236:239], v[184:187]
    v_mfma_f32_16x16x32_bf16 v[188:191], a[252:255], v[236:239], v[188:191]
    v_mfma_f32_16x16x32_bf16 v[188:191], a[236:239], v[232:235], v[188:191]
    v_mfma_f32_16x16x32_bf16 v[188:191], a[220:223], v[228:231], v[188:191]
    s_mov_b32 s39, 151552
    v_mfma_f32_16x16x32_bf16 v[188:191], a[204:207], v[224:227], v[188:191]
    s_waitcnt vmcnt(11)
    buffer_load_dwordx4 v[224:227], v2, s[16:19], s39 offen offset:0 sc1
    v_mfma_f32_16x16x32_bf16 v[192:195], a[192:195], v[240:243], v[192:195]
    s_waitcnt vmcnt(11)
    v_mfma_f32_16x16x32_bf16 v[192:195], a[208:211], v[244:247], v[192:195]
    s_waitcnt vmcnt(10)
    buffer_load_dwordx4 v[228:231], v2, s[16:19], s39 offen offset:1024 sc1
    v_mfma_f32_16x16x32_bf16 v[192:195], a[224:227], v[248:251], v[192:195]
    s_waitcnt vmcnt(10)
    v_mfma_f32_16x16x32_bf16 v[192:195], a[240:243], v[252:255], v[192:195]
    buffer_load_dwordx4 v[232:235], v2, s[16:19], s39 offen offset:2048 sc1
    v_mfma_f32_16x16x32_bf16 v[196:199], a[244:247], v[252:255], v[196:199]
    v_mfma_f32_16x16x32_bf16 v[196:199], a[228:231], v[248:251], v[196:199]
    buffer_load_dwordx4 v[236:239], v2, s[16:19], s39 offen offset:3072 sc1
    v_mfma_f32_16x16x32_bf16 v[196:199], a[212:215], v[244:247], v[196:199]
    v_mfma_f32_16x16x32_bf16 v[196:199], a[196:199], v[240:243], v[196:199]
    v_mfma_f32_16x16x32_bf16 v[200:203], a[200:203], v[240:243], v[200:203]
    v_mfma_f32_16x16x32_bf16 v[200:203], a[216:219], v[244:247], v[200:203]
    v_mfma_f32_16x16x32_bf16 v[200:203], a[232:235], v[248:251], v[200:203]
    v_mfma_f32_16x16x32_bf16 v[200:203], a[248:251], v[252:255], v[200:203]
    v_mfma_f32_16x16x32_bf16 v[204:207], a[252:255], v[252:255], v[204:207]
    v_mfma_f32_16x16x32_bf16 v[204:207], a[236:239], v[248:251], v[204:207]
    v_mfma_f32_16x16x32_bf16 v[204:207], a[220:223], v[244:247], v[204:207]
    s_mov_b32 s39, 155648
    v_mfma_f32_16x16x32_bf16 v[204:207], a[204:207], v[240:243], v[204:207]
    s_waitcnt vmcnt(11)
    buffer_load_dwordx4 v[240:243], v2, s[16:19], s39 offen offset:0 sc1
    v_mfma_f32_16x16x32_bf16 v[128:131], a[0:3], v[36:39], v[128:131]
    s_waitcnt vmcnt(11)
    v_mfma_f32_16x16x32_bf16 v[128:131], a[16:19], v[16:19], v[128:131]
    s_waitcnt vmcnt(10)
    buffer_load_dwordx4 v[244:247], v2, s[16:19], s39 offen offset:1024 sc1
    v_mfma_f32_16x16x32_bf16 v[128:131], a[32:35], v[4:7], v[128:131]
    s_waitcnt vmcnt(10)
    v_mfma_f32_16x16x32_bf16 v[128:131], a[48:51], v[12:15], v[128:131]
    buffer_load_dwordx4 v[248:251], v2, s[16:19], s39 offen offset:2048 sc1
    v_mfma_f32_16x16x32_bf16 v[132:135], a[52:55], v[12:15], v[132:135]
    v_mfma_f32_16x16x32_bf16 v[132:135], a[36:39], v[4:7], v[132:135]
    buffer_load_dwordx4 v[252:255], v2, s[16:19], s39 offen offset:3072 sc1
    v_mfma_f32_16x16x32_bf16 v[132:135], a[20:23], v[16:19], v[132:135]
    v_mfma_f32_16x16x32_bf16 v[132:135], a[4:7], v[36:39], v[132:135]
    v_mfma_f32_16x16x32_bf16 v[136:139], a[8:11], v[36:39], v[136:139]
    v_mfma_f32_16x16x32_bf16 v[136:139], a[24:27], v[16:19], v[136:139]
    v_mfma_f32_16x16x32_bf16 v[136:139], a[40:43], v[4:7], v[136:139]
    v_mfma_f32_16x16x32_bf16 v[136:139], a[56:59], v[12:15], v[136:139]
    ds_write_b128 v8, v[128:131] offset:0
    v_mfma_f32_16x16x32_bf16 v[140:143], a[60:63], v[12:15], v[140:143]
    v_mfma_f32_16x16x32_bf16 v[140:143], a[44:47], v[4:7], v[140:143]
    v_mfma_f32_16x16x32_bf16 v[140:143], a[28:31], v[16:19], v[140:143]
    s_mov_b32 s39, 159744
    v_mfma_f32_16x16x32_bf16 v[140:143], a[12:15], v[36:39], v[140:143]
    s_waitcnt vmcnt(11)
    buffer_load_dwordx4 v[36:39], v2, s[16:19], s39 offen offset:0 sc1
    v_mfma_f32_16x16x32_bf16 v[144:147], a[0:3], v[208:211], v[144:147]
    s_waitcnt vmcnt(11)
    ds_write_b128 v9, v[132:135] offset:1024
    v_mfma_f32_16x16x32_bf16 v[144:147], a[16:19], v[212:215], v[144:147]
    s_waitcnt vmcnt(10)
    buffer_load_dwordx4 v[16:19], v2, s[16:19], s39 offen offset:1024 sc1
    v_mfma_f32_16x16x32_bf16 v[144:147], a[32:35], v[216:219], v[144:147]
    s_waitcnt vmcnt(10)
    v_mfma_f32_16x16x32_bf16 v[144:147], a[48:51], v[220:223], v[144:147]
    buffer_load_dwordx4 v[4:7], v2, s[16:19], s39 offen offset:2048 sc1
    v_mfma_f32_16x16x32_bf16 v[148:151], a[52:55], v[220:223], v[148:151]
    ds_write_b128 v10, v[136:139] offset:2048
    v_mfma_f32_16x16x32_bf16 v[148:151], a[36:39], v[216:219], v[148:151]
    buffer_load_dwordx4 v[12:15], v2, s[16:19], s39 offen offset:3072 sc1
    v_mfma_f32_16x16x32_bf16 v[148:151], a[20:23], v[212:215], v[148:151]
    v_mfma_f32_16x16x32_bf16 v[148:151], a[4:7], v[208:211], v[148:151]
    ds_write_b128 v11, v[140:143] offset:3072
    v_mfma_f32_16x16x32_bf16 v[152:155], a[8:11], v[208:211], v[152:155]
    v_mfma_f32_16x16x32_bf16 v[152:155], a[24:27], v[212:215], v[152:155]
    v_mfma_f32_16x16x32_bf16 v[152:155], a[40:43], v[216:219], v[152:155]
    v_mfma_f32_16x16x32_bf16 v[152:155], a[56:59], v[220:223], v[152:155]
    ds_write_b128 v8, v[144:147] offset:4096
    v_mfma_f32_16x16x32_bf16 v[156:159], a[60:63], v[220:223], v[156:159]
    v_mfma_f32_16x16x32_bf16 v[156:159], a[44:47], v[216:219], v[156:159]
    v_mfma_f32_16x16x32_bf16 v[156:159], a[28:31], v[212:215], v[156:159]
    v_mfma_f32_16x16x32_bf16 v[156:159], a[12:15], v[208:211], v[156:159]
    s_waitcnt vmcnt(11)
    ds_write_b128 v9, v[148:151] offset:5120
    v_mfma_f32_16x16x32_bf16 v[160:163], a[0:3], v[224:227], v[160:163]
    s_waitcnt vmcnt(10)
    v_mfma_f32_16x16x32_bf16 v[160:163], a[16:19], v[228:231], v[160:163]
    s_waitcnt vmcnt(9)
    v_mfma_f32_16x16x32_bf16 v[160:163], a[32:35], v[232:235], v[160:163]
    s_waitcnt vmcnt(8)
    v_mfma_f32_16x16x32_bf16 v[160:163], a[48:51], v[236:239], v[160:163]
    ds_write_b128 v10, v[152:155] offset:6144
    v_mfma_f32_16x16x32_bf16 v[164:167], a[52:55], v[236:239], v[164:167]
    v_mfma_f32_16x16x32_bf16 v[164:167], a[36:39], v[232:235], v[164:167]
    v_mfma_f32_16x16x32_bf16 v[164:167], a[20:23], v[228:231], v[164:167]
    v_mfma_f32_16x16x32_bf16 v[164:167], a[4:7], v[224:227], v[164:167]
    ds_write_b128 v11, v[156:159] offset:7168
    v_mfma_f32_16x16x32_bf16 v[168:171], a[8:11], v[224:227], v[168:171]
    v_mfma_f32_16x16x32_bf16 v[168:171], a[24:27], v[228:231], v[168:171]
    v_mfma_f32_16x16x32_bf16 v[168:171], a[40:43], v[232:235], v[168:171]
    v_mfma_f32_16x16x32_bf16 v[168:171], a[56:59], v[236:239], v[168:171]
    ds_write_b128 v8, v[160:163] offset:8192
    v_mfma_f32_16x16x32_bf16 v[172:175], a[60:63], v[236:239], v[172:175]
    v_mfma_f32_16x16x32_bf16 v[172:175], a[44:47], v[232:235], v[172:175]
    v_mfma_f32_16x16x32_bf16 v[172:175], a[28:31], v[228:231], v[172:175]
    v_mfma_f32_16x16x32_bf16 v[172:175], a[12:15], v[224:227], v[172:175]
    s_waitcnt vmcnt(7)
    ds_write_b128 v9, v[164:167] offset:9216
    v_mfma_f32_16x16x32_bf16 v[176:179], a[0:3], v[240:243], v[176:179]
    s_waitcnt vmcnt(6)
    v_mfma_f32_16x16x32_bf16 v[176:179], a[16:19], v[244:247], v[176:179]
    s_waitcnt vmcnt(5)
    v_mfma_f32_16x16x32_bf16 v[176:179], a[32:35], v[248:251], v[176:179]
    s_waitcnt vmcnt(4)
    v_mfma_f32_16x16x32_bf16 v[176:179], a[48:51], v[252:255], v[176:179]
    ds_write_b128 v10, v[168:171] offset:10240
    v_mfma_f32_16x16x32_bf16 v[180:183], a[52:55], v[252:255], v[180:183]
    v_mfma_f32_16x16x32_bf16 v[180:183], a[36:39], v[248:251], v[180:183]
    v_mfma_f32_16x16x32_bf16 v[180:183], a[20:23], v[244:247], v[180:183]
    v_mfma_f32_16x16x32_bf16 v[180:183], a[4:7], v[240:243], v[180:183]
    ds_write_b128 v11, v[172:175] offset:11264
    v_mfma_f32_16x16x32_bf16 v[184:187], a[8:11], v[240:243], v[184:187]
    v_mfma_f32_16x16x32_bf16 v[184:187], a[24:27], v[244:247], v[184:187]
    v_mfma_f32_16x16x32_bf16 v[184:187], a[40:43], v[248:251], v[184:187]
    v_mfma_f32_16x16x32_bf16 v[184:187], a[56:59], v[252:255], v[184:187]
    ds_write_b128 v8, v[176:179] offset:12288
    v_mfma_f32_16x16x32_bf16 v[188:191], a[60:63], v[252:255], v[188:191]
    v_mfma_f32_16x16x32_bf16 v[188:191], a[44:47], v[248:251], v[188:191]
    v_mfma_f32_16x16x32_bf16 v[188:191], a[28:31], v[244:247], v[188:191]
    v_mfma_f32_16x16x32_bf16 v[188:191], a[12:15], v[240:243], v[188:191]
    s_waitcnt vmcnt(3)
    ds_write_b128 v9, v[180:183] offset:13312
    v_mfma_f32_16x16x32_bf16 v[192:195], a[0:3], v[36:39], v[192:195]
    s_waitcnt vmcnt(2)
    v_mfma_f32_16x16x32_bf16 v[192:195], a[16:19], v[16:19], v[192:195]
    s_waitcnt vmcnt(1)
    v_mfma_f32_16x16x32_bf16 v[192:195], a[32:35], v[4:7], v[192:195]
    s_waitcnt vmcnt(0)
    v_mfma_f32_16x16x32_bf16 v[192:195], a[48:51], v[12:15], v[192:195]
    ds_write_b128 v10, v[184:187] offset:14336
    v_mfma_f32_16x16x32_bf16 v[196:199], a[52:55], v[12:15], v[196:199]
    v_mfma_f32_16x16x32_bf16 v[196:199], a[36:39], v[4:7], v[196:199]
    v_mfma_f32_16x16x32_bf16 v[196:199], a[20:23], v[16:19], v[196:199]
    v_mfma_f32_16x16x32_bf16 v[196:199], a[4:7], v[36:39], v[196:199]
    ds_write_b128 v11, v[188:191] offset:15360
    v_mfma_f32_16x16x32_bf16 v[200:203], a[8:11], v[36:39], v[200:203]
    v_mfma_f32_16x16x32_bf16 v[200:203], a[24:27], v[16:19], v[200:203]
    v_mfma_f32_16x16x32_bf16 v[200:203], a[40:43], v[4:7], v[200:203]
    v_mfma_f32_16x16x32_bf16 v[200:203], a[56:59], v[12:15], v[200:203]
    ds_write_b128 v8, v[192:195] offset:16384
    v_mfma_f32_16x16x32_bf16 v[204:207], a[60:63], v[12:15], v[204:207]
    v_mfma_f32_16x16x32_bf16 v[204:207], a[44:47], v[4:7], v[204:207]
    v_mfma_f32_16x16x32_bf16 v[204:207], a[28:31], v[16:19], v[204:207]
    v_mfma_f32_16x16x32_bf16 v[204:207], a[12:15], v[36:39], v[204:207]
    ds_write_b128 v9, v[196:199] offset:17408
    s_nop 3
    ds_write_b128 v10, v[200:203] offset:18432
    s_nop 2
    ds_write_b128 v11, v[204:207] offset:19456
    s_waitcnt lgkmcnt(0)
    s_barrier
    ds_read_b128 v[128:131], v40 offset:0
    ds_read_b128 v[132:135], v40 offset:256
    ds_read_b128 v[136:139], v40 offset:20480
    ds_read_b128 v[140:143], v40 offset:20736
    ds_read_b128 v[144:147], v40 offset:40960
    ds_read_b128 v[148:151], v40 offset:41216
    ds_read_b128 v[152:155], v40 offset:61440
    ds_read_b128 v[156:159], v40 offset:61696
    ds_read_b128 v[160:163], v41 offset:0
    ds_read_b128 v[164:167], v41 offset:256
    ds_read_b128 v[168:171], v41 offset:20480
    ds_read_b128 v[172:175], v41 offset:20736
    ds_read_b128 v[176:179], v41 offset:40960
    ds_read_b128 v[180:183], v41 offset:41216
    ds_read_b128 v[184:187], v41 offset:61440
    ds_read_b128 v[188:191], v41 offset:61696
    s_waitcnt lgkmcnt(8)
    v_add_f32 v128, v128, v136
    v_add_f32 v129, v129, v137
    v_add_f32 v130, v130, v138
    v_add_f32 v131, v131, v139
    v_add_f32 v132, v132, v140
    v_add_f32 v133, v133, v141
    v_add_f32 v134, v134, v142
    v_add_f32 v135, v135, v143
    v_add_f32 v144, v144, v152
    v_add_f32 v145, v145, v153
    v_add_f32 v146, v146, v154
    v_add_f32 v147, v147, v155
    v_add_f32 v148, v148, v156
    v_add_f32 v149, v149, v157
    v_add_f32 v150, v150, v158
    v_add_f32 v151, v151, v159
    v_add_f32 v128, v128, v144
    v_add_f32 v129, v129, v145
    v_add_f32 v130, v130, v146
    v_add_f32 v131, v131, v147
    v_add_f32 v132, v132, v148
    v_add_f32 v133, v133, v149
    v_add_f32 v134, v134, v150
    v_add_f32 v135, v135, v151
    v_cvt_pk_bf16_f32 v128, v128, v129
    v_cvt_pk_bf16_f32 v129, v130, v131
    v_cvt_pk_bf16_f32 v130, v132, v133
    v_cvt_pk_bf16_f32 v131, v134, v135
    buffer_store_dwordx4 v[128:131], v44, s[20:23], s38 offen
    ds_read_b128 v[192:195], v42 offset:0
    ds_read_b128 v[196:199], v42 offset:256
    ds_read_b128 v[200:203], v42 offset:20480
    ds_read_b128 v[204:207], v42 offset:20736
    ds_read_b128 v[208:211], v42 offset:40960
    ds_read_b128 v[212:215], v42 offset:41216
    ds_read_b128 v[216:219], v42 offset:61440
    ds_read_b128 v[220:223], v42 offset:61696
    s_waitcnt lgkmcnt(8)
    v_add_f32 v160, v160, v168
    v_add_f32 v161, v161, v169
    v_add_f32 v162, v162, v170
    v_add_f32 v163, v163, v171
    v_add_f32 v164, v164, v172
    v_add_f32 v165, v165, v173
    v_add_f32 v166, v166, v174
    v_add_f32 v167, v167, v175
    v_add_f32 v176, v176, v184
    v_add_f32 v177, v177, v185
    v_add_f32 v178, v178, v186
    v_add_f32 v179, v179, v187
    v_add_f32 v180, v180, v188
    v_add_f32 v181, v181, v189
    v_add_f32 v182, v182, v190
    v_add_f32 v183, v183, v191
    v_add_f32 v160, v160, v176
    v_add_f32 v161, v161, v177
    v_add_f32 v162, v162, v178
    v_add_f32 v163, v163, v179
    v_add_f32 v164, v164, v180
    v_add_f32 v165, v165, v181
    v_add_f32 v166, v166, v182
    v_add_f32 v167, v167, v183
    v_cvt_pk_bf16_f32 v160, v160, v161
    v_cvt_pk_bf16_f32 v161, v162, v163
    v_cvt_pk_bf16_f32 v162, v164, v165
    v_cvt_pk_bf16_f32 v163, v166, v167
    buffer_store_dwordx4 v[160:163], v45, s[20:23], s38 offen
    s_waitcnt lgkmcnt(0)
    v_add_f32 v192, v192, v200
    v_add_f32 v193, v193, v201
    v_add_f32 v194, v194, v202
    v_add_f32 v195, v195, v203
    v_add_f32 v196, v196, v204
    v_add_f32 v197, v197, v205
    v_add_f32 v198, v198, v206
    v_add_f32 v199, v199, v207
    v_add_f32 v208, v208, v216
    v_add_f32 v209, v209, v217
    v_add_f32 v210, v210, v218
    v_add_f32 v211, v211, v219
    v_add_f32 v212, v212, v220
    v_add_f32 v213, v213, v221
    v_add_f32 v214, v214, v222
    v_add_f32 v215, v215, v223
    v_add_f32 v192, v192, v208
    v_add_f32 v193, v193, v209
    v_add_f32 v194, v194, v210
    v_add_f32 v195, v195, v211
    v_add_f32 v196, v196, v212
    v_add_f32 v197, v197, v213
    v_add_f32 v198, v198, v214
    v_add_f32 v199, v199, v215
    v_cvt_pk_bf16_f32 v192, v192, v193
    v_cvt_pk_bf16_f32 v193, v194, v195
    v_cvt_pk_bf16_f32 v194, v196, v197
    v_cvt_pk_bf16_f32 v195, v198, v199
    buffer_store_dwordx4 v[192:195], v46, s[20:23], s38 offen
L_exit:
    s_endpgm
.section .rodata,"a"
.p2align 6
.amdhsa_kernel standalone__mha_block_cached__near_ridge_kernel
  .amdhsa_next_free_vgpr 512
  .amdhsa_next_free_sgpr 102
  .amdhsa_accum_offset 256
  .amdhsa_group_segment_fixed_size 0
  .amdhsa_kernarg_size 64
  .amdhsa_user_sgpr_count 2
  .amdhsa_user_sgpr_kernarg_segment_ptr 1
  .amdhsa_system_sgpr_workgroup_id_x 1
.end_amdhsa_kernel
```
